```python
import torch

def _softmax(x, axis=-1):
    return torch.softmax(x, dim=axis)
def _gelu(x):
    return torch.nn.functional.gelu(x, approximate="tanh")
def _silu(x):
    return torch.nn.functional.silu(x)
def _sigmoid(x):
    return torch.sigmoid(x)
def _layernorm(x, axis=-1, eps=1e-5):
    m = x.mean(dim=axis, keepdim=True)
    v = x.var(dim=axis, keepdim=True, unbiased=False)
    return (x - m) / torch.sqrt(v + eps)
def _scatter_add(tgt, idx, src, axis=0):
    return tgt.clone().index_add_(axis, idx, src)
def _segment_sum(src, seg, n):
    out = torch.zeros((n,) + src.shape[1:], dtype=src.dtype)
    return out.index_add_(0, seg, src)
def _pad(x, pw):
    flat = tuple(v for pair in reversed(pw) for v in pair)
    return torch.nn.functional.pad(x, flat)

kernel_name = 'standalone__mha_block_cached__near_ridge'

def setup_inputs():

    _w = (lambda a: (lambda t: t.to(torch.bfloat16) if t.is_floating_point() else t)(torch.as_tensor(a)))
    B, Sq, D = 16, 256, 448
    H, Sk, Dh = 16, 1024, 256
    return {
        "x": _w((lambda *s: torch.randn(*s, dtype=torch.bfloat16) * 0.8)(B, Sq, D)),
        "k_cache": _w((lambda *s: torch.randn(*s, dtype=torch.bfloat16) * 0.8)(B, H, Sk, Dh)),
        "v_cache": _w((lambda *s: torch.randn(*s, dtype=torch.bfloat16) * 0.05)(B, H, Sk, Dh)),
        "wq": _w((lambda *s: torch.randn(*s, dtype=torch.bfloat16) * 0.8)(D, H * Dh) * (D ** -0.5)),
        "wo": _w((lambda *s: torch.randn(*s, dtype=torch.bfloat16) * 0.05)(H * Dh, D) * ((H * Dh) ** -0.5)),
    }

def reference(x, k_cache, v_cache, wq, wo):
    B, Sq, D = x.shape
    H, Dh = 16, 256
    q = (lambda x, *d: x.permute(*d))((x @ wq).reshape(B, Sq, H, Dh), 0, 2, 1, 3)
    scores = torch.einsum("bhqd,bhkd->bhqk", q, k_cache) * (Dh ** -0.5)
    p = _softmax(scores, axis=-1)
    o = torch.einsum("bhqk,bhkd->bhqd", p, v_cache)
    return (lambda x, *d: x.permute(*d))(o, 0, 2, 1, 3).reshape(B, Sq, H * Dh) @ wo
```

```asm
; @launch grid=(256,1,1) block=(256,1,1) lds=163840
.amdgcn_target "amdgcn-amd-amdhsa--gfx950"
.text
.globl standalone__mha_block_cached__near_ridge_kernel
.p2align 8
.type standalone__mha_block_cached__near_ridge_kernel,@function
standalone__mha_block_cached__near_ridge_kernel:
    s_cmp_ge_u32 s2, 0x100
    s_cbranch_scc1 L_end
    s_load_dwordx4 s[60:63], s[0:1], 0
    s_load_dwordx4 s[64:67], s[0:1], 16
    s_load_dwordx2 s[68:69], s[0:1], 32
    s_load_dwordx2 s[70:71], s[0:1], 56
    s_load_dwordx2 s[80:81], s[0:1], 40
    s_load_dwordx2 s[84:85], s[0:1], 48
    s_memrealtime s[88:89]
    v_lshrrev_b32 v1, 6, v0
    v_and_b32 v0, 63, v0
    v_readfirstlane_b32 s3, v1
    s_and_b32 s54, s2, 7
    s_lshr_b32 s55, s2, 3
    s_lshl_b32 s56, s54, 1
    s_and_b32 s57, s55, 1
    s_add_u32 s4, s56, s57
    s_lshr_b32 s5, s55, 1
    s_cmp_lg_u32 s3, 0
    s_cbranch_scc1 L_notouch
    s_getpc_b64 s[56:57]
    s_and_b32 s54, s55, 7
    s_lshl_b32 s54, s54, 13
    v_lshlrev_b32 v1, 7, v0
    v_add_u32 v1, s54, v1
    v_min_u32 v1, L_code_end-standalone__mha_block_cached__near_ridge_kernel-256, v1
    global_load_dword v192, v1, s[56:57]
L_notouch:
    s_lshr_b32 s54, s4, 1
    s_and_b32 s55, s5, 1
    s_mul_i32 s55, s55, 3
    s_add_u32 s54, s54, s55
    s_cmp_ge_u32 s54, 7
    s_cselect_b32 s55, 7, 0
    s_sub_u32 s54, s54, s55
    s_lshl_b32 s72, s54, 7
    v_lshrrev_b32 v2, 3, v0
    v_and_b32 v3, 7, v0
    v_and_b32 v4, 6, v2
    v_xor_b32 v4, v3, v4
    v_lshlrev_b32 v4, 4, v4
    v_mul_u32_u24 v252, 0x380, v2
    v_add_u32 v252, v252, v4
    v_lshrrev_b32 v5, 2, v0
    v_and_b32 v5, 4, v5
    v_xor_b32 v5, v3, v5
    v_lshlrev_b32 v5, 4, v5
    v_lshl_add_u32 v244, v2, 13, v5
    s_lshl_b32 s54, s3, 16
    v_add_u32 v244, s54, v244
    s_lshl_b32 s32, s3, 10
    s_lshl_b32 s54, s3, 13
    s_add_u32 s33, s54, 0x10000
    s_mov_b32 s40, 0x1c00
    s_mov_b32 s41, 0x3800
    s_mov_b32 s42, 0x5400
    s_mov_b32 s43, 0x7000
    s_mov_b32 s44, 0x8c00
    s_mov_b32 s45, 0xa800
    s_mov_b32 s46, 0xc400
    s_waitcnt lgkmcnt(0)
    s_lshl_b32 s54, s5, 9
    s_add_u32 s12, s66, s54
    s_addc_u32 s13, s67, 0
    s_sub_u32 s14, 0x380000, s54
    s_mov_b32 s15, 0x20000
    s_lshl_b32 s38, s72, 12
    s_add_u32 m0, s32, 0x8000
    s_nop 0
    buffer_load_dwordx4 v244, s[12:15], s38 offen lds
    s_add_u32 m0, s32, 0x8f80
    s_nop 0
    buffer_load_dwordx4 v244, s[12:15], s38 offen offset:128 lds
    s_add_u32 m0, s32, 0x9f00
    s_nop 0
    buffer_load_dwordx4 v244, s[12:15], s38 offen offset:256 lds
    s_add_u32 m0, s32, 0xae80
    s_nop 0
    buffer_load_dwordx4 v244, s[12:15], s38 offen offset:384 lds
    s_mul_i32 s54, s4, 0x38000
    s_mul_i32 s55, s3, 0xe000
    s_add_u32 s54, s54, s55
    s_add_u32 s58, s60, s54
    s_addc_u32 s59, s61, 0
    s_mov_b32 s10, 0xdd00
    s_mov_b32 s11, 0x20000
    s_add_u32 s8, s58, s72
    s_addc_u32 s9, s59, 0
    s_add_u32 m0, s33, 0x0
    s_nop 0
    buffer_load_dwordx4 v252, s[8:11], 0 offen lds
    s_add_u32 m0, s33, 0x400
    s_nop 0
    buffer_load_dwordx4 v252, s[8:11], s40 offen lds
    s_add_u32 m0, s33, 0x800
    s_nop 0
    buffer_load_dwordx4 v252, s[8:11], s41 offen lds
    s_add_u32 m0, s33, 0xc00
    s_nop 0
    buffer_load_dwordx4 v252, s[8:11], s42 offen lds
    s_add_u32 m0, s33, 0x1000
    s_nop 0
    buffer_load_dwordx4 v252, s[8:11], s43 offen lds
    s_add_u32 m0, s33, 0x1400
    s_nop 0
    buffer_load_dwordx4 v252, s[8:11], s44 offen lds
    s_add_u32 m0, s33, 0x1800
    s_nop 0
    buffer_load_dwordx4 v252, s[8:11], s45 offen lds
    s_add_u32 m0, s33, 0x1c00
    s_nop 0
    buffer_load_dwordx4 v252, s[8:11], s46 offen lds
    s_add_u32 s73, s72, 128
    s_cmp_ge_u32 s73, 0x380
    s_cselect_b32 s73, 0, s73
    s_add_u32 s74, s73, 128
    s_cmp_ge_u32 s74, 0x380
    s_cselect_b32 s74, 0, s74
    s_add_u32 s75, s74, 128
    s_cmp_ge_u32 s75, 0x380
    s_cselect_b32 s75, 0, s75
    s_add_u32 s76, s75, 128
    s_cmp_ge_u32 s76, 0x380
    s_cselect_b32 s76, 0, s76
    s_add_u32 s77, s76, 128
    s_cmp_ge_u32 s77, 0x380
    s_cselect_b32 s77, 0, s77
    s_add_u32 s78, s77, 128
    s_cmp_ge_u32 s78, 0x380
    s_cselect_b32 s78, 0, s78
    s_lshl_b32 s38, s72, 12
    s_add_u32 s38, s38, 0x40000
    s_add_u32 m0, s32, 0xc000
    s_nop 0
    buffer_load_dwordx4 v244, s[12:15], s38 offen lds
    s_add_u32 m0, s32, 0xcf80
    s_nop 0
    buffer_load_dwordx4 v244, s[12:15], s38 offen offset:128 lds
    s_add_u32 m0, s32, 0xdf00
    s_nop 0
    buffer_load_dwordx4 v244, s[12:15], s38 offen offset:256 lds
    s_add_u32 m0, s32, 0xee80
    s_nop 0
    buffer_load_dwordx4 v244, s[12:15], s38 offen offset:384 lds
    s_lshl_b32 s38, s73, 12
    s_add_u32 m0, s32, 0x20000
    s_nop 0
    buffer_load_dwordx4 v244, s[12:15], s38 offen lds
    s_add_u32 m0, s32, 0x20f80
    s_nop 0
    buffer_load_dwordx4 v244, s[12:15], s38 offen offset:128 lds
    s_add_u32 m0, s32, 0x21f00
    s_nop 0
    buffer_load_dwordx4 v244, s[12:15], s38 offen offset:256 lds
    s_add_u32 m0, s32, 0x22e80
    s_nop 0
    buffer_load_dwordx4 v244, s[12:15], s38 offen offset:384 lds
    s_lshl_b32 s54, s4, 4
    s_add_u32 s54, s54, s5
    s_lshl_b32 s55, s54, 19
    s_add_u32 s16, s62, s55
    s_addc_u32 s17, s63, 0
    s_mov_b32 s18, 0x80000
    s_mov_b32 s19, 0x20000
    s_add_u32 s20, s64, s55
    s_addc_u32 s21, s65, 0
    s_mov_b32 s22, 0x80000
    s_mov_b32 s23, 0x20000
    s_mul_i32 s54, s5, 0x38000
    s_mul_i32 s55, s3, 0x1c00
    s_add_u32 s54, s54, s55
    s_add_u32 s24, s68, s54
    s_addc_u32 s25, s69, 0
    s_sub_u32 s26, 0x380000, s54
    s_mov_b32 s27, 0x20000
    s_mul_i32 s54, s4, 0x100000
    s_mul_i32 s55, s3, 0x40000
    s_add_u32 s54, s54, s55
    s_lshl_b32 s55, s5, 8
    s_add_u32 s54, s54, s55
    s_add_u32 s54, s54, 0x12c00000
    s_add_u32 s28, s70, s54
    s_addc_u32 s29, s71, 0
    s_mov_b32 s30, 0x3f100
    s_mov_b32 s31, 0x20000
    s_lshl_b32 s54, s4, 4
    s_add_u32 s84, s84, s54
    s_addc_u32 s85, s85, 0
    s_mov_b32 s86, 12
    s_mov_b32 s87, 0x20000
    s_or_b32 s88, s88, 1
    s_add_u32 s54, s5, s3
    v_add_u32 v5, s54, v0
    v_lshlrev_b32 v5, 12, v5
    v_mov_b32 v6, s88
    buffer_store_dword v6, v5, s[84:87], 0 offen sc1
    s_getreg_b32 s55, hwreg(HW_REG_XCC_ID, 0, 4)
    s_add_u32 s55, s55, 1
    s_mul_i32 s79, s55, 0x11111111
    s_and_b32 s54, s5, 7
    s_lshl_b32 s54, s54, 2
    s_lshl_b32 s55, s55, s54
    s_lshr_b32 s54, s5, 3
    s_lshl_b32 s54, s54, 2
    s_add_u32 s54, s54, 4
    v_add_u32 v7, s3, v0
    v_lshl_add_u32 v7, v7, 12, s54
    v_mov_b32 v8, s55
    buffer_atomic_or v8, v7, s[84:87], 0 offen sc1
    s_lshl_b32 s88, s5, 2
    s_lshl_b32 s54, s4, 4
    s_add_u32 s54, s54, s5
    s_lshl_b32 s54, s54, 2
    s_add_u32 s54, s54, s3
    s_mul_i32 s54, s54, 0xe00
    s_add_u32 s80, s80, s54
    s_addc_u32 s81, s81, 0
    s_mov_b32 s82, 0xe00
    s_mov_b32 s83, 0x20000
    s_mov_b32 s48, 0x0
    s_mov_b32 s49, 0x10000
    s_mov_b32 s50, 0x20000
    s_mov_b32 s51, 0x30000
    s_mov_b32 s53, 0
    s_mov_b32 s34, s53
    s_mov_b32 s35, s53
    s_mov_b32 s6, 0x3db8aa3b
    s_mov_b32 s7, 0x49800000
    s_mov_b32 s47, 0x2b800000
    v_mov_b32 v251, v4
    v_bfe_u32 v5, v2, 0, 1
    v_lshl_add_u32 v251, v5, 15, v251
    v_bfe_u32 v5, v2, 1, 1
    v_lshl_add_u32 v251, v5, 16, v251
    v_bfe_u32 v5, v2, 2, 1
    v_lshl_add_u32 v251, v5, 9, v251
    s_and_b32 s54, s3, 1
    s_lshl_b32 s54, s54, 10
    s_lshr_b32 s55, s3, 1
    s_lshl_b32 s55, s55, 11
    s_add_u32 s54, s54, s55
    v_add_u32 v251, s54, v251
    s_mov_b32 s90, s53
    v_and_b32 v2, 15, v0
    v_lshrrev_b32 v3, 4, v0
    v_and_b32 v4, 6, v0
    v_xor_b32 v4, v3, v4
    v_lshlrev_b32 v4, 4, v4
    v_lshl_add_u32 v245, v2, 7, v4
    v_xor_b32 v246, 64, v245
    v_add_u32 v247, s33, v245
    v_add_u32 v248, s33, v246
    v_bfe_u32 v4, v0, 2, 2
    v_lshlrev_b32 v4, 7, v4
    v_lshl_add_u32 v4, v3, 10, v4
    v_lshrrev_b32 v5, 1, v0
    v_and_b32 v5, 4, v5
    v_and_or_b32 v5, v0, 3, v5
    v_lshl_add_u32 v249, v5, 4, v4
    v_xor_b32 v250, 64, v249
    v_add_u32 v254, 0x18000, v249
    v_add_u32 v255, 0x18000, v250
    v_lshrrev_b32 v4, 2, v2
    v_lshlrev_b32 v4, 12, v4
    v_and_b32 v5, 3, v0
    v_lshl_add_u32 v4, v5, 4, v4
    v_lshl_add_u32 v253, v3, 6, v4
    s_waitcnt vmcnt(10)
    s_barrier
    ds_read_b128 a[140:143], v247 offset:6144
    ds_read_b128 a[136:139], v247 offset:4096
    ds_read_b128 a[132:135], v247 offset:2048
    ds_read_b128 a[128:131], v247 offset:0
    ds_read_b64_tr_b16 v[224:225], v249 offset:32768
    ds_read_b64_tr_b16 v[226:227], v249 offset:33280
    ds_read_b64_tr_b16 v[228:229], v249 offset:32776
    ds_read_b64_tr_b16 v[230:231], v249 offset:33288
    ds_read_b128 a[144:147], v248 offset:0
    ds_read_b128 a[148:151], v248 offset:2048
    ds_read_b128 a[152:155], v248 offset:4096
    ds_read_b128 a[156:159], v248 offset:6144
    ds_read_b64_tr_b16 v[232:233], v250 offset:32768
    ds_read_b64_tr_b16 v[234:235], v250 offset:33280
    s_waitcnt lgkmcnt(8)
    v_mfma_f32_16x16x32_bf16 v[12:15], v[224:227], a[140:143], 0
    s_add_u32 s8, s58, s73
    v_mfma_f32_16x16x32_bf16 v[8:11], v[224:227], a[136:139], 0
    s_addc_u32 s9, s59, 0
    v_mfma_f32_16x16x32_bf16 v[4:7], v[224:227], a[132:135], 0
    s_add_u32 m0, s33, 0x8000
    v_mfma_f32_16x16x32_bf16 v[0:3], v[224:227], a[128:131], 0
    s_waitcnt lgkmcnt(6)
    ds_read_b64_tr_b16 v[224:225], v250 offset:32776
    ds_read_b64_tr_b16 v[226:227], v250 offset:33288
    buffer_load_dwordx4 v252, s[8:11], 0 offen lds
    v_mfma_f32_16x16x32_bf16 v[208:211], v[228:231], a[128:131], 0
    v_mfma_f32_16x16x32_bf16 v[212:215], v[228:231], a[132:135], 0
    v_mfma_f32_16x16x32_bf16 v[216:219], v[228:231], a[136:139], 0
    s_add_u32 m0, s33, 0x8400
    v_mfma_f32_16x16x32_bf16 v[220:223], v[228:231], a[140:143], 0
    s_waitcnt lgkmcnt(2)
    ds_read_b64_tr_b16 v[228:229], v249 offset:36864
    ds_read_b64_tr_b16 v[230:231], v249 offset:37376
    buffer_load_dwordx4 v252, s[8:11], s40 offen lds
    v_mfma_f32_16x16x32_bf16 v[28:31], v[232:235], a[140:143], 0
    v_mfma_f32_16x16x32_bf16 v[24:27], v[232:235], a[136:139], 0
    v_mfma_f32_16x16x32_bf16 v[20:23], v[232:235], a[132:135], 0
    s_add_u32 m0, s33, 0x8800
    v_mfma_f32_16x16x32_bf16 v[16:19], v[232:235], a[128:131], 0
    s_waitcnt lgkmcnt(2)
    ds_read_b64_tr_b16 v[232:233], v249 offset:36872
    ds_read_b64_tr_b16 v[234:235], v249 offset:37384
    buffer_load_dwordx4 v252, s[8:11], s41 offen lds
    v_mfma_f32_16x16x32_bf16 a[48:51], v[224:227], a[128:131], 0
    v_mfma_f32_16x16x32_bf16 a[52:55], v[224:227], a[132:135], 0
    v_mfma_f32_16x16x32_bf16 a[56:59], v[224:227], a[136:139], 0
    s_add_u32 m0, s33, 0x8c00
    v_mfma_f32_16x16x32_bf16 a[60:63], v[224:227], a[140:143], 0
    s_waitcnt lgkmcnt(2)
    ds_read_b64_tr_b16 v[224:225], v250 offset:36864
    ds_read_b64_tr_b16 v[226:227], v250 offset:37376
    buffer_load_dwordx4 v252, s[8:11], s42 offen lds
    v_mfma_f32_16x16x32_bf16 v[44:47], v[228:231], a[140:143], 0
    v_mfma_f32_16x16x32_bf16 v[40:43], v[228:231], a[136:139], 0
    v_mfma_f32_16x16x32_bf16 v[36:39], v[228:231], a[132:135], 0
    s_add_u32 m0, s33, 0x9000
    v_mfma_f32_16x16x32_bf16 v[32:35], v[228:231], a[128:131], 0
    s_waitcnt lgkmcnt(2)
    ds_read_b64_tr_b16 v[228:229], v250 offset:36872
    ds_read_b64_tr_b16 v[230:231], v250 offset:37384
    buffer_load_dwordx4 v252, s[8:11], s43 offen lds
    v_mfma_f32_16x16x32_bf16 a[80:83], v[232:235], a[128:131], 0
    v_mfma_f32_16x16x32_bf16 a[84:87], v[232:235], a[132:135], 0
    v_mfma_f32_16x16x32_bf16 a[88:91], v[232:235], a[136:139], 0
    s_add_u32 m0, s33, 0x9400
    v_mfma_f32_16x16x32_bf16 a[92:95], v[232:235], a[140:143], 0
    s_waitcnt lgkmcnt(2)
    ds_read_b64_tr_b16 v[232:233], v249 offset:40960
    ds_read_b64_tr_b16 v[234:235], v249 offset:41472
    buffer_load_dwordx4 v252, s[8:11], s44 offen lds
    v_mfma_f32_16x16x32_bf16 v[60:63], v[224:227], a[140:143], 0
    v_mfma_f32_16x16x32_bf16 v[56:59], v[224:227], a[136:139], 0
    v_mfma_f32_16x16x32_bf16 v[52:55], v[224:227], a[132:135], 0
    s_add_u32 m0, s33, 0x9800
    v_mfma_f32_16x16x32_bf16 v[48:51], v[224:227], a[128:131], 0
    s_waitcnt lgkmcnt(2)
    ds_read_b64_tr_b16 v[224:225], v249 offset:40968
    ds_read_b64_tr_b16 v[226:227], v249 offset:41480
    buffer_load_dwordx4 v252, s[8:11], s45 offen lds
    v_mfma_f32_16x16x32_bf16 a[112:115], v[228:231], a[128:131], 0
    v_mfma_f32_16x16x32_bf16 a[116:119], v[228:231], a[132:135], 0
    v_mfma_f32_16x16x32_bf16 a[120:123], v[228:231], a[136:139], 0
    s_add_u32 m0, s33, 0x9c00
    v_mfma_f32_16x16x32_bf16 a[124:127], v[228:231], a[140:143], 0
    s_waitcnt lgkmcnt(2)
    ds_read_b64_tr_b16 v[228:229], v250 offset:40960
    ds_read_b64_tr_b16 v[230:231], v250 offset:41472
    buffer_load_dwordx4 v252, s[8:11], s46 offen lds
    v_mfma_f32_16x16x32_bf16 v[76:79], v[232:235], a[140:143], 0
    v_mfma_f32_16x16x32_bf16 v[72:75], v[232:235], a[136:139], 0
    v_mfma_f32_16x16x32_bf16 v[68:71], v[232:235], a[132:135], 0
    v_mfma_f32_16x16x32_bf16 v[64:67], v[232:235], a[128:131], 0
    s_waitcnt lgkmcnt(2)
    ds_read_b64_tr_b16 v[232:233], v250 offset:40968
    ds_read_b64_tr_b16 v[234:235], v250 offset:41480
    v_mfma_f32_16x16x32_bf16 v[128:131], v[224:227], a[128:131], 0
    v_mfma_f32_16x16x32_bf16 v[132:135], v[224:227], a[132:135], 0
    v_mfma_f32_16x16x32_bf16 v[136:139], v[224:227], a[136:139], 0
    v_mfma_f32_16x16x32_bf16 v[140:143], v[224:227], a[140:143], 0
    s_waitcnt lgkmcnt(2)
    ds_read_b64_tr_b16 v[224:225], v249 offset:45056
    ds_read_b64_tr_b16 v[226:227], v249 offset:45568
    v_mfma_f32_16x16x32_bf16 v[92:95], v[228:231], a[140:143], 0
    v_mfma_f32_16x16x32_bf16 v[88:91], v[228:231], a[136:139], 0
    v_mfma_f32_16x16x32_bf16 v[84:87], v[228:231], a[132:135], 0
    v_mfma_f32_16x16x32_bf16 v[80:83], v[228:231], a[128:131], 0
    s_waitcnt lgkmcnt(2)
    ds_read_b64_tr_b16 v[228:229], v249 offset:45064
    ds_read_b64_tr_b16 v[230:231], v249 offset:45576
    v_mfma_f32_16x16x32_bf16 v[144:147], v[232:235], a[128:131], 0
    v_mfma_f32_16x16x32_bf16 v[148:151], v[232:235], a[132:135], 0
    v_mfma_f32_16x16x32_bf16 v[152:155], v[232:235], a[136:139], 0
    v_mfma_f32_16x16x32_bf16 v[156:159], v[232:235], a[140:143], 0
    s_waitcnt lgkmcnt(2)
    ds_read_b64_tr_b16 v[232:233], v250 offset:45056
    ds_read_b64_tr_b16 v[234:235], v250 offset:45568
    v_mfma_f32_16x16x32_bf16 v[108:111], v[224:227], a[140:143], 0
    v_mfma_f32_16x16x32_bf16 v[104:107], v[224:227], a[136:139], 0
    v_mfma_f32_16x16x32_bf16 v[100:103], v[224:227], a[132:135], 0
    v_mfma_f32_16x16x32_bf16 v[96:99], v[224:227], a[128:131], 0
    s_waitcnt lgkmcnt(2)
    ds_read_b64_tr_b16 v[224:225], v250 offset:45064
    ds_read_b64_tr_b16 v[226:227], v250 offset:45576
    v_mfma_f32_16x16x32_bf16 v[160:163], v[228:231], a[128:131], 0
    v_mfma_f32_16x16x32_bf16 v[164:167], v[228:231], a[132:135], 0
    s_waitcnt vmcnt(14)
    s_barrier
    v_mfma_f32_16x16x32_bf16 v[168:171], v[228:231], a[136:139], 0
    v_mfma_f32_16x16x32_bf16 v[172:175], v[228:231], a[140:143], 0
    s_waitcnt lgkmcnt(2)
    ds_read_b64_tr_b16 v[228:229], v249 offset:49152
    ds_read_b64_tr_b16 v[230:231], v249 offset:49664
    v_mfma_f32_16x16x32_bf16 v[124:127], v[232:235], a[140:143], 0
    v_mfma_f32_16x16x32_bf16 v[120:123], v[232:235], a[136:139], 0
    v_mfma_f32_16x16x32_bf16 v[116:119], v[232:235], a[132:135], 0
    v_mfma_f32_16x16x32_bf16 v[112:115], v[232:235], a[128:131], 0
    s_waitcnt lgkmcnt(2)
    ds_read_b64_tr_b16 v[232:233], v249 offset:49160
    ds_read_b64_tr_b16 v[234:235], v249 offset:49672
    v_mfma_f32_16x16x32_bf16 v[176:179], v[224:227], a[128:131], 0
    v_mfma_f32_16x16x32_bf16 v[180:183], v[224:227], a[132:135], 0
    v_mfma_f32_16x16x32_bf16 v[184:187], v[224:227], a[136:139], 0
    v_mfma_f32_16x16x32_bf16 v[188:191], v[224:227], a[140:143], 0
    s_waitcnt lgkmcnt(2)
    ds_read_b64_tr_b16 v[224:225], v250 offset:49152
    ds_read_b64_tr_b16 v[226:227], v250 offset:49664
    v_mfma_f32_16x16x32_bf16 v[12:15], v[228:231], a[156:159], v[12:15]
    v_mfma_f32_16x16x32_bf16 v[8:11], v[228:231], a[152:155], v[8:11]
    v_mfma_f32_16x16x32_bf16 v[4:7], v[228:231], a[148:151], v[4:7]
    s_add_u32 s8, s58, s74
    v_mfma_f32_16x16x32_bf16 v[0:3], v[228:231], a[144:147], v[0:3]
    s_waitcnt lgkmcnt(2)
    s_addc_u32 s9, s59, 0
    ds_read_b64_tr_b16 v[228:229], v250 offset:49160
    ds_read_b64_tr_b16 v[230:231], v250 offset:49672
    v_mfma_f32_16x16x32_bf16 v[208:211], v[232:235], a[144:147], v[208:211]
    s_add_u32 m0, s33, 0x0
    v_mfma_f32_16x16x32_bf16 v[212:215], v[232:235], a[148:151], v[212:215]
    buffer_load_dwordx4 v252, s[8:11], 0 offen lds
    v_mfma_f32_16x16x32_bf16 v[216:219], v[232:235], a[152:155], v[216:219]
    v_mfma_f32_16x16x32_bf16 v[220:223], v[232:235], a[156:159], v[220:223]
    s_waitcnt lgkmcnt(2)
    ds_read_b64_tr_b16 v[232:233], v249 offset:53248
    ds_read_b64_tr_b16 v[234:235], v249 offset:53760
    v_mfma_f32_16x16x32_bf16 v[28:31], v[224:227], a[156:159], v[28:31]
    s_add_u32 m0, s33, 0x400
    v_mfma_f32_16x16x32_bf16 v[24:27], v[224:227], a[152:155], v[24:27]
    buffer_load_dwordx4 v252, s[8:11], s40 offen lds
    v_mfma_f32_16x16x32_bf16 v[20:23], v[224:227], a[148:151], v[20:23]
    v_mfma_f32_16x16x32_bf16 v[16:19], v[224:227], a[144:147], v[16:19]
    s_waitcnt lgkmcnt(2)
    ds_read_b64_tr_b16 v[224:225], v249 offset:53256
    ds_read_b64_tr_b16 v[226:227], v249 offset:53768
    v_mfma_f32_16x16x32_bf16 a[48:51], v[228:231], a[144:147], a[48:51]
    s_add_u32 m0, s33, 0x800
    v_mfma_f32_16x16x32_bf16 a[52:55], v[228:231], a[148:151], a[52:55]
    buffer_load_dwordx4 v252, s[8:11], s41 offen lds
    v_mfma_f32_16x16x32_bf16 a[56:59], v[228:231], a[152:155], a[56:59]
    v_mfma_f32_16x16x32_bf16 a[60:63], v[228:231], a[156:159], a[60:63]
    s_waitcnt lgkmcnt(2)
    ds_read_b64_tr_b16 v[228:229], v250 offset:53248
    ds_read_b64_tr_b16 v[230:231], v250 offset:53760
    v_mfma_f32_16x16x32_bf16 v[44:47], v[232:235], a[156:159], v[44:47]
    s_add_u32 m0, s33, 0xc00
    v_mfma_f32_16x16x32_bf16 v[40:43], v[232:235], a[152:155], v[40:43]
    buffer_load_dwordx4 v252, s[8:11], s42 offen lds
    v_mfma_f32_16x16x32_bf16 v[36:39], v[232:235], a[148:151], v[36:39]
    v_mfma_f32_16x16x32_bf16 v[32:35], v[232:235], a[144:147], v[32:35]
    s_waitcnt lgkmcnt(2)
    ds_read_b64_tr_b16 v[232:233], v250 offset:53256
    ds_read_b64_tr_b16 v[234:235], v250 offset:53768
    v_mfma_f32_16x16x32_bf16 a[80:83], v[224:227], a[144:147], a[80:83]
    s_add_u32 m0, s33, 0x1000
    v_mfma_f32_16x16x32_bf16 a[84:87], v[224:227], a[148:151], a[84:87]
    buffer_load_dwordx4 v252, s[8:11], s43 offen lds
    v_mfma_f32_16x16x32_bf16 a[88:91], v[224:227], a[152:155], a[88:91]
    v_mfma_f32_16x16x32_bf16 a[92:95], v[224:227], a[156:159], a[92:95]
    s_waitcnt lgkmcnt(2)
    ds_read_b64_tr_b16 v[224:225], v249 offset:57344
    ds_read_b64_tr_b16 v[226:227], v249 offset:57856
    v_mfma_f32_16x16x32_bf16 v[60:63], v[228:231], a[156:159], v[60:63]
    s_add_u32 m0, s33, 0x1400
    v_mfma_f32_16x16x32_bf16 v[56:59], v[228:231], a[152:155], v[56:59]
    buffer_load_dwordx4 v252, s[8:11], s44 offen lds
    v_mfma_f32_16x16x32_bf16 v[52:55], v[228:231], a[148:151], v[52:55]
    v_mfma_f32_16x16x32_bf16 v[48:51], v[228:231], a[144:147], v[48:51]
    s_waitcnt lgkmcnt(2)
    ds_read_b64_tr_b16 v[228:229], v249 offset:57352
    ds_read_b64_tr_b16 v[230:231], v249 offset:57864
    v_mfma_f32_16x16x32_bf16 a[112:115], v[232:235], a[144:147], a[112:115]
    s_add_u32 m0, s33, 0x1800
    v_mfma_f32_16x16x32_bf16 a[116:119], v[232:235], a[148:151], a[116:119]
    buffer_load_dwordx4 v252, s[8:11], s45 offen lds
    v_mfma_f32_16x16x32_bf16 a[120:123], v[232:235], a[152:155], a[120:123]
    v_mfma_f32_16x16x32_bf16 a[124:127], v[232:235], a[156:159], a[124:127]
    s_waitcnt lgkmcnt(2)
    ds_read_b64_tr_b16 v[232:233], v250 offset:57344
    ds_read_b64_tr_b16 v[234:235], v250 offset:57856
    v_mfma_f32_16x16x32_bf16 v[76:79], v[224:227], a[156:159], v[76:79]
    s_add_u32 m0, s33, 0x1c00
    v_mfma_f32_16x16x32_bf16 v[72:75], v[224:227], a[152:155], v[72:75]
    buffer_load_dwordx4 v252, s[8:11], s46 offen lds
    v_mfma_f32_16x16x32_bf16 v[68:71], v[224:227], a[148:151], v[68:71]
    s_lshl_b32 s38, s73, 12
    v_mfma_f32_16x16x32_bf16 v[64:67], v[224:227], a[144:147], v[64:67]
    s_waitcnt lgkmcnt(2)
    s_add_u32 s38, s38, 0x40000
    ds_read_b64_tr_b16 v[224:225], v250 offset:57352
    ds_read_b64_tr_b16 v[226:227], v250 offset:57864
    v_mfma_f32_16x16x32_bf16 v[128:131], v[228:231], a[144:147], v[128:131]
    s_add_u32 m0, s32, 0x24000
    v_mfma_f32_16x16x32_bf16 v[132:135], v[228:231], a[148:151], v[132:135]
    buffer_load_dwordx4 v244, s[12:15], s38 offen lds
    v_mfma_f32_16x16x32_bf16 v[136:139], v[228:231], a[152:155], v[136:139]
    v_mfma_f32_16x16x32_bf16 v[140:143], v[228:231], a[156:159], v[140:143]
    s_waitcnt lgkmcnt(2)
    ds_read_b64_tr_b16 v[228:229], v249 offset:61440
    ds_read_b64_tr_b16 v[230:231], v249 offset:61952
    v_mfma_f32_16x16x32_bf16 v[92:95], v[232:235], a[156:159], v[92:95]
    s_add_u32 m0, s32, 0x24f80
    v_mfma_f32_16x16x32_bf16 v[88:91], v[232:235], a[152:155], v[88:91]
    buffer_load_dwordx4 v244, s[12:15], s38 offen offset:128 lds
    v_mfma_f32_16x16x32_bf16 v[84:87], v[232:235], a[148:151], v[84:87]
    v_mfma_f32_16x16x32_bf16 v[80:83], v[232:235], a[144:147], v[80:83]
    s_waitcnt lgkmcnt(2)
    ds_read_b64_tr_b16 v[232:233], v249 offset:61448
    ds_read_b64_tr_b16 v[234:235], v249 offset:61960
    v_mfma_f32_16x16x32_bf16 v[144:147], v[224:227], a[144:147], v[144:147]
    s_add_u32 m0, s32, 0x25f00
    v_mfma_f32_16x16x32_bf16 v[148:151], v[224:227], a[148:151], v[148:151]
    buffer_load_dwordx4 v244, s[12:15], s38 offen offset:256 lds
    v_mfma_f32_16x16x32_bf16 v[152:155], v[224:227], a[152:155], v[152:155]
    v_mfma_f32_16x16x32_bf16 v[156:159], v[224:227], a[156:159], v[156:159]
    s_waitcnt lgkmcnt(2)
    ds_read_b64_tr_b16 v[224:225], v250 offset:61440
    ds_read_b64_tr_b16 v[226:227], v250 offset:61952
    v_mfma_f32_16x16x32_bf16 v[108:111], v[228:231], a[156:159], v[108:111]
    s_add_u32 m0, s32, 0x26e80
    v_mfma_f32_16x16x32_bf16 v[104:107], v[228:231], a[152:155], v[104:107]
    buffer_load_dwordx4 v244, s[12:15], s38 offen offset:384 lds
    v_mfma_f32_16x16x32_bf16 v[100:103], v[228:231], a[148:151], v[100:103]
    v_mfma_f32_16x16x32_bf16 v[96:99], v[228:231], a[144:147], v[96:99]
    s_waitcnt lgkmcnt(2)
    ds_read_b64_tr_b16 v[228:229], v250 offset:61448
    ds_read_b64_tr_b16 v[230:231], v250 offset:61960
    v_mfma_f32_16x16x32_bf16 v[160:163], v[232:235], a[144:147], v[160:163]
    v_mfma_f32_16x16x32_bf16 v[164:167], v[232:235], a[148:151], v[164:167]
    s_waitcnt vmcnt(12)
    s_barrier
    v_mfma_f32_16x16x32_bf16 v[168:171], v[232:235], a[152:155], v[168:171]
    ds_read_b128 a[172:175], v247 offset:38912
    v_mfma_f32_16x16x32_bf16 v[172:175], v[232:235], a[156:159], v[172:175]
    s_waitcnt lgkmcnt(3)
    ds_read_b64_tr_b16 v[232:233], v254 offset:32768
    ds_read_b64_tr_b16 v[234:235], v254 offset:33280
    v_mfma_f32_16x16x32_bf16 v[124:127], v[224:227], a[156:159], v[124:127]
    ds_read_b128 a[168:171], v247 offset:36864
    v_mfma_f32_16x16x32_bf16 v[120:123], v[224:227], a[152:155], v[120:123]
    ds_read_b128 a[164:167], v247 offset:34816
    v_mfma_f32_16x16x32_bf16 v[116:119], v[224:227], a[148:151], v[116:119]
    ds_read_b128 a[160:163], v247 offset:32768
    v_mfma_f32_16x16x32_bf16 v[112:115], v[224:227], a[144:147], v[112:115]
    s_waitcnt lgkmcnt(6)
    ds_read_b64_tr_b16 v[224:225], v254 offset:32776
    ds_read_b64_tr_b16 v[226:227], v254 offset:33288
    v_mfma_f32_16x16x32_bf16 v[176:179], v[228:231], a[144:147], v[176:179]
    ds_read_b128 a[188:191], v248 offset:38912
    v_mfma_f32_16x16x32_bf16 v[180:183], v[228:231], a[148:151], v[180:183]
    ds_read_b128 a[184:187], v248 offset:36864
    v_mfma_f32_16x16x32_bf16 v[184:187], v[228:231], a[152:155], v[184:187]
    ds_read_b128 a[180:183], v248 offset:34816
    v_mfma_f32_16x16x32_bf16 v[188:191], v[228:231], a[156:159], v[188:191]
    s_waitcnt lgkmcnt(8)
    ds_read_b64_tr_b16 v[228:229], v255 offset:32768
    ds_read_b64_tr_b16 v[230:231], v255 offset:33280
    v_mfma_f32_16x16x32_bf16 v[12:15], v[232:235], a[172:175], v[12:15]
    s_waitcnt lgkmcnt(9)
    ds_read_b128 a[176:179], v248 offset:32768
    v_mfma_f32_16x16x32_bf16 v[8:11], v[232:235], a[168:171], v[8:11]
    s_waitcnt lgkmcnt(9)
    v_mfma_f32_16x16x32_bf16 v[4:7], v[232:235], a[164:167], v[4:7]
    s_waitcnt lgkmcnt(8)
    v_mfma_f32_16x16x32_bf16 v[0:3], v[232:235], a[160:163], v[0:3]
    s_waitcnt lgkmcnt(6)
    s_lshl_b32 s38, s74, 12
    ds_read_b64_tr_b16 v[232:233], v255 offset:32776
    ds_read_b64_tr_b16 v[234:235], v255 offset:33288
    v_mfma_f32_16x16x32_bf16 v[208:211], v[224:227], a[160:163], v[208:211]
    s_add_u32 m0, s32, 0x8000
    v_mfma_f32_16x16x32_bf16 v[212:215], v[224:227], a[164:167], v[212:215]
    buffer_load_dwordx4 v244, s[12:15], s38 offen lds
    v_mfma_f32_16x16x32_bf16 v[216:219], v[224:227], a[168:171], v[216:219]
    v_mfma_f32_16x16x32_bf16 v[220:223], v[224:227], a[172:175], v[220:223]
    s_waitcnt lgkmcnt(3)
    ds_read_b64_tr_b16 v[224:225], v254 offset:36864
    ds_read_b64_tr_b16 v[226:227], v254 offset:37376
    v_mfma_f32_16x16x32_bf16 v[28:31], v[228:231], a[172:175], v[28:31]
    s_add_u32 m0, s32, 0x8f80
    v_mfma_f32_16x16x32_bf16 v[24:27], v[228:231], a[168:171], v[24:27]
    buffer_load_dwordx4 v244, s[12:15], s38 offen offset:128 lds
    v_mfma_f32_16x16x32_bf16 v[20:23], v[228:231], a[164:167], v[20:23]
    v_mfma_f32_16x16x32_bf16 v[16:19], v[228:231], a[160:163], v[16:19]
    s_waitcnt lgkmcnt(2)
    ds_read_b64_tr_b16 v[228:229], v254 offset:36872
    ds_read_b64_tr_b16 v[230:231], v254 offset:37384
    v_mfma_f32_16x16x32_bf16 a[48:51], v[232:235], a[160:163], a[48:51]
    s_add_u32 m0, s32, 0x9f00
    v_mfma_f32_16x16x32_bf16 a[52:55], v[232:235], a[164:167], a[52:55]
    buffer_load_dwordx4 v244, s[12:15], s38 offen offset:256 lds
    v_mfma_f32_16x16x32_bf16 a[56:59], v[232:235], a[168:171], a[56:59]
    v_mfma_f32_16x16x32_bf16 a[60:63], v[232:235], a[172:175], a[60:63]
    s_waitcnt lgkmcnt(2)
    ds_read_b64_tr_b16 v[232:233], v255 offset:36864
    ds_read_b64_tr_b16 v[234:235], v255 offset:37376
    v_mfma_f32_16x16x32_bf16 v[44:47], v[224:227], a[172:175], v[44:47]
    s_add_u32 m0, s32, 0xae80
    v_mfma_f32_16x16x32_bf16 v[40:43], v[224:227], a[168:171], v[40:43]
    buffer_load_dwordx4 v244, s[12:15], s38 offen offset:384 lds
    v_mfma_f32_16x16x32_bf16 v[36:39], v[224:227], a[164:167], v[36:39]
    s_add_u32 s8, s58, s75
    v_mfma_f32_16x16x32_bf16 v[32:35], v[224:227], a[160:163], v[32:35]
    s_waitcnt lgkmcnt(2)
    s_addc_u32 s9, s59, 0
    ds_read_b64_tr_b16 v[224:225], v255 offset:36872
    ds_read_b64_tr_b16 v[226:227], v255 offset:37384
    v_mfma_f32_16x16x32_bf16 a[80:83], v[228:231], a[160:163], a[80:83]
    s_add_u32 m0, s33, 0x8000
    v_mfma_f32_16x16x32_bf16 a[84:87], v[228:231], a[164:167], a[84:87]
    buffer_load_dwordx4 v252, s[8:11], 0 offen lds
    v_mfma_f32_16x16x32_bf16 a[88:91], v[228:231], a[168:171], a[88:91]
    v_mfma_f32_16x16x32_bf16 a[92:95], v[228:231], a[172:175], a[92:95]
    s_waitcnt lgkmcnt(2)
    ds_read_b64_tr_b16 v[228:229], v254 offset:40960
    ds_read_b64_tr_b16 v[230:231], v254 offset:41472
    v_mfma_f32_16x16x32_bf16 v[60:63], v[232:235], a[172:175], v[60:63]
    s_add_u32 m0, s33, 0x8400
    v_mfma_f32_16x16x32_bf16 v[56:59], v[232:235], a[168:171], v[56:59]
    buffer_load_dwordx4 v252, s[8:11], s40 offen lds
    v_mfma_f32_16x16x32_bf16 v[52:55], v[232:235], a[164:167], v[52:55]
    v_mfma_f32_16x16x32_bf16 v[48:51], v[232:235], a[160:163], v[48:51]
    s_waitcnt lgkmcnt(2)
    ds_read_b64_tr_b16 v[232:233], v254 offset:40968
    ds_read_b64_tr_b16 v[234:235], v254 offset:41480
    v_mfma_f32_16x16x32_bf16 a[112:115], v[224:227], a[160:163], a[112:115]
    s_add_u32 m0, s33, 0x8800
    v_mfma_f32_16x16x32_bf16 a[116:119], v[224:227], a[164:167], a[116:119]
    buffer_load_dwordx4 v252, s[8:11], s41 offen lds
    v_mfma_f32_16x16x32_bf16 a[120:123], v[224:227], a[168:171], a[120:123]
    v_mfma_f32_16x16x32_bf16 a[124:127], v[224:227], a[172:175], a[124:127]
    s_waitcnt lgkmcnt(2)
    ds_read_b64_tr_b16 v[224:225], v255 offset:40960
    ds_read_b64_tr_b16 v[226:227], v255 offset:41472
    v_mfma_f32_16x16x32_bf16 v[76:79], v[228:231], a[172:175], v[76:79]
    s_add_u32 m0, s33, 0x8c00
    v_mfma_f32_16x16x32_bf16 v[72:75], v[228:231], a[168:171], v[72:75]
    buffer_load_dwordx4 v252, s[8:11], s42 offen lds
    v_mfma_f32_16x16x32_bf16 v[68:71], v[228:231], a[164:167], v[68:71]
    v_mfma_f32_16x16x32_bf16 v[64:67], v[228:231], a[160:163], v[64:67]
    s_waitcnt lgkmcnt(2)
    ds_read_b64_tr_b16 v[228:229], v255 offset:40968
    ds_read_b64_tr_b16 v[230:231], v255 offset:41480
    v_mfma_f32_16x16x32_bf16 v[128:131], v[232:235], a[160:163], v[128:131]
    s_add_u32 m0, s33, 0x9000
    v_mfma_f32_16x16x32_bf16 v[132:135], v[232:235], a[164:167], v[132:135]
    buffer_load_dwordx4 v252, s[8:11], s43 offen lds
    v_mfma_f32_16x16x32_bf16 v[136:139], v[232:235], a[168:171], v[136:139]
    v_mfma_f32_16x16x32_bf16 v[140:143], v[232:235], a[172:175], v[140:143]
    s_waitcnt lgkmcnt(2)
    ds_read_b64_tr_b16 v[232:233], v254 offset:45056
    ds_read_b64_tr_b16 v[234:235], v254 offset:45568
    v_mfma_f32_16x16x32_bf16 v[92:95], v[224:227], a[172:175], v[92:95]
    s_add_u32 m0, s33, 0x9400
    v_mfma_f32_16x16x32_bf16 v[88:91], v[224:227], a[168:171], v[88:91]
    buffer_load_dwordx4 v252, s[8:11], s44 offen lds
    v_mfma_f32_16x16x32_bf16 v[84:87], v[224:227], a[164:167], v[84:87]
    v_mfma_f32_16x16x32_bf16 v[80:83], v[224:227], a[160:163], v[80:83]
    s_waitcnt lgkmcnt(2)
    ds_read_b64_tr_b16 v[224:225], v254 offset:45064
    ds_read_b64_tr_b16 v[226:227], v254 offset:45576
    v_mfma_f32_16x16x32_bf16 v[144:147], v[228:231], a[160:163], v[144:147]
    s_add_u32 m0, s33, 0x9800
    v_mfma_f32_16x16x32_bf16 v[148:151], v[228:231], a[164:167], v[148:151]
    buffer_load_dwordx4 v252, s[8:11], s45 offen lds
    v_mfma_f32_16x16x32_bf16 v[152:155], v[228:231], a[168:171], v[152:155]
    v_mfma_f32_16x16x32_bf16 v[156:159], v[228:231], a[172:175], v[156:159]
    s_waitcnt lgkmcnt(2)
    ds_read_b64_tr_b16 v[228:229], v255 offset:45056
    ds_read_b64_tr_b16 v[230:231], v255 offset:45568
    v_mfma_f32_16x16x32_bf16 v[108:111], v[232:235], a[172:175], v[108:111]
    s_add_u32 m0, s33, 0x9c00
    v_mfma_f32_16x16x32_bf16 v[104:107], v[232:235], a[168:171], v[104:107]
    buffer_load_dwordx4 v252, s[8:11], s46 offen lds
    v_mfma_f32_16x16x32_bf16 v[100:103], v[232:235], a[164:167], v[100:103]
    v_mfma_f32_16x16x32_bf16 v[96:99], v[232:235], a[160:163], v[96:99]
    s_waitcnt lgkmcnt(2)
    ds_read_b64_tr_b16 v[232:233], v255 offset:45064
    ds_read_b64_tr_b16 v[234:235], v255 offset:45576
    v_mfma_f32_16x16x32_bf16 v[160:163], v[224:227], a[160:163], v[160:163]
    v_mfma_f32_16x16x32_bf16 v[164:167], v[224:227], a[164:167], v[164:167]
    s_waitcnt vmcnt(12)
    s_barrier
    v_mfma_f32_16x16x32_bf16 v[168:171], v[224:227], a[168:171], v[168:171]
    v_mfma_f32_16x16x32_bf16 v[172:175], v[224:227], a[172:175], v[172:175]
    s_waitcnt lgkmcnt(2)
    ds_read_b64_tr_b16 v[224:225], v254 offset:49152
    ds_read_b64_tr_b16 v[226:227], v254 offset:49664
    v_mfma_f32_16x16x32_bf16 v[124:127], v[228:231], a[172:175], v[124:127]
    v_mfma_f32_16x16x32_bf16 v[120:123], v[228:231], a[168:171], v[120:123]
    v_mfma_f32_16x16x32_bf16 v[116:119], v[228:231], a[164:167], v[116:119]
    v_mfma_f32_16x16x32_bf16 v[112:115], v[228:231], a[160:163], v[112:115]
    s_waitcnt lgkmcnt(2)
    ds_read_b64_tr_b16 v[228:229], v254 offset:49160
    ds_read_b64_tr_b16 v[230:231], v254 offset:49672
    v_mfma_f32_16x16x32_bf16 v[176:179], v[232:235], a[160:163], v[176:179]
    v_mfma_f32_16x16x32_bf16 v[180:183], v[232:235], a[164:167], v[180:183]
    v_mfma_f32_16x16x32_bf16 v[184:187], v[232:235], a[168:171], v[184:187]
    v_mfma_f32_16x16x32_bf16 v[188:191], v[232:235], a[172:175], v[188:191]
    s_waitcnt lgkmcnt(2)
    ds_read_b64_tr_b16 v[232:233], v255 offset:49152
    ds_read_b64_tr_b16 v[234:235], v255 offset:49664
    v_mfma_f32_16x16x32_bf16 v[12:15], v[224:227], a[188:191], v[12:15]
    v_mfma_f32_16x16x32_bf16 v[8:11], v[224:227], a[184:187], v[8:11]
    v_mfma_f32_16x16x32_bf16 v[4:7], v[224:227], a[180:183], v[4:7]
    s_lshl_b32 s38, s74, 12
    v_mfma_f32_16x16x32_bf16 v[0:3], v[224:227], a[176:179], v[0:3]
    s_waitcnt lgkmcnt(2)
    s_add_u32 s38, s38, 0x40000
    ds_read_b64_tr_b16 v[224:225], v255 offset:49160
    ds_read_b64_tr_b16 v[226:227], v255 offset:49672
    v_mfma_f32_16x16x32_bf16 v[208:211], v[228:231], a[176:179], v[208:211]
    s_add_u32 m0, s32, 0xc000
    v_mfma_f32_16x16x32_bf16 v[212:215], v[228:231], a[180:183], v[212:215]
    buffer_load_dwordx4 v244, s[12:15], s38 offen lds
    v_mfma_f32_16x16x32_bf16 v[216:219], v[228:231], a[184:187], v[216:219]
    v_mfma_f32_16x16x32_bf16 v[220:223], v[228:231], a[188:191], v[220:223]
    s_waitcnt lgkmcnt(2)
    ds_read_b64_tr_b16 v[228:229], v254 offset:53248
    ds_read_b64_tr_b16 v[230:231], v254 offset:53760
    v_mfma_f32_16x16x32_bf16 v[28:31], v[232:235], a[188:191], v[28:31]
    s_add_u32 m0, s32, 0xcf80
    v_mfma_f32_16x16x32_bf16 v[24:27], v[232:235], a[184:187], v[24:27]
    buffer_load_dwordx4 v244, s[12:15], s38 offen offset:128 lds
    v_mfma_f32_16x16x32_bf16 v[20:23], v[232:235], a[180:183], v[20:23]
    v_mfma_f32_16x16x32_bf16 v[16:19], v[232:235], a[176:179], v[16:19]
    s_waitcnt lgkmcnt(2)
    ds_read_b64_tr_b16 v[232:233], v254 offset:53256
    ds_read_b64_tr_b16 v[234:235], v254 offset:53768
    v_mfma_f32_16x16x32_bf16 a[48:51], v[224:227], a[176:179], a[48:51]
    s_add_u32 m0, s32, 0xdf00
    v_mfma_f32_16x16x32_bf16 a[52:55], v[224:227], a[180:183], a[52:55]
    buffer_load_dwordx4 v244, s[12:15], s38 offen offset:256 lds
    v_mfma_f32_16x16x32_bf16 a[56:59], v[224:227], a[184:187], a[56:59]
    v_mfma_f32_16x16x32_bf16 a[60:63], v[224:227], a[188:191], a[60:63]
    s_waitcnt lgkmcnt(2)
    ds_read_b64_tr_b16 v[224:225], v255 offset:53248
    ds_read_b64_tr_b16 v[226:227], v255 offset:53760
    v_mfma_f32_16x16x32_bf16 v[44:47], v[228:231], a[188:191], v[44:47]
    s_add_u32 m0, s32, 0xee80
    v_mfma_f32_16x16x32_bf16 v[40:43], v[228:231], a[184:187], v[40:43]
    buffer_load_dwordx4 v244, s[12:15], s38 offen offset:384 lds
    v_mfma_f32_16x16x32_bf16 v[36:39], v[228:231], a[180:183], v[36:39]
    v_mfma_f32_16x16x32_bf16 v[32:35], v[228:231], a[176:179], v[32:35]
    s_waitcnt lgkmcnt(2)
    ds_read_b64_tr_b16 v[228:229], v255 offset:53256
    ds_read_b64_tr_b16 v[230:231], v255 offset:53768
    v_mfma_f32_16x16x32_bf16 a[80:83], v[232:235], a[176:179], a[80:83]
    s_add_u32 m0, s32, 0x0
    v_mfma_f32_16x16x32_bf16 a[84:87], v[232:235], a[180:183], a[84:87]
    buffer_load_dwordx4 v251, s[16:19], s34 offen nt lds
    v_mfma_f32_16x16x32_bf16 a[88:91], v[232:235], a[184:187], a[88:91]
    v_mfma_f32_16x16x32_bf16 a[92:95], v[232:235], a[188:191], a[92:95]
    s_waitcnt lgkmcnt(2)
    ds_read_b64_tr_b16 v[232:233], v254 offset:57344
    ds_read_b64_tr_b16 v[234:235], v254 offset:57856
    v_mfma_f32_16x16x32_bf16 v[60:63], v[224:227], a[188:191], v[60:63]
    s_add_u32 m0, s32, 0xf80
    v_mfma_f32_16x16x32_bf16 v[56:59], v[224:227], a[184:187], v[56:59]
    buffer_load_dwordx4 v251, s[16:19], s34 offen offset:128 nt lds
    v_mfma_f32_16x16x32_bf16 v[52:55], v[224:227], a[180:183], v[52:55]
    v_mfma_f32_16x16x32_bf16 v[48:51], v[224:227], a[176:179], v[48:51]
    s_waitcnt lgkmcnt(2)
    ds_read_b64_tr_b16 v[224:225], v254 offset:57352
    ds_read_b64_tr_b16 v[226:227], v254 offset:57864
    v_mfma_f32_16x16x32_bf16 a[112:115], v[228:231], a[176:179], a[112:115]
    s_add_u32 m0, s32, 0x1f00
    v_mfma_f32_16x16x32_bf16 a[116:119], v[228:231], a[180:183], a[116:119]
    buffer_load_dwordx4 v251, s[16:19], s34 offen offset:256 nt lds
    v_mfma_f32_16x16x32_bf16 a[120:123], v[228:231], a[184:187], a[120:123]
    v_mfma_f32_16x16x32_bf16 a[124:127], v[228:231], a[188:191], a[124:127]
    s_waitcnt lgkmcnt(2)
    ds_read_b64_tr_b16 v[228:229], v255 offset:57344
    ds_read_b64_tr_b16 v[230:231], v255 offset:57856
    v_mfma_f32_16x16x32_bf16 v[76:79], v[232:235], a[188:191], v[76:79]
    s_add_u32 m0, s32, 0x2e80
    v_mfma_f32_16x16x32_bf16 v[72:75], v[232:235], a[184:187], v[72:75]
    buffer_load_dwordx4 v251, s[16:19], s34 offen offset:384 nt lds
    v_mfma_f32_16x16x32_bf16 v[68:71], v[232:235], a[180:183], v[68:71]
    s_or_b32 s34, s34, 0x18fff
    v_mfma_f32_16x16x32_bf16 v[64:67], v[232:235], a[176:179], v[64:67]
    s_waitcnt lgkmcnt(2)
    s_add_u32 s34, s34, 1
    ds_read_b64_tr_b16 v[232:233], v255 offset:57352
    ds_read_b64_tr_b16 v[234:235], v255 offset:57864
    v_mfma_f32_16x16x32_bf16 v[128:131], v[224:227], a[176:179], v[128:131]
    s_andn2_b32 s34, s34, 0x18fff
    v_mfma_f32_16x16x32_bf16 v[132:135], v[224:227], a[180:183], v[132:135]
    v_mfma_f32_16x16x32_bf16 v[136:139], v[224:227], a[184:187], v[136:139]
    v_mfma_f32_16x16x32_bf16 v[140:143], v[224:227], a[188:191], v[140:143]
    s_waitcnt lgkmcnt(2)
    ds_read_b64_tr_b16 v[224:225], v254 offset:61440
    ds_read_b64_tr_b16 v[226:227], v254 offset:61952
    v_mfma_f32_16x16x32_bf16 v[92:95], v[228:231], a[188:191], v[92:95]
    v_mfma_f32_16x16x32_bf16 v[88:91], v[228:231], a[184:187], v[88:91]
    v_mfma_f32_16x16x32_bf16 v[84:87], v[228:231], a[180:183], v[84:87]
    v_mfma_f32_16x16x32_bf16 v[80:83], v[228:231], a[176:179], v[80:83]
    s_waitcnt lgkmcnt(2)
    ds_read_b64_tr_b16 v[228:229], v254 offset:61448
    ds_read_b64_tr_b16 v[230:231], v254 offset:61960
    v_mfma_f32_16x16x32_bf16 v[144:147], v[232:235], a[176:179], v[144:147]
    v_mfma_f32_16x16x32_bf16 v[148:151], v[232:235], a[180:183], v[148:151]
    v_mfma_f32_16x16x32_bf16 v[152:155], v[232:235], a[184:187], v[152:155]
    v_mfma_f32_16x16x32_bf16 v[156:159], v[232:235], a[188:191], v[156:159]
    s_waitcnt lgkmcnt(2)
    ds_read_b64_tr_b16 v[232:233], v255 offset:61440
    ds_read_b64_tr_b16 v[234:235], v255 offset:61952
    v_mfma_f32_16x16x32_bf16 v[108:111], v[224:227], a[188:191], v[108:111]
    v_mfma_f32_16x16x32_bf16 v[104:107], v[224:227], a[184:187], v[104:107]
    v_mfma_f32_16x16x32_bf16 v[100:103], v[224:227], a[180:183], v[100:103]
    v_mfma_f32_16x16x32_bf16 v[96:99], v[224:227], a[176:179], v[96:99]
    s_waitcnt lgkmcnt(2)
    ds_read_b64_tr_b16 v[224:225], v255 offset:61448
    ds_read_b64_tr_b16 v[226:227], v255 offset:61960
    v_mfma_f32_16x16x32_bf16 v[160:163], v[228:231], a[176:179], v[160:163]
    v_mfma_f32_16x16x32_bf16 v[164:167], v[228:231], a[180:183], v[164:167]
    s_waitcnt vmcnt(16)
    s_barrier
    v_mfma_f32_16x16x32_bf16 v[168:171], v[228:231], a[184:187], v[168:171]
    ds_read_b128 a[204:207], v247 offset:6144
    v_mfma_f32_16x16x32_bf16 v[172:175], v[228:231], a[188:191], v[172:175]
    s_waitcnt lgkmcnt(3)
    ds_read_b64_tr_b16 v[228:229], v249 offset:32768
    ds_read_b64_tr_b16 v[230:231], v249 offset:33280
    v_mfma_f32_16x16x32_bf16 v[124:127], v[232:235], a[188:191], v[124:127]
    ds_read_b128 a[200:203], v247 offset:4096
    v_mfma_f32_16x16x32_bf16 v[120:123], v[232:235], a[184:187], v[120:123]
    ds_read_b128 a[196:199], v247 offset:2048
    v_mfma_f32_16x16x32_bf16 v[116:119], v[232:235], a[180:183], v[116:119]
    ds_read_b128 a[192:195], v247 offset:0
    v_mfma_f32_16x16x32_bf16 v[112:115], v[232:235], a[176:179], v[112:115]
    s_waitcnt lgkmcnt(6)
    ds_read_b64_tr_b16 v[232:233], v249 offset:32776
    ds_read_b64_tr_b16 v[234:235], v249 offset:33288
    v_mfma_f32_16x16x32_bf16 v[176:179], v[224:227], a[176:179], v[176:179]
    ds_read_b128 a[220:223], v248 offset:6144
    v_mfma_f32_16x16x32_bf16 v[180:183], v[224:227], a[180:183], v[180:183]
    ds_read_b128 a[216:219], v248 offset:4096
    v_mfma_f32_16x16x32_bf16 v[184:187], v[224:227], a[184:187], v[184:187]
    ds_read_b128 a[212:215], v248 offset:2048
    v_mfma_f32_16x16x32_bf16 v[188:191], v[224:227], a[188:191], v[188:191]
    s_waitcnt lgkmcnt(8)
    ds_read_b64_tr_b16 v[224:225], v250 offset:32768
    ds_read_b64_tr_b16 v[226:227], v250 offset:33280
    v_mfma_f32_16x16x32_bf16 v[12:15], v[228:231], a[204:207], v[12:15]
    s_waitcnt lgkmcnt(9)
    ds_read_b128 a[208:211], v248 offset:0
    v_mfma_f32_16x16x32_bf16 v[8:11], v[228:231], a[200:203], v[8:11]
    s_waitcnt lgkmcnt(9)
    v_mfma_f32_16x16x32_bf16 v[4:7], v[228:231], a[196:199], v[4:7]
    s_waitcnt lgkmcnt(8)
    v_mfma_f32_16x16x32_bf16 v[0:3], v[228:231], a[192:195], v[0:3]
    s_waitcnt lgkmcnt(6)
    s_lshl_b32 s38, s75, 12
    ds_read_b64_tr_b16 v[228:229], v250 offset:32776
    ds_read_b64_tr_b16 v[230:231], v250 offset:33288
    v_mfma_f32_16x16x32_bf16 v[208:211], v[232:235], a[192:195], v[208:211]
    s_add_u32 m0, s32, 0x20000
    v_mfma_f32_16x16x32_bf16 v[212:215], v[232:235], a[196:199], v[212:215]
    buffer_load_dwordx4 v244, s[12:15], s38 offen lds
    v_mfma_f32_16x16x32_bf16 v[216:219], v[232:235], a[200:203], v[216:219]
    v_mfma_f32_16x16x32_bf16 v[220:223], v[232:235], a[204:207], v[220:223]
    s_waitcnt lgkmcnt(3)
    ds_read_b64_tr_b16 v[232:233], v249 offset:36864
    ds_read_b64_tr_b16 v[234:235], v249 offset:37376
    v_mfma_f32_16x16x32_bf16 v[28:31], v[224:227], a[204:207], v[28:31]
    s_add_u32 m0, s32, 0x20f80
    v_mfma_f32_16x16x32_bf16 v[24:27], v[224:227], a[200:203], v[24:27]
    buffer_load_dwordx4 v244, s[12:15], s38 offen offset:128 lds
    v_mfma_f32_16x16x32_bf16 v[20:23], v[224:227], a[196:199], v[20:23]
    v_mfma_f32_16x16x32_bf16 v[16:19], v[224:227], a[192:195], v[16:19]
    s_waitcnt lgkmcnt(2)
    ds_read_b64_tr_b16 v[224:225], v249 offset:36872
    ds_read_b64_tr_b16 v[226:227], v249 offset:37384
    v_mfma_f32_16x16x32_bf16 a[48:51], v[228:231], a[192:195], a[48:51]
    s_add_u32 m0, s32, 0x21f00
    v_mfma_f32_16x16x32_bf16 a[52:55], v[228:231], a[196:199], a[52:55]
    buffer_load_dwordx4 v244, s[12:15], s38 offen offset:256 lds
    v_mfma_f32_16x16x32_bf16 a[56:59], v[228:231], a[200:203], a[56:59]
    v_mfma_f32_16x16x32_bf16 a[60:63], v[228:231], a[204:207], a[60:63]
    s_waitcnt lgkmcnt(2)
    ds_read_b64_tr_b16 v[228:229], v250 offset:36864
    ds_read_b64_tr_b16 v[230:231], v250 offset:37376
    v_mfma_f32_16x16x32_bf16 v[44:47], v[232:235], a[204:207], v[44:47]
    s_add_u32 m0, s32, 0x22e80
    v_mfma_f32_16x16x32_bf16 v[40:43], v[232:235], a[200:203], v[40:43]
    buffer_load_dwordx4 v244, s[12:15], s38 offen offset:384 lds
    v_mfma_f32_16x16x32_bf16 v[36:39], v[232:235], a[196:199], v[36:39]
    s_add_u32 s8, s58, s76
    v_mfma_f32_16x16x32_bf16 v[32:35], v[232:235], a[192:195], v[32:35]
    s_waitcnt lgkmcnt(2)
    s_addc_u32 s9, s59, 0
    ds_read_b64_tr_b16 v[232:233], v250 offset:36872
    ds_read_b64_tr_b16 v[234:235], v250 offset:37384
    v_mfma_f32_16x16x32_bf16 a[80:83], v[224:227], a[192:195], a[80:83]
    s_add_u32 m0, s33, 0x0
    v_mfma_f32_16x16x32_bf16 a[84:87], v[224:227], a[196:199], a[84:87]
    buffer_load_dwordx4 v252, s[8:11], 0 offen lds
    v_mfma_f32_16x16x32_bf16 a[88:91], v[224:227], a[200:203], a[88:91]
    v_mfma_f32_16x16x32_bf16 a[92:95], v[224:227], a[204:207], a[92:95]
    s_waitcnt lgkmcnt(2)
    ds_read_b64_tr_b16 v[224:225], v249 offset:40960
    ds_read_b64_tr_b16 v[226:227], v249 offset:41472
    v_mfma_f32_16x16x32_bf16 v[60:63], v[228:231], a[204:207], v[60:63]
    s_add_u32 m0, s33, 0x400
    v_mfma_f32_16x16x32_bf16 v[56:59], v[228:231], a[200:203], v[56:59]
    buffer_load_dwordx4 v252, s[8:11], s40 offen lds
    v_mfma_f32_16x16x32_bf16 v[52:55], v[228:231], a[196:199], v[52:55]
    v_mfma_f32_16x16x32_bf16 v[48:51], v[228:231], a[192:195], v[48:51]
    s_waitcnt lgkmcnt(2)
    ds_read_b64_tr_b16 v[228:229], v249 offset:40968
    ds_read_b64_tr_b16 v[230:231], v249 offset:41480
    v_mfma_f32_16x16x32_bf16 a[112:115], v[232:235], a[192:195], a[112:115]
    s_add_u32 m0, s33, 0x800
    v_mfma_f32_16x16x32_bf16 a[116:119], v[232:235], a[196:199], a[116:119]
    buffer_load_dwordx4 v252, s[8:11], s41 offen lds
    v_mfma_f32_16x16x32_bf16 a[120:123], v[232:235], a[200:203], a[120:123]
    v_mfma_f32_16x16x32_bf16 a[124:127], v[232:235], a[204:207], a[124:127]
    s_waitcnt lgkmcnt(2)
    ds_read_b64_tr_b16 v[232:233], v250 offset:40960
    ds_read_b64_tr_b16 v[234:235], v250 offset:41472
    v_mfma_f32_16x16x32_bf16 v[76:79], v[224:227], a[204:207], v[76:79]
    s_add_u32 m0, s33, 0xc00
    v_mfma_f32_16x16x32_bf16 v[72:75], v[224:227], a[200:203], v[72:75]
    buffer_load_dwordx4 v252, s[8:11], s42 offen lds
    v_mfma_f32_16x16x32_bf16 v[68:71], v[224:227], a[196:199], v[68:71]
    v_mfma_f32_16x16x32_bf16 v[64:67], v[224:227], a[192:195], v[64:67]
    s_waitcnt lgkmcnt(2)
    ds_read_b64_tr_b16 v[224:225], v250 offset:40968
    ds_read_b64_tr_b16 v[226:227], v250 offset:41480
    v_mfma_f32_16x16x32_bf16 v[128:131], v[228:231], a[192:195], v[128:131]
    s_add_u32 m0, s33, 0x1000
    v_mfma_f32_16x16x32_bf16 v[132:135], v[228:231], a[196:199], v[132:135]
    buffer_load_dwordx4 v252, s[8:11], s43 offen lds
    v_mfma_f32_16x16x32_bf16 v[136:139], v[228:231], a[200:203], v[136:139]
    v_mfma_f32_16x16x32_bf16 v[140:143], v[228:231], a[204:207], v[140:143]
    s_waitcnt lgkmcnt(2)
    ds_read_b64_tr_b16 v[228:229], v249 offset:45056
    ds_read_b64_tr_b16 v[230:231], v249 offset:45568
    v_mfma_f32_16x16x32_bf16 v[92:95], v[232:235], a[204:207], v[92:95]
    s_add_u32 m0, s33, 0x1400
    v_mfma_f32_16x16x32_bf16 v[88:91], v[232:235], a[200:203], v[88:91]
    buffer_load_dwordx4 v252, s[8:11], s44 offen lds
    v_mfma_f32_16x16x32_bf16 v[84:87], v[232:235], a[196:199], v[84:87]
    v_mfma_f32_16x16x32_bf16 v[80:83], v[232:235], a[192:195], v[80:83]
    s_waitcnt lgkmcnt(2)
    ds_read_b64_tr_b16 v[232:233], v249 offset:45064
    ds_read_b64_tr_b16 v[234:235], v249 offset:45576
    v_mfma_f32_16x16x32_bf16 v[144:147], v[224:227], a[192:195], v[144:147]
    s_add_u32 m0, s33, 0x1800
    v_mfma_f32_16x16x32_bf16 v[148:151], v[224:227], a[196:199], v[148:151]
    buffer_load_dwordx4 v252, s[8:11], s45 offen lds
    v_mfma_f32_16x16x32_bf16 v[152:155], v[224:227], a[200:203], v[152:155]
    v_mfma_f32_16x16x32_bf16 v[156:159], v[224:227], a[204:207], v[156:159]
    s_waitcnt lgkmcnt(2)
    ds_read_b64_tr_b16 v[224:225], v250 offset:45056
    ds_read_b64_tr_b16 v[226:227], v250 offset:45568
    v_mfma_f32_16x16x32_bf16 v[108:111], v[228:231], a[204:207], v[108:111]
    s_add_u32 m0, s33, 0x1c00
    v_mfma_f32_16x16x32_bf16 v[104:107], v[228:231], a[200:203], v[104:107]
    buffer_load_dwordx4 v252, s[8:11], s46 offen lds
    v_mfma_f32_16x16x32_bf16 v[100:103], v[228:231], a[196:199], v[100:103]
    v_mfma_f32_16x16x32_bf16 v[96:99], v[228:231], a[192:195], v[96:99]
    s_waitcnt lgkmcnt(2)
    ds_read_b64_tr_b16 v[228:229], v250 offset:45064
    ds_read_b64_tr_b16 v[230:231], v250 offset:45576
    v_mfma_f32_16x16x32_bf16 v[160:163], v[232:235], a[192:195], v[160:163]
    v_mfma_f32_16x16x32_bf16 v[164:167], v[232:235], a[196:199], v[164:167]
    s_waitcnt vmcnt(16)
    s_barrier
    v_mfma_f32_16x16x32_bf16 v[168:171], v[232:235], a[200:203], v[168:171]
    ds_read_b128 a[236:239], v247 offset:38912
    v_mfma_f32_16x16x32_bf16 v[172:175], v[232:235], a[204:207], v[172:175]
    s_waitcnt lgkmcnt(3)
    ds_read_b64_tr_b16 v[232:233], v249 offset:49152
    ds_read_b64_tr_b16 v[234:235], v249 offset:49664
    v_mfma_f32_16x16x32_bf16 v[124:127], v[224:227], a[204:207], v[124:127]
    ds_read_b128 a[232:235], v247 offset:36864
    v_mfma_f32_16x16x32_bf16 v[120:123], v[224:227], a[200:203], v[120:123]
    ds_read_b128 a[228:231], v247 offset:34816
    v_mfma_f32_16x16x32_bf16 v[116:119], v[224:227], a[196:199], v[116:119]
    ds_read_b128 a[224:227], v247 offset:32768
    v_mfma_f32_16x16x32_bf16 v[112:115], v[224:227], a[192:195], v[112:115]
    s_waitcnt lgkmcnt(6)
    ds_read_b64_tr_b16 v[224:225], v249 offset:49160
    ds_read_b64_tr_b16 v[226:227], v249 offset:49672
    v_mfma_f32_16x16x32_bf16 v[176:179], v[228:231], a[192:195], v[176:179]
    ds_read_b128 a[252:255], v248 offset:38912
    v_mfma_f32_16x16x32_bf16 v[180:183], v[228:231], a[196:199], v[180:183]
    ds_read_b128 a[248:251], v248 offset:36864
    v_mfma_f32_16x16x32_bf16 v[184:187], v[228:231], a[200:203], v[184:187]
    ds_read_b128 a[244:247], v248 offset:34816
    v_mfma_f32_16x16x32_bf16 v[188:191], v[228:231], a[204:207], v[188:191]
    s_waitcnt lgkmcnt(8)
    ds_read_b64_tr_b16 v[228:229], v250 offset:49152
    ds_read_b64_tr_b16 v[230:231], v250 offset:49664
    v_mfma_f32_16x16x32_bf16 v[12:15], v[232:235], a[220:223], v[12:15]
    ds_read_b128 a[240:243], v248 offset:32768
    v_mfma_f32_16x16x32_bf16 v[8:11], v[232:235], a[216:219], v[8:11]
    v_mfma_f32_16x16x32_bf16 v[4:7], v[232:235], a[212:215], v[4:7]
    s_lshl_b32 s38, s75, 12
    v_mfma_f32_16x16x32_bf16 v[0:3], v[232:235], a[208:211], v[0:3]
    s_waitcnt lgkmcnt(6)
    s_add_u32 s38, s38, 0x40000
    ds_read_b64_tr_b16 v[232:233], v250 offset:49160
    ds_read_b64_tr_b16 v[234:235], v250 offset:49672
    v_mfma_f32_16x16x32_bf16 v[208:211], v[224:227], a[208:211], v[208:211]
    s_add_u32 m0, s32, 0x24000
    v_mfma_f32_16x16x32_bf16 v[212:215], v[224:227], a[212:215], v[212:215]
    buffer_load_dwordx4 v244, s[12:15], s38 offen lds
    v_mfma_f32_16x16x32_bf16 v[216:219], v[224:227], a[216:219], v[216:219]
    v_mfma_f32_16x16x32_bf16 v[220:223], v[224:227], a[220:223], v[220:223]
    s_waitcnt lgkmcnt(3)
    ds_read_b64_tr_b16 v[224:225], v249 offset:53248
    ds_read_b64_tr_b16 v[226:227], v249 offset:53760
    v_mfma_f32_16x16x32_bf16 v[28:31], v[228:231], a[220:223], v[28:31]
    s_add_u32 m0, s32, 0x24f80
    v_mfma_f32_16x16x32_bf16 v[24:27], v[228:231], a[216:219], v[24:27]
    buffer_load_dwordx4 v244, s[12:15], s38 offen offset:128 lds
    v_mfma_f32_16x16x32_bf16 v[20:23], v[228:231], a[212:215], v[20:23]
    v_mfma_f32_16x16x32_bf16 v[16:19], v[228:231], a[208:211], v[16:19]
    s_waitcnt lgkmcnt(2)
    ds_read_b64_tr_b16 v[228:229], v249 offset:53256
    ds_read_b64_tr_b16 v[230:231], v249 offset:53768
    v_mfma_f32_16x16x32_bf16 a[48:51], v[232:235], a[208:211], a[48:51]
    s_add_u32 m0, s32, 0x25f00
    v_mfma_f32_16x16x32_bf16 a[52:55], v[232:235], a[212:215], a[52:55]
    buffer_load_dwordx4 v244, s[12:15], s38 offen offset:256 lds
    v_mfma_f32_16x16x32_bf16 a[56:59], v[232:235], a[216:219], a[56:59]
    v_mfma_f32_16x16x32_bf16 a[60:63], v[232:235], a[220:223], a[60:63]
    s_waitcnt lgkmcnt(2)
    ds_read_b64_tr_b16 v[232:233], v250 offset:53248
    ds_read_b64_tr_b16 v[234:235], v250 offset:53760
    v_mfma_f32_16x16x32_bf16 v[44:47], v[224:227], a[220:223], v[44:47]
    s_add_u32 m0, s32, 0x26e80
    v_mfma_f32_16x16x32_bf16 v[40:43], v[224:227], a[216:219], v[40:43]
    buffer_load_dwordx4 v244, s[12:15], s38 offen offset:384 lds
    v_mfma_f32_16x16x32_bf16 v[36:39], v[224:227], a[212:215], v[36:39]
    s_add_u32 s8, s58, s77
    v_mfma_f32_16x16x32_bf16 v[32:35], v[224:227], a[208:211], v[32:35]
    s_waitcnt lgkmcnt(2)
    s_addc_u32 s9, s59, 0
    ds_read_b64_tr_b16 v[224:225], v250 offset:53256
    ds_read_b64_tr_b16 v[226:227], v250 offset:53768
    v_mfma_f32_16x16x32_bf16 a[80:83], v[228:231], a[208:211], a[80:83]
    s_add_u32 m0, s33, 0x8000
    v_mfma_f32_16x16x32_bf16 a[84:87], v[228:231], a[212:215], a[84:87]
    buffer_load_dwordx4 v252, s[8:11], 0 offen lds
    v_mfma_f32_16x16x32_bf16 a[88:91], v[228:231], a[216:219], a[88:91]
    v_mfma_f32_16x16x32_bf16 a[92:95], v[228:231], a[220:223], a[92:95]
    s_waitcnt lgkmcnt(2)
    ds_read_b64_tr_b16 v[228:229], v249 offset:57344
    ds_read_b64_tr_b16 v[230:231], v249 offset:57856
    v_mfma_f32_16x16x32_bf16 v[60:63], v[232:235], a[220:223], v[60:63]
    s_add_u32 m0, s33, 0x8400
    v_mfma_f32_16x16x32_bf16 v[56:59], v[232:235], a[216:219], v[56:59]
    buffer_load_dwordx4 v252, s[8:11], s40 offen lds
    v_mfma_f32_16x16x32_bf16 v[52:55], v[232:235], a[212:215], v[52:55]
    v_mfma_f32_16x16x32_bf16 v[48:51], v[232:235], a[208:211], v[48:51]
    s_waitcnt lgkmcnt(2)
    ds_read_b64_tr_b16 v[232:233], v249 offset:57352
    ds_read_b64_tr_b16 v[234:235], v249 offset:57864
    v_mfma_f32_16x16x32_bf16 a[112:115], v[224:227], a[208:211], a[112:115]
    s_add_u32 m0, s33, 0x8800
    v_mfma_f32_16x16x32_bf16 a[116:119], v[224:227], a[212:215], a[116:119]
    buffer_load_dwordx4 v252, s[8:11], s41 offen lds
    v_mfma_f32_16x16x32_bf16 a[120:123], v[224:227], a[216:219], a[120:123]
    v_mfma_f32_16x16x32_bf16 a[124:127], v[224:227], a[220:223], a[124:127]
    s_waitcnt lgkmcnt(2)
    ds_read_b64_tr_b16 v[224:225], v250 offset:57344
    ds_read_b64_tr_b16 v[226:227], v250 offset:57856
    v_mfma_f32_16x16x32_bf16 v[76:79], v[228:231], a[220:223], v[76:79]
    s_add_u32 m0, s33, 0x8c00
    v_mfma_f32_16x16x32_bf16 v[72:75], v[228:231], a[216:219], v[72:75]
    buffer_load_dwordx4 v252, s[8:11], s42 offen lds
    v_mfma_f32_16x16x32_bf16 v[68:71], v[228:231], a[212:215], v[68:71]
    v_mfma_f32_16x16x32_bf16 v[64:67], v[228:231], a[208:211], v[64:67]
    s_waitcnt lgkmcnt(2)
    ds_read_b64_tr_b16 v[228:229], v250 offset:57352
    ds_read_b64_tr_b16 v[230:231], v250 offset:57864
    v_mfma_f32_16x16x32_bf16 v[128:131], v[232:235], a[208:211], v[128:131]
    s_add_u32 m0, s33, 0x9000
    v_mfma_f32_16x16x32_bf16 v[132:135], v[232:235], a[212:215], v[132:135]
    buffer_load_dwordx4 v252, s[8:11], s43 offen lds
    v_mfma_f32_16x16x32_bf16 v[136:139], v[232:235], a[216:219], v[136:139]
    v_mfma_f32_16x16x32_bf16 v[140:143], v[232:235], a[220:223], v[140:143]
    s_waitcnt lgkmcnt(2)
    ds_read_b64_tr_b16 v[232:233], v249 offset:61440
    ds_read_b64_tr_b16 v[234:235], v249 offset:61952
    v_mfma_f32_16x16x32_bf16 v[92:95], v[224:227], a[220:223], v[92:95]
    s_add_u32 m0, s33, 0x9400
    v_mfma_f32_16x16x32_bf16 v[88:91], v[224:227], a[216:219], v[88:91]
    buffer_load_dwordx4 v252, s[8:11], s44 offen lds
    v_mfma_f32_16x16x32_bf16 v[84:87], v[224:227], a[212:215], v[84:87]
    v_mfma_f32_16x16x32_bf16 v[80:83], v[224:227], a[208:211], v[80:83]
    s_waitcnt lgkmcnt(2)
    ds_read_b64_tr_b16 v[224:225], v249 offset:61448
    ds_read_b64_tr_b16 v[226:227], v249 offset:61960
    v_mfma_f32_16x16x32_bf16 v[144:147], v[228:231], a[208:211], v[144:147]
    s_add_u32 m0, s33, 0x9800
    v_mfma_f32_16x16x32_bf16 v[148:151], v[228:231], a[212:215], v[148:151]
    buffer_load_dwordx4 v252, s[8:11], s45 offen lds
    v_mfma_f32_16x16x32_bf16 v[152:155], v[228:231], a[216:219], v[152:155]
    v_mfma_f32_16x16x32_bf16 v[156:159], v[228:231], a[220:223], v[156:159]
    s_waitcnt lgkmcnt(2)
    ds_read_b64_tr_b16 v[228:229], v250 offset:61440
    ds_read_b64_tr_b16 v[230:231], v250 offset:61952
    v_mfma_f32_16x16x32_bf16 v[108:111], v[232:235], a[220:223], v[108:111]
    s_add_u32 m0, s33, 0x9c00
    v_mfma_f32_16x16x32_bf16 v[104:107], v[232:235], a[216:219], v[104:107]
    buffer_load_dwordx4 v252, s[8:11], s46 offen lds
    v_mfma_f32_16x16x32_bf16 v[100:103], v[232:235], a[212:215], v[100:103]
    v_mfma_f32_16x16x32_bf16 v[96:99], v[232:235], a[208:211], v[96:99]
    s_waitcnt lgkmcnt(2)
    ds_read_b64_tr_b16 v[232:233], v250 offset:61448
    ds_read_b64_tr_b16 v[234:235], v250 offset:61960
    v_mfma_f32_16x16x32_bf16 v[160:163], v[224:227], a[208:211], v[160:163]
    v_mfma_f32_16x16x32_bf16 v[164:167], v[224:227], a[212:215], v[164:167]
    s_waitcnt vmcnt(12)
    s_barrier
    v_mfma_f32_16x16x32_bf16 v[168:171], v[224:227], a[216:219], v[168:171]
    ds_read_b128 a[140:143], v247 offset:6144
    v_mfma_f32_16x16x32_bf16 v[172:175], v[224:227], a[220:223], v[172:175]
    s_waitcnt lgkmcnt(3)
    ds_read_b64_tr_b16 v[224:225], v254 offset:32768
    ds_read_b64_tr_b16 v[226:227], v254 offset:33280
    v_mfma_f32_16x16x32_bf16 v[124:127], v[228:231], a[220:223], v[124:127]
    ds_read_b128 a[136:139], v247 offset:4096
    v_mfma_f32_16x16x32_bf16 v[120:123], v[228:231], a[216:219], v[120:123]
    ds_read_b128 a[132:135], v247 offset:2048
    v_mfma_f32_16x16x32_bf16 v[116:119], v[228:231], a[212:215], v[116:119]
    ds_read_b128 a[128:131], v247 offset:0
    v_mfma_f32_16x16x32_bf16 v[112:115], v[228:231], a[208:211], v[112:115]
    s_waitcnt lgkmcnt(6)
    ds_read_b64_tr_b16 v[228:229], v254 offset:32776
    ds_read_b64_tr_b16 v[230:231], v254 offset:33288
    v_mfma_f32_16x16x32_bf16 v[176:179], v[232:235], a[208:211], v[176:179]
    ds_read_b128 a[156:159], v248 offset:6144
    v_mfma_f32_16x16x32_bf16 v[180:183], v[232:235], a[212:215], v[180:183]
    ds_read_b128 a[152:155], v248 offset:4096
    v_mfma_f32_16x16x32_bf16 v[184:187], v[232:235], a[216:219], v[184:187]
    ds_read_b128 a[148:151], v248 offset:2048
    v_mfma_f32_16x16x32_bf16 v[188:191], v[232:235], a[220:223], v[188:191]
    s_waitcnt lgkmcnt(8)
    ds_read_b64_tr_b16 v[232:233], v255 offset:32768
    ds_read_b64_tr_b16 v[234:235], v255 offset:33280
    v_mfma_f32_16x16x32_bf16 v[12:15], v[224:227], a[236:239], v[12:15]
    ds_read_b128 a[144:147], v248 offset:0
    v_mfma_f32_16x16x32_bf16 v[8:11], v[224:227], a[232:235], v[8:11]
    v_mfma_f32_16x16x32_bf16 v[4:7], v[224:227], a[228:231], v[4:7]
    v_mfma_f32_16x16x32_bf16 v[0:3], v[224:227], a[224:227], v[0:3]
    s_waitcnt lgkmcnt(6)
    s_lshl_b32 s38, s76, 12
    ds_read_b64_tr_b16 v[224:225], v255 offset:32776
    ds_read_b64_tr_b16 v[226:227], v255 offset:33288
    v_mfma_f32_16x16x32_bf16 v[208:211], v[228:231], a[224:227], v[208:211]
    s_add_u32 m0, s32, 0x8000
    v_mfma_f32_16x16x32_bf16 v[212:215], v[228:231], a[228:231], v[212:215]
    buffer_load_dwordx4 v244, s[12:15], s38 offen lds
    v_mfma_f32_16x16x32_bf16 v[216:219], v[228:231], a[232:235], v[216:219]
    v_mfma_f32_16x16x32_bf16 v[220:223], v[228:231], a[236:239], v[220:223]
    s_waitcnt lgkmcnt(3)
    ds_read_b64_tr_b16 v[228:229], v254 offset:36864
    ds_read_b64_tr_b16 v[230:231], v254 offset:37376
    v_mfma_f32_16x16x32_bf16 v[28:31], v[232:235], a[236:239], v[28:31]
    s_add_u32 m0, s32, 0x8f80
    v_mfma_f32_16x16x32_bf16 v[24:27], v[232:235], a[232:235], v[24:27]
    buffer_load_dwordx4 v244, s[12:15], s38 offen offset:128 lds
    v_mfma_f32_16x16x32_bf16 v[20:23], v[232:235], a[228:231], v[20:23]
    v_mfma_f32_16x16x32_bf16 v[16:19], v[232:235], a[224:227], v[16:19]
    s_waitcnt lgkmcnt(2)
    ds_read_b64_tr_b16 v[232:233], v254 offset:36872
    ds_read_b64_tr_b16 v[234:235], v254 offset:37384
    v_mfma_f32_16x16x32_bf16 a[48:51], v[224:227], a[224:227], a[48:51]
    s_add_u32 m0, s32, 0x9f00
    v_mfma_f32_16x16x32_bf16 a[52:55], v[224:227], a[228:231], a[52:55]
    buffer_load_dwordx4 v244, s[12:15], s38 offen offset:256 lds
    v_mfma_f32_16x16x32_bf16 a[56:59], v[224:227], a[232:235], a[56:59]
    v_mfma_f32_16x16x32_bf16 a[60:63], v[224:227], a[236:239], a[60:63]
    s_waitcnt lgkmcnt(2)
    ds_read_b64_tr_b16 v[224:225], v255 offset:36864
    ds_read_b64_tr_b16 v[226:227], v255 offset:37376
    v_mfma_f32_16x16x32_bf16 v[44:47], v[228:231], a[236:239], v[44:47]
    s_add_u32 m0, s32, 0xae80
    v_mfma_f32_16x16x32_bf16 v[40:43], v[228:231], a[232:235], v[40:43]
    buffer_load_dwordx4 v244, s[12:15], s38 offen offset:384 lds
    v_mfma_f32_16x16x32_bf16 v[36:39], v[228:231], a[228:231], v[36:39]
    s_add_u32 s8, s58, s78
    v_mfma_f32_16x16x32_bf16 v[32:35], v[228:231], a[224:227], v[32:35]
    s_waitcnt lgkmcnt(2)
    s_addc_u32 s9, s59, 0
    ds_read_b64_tr_b16 v[228:229], v255 offset:36872
    ds_read_b64_tr_b16 v[230:231], v255 offset:37384
    v_mfma_f32_16x16x32_bf16 a[80:83], v[232:235], a[224:227], a[80:83]
    s_add_u32 m0, s33, 0x0
    v_mfma_f32_16x16x32_bf16 a[84:87], v[232:235], a[228:231], a[84:87]
    buffer_load_dwordx4 v252, s[8:11], 0 offen lds
    v_mfma_f32_16x16x32_bf16 a[88:91], v[232:235], a[232:235], a[88:91]
    v_mfma_f32_16x16x32_bf16 a[92:95], v[232:235], a[236:239], a[92:95]
    s_waitcnt lgkmcnt(2)
    ds_read_b64_tr_b16 v[232:233], v254 offset:40960
    ds_read_b64_tr_b16 v[234:235], v254 offset:41472
    v_mfma_f32_16x16x32_bf16 v[60:63], v[224:227], a[236:239], v[60:63]
    s_add_u32 m0, s33, 0x400
    v_mfma_f32_16x16x32_bf16 v[56:59], v[224:227], a[232:235], v[56:59]
    buffer_load_dwordx4 v252, s[8:11], s40 offen lds
    v_mfma_f32_16x16x32_bf16 v[52:55], v[224:227], a[228:231], v[52:55]
    v_mfma_f32_16x16x32_bf16 v[48:51], v[224:227], a[224:227], v[48:51]
    s_waitcnt lgkmcnt(2)
    ds_read_b64_tr_b16 v[224:225], v254 offset:40968
    ds_read_b64_tr_b16 v[226:227], v254 offset:41480
    v_mfma_f32_16x16x32_bf16 a[112:115], v[228:231], a[224:227], a[112:115]
    s_add_u32 m0, s33, 0x800
    v_mfma_f32_16x16x32_bf16 a[116:119], v[228:231], a[228:231], a[116:119]
    buffer_load_dwordx4 v252, s[8:11], s41 offen lds
    v_mfma_f32_16x16x32_bf16 a[120:123], v[228:231], a[232:235], a[120:123]
    v_mfma_f32_16x16x32_bf16 a[124:127], v[228:231], a[236:239], a[124:127]
    s_waitcnt lgkmcnt(2)
    ds_read_b64_tr_b16 v[228:229], v255 offset:40960
    ds_read_b64_tr_b16 v[230:231], v255 offset:41472
    v_mfma_f32_16x16x32_bf16 v[76:79], v[232:235], a[236:239], v[76:79]
    s_add_u32 m0, s33, 0xc00
    v_mfma_f32_16x16x32_bf16 v[72:75], v[232:235], a[232:235], v[72:75]
    buffer_load_dwordx4 v252, s[8:11], s42 offen lds
    v_mfma_f32_16x16x32_bf16 v[68:71], v[232:235], a[228:231], v[68:71]
    v_mfma_f32_16x16x32_bf16 v[64:67], v[232:235], a[224:227], v[64:67]
    s_waitcnt lgkmcnt(2)
    ds_read_b64_tr_b16 v[232:233], v255 offset:40968
    ds_read_b64_tr_b16 v[234:235], v255 offset:41480
    v_mfma_f32_16x16x32_bf16 v[128:131], v[224:227], a[224:227], v[128:131]
    s_add_u32 m0, s33, 0x1000
    v_mfma_f32_16x16x32_bf16 v[132:135], v[224:227], a[228:231], v[132:135]
    buffer_load_dwordx4 v252, s[8:11], s43 offen lds
    v_mfma_f32_16x16x32_bf16 v[136:139], v[224:227], a[232:235], v[136:139]
    v_mfma_f32_16x16x32_bf16 v[140:143], v[224:227], a[236:239], v[140:143]
    s_waitcnt lgkmcnt(2)
    ds_read_b64_tr_b16 v[224:225], v254 offset:45056
    ds_read_b64_tr_b16 v[226:227], v254 offset:45568
    v_mfma_f32_16x16x32_bf16 v[92:95], v[228:231], a[236:239], v[92:95]
    s_add_u32 m0, s33, 0x1400
    v_mfma_f32_16x16x32_bf16 v[88:91], v[228:231], a[232:235], v[88:91]
    buffer_load_dwordx4 v252, s[8:11], s44 offen lds
    v_mfma_f32_16x16x32_bf16 v[84:87], v[228:231], a[228:231], v[84:87]
    v_mfma_f32_16x16x32_bf16 v[80:83], v[228:231], a[224:227], v[80:83]
    s_waitcnt lgkmcnt(2)
    ds_read_b64_tr_b16 v[228:229], v254 offset:45064
    ds_read_b64_tr_b16 v[230:231], v254 offset:45576
    v_mfma_f32_16x16x32_bf16 v[144:147], v[232:235], a[224:227], v[144:147]
    s_add_u32 m0, s33, 0x1800
    v_mfma_f32_16x16x32_bf16 v[148:151], v[232:235], a[228:231], v[148:151]
    buffer_load_dwordx4 v252, s[8:11], s45 offen lds
    v_mfma_f32_16x16x32_bf16 v[152:155], v[232:235], a[232:235], v[152:155]
    v_mfma_f32_16x16x32_bf16 v[156:159], v[232:235], a[236:239], v[156:159]
    s_waitcnt lgkmcnt(2)
    ds_read_b64_tr_b16 v[232:233], v255 offset:45056
    ds_read_b64_tr_b16 v[234:235], v255 offset:45568
    v_mfma_f32_16x16x32_bf16 v[108:111], v[224:227], a[236:239], v[108:111]
    s_add_u32 m0, s33, 0x1c00
    v_mfma_f32_16x16x32_bf16 v[104:107], v[224:227], a[232:235], v[104:107]
    buffer_load_dwordx4 v252, s[8:11], s46 offen lds
    v_mfma_f32_16x16x32_bf16 v[100:103], v[224:227], a[228:231], v[100:103]
    v_mfma_f32_16x16x32_bf16 v[96:99], v[224:227], a[224:227], v[96:99]
    s_waitcnt lgkmcnt(2)
    ds_read_b64_tr_b16 v[224:225], v255 offset:45064
    ds_read_b64_tr_b16 v[226:227], v255 offset:45576
    v_mfma_f32_16x16x32_bf16 v[160:163], v[228:231], a[224:227], v[160:163]
    v_mfma_f32_16x16x32_bf16 v[164:167], v[228:231], a[228:231], v[164:167]
    s_waitcnt vmcnt(12)
    s_barrier
    v_mfma_f32_16x16x32_bf16 v[168:171], v[228:231], a[232:235], v[168:171]
    ds_read_b128 a[172:175], v247 offset:38912
    v_mfma_f32_16x16x32_bf16 v[172:175], v[228:231], a[236:239], v[172:175]
    s_waitcnt lgkmcnt(3)
    ds_read_b64_tr_b16 v[228:229], v254 offset:49152
    ds_read_b64_tr_b16 v[230:231], v254 offset:49664
    v_mfma_f32_16x16x32_bf16 v[124:127], v[232:235], a[236:239], v[124:127]
    ds_read_b128 a[168:171], v247 offset:36864
    v_mfma_f32_16x16x32_bf16 v[120:123], v[232:235], a[232:235], v[120:123]
    ds_read_b128 a[164:167], v247 offset:34816
    v_mfma_f32_16x16x32_bf16 v[116:119], v[232:235], a[228:231], v[116:119]
    ds_read_b128 a[160:163], v247 offset:32768
    v_mfma_f32_16x16x32_bf16 v[112:115], v[232:235], a[224:227], v[112:115]
    s_waitcnt lgkmcnt(6)
    ds_read_b64_tr_b16 v[232:233], v254 offset:49160
    ds_read_b64_tr_b16 v[234:235], v254 offset:49672
    v_mfma_f32_16x16x32_bf16 v[176:179], v[224:227], a[224:227], v[176:179]
    ds_read_b128 a[188:191], v248 offset:38912
    v_mfma_f32_16x16x32_bf16 v[180:183], v[224:227], a[228:231], v[180:183]
    ds_read_b128 a[184:187], v248 offset:36864
    v_mfma_f32_16x16x32_bf16 v[184:187], v[224:227], a[232:235], v[184:187]
    ds_read_b128 a[180:183], v248 offset:34816
    v_mfma_f32_16x16x32_bf16 v[188:191], v[224:227], a[236:239], v[188:191]
    s_waitcnt lgkmcnt(8)
    ds_read_b64_tr_b16 v[224:225], v255 offset:49152
    ds_read_b64_tr_b16 v[226:227], v255 offset:49664
    v_mfma_f32_16x16x32_bf16 v[12:15], v[228:231], a[252:255], v[12:15]
    ds_read_b128 a[176:179], v248 offset:32768
    v_mfma_f32_16x16x32_bf16 v[8:11], v[228:231], a[248:251], v[8:11]
    v_mfma_f32_16x16x32_bf16 v[4:7], v[228:231], a[244:247], v[4:7]
    s_lshl_b32 s38, s76, 12
    v_mfma_f32_16x16x32_bf16 v[0:3], v[228:231], a[240:243], v[0:3]
    s_waitcnt lgkmcnt(6)
    s_add_u32 s38, s38, 0x40000
    ds_read_b64_tr_b16 v[228:229], v255 offset:49160
    ds_read_b64_tr_b16 v[230:231], v255 offset:49672
    v_mfma_f32_16x16x32_bf16 v[208:211], v[232:235], a[240:243], v[208:211]
    s_add_u32 m0, s32, 0xc000
    v_mfma_f32_16x16x32_bf16 v[212:215], v[232:235], a[244:247], v[212:215]
    buffer_load_dwordx4 v244, s[12:15], s38 offen lds
    v_mfma_f32_16x16x32_bf16 v[216:219], v[232:235], a[248:251], v[216:219]
    v_mfma_f32_16x16x32_bf16 v[220:223], v[232:235], a[252:255], v[220:223]
    s_waitcnt lgkmcnt(3)
    ds_read_b64_tr_b16 v[232:233], v254 offset:53248
    ds_read_b64_tr_b16 v[234:235], v254 offset:53760
    v_mfma_f32_16x16x32_bf16 v[28:31], v[224:227], a[252:255], v[28:31]
    s_add_u32 m0, s32, 0xcf80
    v_mfma_f32_16x16x32_bf16 v[24:27], v[224:227], a[248:251], v[24:27]
    buffer_load_dwordx4 v244, s[12:15], s38 offen offset:128 lds
    v_mfma_f32_16x16x32_bf16 v[20:23], v[224:227], a[244:247], v[20:23]
    v_mfma_f32_16x16x32_bf16 v[16:19], v[224:227], a[240:243], v[16:19]
    s_waitcnt lgkmcnt(2)
    ds_read_b64_tr_b16 v[224:225], v254 offset:53256
    ds_read_b64_tr_b16 v[226:227], v254 offset:53768
    v_mfma_f32_16x16x32_bf16 a[48:51], v[228:231], a[240:243], a[48:51]
    s_add_u32 m0, s32, 0xdf00
    v_mfma_f32_16x16x32_bf16 a[52:55], v[228:231], a[244:247], a[52:55]
    buffer_load_dwordx4 v244, s[12:15], s38 offen offset:256 lds
    v_mfma_f32_16x16x32_bf16 a[56:59], v[228:231], a[248:251], a[56:59]
    v_mfma_f32_16x16x32_bf16 a[60:63], v[228:231], a[252:255], a[60:63]
    s_waitcnt lgkmcnt(2)
    ds_read_b64_tr_b16 v[228:229], v255 offset:53248
    ds_read_b64_tr_b16 v[230:231], v255 offset:53760
    v_mfma_f32_16x16x32_bf16 v[44:47], v[232:235], a[252:255], v[44:47]
    s_add_u32 m0, s32, 0xee80
    v_mfma_f32_16x16x32_bf16 v[40:43], v[232:235], a[248:251], v[40:43]
    buffer_load_dwordx4 v244, s[12:15], s38 offen offset:384 lds
    v_mfma_f32_16x16x32_bf16 v[36:39], v[232:235], a[244:247], v[36:39]
    s_lshl_b32 s38, s78, 12
    v_mfma_f32_16x16x32_bf16 v[32:35], v[232:235], a[240:243], v[32:35]
    s_waitcnt lgkmcnt(2)
    s_add_u32 s38, s38, 0x40000
    ds_read_b64_tr_b16 v[232:233], v255 offset:53256
    ds_read_b64_tr_b16 v[234:235], v255 offset:53768
    v_mfma_f32_16x16x32_bf16 a[80:83], v[224:227], a[240:243], a[80:83]
    s_add_u32 m0, s32, 0x4000
    v_mfma_f32_16x16x32_bf16 a[84:87], v[224:227], a[244:247], a[84:87]
    buffer_load_dwordx4 v244, s[12:15], s38 offen lds
    v_mfma_f32_16x16x32_bf16 a[88:91], v[224:227], a[248:251], a[88:91]
    v_mfma_f32_16x16x32_bf16 a[92:95], v[224:227], a[252:255], a[92:95]
    s_waitcnt lgkmcnt(2)
    ds_read_b64_tr_b16 v[224:225], v254 offset:57344
    ds_read_b64_tr_b16 v[226:227], v254 offset:57856
    v_mfma_f32_16x16x32_bf16 v[60:63], v[228:231], a[252:255], v[60:63]
    s_add_u32 m0, s32, 0x4f80
    v_mfma_f32_16x16x32_bf16 v[56:59], v[228:231], a[248:251], v[56:59]
    buffer_load_dwordx4 v244, s[12:15], s38 offen offset:128 lds
    v_mfma_f32_16x16x32_bf16 v[52:55], v[228:231], a[244:247], v[52:55]
    v_mfma_f32_16x16x32_bf16 v[48:51], v[228:231], a[240:243], v[48:51]
    s_waitcnt lgkmcnt(2)
    ds_read_b64_tr_b16 v[228:229], v254 offset:57352
    ds_read_b64_tr_b16 v[230:231], v254 offset:57864
    v_mfma_f32_16x16x32_bf16 a[112:115], v[232:235], a[240:243], a[112:115]
    s_add_u32 m0, s32, 0x5f00
    v_mfma_f32_16x16x32_bf16 a[116:119], v[232:235], a[244:247], a[116:119]
    buffer_load_dwordx4 v244, s[12:15], s38 offen offset:256 lds
    v_mfma_f32_16x16x32_bf16 a[120:123], v[232:235], a[248:251], a[120:123]
    v_mfma_f32_16x16x32_bf16 a[124:127], v[232:235], a[252:255], a[124:127]
    s_waitcnt lgkmcnt(2)
    ds_read_b64_tr_b16 v[232:233], v255 offset:57344
    ds_read_b64_tr_b16 v[234:235], v255 offset:57856
    v_mfma_f32_16x16x32_bf16 v[76:79], v[224:227], a[252:255], v[76:79]
    s_add_u32 m0, s32, 0x6e80
    v_mfma_f32_16x16x32_bf16 v[72:75], v[224:227], a[248:251], v[72:75]
    buffer_load_dwordx4 v244, s[12:15], s38 offen offset:384 lds
    v_mfma_f32_16x16x32_bf16 v[68:71], v[224:227], a[244:247], v[68:71]
    v_mfma_f32_16x16x32_bf16 v[64:67], v[224:227], a[240:243], v[64:67]
    s_waitcnt lgkmcnt(2)
    ds_read_b64_tr_b16 v[224:225], v255 offset:57352
    ds_read_b64_tr_b16 v[226:227], v255 offset:57864
    v_mfma_f32_16x16x32_bf16 v[128:131], v[228:231], a[240:243], v[128:131]
    v_mfma_f32_16x16x32_bf16 v[132:135], v[228:231], a[244:247], v[132:135]
    v_mfma_f32_16x16x32_bf16 v[136:139], v[228:231], a[248:251], v[136:139]
    v_mfma_f32_16x16x32_bf16 v[140:143], v[228:231], a[252:255], v[140:143]
    s_waitcnt lgkmcnt(2)
    ds_read_b64_tr_b16 v[228:229], v254 offset:61440
    ds_read_b64_tr_b16 v[230:231], v254 offset:61952
    v_mfma_f32_16x16x32_bf16 v[92:95], v[232:235], a[252:255], v[92:95]
    v_mfma_f32_16x16x32_bf16 v[88:91], v[232:235], a[248:251], v[88:91]
    v_mfma_f32_16x16x32_bf16 v[84:87], v[232:235], a[244:247], v[84:87]
    v_mfma_f32_16x16x32_bf16 v[80:83], v[232:235], a[240:243], v[80:83]
    s_waitcnt lgkmcnt(2)
    ds_read_b64_tr_b16 v[232:233], v254 offset:61448
    ds_read_b64_tr_b16 v[234:235], v254 offset:61960
    v_mfma_f32_16x16x32_bf16 v[144:147], v[224:227], a[240:243], v[144:147]
    v_mfma_f32_16x16x32_bf16 v[148:151], v[224:227], a[244:247], v[148:151]
    v_mfma_f32_16x16x32_bf16 v[152:155], v[224:227], a[248:251], v[152:155]
    v_mfma_f32_16x16x32_bf16 v[156:159], v[224:227], a[252:255], v[156:159]
    s_waitcnt lgkmcnt(2)
    ds_read_b64_tr_b16 v[224:225], v255 offset:61440
    ds_read_b64_tr_b16 v[226:227], v255 offset:61952
    v_mfma_f32_16x16x32_bf16 v[108:111], v[228:231], a[252:255], v[108:111]
    v_mfma_f32_16x16x32_bf16 v[104:107], v[228:231], a[248:251], v[104:107]
    v_mfma_f32_16x16x32_bf16 v[100:103], v[228:231], a[244:247], v[100:103]
    v_mfma_f32_16x16x32_bf16 v[96:99], v[228:231], a[240:243], v[96:99]
    s_waitcnt lgkmcnt(2)
    ds_read_b64_tr_b16 v[228:229], v255 offset:61448
    ds_read_b64_tr_b16 v[230:231], v255 offset:61960
    v_mfma_f32_16x16x32_bf16 v[160:163], v[232:235], a[240:243], v[160:163]
    v_mfma_f32_16x16x32_bf16 v[164:167], v[232:235], a[244:247], v[164:167]
    s_waitcnt vmcnt(8)
    s_barrier
    v_mfma_f32_16x16x32_bf16 v[168:171], v[232:235], a[248:251], v[168:171]
    ds_read_b128 a[204:207], v247 offset:6144
    v_mfma_f32_16x16x32_bf16 v[172:175], v[232:235], a[252:255], v[172:175]
    s_waitcnt lgkmcnt(3)
    ds_read_b64_tr_b16 v[232:233], v249 offset:32768
    ds_read_b64_tr_b16 v[234:235], v249 offset:33280
    v_mfma_f32_16x16x32_bf16 v[124:127], v[224:227], a[252:255], v[124:127]
    ds_read_b128 a[200:203], v247 offset:4096
    v_mfma_f32_16x16x32_bf16 v[120:123], v[224:227], a[248:251], v[120:123]
    ds_read_b128 a[196:199], v247 offset:2048
    v_mfma_f32_16x16x32_bf16 v[116:119], v[224:227], a[244:247], v[116:119]
    ds_read_b128 a[192:195], v247 offset:0
    v_mfma_f32_16x16x32_bf16 v[112:115], v[224:227], a[240:243], v[112:115]
    s_waitcnt lgkmcnt(6)
    ds_read_b64_tr_b16 v[224:225], v249 offset:32776
    ds_read_b64_tr_b16 v[226:227], v249 offset:33288
    v_mfma_f32_16x16x32_bf16 v[176:179], v[228:231], a[240:243], v[176:179]
    ds_read_b128 a[220:223], v248 offset:6144
    v_mfma_f32_16x16x32_bf16 v[180:183], v[228:231], a[244:247], v[180:183]
    ds_read_b128 a[216:219], v248 offset:4096
    v_mfma_f32_16x16x32_bf16 v[184:187], v[228:231], a[248:251], v[184:187]
    ds_read_b128 a[212:215], v248 offset:2048
    v_mfma_f32_16x16x32_bf16 v[188:191], v[228:231], a[252:255], v[188:191]
    s_waitcnt lgkmcnt(8)
    ds_read_b64_tr_b16 v[228:229], v250 offset:32768
    ds_read_b64_tr_b16 v[230:231], v250 offset:33280
    v_mfma_f32_16x16x32_bf16 v[12:15], v[232:235], a[140:143], v[12:15]
    ds_read_b128 a[208:211], v248 offset:0
    v_mfma_f32_16x16x32_bf16 v[8:11], v[232:235], a[136:139], v[8:11]
    v_mfma_f32_16x16x32_bf16 v[4:7], v[232:235], a[132:135], v[4:7]
    v_mfma_f32_16x16x32_bf16 v[0:3], v[232:235], a[128:131], v[0:3]
    s_waitcnt lgkmcnt(6)
    s_lshl_b32 s38, s77, 12
    ds_read_b64_tr_b16 v[232:233], v250 offset:32776
    ds_read_b64_tr_b16 v[234:235], v250 offset:33288
    v_mfma_f32_16x16x32_bf16 v[208:211], v[224:227], a[128:131], v[208:211]
    s_add_u32 m0, s32, 0x20000
    v_mfma_f32_16x16x32_bf16 v[212:215], v[224:227], a[132:135], v[212:215]
    buffer_load_dwordx4 v244, s[12:15], s38 offen lds
    v_mfma_f32_16x16x32_bf16 v[216:219], v[224:227], a[136:139], v[216:219]
    v_mfma_f32_16x16x32_bf16 v[220:223], v[224:227], a[140:143], v[220:223]
    s_waitcnt lgkmcnt(3)
    ds_read_b64_tr_b16 v[224:225], v249 offset:36864
    ds_read_b64_tr_b16 v[226:227], v249 offset:37376
    v_mfma_f32_16x16x32_bf16 v[28:31], v[228:231], a[140:143], v[28:31]
    s_add_u32 m0, s32, 0x20f80
    v_mfma_f32_16x16x32_bf16 v[24:27], v[228:231], a[136:139], v[24:27]
    buffer_load_dwordx4 v244, s[12:15], s38 offen offset:128 lds
    v_mfma_f32_16x16x32_bf16 v[20:23], v[228:231], a[132:135], v[20:23]
    v_mfma_f32_16x16x32_bf16 v[16:19], v[228:231], a[128:131], v[16:19]
    s_waitcnt lgkmcnt(2)
    ds_read_b64_tr_b16 v[228:229], v249 offset:36872
    ds_read_b64_tr_b16 v[230:231], v249 offset:37384
    v_mfma_f32_16x16x32_bf16 a[48:51], v[232:235], a[128:131], a[48:51]
    s_add_u32 m0, s32, 0x21f00
    v_mfma_f32_16x16x32_bf16 a[52:55], v[232:235], a[132:135], a[52:55]
    buffer_load_dwordx4 v244, s[12:15], s38 offen offset:256 lds
    v_mfma_f32_16x16x32_bf16 a[56:59], v[232:235], a[136:139], a[56:59]
    v_mfma_f32_16x16x32_bf16 a[60:63], v[232:235], a[140:143], a[60:63]
    s_waitcnt lgkmcnt(2)
    ds_read_b64_tr_b16 v[232:233], v250 offset:36864
    ds_read_b64_tr_b16 v[234:235], v250 offset:37376
    v_mfma_f32_16x16x32_bf16 v[44:47], v[224:227], a[140:143], v[44:47]
    s_add_u32 m0, s32, 0x22e80
    v_mfma_f32_16x16x32_bf16 v[40:43], v[224:227], a[136:139], v[40:43]
    buffer_load_dwordx4 v244, s[12:15], s38 offen offset:384 lds
    v_mfma_f32_16x16x32_bf16 v[36:39], v[224:227], a[132:135], v[36:39]
    s_lshl_b32 s38, s77, 12
    v_mfma_f32_16x16x32_bf16 v[32:35], v[224:227], a[128:131], v[32:35]
    s_waitcnt lgkmcnt(2)
    s_add_u32 s38, s38, 0x40000
    ds_read_b64_tr_b16 v[224:225], v250 offset:36872
    ds_read_b64_tr_b16 v[226:227], v250 offset:37384
    v_mfma_f32_16x16x32_bf16 a[80:83], v[228:231], a[128:131], a[80:83]
    s_add_u32 m0, s32, 0x18000
    v_mfma_f32_16x16x32_bf16 a[84:87], v[228:231], a[132:135], a[84:87]
    buffer_load_dwordx4 v244, s[12:15], s38 offen lds
    v_mfma_f32_16x16x32_bf16 a[88:91], v[228:231], a[136:139], a[88:91]
    v_mfma_f32_16x16x32_bf16 a[92:95], v[228:231], a[140:143], a[92:95]
    s_waitcnt lgkmcnt(2)
    ds_read_b64_tr_b16 v[228:229], v249 offset:40960
    ds_read_b64_tr_b16 v[230:231], v249 offset:41472
    v_mfma_f32_16x16x32_bf16 v[60:63], v[232:235], a[140:143], v[60:63]
    s_add_u32 m0, s32, 0x18f80
    v_mfma_f32_16x16x32_bf16 v[56:59], v[232:235], a[136:139], v[56:59]
    buffer_load_dwordx4 v244, s[12:15], s38 offen offset:128 lds
    v_mfma_f32_16x16x32_bf16 v[52:55], v[232:235], a[132:135], v[52:55]
    v_mfma_f32_16x16x32_bf16 v[48:51], v[232:235], a[128:131], v[48:51]
    s_waitcnt lgkmcnt(2)
    ds_read_b64_tr_b16 v[232:233], v249 offset:40968
    ds_read_b64_tr_b16 v[234:235], v249 offset:41480
    v_mfma_f32_16x16x32_bf16 a[112:115], v[224:227], a[128:131], a[112:115]
    s_add_u32 m0, s32, 0x19f00
    v_mbcnt_lo_u32_b32 v195, -1, 0
    v_mbcnt_hi_u32_b32 v195, -1, v195
    v_mfma_f32_16x16x32_bf16 a[116:119], v[224:227], a[132:135], a[116:119]
    buffer_load_dwordx4 v244, s[12:15], s38 offen offset:256 lds
    v_lshlrev_b32 v195, 7, v195
    v_mfma_f32_16x16x32_bf16 a[120:123], v[224:227], a[136:139], a[120:123]
    v_mfma_f32_16x16x32_bf16 a[124:127], v[224:227], a[140:143], a[124:127]
    s_waitcnt lgkmcnt(2)
    ds_read_b64_tr_b16 v[224:225], v250 offset:40960
    ds_read_b64_tr_b16 v[226:227], v250 offset:41472
    v_mfma_f32_16x16x32_bf16 v[76:79], v[228:231], a[140:143], v[76:79]
    s_add_u32 m0, s32, 0x1ae80
    v_mfma_f32_16x16x32_bf16 v[72:75], v[228:231], a[136:139], v[72:75]
    buffer_load_dwordx4 v244, s[12:15], s38 offen offset:384 lds
    v_mfma_f32_16x16x32_bf16 v[68:71], v[228:231], a[132:135], v[68:71]
    v_mfma_f32_16x16x32_bf16 v[64:67], v[228:231], a[128:131], v[64:67]
    s_waitcnt lgkmcnt(2)
    s_lshl_b32 s38, s78, 12
    ds_read_b64_tr_b16 v[228:229], v250 offset:40968
    ds_read_b64_tr_b16 v[230:231], v250 offset:41480
    v_mfma_f32_16x16x32_bf16 v[128:131], v[232:235], a[128:131], v[128:131]
    s_add_u32 m0, s32, 0x1c000
    v_mfma_f32_16x16x32_bf16 v[132:135], v[232:235], a[132:135], v[132:135]
    buffer_load_dwordx4 v244, s[12:15], s38 offen lds
    v_mfma_f32_16x16x32_bf16 v[136:139], v[232:235], a[136:139], v[136:139]
    v_mfma_f32_16x16x32_bf16 v[140:143], v[232:235], a[140:143], v[140:143]
    s_waitcnt lgkmcnt(2)
    ds_read_b64_tr_b16 v[232:233], v249 offset:45056
    ds_read_b64_tr_b16 v[234:235], v249 offset:45568
    v_mfma_f32_16x16x32_bf16 v[92:95], v[224:227], a[140:143], v[92:95]
    s_add_u32 m0, s32, 0x1cf80
    v_mfma_f32_16x16x32_bf16 v[88:91], v[224:227], a[136:139], v[88:91]
    buffer_load_dwordx4 v244, s[12:15], s38 offen offset:128 lds
    v_mfma_f32_16x16x32_bf16 v[84:87], v[224:227], a[132:135], v[84:87]
    v_mfma_f32_16x16x32_bf16 v[80:83], v[224:227], a[128:131], v[80:83]
    s_waitcnt lgkmcnt(2)
    ds_read_b64_tr_b16 v[224:225], v249 offset:45064
    ds_read_b64_tr_b16 v[226:227], v249 offset:45576
    v_mfma_f32_16x16x32_bf16 v[144:147], v[228:231], a[128:131], v[144:147]
    s_add_u32 m0, s32, 0x1df00
    v_mfma_f32_16x16x32_bf16 v[148:151], v[228:231], a[132:135], v[148:151]
    buffer_load_dwordx4 v244, s[12:15], s38 offen offset:256 lds
    v_mfma_f32_16x16x32_bf16 v[152:155], v[228:231], a[136:139], v[152:155]
    v_mfma_f32_16x16x32_bf16 v[156:159], v[228:231], a[140:143], v[156:159]
    s_waitcnt lgkmcnt(2)
    ds_read_b64_tr_b16 v[228:229], v250 offset:45056
    ds_read_b64_tr_b16 v[230:231], v250 offset:45568
    v_mfma_f32_16x16x32_bf16 v[108:111], v[232:235], a[140:143], v[108:111]
    s_add_u32 m0, s32, 0x1ee80
    v_mfma_f32_16x16x32_bf16 v[104:107], v[232:235], a[136:139], v[104:107]
    buffer_load_dwordx4 v244, s[12:15], s38 offen offset:384 lds
    v_mfma_f32_16x16x32_bf16 v[100:103], v[232:235], a[132:135], v[100:103]
    s_and_b32 s64, s3, 3
    v_mfma_f32_16x16x32_bf16 v[96:99], v[232:235], a[128:131], v[96:99]
    s_waitcnt lgkmcnt(2)
    s_lshl_b32 s64, s64, 13
    ds_read_b64_tr_b16 v[232:233], v250 offset:45064
    ds_read_b64_tr_b16 v[234:235], v250 offset:45576
    buffer_load_dwordx3 v[196:198], off, s[84:87], 0 sc1
    v_mfma_f32_16x16x32_bf16 v[160:163], v[224:227], a[128:131], v[160:163]
    s_getpc_b64 s[62:63]
    L_pcz:
    v_mfma_f32_16x16x32_bf16 v[164:167], v[224:227], a[132:135], v[164:167]
    s_waitcnt vmcnt(17)
    s_barrier
    s_add_u32 s64, s64, L_pcz-L_pcz
    v_mfma_f32_16x16x32_bf16 v[168:171], v[224:227], a[136:139], v[168:171]
    v_mfma_f32_16x16x32_bf16 v[172:175], v[224:227], a[140:143], v[172:175]
    s_waitcnt lgkmcnt(2)
    ds_read_b64_tr_b16 v[224:225], v249 offset:49152
    ds_read_b64_tr_b16 v[226:227], v249 offset:49664
    v_mfma_f32_16x16x32_bf16 v[124:127], v[228:231], a[140:143], v[124:127]
    v_add_u32 v195, s64, v195
    v_min_u32 v195, L_code_end-L_pcz-4, v195
    v_mfma_f32_16x16x32_bf16 v[120:123], v[228:231], a[136:139], v[120:123]
    v_mfma_f32_16x16x32_bf16 v[116:119], v[228:231], a[132:135], v[116:119]
    global_load_dword v199, v195, s[62:63]
    v_mfma_f32_16x16x32_bf16 v[112:115], v[228:231], a[128:131], v[112:115]
    s_waitcnt lgkmcnt(2)
    ds_read_b64_tr_b16 v[228:229], v249 offset:49160
    ds_read_b64_tr_b16 v[230:231], v249 offset:49672
    v_mfma_f32_16x16x32_bf16 v[176:179], v[232:235], a[128:131], v[176:179]
    v_mfma_f32_16x16x32_bf16 v[180:183], v[232:235], a[132:135], v[180:183]
    v_mfma_f32_16x16x32_bf16 v[184:187], v[232:235], a[136:139], v[184:187]
    v_mfma_f32_16x16x32_bf16 v[188:191], v[232:235], a[140:143], v[188:191]
    s_waitcnt lgkmcnt(2)
    ds_read_b64_tr_b16 v[232:233], v250 offset:49152
    ds_read_b64_tr_b16 v[234:235], v250 offset:49664
    v_mfma_f32_16x16x32_bf16 v[12:15], v[224:227], a[156:159], v[12:15]
    v_mfma_f32_16x16x32_bf16 v[8:11], v[224:227], a[152:155], v[8:11]
    v_mfma_f32_16x16x32_bf16 v[4:7], v[224:227], a[148:151], v[4:7]
    v_mfma_f32_16x16x32_bf16 v[0:3], v[224:227], a[144:147], v[0:3]
    s_waitcnt lgkmcnt(2)
    ds_read_b64_tr_b16 v[224:225], v250 offset:49160
    ds_read_b64_tr_b16 v[226:227], v250 offset:49672
    v_mfma_f32_16x16x32_bf16 v[208:211], v[228:231], a[144:147], v[208:211]
    s_add_u32 m0, s32, 0x24000
    v_mfma_f32_16x16x32_bf16 v[212:215], v[228:231], a[148:151], v[212:215]
    buffer_load_dwordx4 v251, s[16:19], s34 offen nt lds
    v_mfma_f32_16x16x32_bf16 v[216:219], v[228:231], a[152:155], v[216:219]
    v_mfma_f32_16x16x32_bf16 v[220:223], v[228:231], a[156:159], v[220:223]
    s_waitcnt lgkmcnt(2)
    ds_read_b64_tr_b16 v[228:229], v249 offset:53248
    ds_read_b64_tr_b16 v[230:231], v249 offset:53760
    v_mfma_f32_16x16x32_bf16 v[28:31], v[232:235], a[156:159], v[28:31]
    v_mfma_f32_16x16x32_bf16 v[24:27], v[232:235], a[152:155], v[24:27]
    v_mfma_f32_16x16x32_bf16 v[20:23], v[232:235], a[148:151], v[20:23]
    v_mfma_f32_16x16x32_bf16 v[16:19], v[232:235], a[144:147], v[16:19]
    s_waitcnt lgkmcnt(2)
    ds_read_b64_tr_b16 v[232:233], v249 offset:53256
    ds_read_b64_tr_b16 v[234:235], v249 offset:53768
    v_mfma_f32_16x16x32_bf16 a[48:51], v[224:227], a[144:147], a[48:51]
    v_mfma_f32_16x16x32_bf16 a[52:55], v[224:227], a[148:151], a[52:55]
    v_mfma_f32_16x16x32_bf16 a[56:59], v[224:227], a[152:155], a[56:59]
    v_mfma_f32_16x16x32_bf16 a[60:63], v[224:227], a[156:159], a[60:63]
    s_waitcnt lgkmcnt(2)
    ds_read_b64_tr_b16 v[224:225], v250 offset:53248
    ds_read_b64_tr_b16 v[226:227], v250 offset:53760
    v_mfma_f32_16x16x32_bf16 v[44:47], v[228:231], a[156:159], v[44:47]
    s_add_u32 m0, s32, 0x24f80
    v_mfma_f32_16x16x32_bf16 v[40:43], v[228:231], a[152:155], v[40:43]
    buffer_load_dwordx4 v251, s[16:19], s34 offen offset:128 nt lds
    v_mfma_f32_16x16x32_bf16 v[36:39], v[228:231], a[148:151], v[36:39]
    v_mfma_f32_16x16x32_bf16 v[32:35], v[228:231], a[144:147], v[32:35]
    s_waitcnt lgkmcnt(2)
    ds_read_b64_tr_b16 v[228:229], v250 offset:53256
    ds_read_b64_tr_b16 v[230:231], v250 offset:53768
    v_mfma_f32_16x16x32_bf16 a[80:83], v[232:235], a[144:147], a[80:83]
    v_mfma_f32_16x16x32_bf16 a[84:87], v[232:235], a[148:151], a[84:87]
    v_mfma_f32_16x16x32_bf16 a[88:91], v[232:235], a[152:155], a[88:91]
    v_mfma_f32_16x16x32_bf16 a[92:95], v[232:235], a[156:159], a[92:95]
    s_waitcnt lgkmcnt(2)
    ds_read_b64_tr_b16 v[232:233], v249 offset:57344
    ds_read_b64_tr_b16 v[234:235], v249 offset:57856
    v_mfma_f32_16x16x32_bf16 v[60:63], v[224:227], a[156:159], v[60:63]
    v_mfma_f32_16x16x32_bf16 v[56:59], v[224:227], a[152:155], v[56:59]
    v_mfma_f32_16x16x32_bf16 v[52:55], v[224:227], a[148:151], v[52:55]
    v_mfma_f32_16x16x32_bf16 v[48:51], v[224:227], a[144:147], v[48:51]
    s_waitcnt lgkmcnt(2)
    ds_read_b64_tr_b16 v[224:225], v249 offset:57352
    ds_read_b64_tr_b16 v[226:227], v249 offset:57864
    v_mfma_f32_16x16x32_bf16 a[112:115], v[228:231], a[144:147], a[112:115]
    s_add_u32 m0, s32, 0x25f00
    v_mfma_f32_16x16x32_bf16 a[116:119], v[228:231], a[148:151], a[116:119]
    buffer_load_dwordx4 v251, s[16:19], s34 offen offset:256 nt lds
    v_mfma_f32_16x16x32_bf16 a[120:123], v[228:231], a[152:155], a[120:123]
    v_mfma_f32_16x16x32_bf16 a[124:127], v[228:231], a[156:159], a[124:127]
    s_waitcnt lgkmcnt(2)
    ds_read_b64_tr_b16 v[228:229], v250 offset:57344
    ds_read_b64_tr_b16 v[230:231], v250 offset:57856
    v_mfma_f32_16x16x32_bf16 v[76:79], v[232:235], a[156:159], v[76:79]
    v_mfma_f32_16x16x32_bf16 v[72:75], v[232:235], a[152:155], v[72:75]
    v_mfma_f32_16x16x32_bf16 v[68:71], v[232:235], a[148:151], v[68:71]
    v_mfma_f32_16x16x32_bf16 v[64:67], v[232:235], a[144:147], v[64:67]
    s_waitcnt lgkmcnt(2)
    ds_read_b64_tr_b16 v[232:233], v250 offset:57352
    ds_read_b64_tr_b16 v[234:235], v250 offset:57864
    v_mfma_f32_16x16x32_bf16 v[128:131], v[224:227], a[144:147], v[128:131]
    v_mfma_f32_16x16x32_bf16 v[132:135], v[224:227], a[148:151], v[132:135]
    v_mfma_f32_16x16x32_bf16 v[136:139], v[224:227], a[152:155], v[136:139]
    v_mfma_f32_16x16x32_bf16 v[140:143], v[224:227], a[156:159], v[140:143]
    s_waitcnt lgkmcnt(2)
    ds_read_b64_tr_b16 v[224:225], v249 offset:61440
    ds_read_b64_tr_b16 v[226:227], v249 offset:61952
    v_mfma_f32_16x16x32_bf16 v[92:95], v[228:231], a[156:159], v[92:95]
    s_add_u32 m0, s32, 0x26e80
    v_mfma_f32_16x16x32_bf16 v[88:91], v[228:231], a[152:155], v[88:91]
    buffer_load_dwordx4 v251, s[16:19], s34 offen offset:384 nt lds
    v_mfma_f32_16x16x32_bf16 v[84:87], v[228:231], a[148:151], v[84:87]
    s_or_b32 s34, s34, 0x18fff
    v_mfma_f32_16x16x32_bf16 v[80:83], v[228:231], a[144:147], v[80:83]
    s_waitcnt lgkmcnt(2)
    s_add_u32 s34, s34, 1
    ds_read_b64_tr_b16 v[228:229], v249 offset:61448
    ds_read_b64_tr_b16 v[230:231], v249 offset:61960
    v_mfma_f32_16x16x32_bf16 v[144:147], v[232:235], a[144:147], v[144:147]
    s_andn2_b32 s34, s34, 0x18fff
    v_mfma_f32_16x16x32_bf16 v[148:151], v[232:235], a[148:151], v[148:151]
    v_mfma_f32_16x16x32_bf16 v[152:155], v[232:235], a[152:155], v[152:155]
    v_mfma_f32_16x16x32_bf16 v[156:159], v[232:235], a[156:159], v[156:159]
    s_waitcnt lgkmcnt(2)
    ds_read_b64_tr_b16 v[232:233], v250 offset:61440
    ds_read_b64_tr_b16 v[234:235], v250 offset:61952
    v_mfma_f32_16x16x32_bf16 v[108:111], v[224:227], a[156:159], v[108:111]
    v_mfma_f32_16x16x32_bf16 v[104:107], v[224:227], a[152:155], v[104:107]
    v_mfma_f32_16x16x32_bf16 v[100:103], v[224:227], a[148:151], v[100:103]
    v_mfma_f32_16x16x32_bf16 v[96:99], v[224:227], a[144:147], v[96:99]
    s_waitcnt lgkmcnt(2)
    ds_read_b64_tr_b16 v[224:225], v250 offset:61448
    ds_read_b64_tr_b16 v[226:227], v250 offset:61960
    v_mfma_f32_16x16x32_bf16 v[160:163], v[228:231], a[144:147], v[160:163]
    v_mfma_f32_16x16x32_bf16 v[164:167], v[228:231], a[148:151], v[164:167]
    s_waitcnt vmcnt(5)
    s_barrier
    v_mfma_f32_16x16x32_bf16 v[168:171], v[228:231], a[152:155], v[168:171]
    v_readfirstlane_b32 s72, v196
    v_readfirstlane_b32 s73, v197
    v_mfma_f32_16x16x32_bf16 v[172:175], v[228:231], a[156:159], v[172:175]
    s_waitcnt lgkmcnt(2)
    ds_read_b64_tr_b16 v[228:229], v254 offset:32768
    ds_read_b64_tr_b16 v[230:231], v254 offset:33280
    v_mfma_f32_16x16x32_bf16 v[124:127], v[232:235], a[156:159], v[124:127]
    v_readfirstlane_b32 s74, v198
    v_mfma_f32_16x16x32_bf16 v[120:123], v[232:235], a[152:155], v[120:123]
    v_mfma_f32_16x16x32_bf16 v[116:119], v[232:235], a[148:151], v[116:119]
    s_cmp_eq_u32 s73, s79
    s_cselect_b32 s76, 0, -1
    s_cmp_eq_u32 s74, s79
    s_cselect_b32 s76, s76, -1
    v_mfma_f32_16x16x32_bf16 v[112:115], v[232:235], a[144:147], v[112:115]
    s_waitcnt lgkmcnt(2)
    ds_read_b64_tr_b16 v[232:233], v254 offset:0
    ds_read_b64_tr_b16 v[234:235], v254 offset:512
    v_mfma_f32_16x16x32_bf16 v[176:179], v[224:227], a[144:147], v[176:179]
    s_cmp_lg_u32 s72, 0
    s_cselect_b32 s76, s76, -1
    v_mfma_f32_16x16x32_bf16 v[180:183], v[224:227], a[148:151], v[180:183]
    s_cmp_lg_u32 s76, 0
    s_cbranch_scc1 L_mode
L_moder:
    v_mfma_f32_16x16x32_bf16 v[184:187], v[224:227], a[152:155], v[184:187]
    v_mfma_f32_16x16x32_bf16 v[188:191], v[224:227], a[156:159], v[188:191]
    s_waitcnt lgkmcnt(2)
    s_mov_b32 s77, s76
    ds_read_b64_tr_b16 v[224:225], v254 offset:16384
    ds_read_b64_tr_b16 v[226:227], v254 offset:16896
    v_mfma_f32_16x16x32_bf16 v[12:15], v[228:231], a[172:175], v[12:15]
    v_mfma_f32_16x16x32_bf16 v[8:11], v[228:231], a[168:171], v[8:11]
    v_mfma_f32_16x16x32_bf16 v[4:7], v[228:231], a[164:167], v[4:7]
    v_mfma_f32_16x16x32_bf16 v[0:3], v[228:231], a[160:163], v[0:3]
    s_waitcnt lgkmcnt(2)
    ds_read_b64_tr_b16 v[228:229], v249 offset:16384
    ds_read_b64_tr_b16 v[230:231], v249 offset:16896
    v_mfma_f32_16x16x32_bf16 v[0:3], v[232:235], a[176:179], v[0:3]
    s_add_u32 m0, s32, 0x10000
    v_mfma_f32_16x16x32_bf16 v[4:7], v[232:235], a[180:183], v[4:7]
    buffer_load_dwordx4 v251, s[20:23], s35 offen nt lds
    v_mfma_f32_16x16x32_bf16 v[8:11], v[232:235], a[184:187], v[8:11]
    v_mfma_f32_16x16x32_bf16 v[12:15], v[232:235], a[188:191], v[12:15]
    s_waitcnt lgkmcnt(2)
    ds_read_b64_tr_b16 v[232:233], v254 offset:32776
    ds_read_b64_tr_b16 v[234:235], v254 offset:33288
    v_mfma_f32_16x16x32_bf16 v[12:15], v[224:227], a[204:207], v[12:15]
    v_mfma_f32_16x16x32_bf16 v[8:11], v[224:227], a[200:203], v[8:11]
    v_mfma_f32_16x16x32_bf16 v[4:7], v[224:227], a[196:199], v[4:7]
    v_mfma_f32_16x16x32_bf16 v[0:3], v[224:227], a[192:195], v[0:3]
    s_waitcnt lgkmcnt(2)
    ds_read_b64_tr_b16 v[224:225], v254 offset:8
    ds_read_b64_tr_b16 v[226:227], v254 offset:520
    v_mfma_f32_16x16x32_bf16 v[0:3], v[228:231], a[208:211], v[0:3]
    v_mfma_f32_16x16x32_bf16 v[4:7], v[228:231], a[212:215], v[4:7]
    v_mfma_f32_16x16x32_bf16 v[8:11], v[228:231], a[216:219], v[8:11]
    v_mul_f32 v0, s6, v0
    v_mul_f32 v1, s6, v1
    v_mfma_f32_16x16x32_bf16 v[12:15], v[228:231], a[220:223], v[12:15]
    s_waitcnt lgkmcnt(2)
    ds_read_b64_tr_b16 v[228:229], v254 offset:16392
    ds_read_b64_tr_b16 v[230:231], v254 offset:16904
    v_mfma_f32_16x16x32_bf16 v[220:223], v[232:235], a[172:175], v[220:223]
    s_add_u32 m0, s32, 0x10f80
    v_mul_f32 v2, s6, v2
    v_mul_f32 v3, s6, v3
    v_mfma_f32_16x16x32_bf16 v[216:219], v[232:235], a[168:171], v[216:219]
    buffer_load_dwordx4 v251, s[20:23], s35 offen offset:128 nt lds
    v_cvt_pk_bf16_f32 v0, v0, v1
    v_mfma_f32_16x16x32_bf16 v[212:215], v[232:235], a[164:167], v[212:215]
    v_cvt_pk_bf16_f32 v1, v2, v3
    v_mul_f32 v4, s6, v4
    v_mfma_f32_16x16x32_bf16 v[208:211], v[232:235], a[160:163], v[208:211]
    s_waitcnt lgkmcnt(2)
    ds_read_b64_tr_b16 v[232:233], v249 offset:16392
    ds_read_b64_tr_b16 v[234:235], v249 offset:16904
    v_mfma_f32_16x16x32_bf16 v[208:211], v[224:227], a[176:179], v[208:211]
    v_mul_f32 v5, s6, v5
    v_mul_f32 v6, s6, v6
    v_mfma_f32_16x16x32_bf16 v[212:215], v[224:227], a[180:183], v[212:215]
    v_mul_f32 v7, s6, v7
    v_cvt_pk_bf16_f32 v4, v4, v5
    v_mfma_f32_16x16x32_bf16 v[216:219], v[224:227], a[184:187], v[216:219]
    v_cvt_pk_bf16_f32 v5, v6, v7
    v_mul_f32 v8, s6, v8
    v_mfma_f32_16x16x32_bf16 v[220:223], v[224:227], a[188:191], v[220:223]
    s_waitcnt lgkmcnt(2)
    ds_read_b64_tr_b16 v[224:225], v255 offset:32768
    ds_read_b64_tr_b16 v[226:227], v255 offset:33280
    v_mfma_f32_16x16x32_bf16 v[220:223], v[228:231], a[204:207], v[220:223]
    v_mul_f32 v9, s6, v9
    v_mul_f32 v10, s6, v10
    v_mfma_f32_16x16x32_bf16 v[216:219], v[228:231], a[200:203], v[216:219]
    v_mul_f32 v11, s6, v11
    v_cvt_pk_bf16_f32 v8, v8, v9
    v_mfma_f32_16x16x32_bf16 v[212:215], v[228:231], a[196:199], v[212:215]
    v_cvt_pk_bf16_f32 v9, v10, v11
    v_mul_f32 v12, s6, v12
    v_mfma_f32_16x16x32_bf16 v[208:211], v[228:231], a[192:195], v[208:211]
    s_waitcnt lgkmcnt(2)
    ds_read_b64_tr_b16 v[228:229], v255 offset:0
    ds_read_b64_tr_b16 v[230:231], v255 offset:512
    v_mfma_f32_16x16x32_bf16 v[208:211], v[232:235], a[208:211], v[208:211]
    s_add_u32 m0, s32, 0x11f00
    v_mul_f32 v13, s6, v13
    v_mul_f32 v14, s6, v14
    v_mfma_f32_16x16x32_bf16 v[212:215], v[232:235], a[212:215], v[212:215]
    buffer_load_dwordx4 v251, s[20:23], s35 offen offset:256 nt lds
    v_mul_f32 v15, s6, v15
    v_mfma_f32_16x16x32_bf16 v[216:219], v[232:235], a[216:219], v[216:219]
    v_cvt_pk_bf16_f32 v12, v12, v13
    v_cvt_pk_bf16_f32 v13, v14, v15
    v_mfma_f32_16x16x32_bf16 v[220:223], v[232:235], a[220:223], v[220:223]
    s_waitcnt lgkmcnt(2)
    ds_read_b64_tr_b16 v[232:233], v255 offset:16384
    ds_read_b64_tr_b16 v[234:235], v255 offset:16896
    v_mfma_f32_16x16x32_bf16 v[28:31], v[224:227], a[172:175], v[28:31]
    v_mul_f32 v208, s6, v208
    v_mul_f32 v209, s6, v209
    v_mfma_f32_16x16x32_bf16 v[24:27], v[224:227], a[168:171], v[24:27]
    v_mul_f32 v210, s6, v210
    v_mul_f32 v211, s6, v211
    v_mfma_f32_16x16x32_bf16 v[20:23], v[224:227], a[164:167], v[20:23]
    v_cvt_pk_bf16_f32 v2, v208, v209
    v_cvt_pk_bf16_f32 v3, v210, v211
    v_mfma_f32_16x16x32_bf16 v[16:19], v[224:227], a[160:163], v[16:19]
    s_waitcnt lgkmcnt(2)
    ds_read_b64_tr_b16 v[224:225], v250 offset:16384
    ds_read_b64_tr_b16 v[226:227], v250 offset:16896
    v_mfma_f32_16x16x32_bf16 v[16:19], v[228:231], a[176:179], v[16:19]
    v_mul_f32 v212, s6, v212
    v_mul_f32 v213, s6, v213
    v_mfma_f32_16x16x32_bf16 v[20:23], v[228:231], a[180:183], v[20:23]
    v_mul_f32 v214, s6, v214
    v_mul_f32 v215, s6, v215
    v_mfma_f32_16x16x32_bf16 v[24:27], v[228:231], a[184:187], v[24:27]
    v_cvt_pk_bf16_f32 v6, v212, v213
    v_cvt_pk_bf16_f32 v7, v214, v215
    v_mfma_f32_16x16x32_bf16 v[28:31], v[228:231], a[188:191], v[28:31]
    s_waitcnt lgkmcnt(2)
    ds_read_b64_tr_b16 v[228:229], v255 offset:32776
    ds_read_b64_tr_b16 v[230:231], v255 offset:33288
    v_mfma_f32_16x16x32_bf16 v[28:31], v[232:235], a[204:207], v[28:31]
    s_add_u32 m0, s32, 0x12e80
    v_mul_f32 v216, s6, v216
    v_mul_f32 v217, s6, v217
    v_mfma_f32_16x16x32_bf16 v[24:27], v[232:235], a[200:203], v[24:27]
    buffer_load_dwordx4 v251, s[20:23], s35 offen offset:384 nt lds
    v_mul_f32 v218, s6, v218
    v_mfma_f32_16x16x32_bf16 v[20:23], v[232:235], a[196:199], v[20:23]
    s_or_b32 s35, s35, 0x18fff
    v_mul_f32 v219, s6, v219
    v_cvt_pk_bf16_f32 v10, v216, v217
    v_mfma_f32_16x16x32_bf16 v[16:19], v[232:235], a[192:195], v[16:19]
    s_waitcnt lgkmcnt(2)
    s_add_u32 s35, s35, 1
    ds_read_b64_tr_b16 v[232:233], v255 offset:8
    ds_read_b64_tr_b16 v[234:235], v255 offset:520
    v_mfma_f32_16x16x32_bf16 v[16:19], v[224:227], a[208:211], v[16:19]
    s_andn2_b32 s35, s35, 0x18fff
    v_cvt_pk_bf16_f32 v11, v218, v219
    v_mul_f32 v220, s6, v220
    v_mfma_f32_16x16x32_bf16 v[20:23], v[224:227], a[212:215], v[20:23]
    v_mul_f32 v221, s6, v221
    v_mul_f32 v222, s6, v222
    v_mfma_f32_16x16x32_bf16 v[24:27], v[224:227], a[216:219], v[24:27]
    v_mul_f32 v223, s6, v223
    v_cvt_pk_bf16_f32 v14, v220, v221
    v_mfma_f32_16x16x32_bf16 v[28:31], v[224:227], a[220:223], v[28:31]
    s_waitcnt lgkmcnt(2)
    ds_read_b64_tr_b16 v[224:225], v255 offset:16392
    ds_read_b64_tr_b16 v[226:227], v255 offset:16904
    v_mfma_f32_16x16x32_bf16 a[60:63], v[228:231], a[172:175], a[60:63]
    v_cvt_pk_bf16_f32 v15, v222, v223
    v_mul_f32 v16, s6, v16
    v_mfma_f32_16x16x32_bf16 a[56:59], v[228:231], a[168:171], a[56:59]
    v_mul_f32 v17, s6, v17
    v_mul_f32 v18, s6, v18
    v_mfma_f32_16x16x32_bf16 a[52:55], v[228:231], a[164:167], a[52:55]
    v_mul_f32 v19, s6, v19
    v_cvt_pk_bf16_f32 v16, v16, v17
    v_mfma_f32_16x16x32_bf16 a[48:51], v[228:231], a[160:163], a[48:51]
    s_waitcnt lgkmcnt(2)
    ds_read_b64_tr_b16 v[228:229], v250 offset:16392
    ds_read_b64_tr_b16 v[230:231], v250 offset:16904
    v_mfma_f32_16x16x32_bf16 a[48:51], v[232:235], a[176:179], a[48:51]
    v_cvt_pk_bf16_f32 v17, v18, v19
    v_mul_f32 v20, s6, v20
    v_mfma_f32_16x16x32_bf16 a[52:55], v[232:235], a[180:183], a[52:55]
    v_mul_f32 v21, s6, v21
    v_mul_f32 v22, s6, v22
    v_mfma_f32_16x16x32_bf16 a[56:59], v[232:235], a[184:187], a[56:59]
    v_mul_f32 v23, s6, v23
    v_cvt_pk_bf16_f32 v20, v20, v21
    v_mfma_f32_16x16x32_bf16 a[60:63], v[232:235], a[188:191], a[60:63]
    s_waitcnt lgkmcnt(2)
    ds_read_b64_tr_b16 v[232:233], v254 offset:36864
    ds_read_b64_tr_b16 v[234:235], v254 offset:37376
    v_mfma_f32_16x16x32_bf16 a[60:63], v[224:227], a[204:207], a[60:63]
    v_cvt_pk_bf16_f32 v21, v22, v23
    v_mul_f32 v24, s6, v24
    v_mfma_f32_16x16x32_bf16 a[56:59], v[224:227], a[200:203], a[56:59]
    v_mul_f32 v25, s6, v25
    v_mul_f32 v26, s6, v26
    v_mfma_f32_16x16x32_bf16 a[52:55], v[224:227], a[196:199], a[52:55]
    v_mul_f32 v27, s6, v27
    v_cvt_pk_bf16_f32 v24, v24, v25
    v_mfma_f32_16x16x32_bf16 a[48:51], v[224:227], a[192:195], a[48:51]
    s_waitcnt lgkmcnt(2)
    ds_read_b64_tr_b16 v[224:225], v254 offset:4096
    ds_read_b64_tr_b16 v[226:227], v254 offset:4608
    v_mfma_f32_16x16x32_bf16 a[48:51], v[228:231], a[208:211], a[48:51]
    v_cvt_pk_bf16_f32 v25, v26, v27
    v_mul_f32 v28, s6, v28
    v_mfma_f32_16x16x32_bf16 a[52:55], v[228:231], a[212:215], a[52:55]
    v_mul_f32 v29, s6, v29
    v_mul_f32 v30, s6, v30
    v_mfma_f32_16x16x32_bf16 a[56:59], v[228:231], a[216:219], a[56:59]
    v_mul_f32 v31, s6, v31
    v_cvt_pk_bf16_f32 v28, v28, v29
    v_mfma_f32_16x16x32_bf16 a[60:63], v[228:231], a[220:223], a[60:63]
    s_waitcnt lgkmcnt(2)
    ds_read_b64_tr_b16 v[228:229], v254 offset:20480
    ds_read_b64_tr_b16 v[230:231], v254 offset:20992
    v_mfma_f32_16x16x32_bf16 v[44:47], v[232:235], a[172:175], v[44:47]
    v_cvt_pk_bf16_f32 v29, v30, v31
    v_accvgpr_read_b32 v236, a48
    v_mfma_f32_16x16x32_bf16 v[40:43], v[232:235], a[168:171], v[40:43]
    v_accvgpr_read_b32 v237, a49
    v_accvgpr_read_b32 v238, a50
    v_mfma_f32_16x16x32_bf16 v[36:39], v[232:235], a[164:167], v[36:39]
    v_accvgpr_read_b32 v239, a51
    v_mul_f32 v236, s6, v236
    v_mfma_f32_16x16x32_bf16 v[32:35], v[232:235], a[160:163], v[32:35]
    s_waitcnt lgkmcnt(2)
    ds_read_b64_tr_b16 v[232:233], v249 offset:20480
    ds_read_b64_tr_b16 v[234:235], v249 offset:20992
    v_mfma_f32_16x16x32_bf16 v[32:35], v[224:227], a[176:179], v[32:35]
    s_add_u32 m0, s32, 0x8000
    v_mul_f32 v237, s6, v237
    v_mul_f32 v238, s6, v238
    v_mfma_f32_16x16x32_bf16 v[36:39], v[224:227], a[180:183], v[36:39]
    buffer_load_dwordx4 v251, s[16:19], s34 offen nt lds
    v_mul_f32 v239, s6, v239
    v_mfma_f32_16x16x32_bf16 v[40:43], v[224:227], a[184:187], v[40:43]
    v_cvt_pk_bf16_f32 v18, v236, v237
    v_cvt_pk_bf16_f32 v19, v238, v239
    v_mfma_f32_16x16x32_bf16 v[44:47], v[224:227], a[188:191], v[44:47]
    s_waitcnt lgkmcnt(2)
    ds_read_b64_tr_b16 v[224:225], v254 offset:36872
    ds_read_b64_tr_b16 v[226:227], v254 offset:37384
    v_mfma_f32_16x16x32_bf16 v[44:47], v[228:231], a[204:207], v[44:47]
    v_accvgpr_read_b32 v240, a52
    v_accvgpr_read_b32 v241, a53
    v_mfma_f32_16x16x32_bf16 v[40:43], v[228:231], a[200:203], v[40:43]
    v_accvgpr_read_b32 v242, a54
    v_accvgpr_read_b32 v243, a55
    v_mfma_f32_16x16x32_bf16 v[36:39], v[228:231], a[196:199], v[36:39]
    v_mul_f32 v240, s6, v240
    v_mul_f32 v241, s6, v241
    v_mfma_f32_16x16x32_bf16 v[32:35], v[228:231], a[192:195], v[32:35]
    s_waitcnt lgkmcnt(2)
    ds_read_b64_tr_b16 v[228:229], v254 offset:4104
    ds_read_b64_tr_b16 v[230:231], v254 offset:4616
    v_mfma_f32_16x16x32_bf16 v[32:35], v[232:235], a[208:211], v[32:35]
    v_mul_f32 v242, s6, v242
    v_mul_f32 v243, s6, v243
    v_mfma_f32_16x16x32_bf16 v[36:39], v[232:235], a[212:215], v[36:39]
    v_cvt_pk_bf16_f32 v22, v240, v241
    v_cvt_pk_bf16_f32 v23, v242, v243
    v_mfma_f32_16x16x32_bf16 v[40:43], v[232:235], a[216:219], v[40:43]
    v_accvgpr_read_b32 v236, a56
    v_accvgpr_read_b32 v237, a57
    v_mfma_f32_16x16x32_bf16 v[44:47], v[232:235], a[220:223], v[44:47]
    s_waitcnt lgkmcnt(2)
    ds_read_b64_tr_b16 v[232:233], v254 offset:20488
    ds_read_b64_tr_b16 v[234:235], v254 offset:21000
    v_mfma_f32_16x16x32_bf16 a[92:95], v[224:227], a[172:175], a[92:95]
    s_add_u32 m0, s32, 0x8f80
    v_accvgpr_read_b32 v238, a58
    v_accvgpr_read_b32 v239, a59
    v_mfma_f32_16x16x32_bf16 a[88:91], v[224:227], a[168:171], a[88:91]
    buffer_load_dwordx4 v251, s[16:19], s34 offen offset:128 nt lds
    v_mul_f32 v236, s6, v236
    v_mfma_f32_16x16x32_bf16 a[84:87], v[224:227], a[164:167], a[84:87]
    v_mul_f32 v237, s6, v237
    v_mul_f32 v238, s6, v238
    v_mfma_f32_16x16x32_bf16 a[80:83], v[224:227], a[160:163], a[80:83]
    s_waitcnt lgkmcnt(2)
    ds_read_b64_tr_b16 v[224:225], v249 offset:20488
    ds_read_b64_tr_b16 v[226:227], v249 offset:21000
    v_mfma_f32_16x16x32_bf16 a[80:83], v[228:231], a[176:179], a[80:83]
    v_mul_f32 v239, s6, v239
    v_cvt_pk_bf16_f32 v26, v236, v237
    v_mfma_f32_16x16x32_bf16 a[84:87], v[228:231], a[180:183], a[84:87]
    v_cvt_pk_bf16_f32 v27, v238, v239
    v_accvgpr_read_b32 v240, a60
    v_mfma_f32_16x16x32_bf16 a[88:91], v[228:231], a[184:187], a[88:91]
    v_accvgpr_read_b32 v241, a61
    v_accvgpr_read_b32 v242, a62
    v_mfma_f32_16x16x32_bf16 a[92:95], v[228:231], a[188:191], a[92:95]
    s_waitcnt lgkmcnt(2)
    ds_read_b64_tr_b16 v[228:229], v255 offset:36864
    ds_read_b64_tr_b16 v[230:231], v255 offset:37376
    v_mfma_f32_16x16x32_bf16 a[92:95], v[232:235], a[204:207], a[92:95]
    v_accvgpr_read_b32 v243, a63
    v_mul_f32 v240, s6, v240
    v_mfma_f32_16x16x32_bf16 a[88:91], v[232:235], a[200:203], a[88:91]
    v_mul_f32 v241, s6, v241
    v_mul_f32 v242, s6, v242
    v_mfma_f32_16x16x32_bf16 a[84:87], v[232:235], a[196:199], a[84:87]
    v_mul_f32 v243, s6, v243
    v_cvt_pk_bf16_f32 v30, v240, v241
    v_mfma_f32_16x16x32_bf16 a[80:83], v[232:235], a[192:195], a[80:83]
    s_waitcnt lgkmcnt(2)
    ds_read_b64_tr_b16 v[232:233], v255 offset:4096
    ds_read_b64_tr_b16 v[234:235], v255 offset:4608
    v_mfma_f32_16x16x32_bf16 a[80:83], v[224:227], a[208:211], a[80:83]
    s_add_u32 m0, s32, 0x9f00
    v_cvt_pk_bf16_f32 v31, v242, v243
    v_mul_f32 v32, s6, v32
    v_mfma_f32_16x16x32_bf16 a[84:87], v[224:227], a[212:215], a[84:87]
    buffer_load_dwordx4 v251, s[16:19], s34 offen offset:256 nt lds
    v_mul_f32 v33, s6, v33
    v_mfma_f32_16x16x32_bf16 a[88:91], v[224:227], a[216:219], a[88:91]
    v_mul_f32 v34, s6, v34
    v_mul_f32 v35, s6, v35
    v_mfma_f32_16x16x32_bf16 a[92:95], v[224:227], a[220:223], a[92:95]
    s_waitcnt lgkmcnt(2)
    ds_read_b64_tr_b16 v[224:225], v255 offset:20480
    ds_read_b64_tr_b16 v[226:227], v255 offset:20992
    v_mfma_f32_16x16x32_bf16 v[60:63], v[228:231], a[172:175], v[60:63]
    v_cvt_pk_bf16_f32 v32, v32, v33
    v_cvt_pk_bf16_f32 v33, v34, v35
    v_mfma_f32_16x16x32_bf16 v[56:59], v[228:231], a[168:171], v[56:59]
    v_mul_f32 v36, s6, v36
    v_mul_f32 v37, s6, v37
    v_mfma_f32_16x16x32_bf16 v[52:55], v[228:231], a[164:167], v[52:55]
    v_mul_f32 v38, s6, v38
    v_mul_f32 v39, s6, v39
    v_mfma_f32_16x16x32_bf16 v[48:51], v[228:231], a[160:163], v[48:51]
    s_waitcnt lgkmcnt(2)
    ds_read_b64_tr_b16 v[228:229], v250 offset:20480
    ds_read_b64_tr_b16 v[230:231], v250 offset:20992
    v_mfma_f32_16x16x32_bf16 v[48:51], v[232:235], a[176:179], v[48:51]
    v_cvt_pk_bf16_f32 v36, v36, v37
    v_cvt_pk_bf16_f32 v37, v38, v39
    v_mfma_f32_16x16x32_bf16 v[52:55], v[232:235], a[180:183], v[52:55]
    v_mul_f32 v40, s6, v40
    v_mul_f32 v41, s6, v41
    v_mfma_f32_16x16x32_bf16 v[56:59], v[232:235], a[184:187], v[56:59]
    v_mul_f32 v42, s6, v42
    v_mul_f32 v43, s6, v43
    v_mfma_f32_16x16x32_bf16 v[60:63], v[232:235], a[188:191], v[60:63]
    s_waitcnt lgkmcnt(2)
    ds_read_b64_tr_b16 v[232:233], v255 offset:36872
    ds_read_b64_tr_b16 v[234:235], v255 offset:37384
    v_mfma_f32_16x16x32_bf16 v[60:63], v[224:227], a[204:207], v[60:63]
    s_add_u32 m0, s32, 0xae80
    v_cvt_pk_bf16_f32 v40, v40, v41
    v_cvt_pk_bf16_f32 v41, v42, v43
    v_mfma_f32_16x16x32_bf16 v[56:59], v[224:227], a[200:203], v[56:59]
    buffer_load_dwordx4 v251, s[16:19], s34 offen offset:384 nt lds
    v_mul_f32 v44, s6, v44
    v_mfma_f32_16x16x32_bf16 v[52:55], v[224:227], a[196:199], v[52:55]
    s_or_b32 s34, s34, 0x18fff
    v_mul_f32 v45, s6, v45
    v_mul_f32 v46, s6, v46
    v_mfma_f32_16x16x32_bf16 v[48:51], v[224:227], a[192:195], v[48:51]
    s_waitcnt lgkmcnt(2)
    s_add_u32 s34, s34, 1
    ds_read_b64_tr_b16 v[224:225], v255 offset:4104
    ds_read_b64_tr_b16 v[226:227], v255 offset:4616
    v_mfma_f32_16x16x32_bf16 v[48:51], v[228:231], a[208:211], v[48:51]
    s_andn2_b32 s34, s34, 0x18fff
    v_mul_f32 v47, s6, v47
    v_cvt_pk_bf16_f32 v44, v44, v45
    v_mfma_f32_16x16x32_bf16 v[52:55], v[228:231], a[212:215], v[52:55]
    v_cvt_pk_bf16_f32 v45, v46, v47
    v_accvgpr_read_b32 v236, a80
    v_mfma_f32_16x16x32_bf16 v[56:59], v[228:231], a[216:219], v[56:59]
    v_accvgpr_read_b32 v237, a81
    v_accvgpr_read_b32 v238, a82
    v_mfma_f32_16x16x32_bf16 v[60:63], v[228:231], a[220:223], v[60:63]
    s_waitcnt lgkmcnt(2)
    ds_read_b64_tr_b16 v[228:229], v255 offset:20488
    ds_read_b64_tr_b16 v[230:231], v255 offset:21000
    v_mfma_f32_16x16x32_bf16 a[124:127], v[232:235], a[172:175], a[124:127]
    v_accvgpr_read_b32 v239, a83
    v_mul_f32 v236, s6, v236
    v_mfma_f32_16x16x32_bf16 a[120:123], v[232:235], a[168:171], a[120:123]
    v_mul_f32 v237, s6, v237
    v_mul_f32 v238, s6, v238
    v_mfma_f32_16x16x32_bf16 a[116:119], v[232:235], a[164:167], a[116:119]
    v_mul_f32 v239, s6, v239
    v_cvt_pk_bf16_f32 v34, v236, v237
    v_mfma_f32_16x16x32_bf16 a[112:115], v[232:235], a[160:163], a[112:115]
    s_waitcnt lgkmcnt(2)
    ds_read_b64_tr_b16 v[232:233], v250 offset:20488
    ds_read_b64_tr_b16 v[234:235], v250 offset:21000
    v_mfma_f32_16x16x32_bf16 a[112:115], v[224:227], a[176:179], a[112:115]
    v_cvt_pk_bf16_f32 v35, v238, v239
    v_accvgpr_read_b32 v240, a84
    v_mfma_f32_16x16x32_bf16 a[116:119], v[224:227], a[180:183], a[116:119]
    v_accvgpr_read_b32 v241, a85
    v_accvgpr_read_b32 v242, a86
    v_mfma_f32_16x16x32_bf16 a[120:123], v[224:227], a[184:187], a[120:123]
    v_accvgpr_read_b32 v243, a87
    v_mul_f32 v240, s6, v240
    v_mfma_f32_16x16x32_bf16 a[124:127], v[224:227], a[188:191], a[124:127]
    s_waitcnt lgkmcnt(2)
    ds_read_b64_tr_b16 v[224:225], v254 offset:40960
    ds_read_b64_tr_b16 v[226:227], v254 offset:41472
    v_mfma_f32_16x16x32_bf16 a[124:127], v[228:231], a[204:207], a[124:127]
    v_mul_f32 v241, s6, v241
    v_mul_f32 v242, s6, v242
    v_mfma_f32_16x16x32_bf16 a[120:123], v[228:231], a[200:203], a[120:123]
    v_mul_f32 v243, s6, v243
    v_cvt_pk_bf16_f32 v38, v240, v241
    v_mfma_f32_16x16x32_bf16 a[116:119], v[228:231], a[196:199], a[116:119]
    v_cvt_pk_bf16_f32 v39, v242, v243
    v_accvgpr_read_b32 v236, a88
    v_mfma_f32_16x16x32_bf16 a[112:115], v[228:231], a[192:195], a[112:115]
    s_waitcnt lgkmcnt(2)
    ds_read_b64_tr_b16 v[228:229], v254 offset:8192
    ds_read_b64_tr_b16 v[230:231], v254 offset:8704
    v_mfma_f32_16x16x32_bf16 a[112:115], v[232:235], a[208:211], a[112:115]
    v_accvgpr_read_b32 v237, a89
    v_accvgpr_read_b32 v238, a90
    v_mfma_f32_16x16x32_bf16 a[116:119], v[232:235], a[212:215], a[116:119]
    v_accvgpr_read_b32 v239, a91
    v_mul_f32 v236, s6, v236
    v_mfma_f32_16x16x32_bf16 a[120:123], v[232:235], a[216:219], a[120:123]
    v_mul_f32 v237, s6, v237
    v_mul_f32 v238, s6, v238
    v_mfma_f32_16x16x32_bf16 a[124:127], v[232:235], a[220:223], a[124:127]
    s_waitcnt lgkmcnt(2)
    ds_read_b64_tr_b16 v[232:233], v254 offset:24576
    ds_read_b64_tr_b16 v[234:235], v254 offset:25088
    v_mfma_f32_16x16x32_bf16 v[76:79], v[224:227], a[172:175], v[76:79]
    v_mul_f32 v239, s6, v239
    v_cvt_pk_bf16_f32 v42, v236, v237
    v_mfma_f32_16x16x32_bf16 v[72:75], v[224:227], a[168:171], v[72:75]
    v_cvt_pk_bf16_f32 v43, v238, v239
    v_accvgpr_read_b32 v240, a92
    v_mfma_f32_16x16x32_bf16 v[68:71], v[224:227], a[164:167], v[68:71]
    v_accvgpr_read_b32 v241, a93
    v_accvgpr_read_b32 v242, a94
    v_mfma_f32_16x16x32_bf16 v[64:67], v[224:227], a[160:163], v[64:67]
    s_waitcnt lgkmcnt(2)
    ds_read_b64_tr_b16 v[224:225], v249 offset:24576
    ds_read_b64_tr_b16 v[226:227], v249 offset:25088
    v_mfma_f32_16x16x32_bf16 v[64:67], v[228:231], a[176:179], v[64:67]
    s_add_u32 m0, s32, 0x14000
    v_accvgpr_read_b32 v243, a95
    v_mul_f32 v240, s6, v240
    v_mfma_f32_16x16x32_bf16 v[68:71], v[228:231], a[180:183], v[68:71]
    buffer_load_dwordx4 v251, s[20:23], s35 offen nt lds
    v_mul_f32 v241, s6, v241
    v_mfma_f32_16x16x32_bf16 v[72:75], v[228:231], a[184:187], v[72:75]
    v_mul_f32 v242, s6, v242
    v_mul_f32 v243, s6, v243
    v_mfma_f32_16x16x32_bf16 v[76:79], v[228:231], a[188:191], v[76:79]
    s_waitcnt lgkmcnt(2)
    ds_read_b64_tr_b16 v[228:229], v254 offset:40968
    ds_read_b64_tr_b16 v[230:231], v254 offset:41480
    v_mfma_f32_16x16x32_bf16 v[76:79], v[232:235], a[204:207], v[76:79]
    v_cvt_pk_bf16_f32 v46, v240, v241
    v_cvt_pk_bf16_f32 v47, v242, v243
    v_mfma_f32_16x16x32_bf16 v[72:75], v[232:235], a[200:203], v[72:75]
    v_mul_f32 v48, s6, v48
    v_mul_f32 v49, s6, v49
    v_mfma_f32_16x16x32_bf16 v[68:71], v[232:235], a[196:199], v[68:71]
    v_mul_f32 v50, s6, v50
    v_mul_f32 v51, s6, v51
    v_mfma_f32_16x16x32_bf16 v[64:67], v[232:235], a[192:195], v[64:67]
    s_waitcnt lgkmcnt(2)
    ds_read_b64_tr_b16 v[232:233], v254 offset:8200
    ds_read_b64_tr_b16 v[234:235], v254 offset:8712
    v_mfma_f32_16x16x32_bf16 v[64:67], v[224:227], a[208:211], v[64:67]
    s_add_u32 m0, s32, 0x14f80
    v_cvt_pk_bf16_f32 v48, v48, v49
    v_cvt_pk_bf16_f32 v49, v50, v51
    v_mfma_f32_16x16x32_bf16 v[68:71], v[224:227], a[212:215], v[68:71]
    buffer_load_dwordx4 v251, s[20:23], s35 offen offset:128 nt lds
    v_mul_f32 v52, s6, v52
    v_mfma_f32_16x16x32_bf16 v[72:75], v[224:227], a[216:219], v[72:75]
    v_mul_f32 v53, s6, v53
    v_mul_f32 v54, s6, v54
    v_mfma_f32_16x16x32_bf16 v[76:79], v[224:227], a[220:223], v[76:79]
    s_waitcnt lgkmcnt(2)
    ds_read_b64_tr_b16 v[224:225], v254 offset:24584
    ds_read_b64_tr_b16 v[226:227], v254 offset:25096
    v_mfma_f32_16x16x32_bf16 v[140:143], v[228:231], a[172:175], v[140:143]
    v_mul_f32 v55, s6, v55
    v_cvt_pk_bf16_f32 v52, v52, v53
    v_mfma_f32_16x16x32_bf16 v[136:139], v[228:231], a[168:171], v[136:139]
    v_cvt_pk_bf16_f32 v53, v54, v55
    v_mul_f32 v56, s6, v56
    v_mfma_f32_16x16x32_bf16 v[132:135], v[228:231], a[164:167], v[132:135]
    v_mul_f32 v57, s6, v57
    v_mul_f32 v58, s6, v58
    v_mfma_f32_16x16x32_bf16 v[128:131], v[228:231], a[160:163], v[128:131]
    s_waitcnt lgkmcnt(2)
    ds_read_b64_tr_b16 v[228:229], v249 offset:24584
    ds_read_b64_tr_b16 v[230:231], v249 offset:25096
    v_mfma_f32_16x16x32_bf16 v[128:131], v[232:235], a[176:179], v[128:131]
    s_add_u32 m0, s32, 0x15f00
    v_mul_f32 v59, s6, v59
    v_cvt_pk_bf16_f32 v56, v56, v57
    v_mfma_f32_16x16x32_bf16 v[132:135], v[232:235], a[180:183], v[132:135]
    buffer_load_dwordx4 v251, s[20:23], s35 offen offset:256 nt lds
    v_cvt_pk_bf16_f32 v57, v58, v59
    v_mfma_f32_16x16x32_bf16 v[136:139], v[232:235], a[184:187], v[136:139]
    v_mul_f32 v60, s6, v60
    v_mul_f32 v61, s6, v61
    v_mfma_f32_16x16x32_bf16 v[140:143], v[232:235], a[188:191], v[140:143]
    s_waitcnt lgkmcnt(2)
    ds_read_b64_tr_b16 v[232:233], v255 offset:40960
    ds_read_b64_tr_b16 v[234:235], v255 offset:41472
    v_mfma_f32_16x16x32_bf16 v[140:143], v[224:227], a[204:207], v[140:143]
    v_mul_f32 v62, s6, v62
    v_mul_f32 v63, s6, v63
    v_mfma_f32_16x16x32_bf16 v[136:139], v[224:227], a[200:203], v[136:139]
    v_cvt_pk_bf16_f32 v60, v60, v61
    v_cvt_pk_bf16_f32 v61, v62, v63
    v_mfma_f32_16x16x32_bf16 v[132:135], v[224:227], a[196:199], v[132:135]
    v_accvgpr_read_b32 v236, a112
    v_accvgpr_read_b32 v237, a113
    v_mfma_f32_16x16x32_bf16 v[128:131], v[224:227], a[192:195], v[128:131]
    s_waitcnt lgkmcnt(2)
    ds_read_b64_tr_b16 v[224:225], v255 offset:8192
    ds_read_b64_tr_b16 v[226:227], v255 offset:8704
    v_mfma_f32_16x16x32_bf16 v[128:131], v[228:231], a[208:211], v[128:131]
    s_add_u32 m0, s32, 0x16e80
    v_accvgpr_read_b32 v238, a114
    v_accvgpr_read_b32 v239, a115
    v_mfma_f32_16x16x32_bf16 v[132:135], v[228:231], a[212:215], v[132:135]
    s_waitcnt vmcnt(11)
    s_barrier
    buffer_load_dwordx4 v251, s[20:23], s35 offen offset:384 nt lds
    v_mul_f32 v236, s6, v236
    v_mfma_f32_16x16x32_bf16 v[136:139], v[228:231], a[216:219], v[136:139]
    s_or_b32 s35, s35, 0x18fff
    v_mul_f32 v237, s6, v237
    v_mul_f32 v238, s6, v238
    v_mfma_f32_16x16x32_bf16 v[140:143], v[228:231], a[220:223], v[140:143]
    s_waitcnt lgkmcnt(2)
    s_add_u32 s35, s35, 1
    ds_read_b64_tr_b16 v[228:229], v255 offset:24576
    ds_read_b64_tr_b16 v[230:231], v255 offset:25088
    v_mfma_f32_16x16x32_bf16 v[92:95], v[232:235], a[172:175], v[92:95]
    s_andn2_b32 s35, s35, 0x18fff
    v_mul_f32 v239, s6, v239
    v_cvt_pk_bf16_f32 v50, v236, v237
    v_mfma_f32_16x16x32_bf16 v[88:91], v[232:235], a[168:171], v[88:91]
    v_cvt_pk_bf16_f32 v51, v238, v239
    v_accvgpr_read_b32 v240, a116
    v_mfma_f32_16x16x32_bf16 v[84:87], v[232:235], a[164:167], v[84:87]
    v_accvgpr_read_b32 v241, a117
    v_accvgpr_read_b32 v242, a118
    v_mfma_f32_16x16x32_bf16 v[80:83], v[232:235], a[160:163], v[80:83]
    s_waitcnt lgkmcnt(2)
    ds_read_b64_tr_b16 v[232:233], v250 offset:24576
    ds_read_b64_tr_b16 v[234:235], v250 offset:25088
    v_mfma_f32_16x16x32_bf16 v[80:83], v[224:227], a[176:179], v[80:83]
    v_accvgpr_read_b32 v243, a119
    v_mul_f32 v240, s6, v240
    v_mfma_f32_16x16x32_bf16 v[84:87], v[224:227], a[180:183], v[84:87]
    v_mul_f32 v241, s6, v241
    v_mul_f32 v242, s6, v242
    v_mfma_f32_16x16x32_bf16 v[88:91], v[224:227], a[184:187], v[88:91]
    v_mul_f32 v243, s6, v243
    v_cvt_pk_bf16_f32 v54, v240, v241
    v_mfma_f32_16x16x32_bf16 v[92:95], v[224:227], a[188:191], v[92:95]
    s_waitcnt lgkmcnt(2)
    ds_read_b64_tr_b16 v[224:225], v255 offset:40968
    ds_read_b64_tr_b16 v[226:227], v255 offset:41480
    v_mfma_f32_16x16x32_bf16 v[92:95], v[228:231], a[204:207], v[92:95]
    v_cvt_pk_bf16_f32 v55, v242, v243
    v_accvgpr_read_b32 v236, a120
    v_mfma_f32_16x16x32_bf16 v[88:91], v[228:231], a[200:203], v[88:91]
    v_accvgpr_read_b32 v237, a121
    v_accvgpr_read_b32 v238, a122
    v_mfma_f32_16x16x32_bf16 v[84:87], v[228:231], a[196:199], v[84:87]
    v_accvgpr_read_b32 v239, a123
    v_mul_f32 v236, s6, v236
    v_mfma_f32_16x16x32_bf16 v[80:83], v[228:231], a[192:195], v[80:83]
    s_waitcnt lgkmcnt(2)
    ds_read_b64_tr_b16 v[228:229], v255 offset:8200
    ds_read_b64_tr_b16 v[230:231], v255 offset:8712
    v_mfma_f32_16x16x32_bf16 v[80:83], v[232:235], a[208:211], v[80:83]
    v_mul_f32 v237, s6, v237
    v_mul_f32 v238, s6, v238
    v_mfma_f32_16x16x32_bf16 v[84:87], v[232:235], a[212:215], v[84:87]
    v_mul_f32 v239, s6, v239
    v_cvt_pk_bf16_f32 v58, v236, v237
    v_mfma_f32_16x16x32_bf16 v[88:91], v[232:235], a[216:219], v[88:91]
    v_cvt_pk_bf16_f32 v59, v238, v239
    v_accvgpr_read_b32 v240, a124
    v_mfma_f32_16x16x32_bf16 v[92:95], v[232:235], a[220:223], v[92:95]
    s_waitcnt lgkmcnt(2)
    ds_read_b64_tr_b16 v[232:233], v255 offset:24584
    ds_read_b64_tr_b16 v[234:235], v255 offset:25096
    v_mfma_f32_16x16x32_bf16 v[156:159], v[224:227], a[172:175], v[156:159]
    v_accvgpr_read_b32 v241, a125
    v_accvgpr_read_b32 v242, a126
    v_mfma_f32_16x16x32_bf16 v[152:155], v[224:227], a[168:171], v[152:155]
    v_accvgpr_read_b32 v243, a127
    v_mul_f32 v240, s6, v240
    v_mfma_f32_16x16x32_bf16 v[148:151], v[224:227], a[164:167], v[148:151]
    v_mul_f32 v241, s6, v241
    v_mul_f32 v242, s6, v242
    v_mfma_f32_16x16x32_bf16 v[144:147], v[224:227], a[160:163], v[144:147]
    s_waitcnt lgkmcnt(2)
    ds_read_b64_tr_b16 v[224:225], v250 offset:24584
    ds_read_b64_tr_b16 v[226:227], v250 offset:25096
    v_mfma_f32_16x16x32_bf16 v[144:147], v[228:231], a[176:179], v[144:147]
    v_mul_f32 v243, s6, v243
    v_cvt_pk_bf16_f32 v62, v240, v241
    v_mfma_f32_16x16x32_bf16 v[148:151], v[228:231], a[180:183], v[148:151]
    v_cvt_pk_bf16_f32 v63, v242, v243
    v_mul_f32 v64, s6, v64
    v_mfma_f32_16x16x32_bf16 v[152:155], v[228:231], a[184:187], v[152:155]
    v_mul_f32 v65, s6, v65
    v_mul_f32 v66, s6, v66
    v_mfma_f32_16x16x32_bf16 v[156:159], v[228:231], a[188:191], v[156:159]
    s_waitcnt lgkmcnt(2)
    ds_read_b64_tr_b16 v[228:229], v254 offset:45056
    ds_read_b64_tr_b16 v[230:231], v254 offset:45568
    v_mfma_f32_16x16x32_bf16 v[156:159], v[232:235], a[204:207], v[156:159]
    v_mul_f32 v67, s6, v67
    v_cvt_pk_bf16_f32 v64, v64, v65
    v_mfma_f32_16x16x32_bf16 v[152:155], v[232:235], a[200:203], v[152:155]
    v_cvt_pk_bf16_f32 v65, v66, v67
    v_mul_f32 v68, s6, v68
    v_mfma_f32_16x16x32_bf16 v[148:151], v[232:235], a[196:199], v[148:151]
    v_mul_f32 v69, s6, v69
    v_mul_f32 v70, s6, v70
    v_mfma_f32_16x16x32_bf16 v[144:147], v[232:235], a[192:195], v[144:147]
    s_waitcnt lgkmcnt(2)
    ds_read_b64_tr_b16 v[232:233], v254 offset:12288
    ds_read_b64_tr_b16 v[234:235], v254 offset:12800
    v_mfma_f32_16x16x32_bf16 v[144:147], v[224:227], a[208:211], v[144:147]
    v_mul_f32 v71, s6, v71
    v_cvt_pk_bf16_f32 v68, v68, v69
    v_mfma_f32_16x16x32_bf16 v[148:151], v[224:227], a[212:215], v[148:151]
    v_cvt_pk_bf16_f32 v69, v70, v71
    v_mul_f32 v72, s6, v72
    v_mfma_f32_16x16x32_bf16 v[152:155], v[224:227], a[216:219], v[152:155]
    v_mul_f32 v73, s6, v73
    v_mul_f32 v74, s6, v74
    v_mfma_f32_16x16x32_bf16 v[156:159], v[224:227], a[220:223], v[156:159]
    s_waitcnt lgkmcnt(2)
    ds_read_b64_tr_b16 v[224:225], v254 offset:28672
    ds_read_b64_tr_b16 v[226:227], v254 offset:29184
    v_mfma_f32_16x16x32_bf16 v[108:111], v[228:231], a[172:175], v[108:111]
    v_mul_f32 v75, s6, v75
    v_cvt_pk_bf16_f32 v72, v72, v73
    v_mfma_f32_16x16x32_bf16 v[104:107], v[228:231], a[168:171], v[104:107]
    v_cvt_pk_bf16_f32 v73, v74, v75
    v_mul_f32 v76, s6, v76
    v_mfma_f32_16x16x32_bf16 v[100:103], v[228:231], a[164:167], v[100:103]
    v_mul_f32 v77, s6, v77
    v_mul_f32 v78, s6, v78
    v_mfma_f32_16x16x32_bf16 v[96:99], v[228:231], a[160:163], v[96:99]
    s_waitcnt lgkmcnt(2)
    ds_read_b64_tr_b16 v[228:229], v249 offset:28672
    ds_read_b64_tr_b16 v[230:231], v249 offset:29184
    v_mfma_f32_16x16x32_bf16 v[96:99], v[232:235], a[176:179], v[96:99]
    s_add_u32 m0, s32, 0xc000
    v_mul_f32 v79, s6, v79
    v_cvt_pk_bf16_f32 v76, v76, v77
    v_mfma_f32_16x16x32_bf16 v[100:103], v[232:235], a[180:183], v[100:103]
    buffer_load_dwordx4 v251, s[16:19], s34 offen nt lds
    v_cvt_pk_bf16_f32 v77, v78, v79
    v_mfma_f32_16x16x32_bf16 v[104:107], v[232:235], a[184:187], v[104:107]
    v_mul_f32 v128, s6, v128
    v_mul_f32 v129, s6, v129
    v_mfma_f32_16x16x32_bf16 v[108:111], v[232:235], a[188:191], v[108:111]
    s_waitcnt lgkmcnt(2)
    ds_read_b64_tr_b16 v[232:233], v254 offset:45064
    ds_read_b64_tr_b16 v[234:235], v254 offset:45576
    v_mfma_f32_16x16x32_bf16 v[108:111], v[224:227], a[204:207], v[108:111]
    v_mul_f32 v130, s6, v130
    v_mul_f32 v131, s6, v131
    v_mfma_f32_16x16x32_bf16 v[104:107], v[224:227], a[200:203], v[104:107]
    v_cvt_pk_bf16_f32 v66, v128, v129
    v_cvt_pk_bf16_f32 v67, v130, v131
    v_mfma_f32_16x16x32_bf16 v[100:103], v[224:227], a[196:199], v[100:103]
    v_mul_f32 v132, s6, v132
    v_mul_f32 v133, s6, v133
    v_mfma_f32_16x16x32_bf16 v[96:99], v[224:227], a[192:195], v[96:99]
    s_waitcnt lgkmcnt(2)
    ds_read_b64_tr_b16 v[224:225], v254 offset:12296
    ds_read_b64_tr_b16 v[226:227], v254 offset:12808
    v_mfma_f32_16x16x32_bf16 v[96:99], v[228:231], a[208:211], v[96:99]
    v_mul_f32 v134, s6, v134
    v_mul_f32 v135, s6, v135
    v_mfma_f32_16x16x32_bf16 v[100:103], v[228:231], a[212:215], v[100:103]
    v_cvt_pk_bf16_f32 v70, v132, v133
    v_cvt_pk_bf16_f32 v71, v134, v135
    v_mfma_f32_16x16x32_bf16 v[104:107], v[228:231], a[216:219], v[104:107]
    v_mul_f32 v136, s6, v136
    v_mul_f32 v137, s6, v137
    v_mfma_f32_16x16x32_bf16 v[108:111], v[228:231], a[220:223], v[108:111]
    s_waitcnt lgkmcnt(2)
    ds_read_b64_tr_b16 v[228:229], v254 offset:28680
    ds_read_b64_tr_b16 v[230:231], v254 offset:29192
    v_mfma_f32_16x16x32_bf16 v[172:175], v[232:235], a[172:175], v[172:175]
    s_add_u32 m0, s32, 0xcf80
    v_mul_f32 v138, s6, v138
    v_mul_f32 v139, s6, v139
    v_mfma_f32_16x16x32_bf16 v[168:171], v[232:235], a[168:171], v[168:171]
    buffer_load_dwordx4 v251, s[16:19], s34 offen offset:128 nt lds
    v_cvt_pk_bf16_f32 v74, v136, v137
    v_mfma_f32_16x16x32_bf16 v[164:167], v[232:235], a[164:167], v[164:167]
    v_cvt_pk_bf16_f32 v75, v138, v139
    v_mul_f32 v140, s6, v140
    v_mfma_f32_16x16x32_bf16 v[160:163], v[232:235], a[160:163], v[160:163]
    s_waitcnt lgkmcnt(2)
    ds_read_b64_tr_b16 v[232:233], v249 offset:28680
    ds_read_b64_tr_b16 v[234:235], v249 offset:29192
    v_mfma_f32_16x16x32_bf16 v[160:163], v[224:227], a[176:179], v[160:163]
    v_mul_f32 v141, s6, v141
    v_mul_f32 v142, s6, v142
    v_mfma_f32_16x16x32_bf16 v[164:167], v[224:227], a[180:183], v[164:167]
    v_mul_f32 v143, s6, v143
    v_cvt_pk_bf16_f32 v78, v140, v141
    v_mfma_f32_16x16x32_bf16 v[168:171], v[224:227], a[184:187], v[168:171]
    v_cvt_pk_bf16_f32 v79, v142, v143
    v_mul_f32 v80, s6, v80
    v_mfma_f32_16x16x32_bf16 v[172:175], v[224:227], a[188:191], v[172:175]
    s_waitcnt lgkmcnt(2)
    ds_read_b64_tr_b16 v[224:225], v255 offset:45056
    ds_read_b64_tr_b16 v[226:227], v255 offset:45568
    v_mfma_f32_16x16x32_bf16 v[172:175], v[228:231], a[204:207], v[172:175]
    v_mul_f32 v81, s6, v81
    v_mul_f32 v82, s6, v82
    v_mfma_f32_16x16x32_bf16 v[168:171], v[228:231], a[200:203], v[168:171]
    v_mul_f32 v83, s6, v83
    v_cvt_pk_bf16_f32 v80, v80, v81
    v_mfma_f32_16x16x32_bf16 v[164:167], v[228:231], a[196:199], v[164:167]
    v_cvt_pk_bf16_f32 v81, v82, v83
    v_mul_f32 v84, s6, v84
    v_mfma_f32_16x16x32_bf16 v[160:163], v[228:231], a[192:195], v[160:163]
    s_waitcnt lgkmcnt(2)
    ds_read_b64_tr_b16 v[228:229], v255 offset:12288
    ds_read_b64_tr_b16 v[230:231], v255 offset:12800
    v_mfma_f32_16x16x32_bf16 v[160:163], v[232:235], a[208:211], v[160:163]
    s_add_u32 m0, s32, 0xdf00
    v_mul_f32 v85, s6, v85
    v_mul_f32 v86, s6, v86
    v_mfma_f32_16x16x32_bf16 v[164:167], v[232:235], a[212:215], v[164:167]
    buffer_load_dwordx4 v251, s[16:19], s34 offen offset:256 nt lds
    v_mul_f32 v87, s6, v87
    v_mfma_f32_16x16x32_bf16 v[168:171], v[232:235], a[216:219], v[168:171]
    v_cvt_pk_bf16_f32 v84, v84, v85
    v_cvt_pk_bf16_f32 v85, v86, v87
    v_mfma_f32_16x16x32_bf16 v[172:175], v[232:235], a[220:223], v[172:175]
    s_waitcnt lgkmcnt(2)
    ds_read_b64_tr_b16 v[232:233], v255 offset:28672
    ds_read_b64_tr_b16 v[234:235], v255 offset:29184
    v_mfma_f32_16x16x32_bf16 v[124:127], v[224:227], a[172:175], v[124:127]
    v_mul_f32 v88, s6, v88
    v_mul_f32 v89, s6, v89
    v_mfma_f32_16x16x32_bf16 v[120:123], v[224:227], a[168:171], v[120:123]
    v_mul_f32 v90, s6, v90
    v_mul_f32 v91, s6, v91
    v_mfma_f32_16x16x32_bf16 v[116:119], v[224:227], a[164:167], v[116:119]
    v_cvt_pk_bf16_f32 v88, v88, v89
    v_cvt_pk_bf16_f32 v89, v90, v91
    v_mfma_f32_16x16x32_bf16 v[112:115], v[224:227], a[160:163], v[112:115]
    s_waitcnt lgkmcnt(2)
    ds_read_b64_tr_b16 v[224:225], v250 offset:28672
    ds_read_b64_tr_b16 v[226:227], v250 offset:29184
    v_mfma_f32_16x16x32_bf16 v[112:115], v[228:231], a[176:179], v[112:115]
    v_mul_f32 v92, s6, v92
    v_mul_f32 v93, s6, v93
    v_mfma_f32_16x16x32_bf16 v[116:119], v[228:231], a[180:183], v[116:119]
    v_mul_f32 v94, s6, v94
    v_mul_f32 v95, s6, v95
    v_mfma_f32_16x16x32_bf16 v[120:123], v[228:231], a[184:187], v[120:123]
    v_cvt_pk_bf16_f32 v92, v92, v93
    v_cvt_pk_bf16_f32 v93, v94, v95
    v_mfma_f32_16x16x32_bf16 v[124:127], v[228:231], a[188:191], v[124:127]
    s_waitcnt lgkmcnt(2)
    ds_read_b64_tr_b16 v[228:229], v255 offset:45064
    ds_read_b64_tr_b16 v[230:231], v255 offset:45576
    v_mfma_f32_16x16x32_bf16 v[124:127], v[232:235], a[204:207], v[124:127]
    s_add_u32 m0, s32, 0xee80
    v_mul_f32 v144, s6, v144
    v_mul_f32 v145, s6, v145
    v_mfma_f32_16x16x32_bf16 v[120:123], v[232:235], a[200:203], v[120:123]
    buffer_load_dwordx4 v251, s[16:19], s34 offen offset:384 nt lds
    v_mul_f32 v146, s6, v146
    v_mfma_f32_16x16x32_bf16 v[116:119], v[232:235], a[196:199], v[116:119]
    s_or_b32 s34, s34, 0x18fff
    v_mul_f32 v147, s6, v147
    v_cvt_pk_bf16_f32 v82, v144, v145
    v_mfma_f32_16x16x32_bf16 v[112:115], v[232:235], a[192:195], v[112:115]
    s_waitcnt lgkmcnt(2)
    s_add_u32 s34, s34, 1
    ds_read_b64_tr_b16 v[232:233], v255 offset:12296
    ds_read_b64_tr_b16 v[234:235], v255 offset:12808
    v_mfma_f32_16x16x32_bf16 v[112:115], v[224:227], a[208:211], v[112:115]
    s_andn2_b32 s34, s34, 0x18fff
    v_cvt_pk_bf16_f32 v83, v146, v147
    v_mul_f32 v148, s6, v148
    v_mfma_f32_16x16x32_bf16 v[116:119], v[224:227], a[212:215], v[116:119]
    v_mul_f32 v149, s6, v149
    v_mul_f32 v150, s6, v150
    v_mfma_f32_16x16x32_bf16 v[120:123], v[224:227], a[216:219], v[120:123]
    v_mul_f32 v151, s6, v151
    v_cvt_pk_bf16_f32 v86, v148, v149
    v_mfma_f32_16x16x32_bf16 v[124:127], v[224:227], a[220:223], v[124:127]
    s_waitcnt lgkmcnt(2)
    ds_read_b64_tr_b16 v[224:225], v255 offset:28680
    ds_read_b64_tr_b16 v[226:227], v255 offset:29192
    v_mfma_f32_16x16x32_bf16 v[188:191], v[228:231], a[172:175], v[188:191]
    v_cvt_pk_bf16_f32 v87, v150, v151
    v_mul_f32 v152, s6, v152
    v_mfma_f32_16x16x32_bf16 v[184:187], v[228:231], a[168:171], v[184:187]
    v_mul_f32 v153, s6, v153
    v_mul_f32 v154, s6, v154
    v_mfma_f32_16x16x32_bf16 v[180:183], v[228:231], a[164:167], v[180:183]
    v_mul_f32 v155, s6, v155
    v_cvt_pk_bf16_f32 v90, v152, v153
    v_mfma_f32_16x16x32_bf16 v[176:179], v[228:231], a[160:163], v[176:179]
    s_waitcnt lgkmcnt(2)
    ds_read_b64_tr_b16 v[228:229], v250 offset:28680
    ds_read_b64_tr_b16 v[230:231], v250 offset:29192
    v_mfma_f32_16x16x32_bf16 v[176:179], v[232:235], a[176:179], v[176:179]
    ds_read_b128 v[192:195], v245 offset:0
    v_cvt_pk_bf16_f32 v91, v154, v155
    v_mfma_f32_16x16x32_bf16 v[180:183], v[232:235], a[180:183], v[180:183]
    ds_read_b128 v[196:199], v246 offset:0
    v_mul_f32 v156, s6, v156
    v_mfma_f32_16x16x32_bf16 v[184:187], v[232:235], a[184:187], v[184:187]
    ds_read_b128 v[200:203], v245 offset:4096
    v_mul_f32 v157, s6, v157
    v_mfma_f32_16x16x32_bf16 v[188:191], v[232:235], a[188:191], v[188:191]
    s_waitcnt lgkmcnt(5)
    ds_read_b128 v[204:207], v246 offset:4096
    v_mul_f32 v158, s6, v158
    v_mfma_f32_16x16x32_bf16 v[188:191], v[224:227], a[204:207], v[188:191]
    ds_read_b128 v[208:211], v245 offset:8192
    v_mul_f32 v159, s6, v159
    v_mfma_f32_16x16x32_bf16 v[184:187], v[224:227], a[200:203], v[184:187]
    ds_read_b128 v[212:215], v246 offset:8192
    v_cvt_pk_bf16_f32 v94, v156, v157
    v_mfma_f32_16x16x32_bf16 v[180:183], v[224:227], a[196:199], v[180:183]
    ds_read_b128 v[216:219], v245 offset:12288
    v_cvt_pk_bf16_f32 v95, v158, v159
    v_mfma_f32_16x16x32_bf16 v[176:179], v[224:227], a[192:195], v[176:179]
    s_waitcnt lgkmcnt(7)
    ds_read_b128 v[220:223], v246 offset:12288
    v_mul_f32 v96, s6, v96
    v_mfma_f32_16x16x32_bf16 v[176:179], v[228:231], a[208:211], v[176:179]
    v_mul_f32 v97, s6, v97
    v_mul_f32 v98, s6, v98
    v_mfma_f32_16x16x32_bf16 v[180:183], v[228:231], a[212:215], v[180:183]
    v_mul_f32 v99, s6, v99
    v_cvt_pk_bf16_f32 v96, v96, v97
    v_mfma_f32_16x16x32_bf16 v[184:187], v[228:231], a[216:219], v[184:187]
    v_cvt_pk_bf16_f32 v97, v98, v99
    v_mul_f32 v100, s6, v100
    v_mfma_f32_16x16x32_bf16 v[188:191], v[228:231], a[220:223], v[188:191]
    s_waitcnt lgkmcnt(7)
    v_mul_f32 v101, s6, v101
    v_mul_f32 v102, s6, v102
    v_mfma_f32_16x16x32_bf16 v[128:131], v[192:195], v[0:3], 0
    s_waitcnt lgkmcnt(6)
    ds_read_b128 v[224:227], v245 offset:2048
    v_mul_f32 v103, s6, v103
    v_mfma_f32_16x16x32_bf16 v[128:131], v[196:199], v[16:19], v[128:131]
    s_waitcnt lgkmcnt(6)
    ds_read_b128 v[228:231], v246 offset:2048
    v_cvt_pk_bf16_f32 v100, v100, v101
    v_mfma_f32_16x16x32_bf16 v[128:131], v[200:203], v[32:35], v[128:131]
    s_waitcnt lgkmcnt(6)
    v_cvt_pk_bf16_f32 v101, v102, v103
    v_mul_f32 v104, s6, v104
    v_mfma_f32_16x16x32_bf16 v[128:131], v[204:207], v[48:51], v[128:131]
    s_waitcnt lgkmcnt(5)
    s_mov_b32 s40, 0x7000
    v_mul_f32 v105, s6, v105
    v_mul_f32 v106, s6, v106
    v_mfma_f32_16x16x32_bf16 v[128:131], v[208:211], v[64:67], v[128:131]
    s_waitcnt lgkmcnt(4)
    s_mov_b32 s41, 0xe000
    v_mul_f32 v107, s6, v107
    v_cvt_pk_bf16_f32 v104, v104, v105
    v_cvt_pk_bf16_f32 v105, v106, v107
    v_mul_f32 v108, s6, v108
    v_mul_f32 v109, s6, v109
    v_mul_f32 v110, s6, v110
    v_mul_f32 v111, s6, v111
    v_cvt_pk_bf16_f32 v108, v108, v109
    v_cvt_pk_bf16_f32 v109, v110, v111
    v_mul_f32 v160, s6, v160
    v_mul_f32 v161, s6, v161
    v_mul_f32 v162, s6, v162
    v_mul_f32 v163, s6, v163
    v_cvt_pk_bf16_f32 v98, v160, v161
    v_cvt_pk_bf16_f32 v99, v162, v163
    v_mfma_f32_16x16x32_bf16 v[128:131], v[212:215], v[80:83], v[128:131]
    s_waitcnt lgkmcnt(3)
    s_mov_b32 s42, 0x15000
    v_mul_f32 v164, s6, v164
    v_mul_f32 v165, s6, v165
    v_mul_f32 v166, s6, v166
    v_mul_f32 v167, s6, v167
    v_cvt_pk_bf16_f32 v102, v164, v165
    v_cvt_pk_bf16_f32 v103, v166, v167
    v_mul_f32 v168, s6, v168
    v_mul_f32 v169, s6, v169
    v_mul_f32 v170, s6, v170
    v_mul_f32 v171, s6, v171
    v_cvt_pk_bf16_f32 v106, v168, v169
    v_cvt_pk_bf16_f32 v107, v170, v171
    v_mul_f32 v172, s6, v172
    v_mul_f32 v173, s6, v173
    v_mul_f32 v174, s6, v174
    v_mul_f32 v175, s6, v175
    v_cvt_pk_bf16_f32 v110, v172, v173
    v_cvt_pk_bf16_f32 v111, v174, v175
    v_mul_f32 v112, s6, v112
    v_mul_f32 v113, s6, v113
    v_mul_f32 v114, s6, v114
    v_mul_f32 v115, s6, v115
    v_cvt_pk_bf16_f32 v112, v112, v113
    v_cvt_pk_bf16_f32 v113, v114, v115
    v_mul_f32 v116, s6, v116
    v_mul_f32 v117, s6, v117
    v_mul_f32 v118, s6, v118
    v_mul_f32 v119, s6, v119
    v_cvt_pk_bf16_f32 v116, v116, v117
    v_cvt_pk_bf16_f32 v117, v118, v119
    v_mul_f32 v120, s6, v120
    v_mul_f32 v121, s6, v121
    v_mul_f32 v122, s6, v122
    v_mul_f32 v123, s6, v123
    v_cvt_pk_bf16_f32 v120, v120, v121
    v_cvt_pk_bf16_f32 v121, v122, v123
    v_mul_f32 v124, s6, v124
    v_mul_f32 v125, s6, v125
    v_mul_f32 v126, s6, v126
    v_mul_f32 v127, s6, v127
    v_cvt_pk_bf16_f32 v124, v124, v125
    v_cvt_pk_bf16_f32 v125, v126, v127
    v_mul_f32 v176, s6, v176
    v_mul_f32 v177, s6, v177
    v_mul_f32 v178, s6, v178
    v_mul_f32 v179, s6, v179
    v_cvt_pk_bf16_f32 v114, v176, v177
    v_cvt_pk_bf16_f32 v115, v178, v179
    v_mfma_f32_16x16x32_bf16 v[128:131], v[216:219], v[96:99], v[128:131]
    s_waitcnt lgkmcnt(2)
    s_mov_b32 s43, 0x1c000
    v_mul_f32 v180, s6, v180
    v_mul_f32 v181, s6, v181
    v_mfma_f32_16x16x32_bf16 v[128:131], v[220:223], v[112:115], v[128:131]
    s_mov_b32 s44, 0x23000
    v_mul_f32 v182, s6, v182
    v_mul_f32 v183, s6, v183
    v_mfma_f32_16x16x32_bf16 v[132:135], v[192:195], v[4:7], 0
    s_mov_b32 s45, 0x2a000
    v_cvt_pk_bf16_f32 v118, v180, v181
    v_cvt_pk_bf16_f32 v119, v182, v183
    v_mfma_f32_16x16x32_bf16 v[132:135], v[196:199], v[20:23], v[132:135]
    s_mov_b32 s46, 0x31000
    v_exp_f32 v128, v128
    v_mfma_f32_16x16x32_bf16 v[132:135], v[200:203], v[36:39], v[132:135]
    v_exp_f32 v129, v129
    v_mfma_f32_16x16x32_bf16 v[132:135], v[204:207], v[52:55], v[132:135]
    v_exp_f32 v130, v130
    v_mfma_f32_16x16x32_bf16 v[132:135], v[208:211], v[68:71], v[132:135]
    v_exp_f32 v131, v131
    v_mfma_f32_16x16x32_bf16 v[132:135], v[212:215], v[84:87], v[132:135]
    v_mul_f32 v184, s6, v184
    v_mul_f32 v185, s6, v185
    v_mfma_f32_16x16x32_bf16 v[132:135], v[216:219], v[100:103], v[132:135]
    v_mul_f32 v186, s6, v186
    v_mul_f32 v187, s6, v187
    v_mfma_f32_16x16x32_bf16 v[132:135], v[220:223], v[116:119], v[132:135]
    v_cvt_pk_bf16_f32 v122, v184, v185
    v_cvt_pk_bf16_f32 v123, v186, v187
    v_mfma_f32_16x16x32_bf16 v[136:139], v[192:195], v[8:11], 0
    v_mul_f32 v188, s6, v188
    v_mul_f32 v189, s6, v189
    v_mfma_f32_16x16x32_bf16 v[136:139], v[196:199], v[24:27], v[136:139]
    v_exp_f32 v132, v132
    v_mfma_f32_16x16x32_bf16 v[136:139], v[200:203], v[40:43], v[136:139]
    v_exp_f32 v133, v133
    v_mfma_f32_16x16x32_bf16 v[136:139], v[204:207], v[56:59], v[136:139]
    v_exp_f32 v134, v134
    v_mfma_f32_16x16x32_bf16 v[136:139], v[208:211], v[72:75], v[136:139]
    v_exp_f32 v135, v135
    v_mfma_f32_16x16x32_bf16 v[136:139], v[212:215], v[88:91], v[136:139]
    v_mul_f32 v190, s6, v190
    v_mul_f32 v191, s6, v191
    v_mfma_f32_16x16x32_bf16 v[136:139], v[216:219], v[104:107], v[136:139]
    v_cvt_pk_bf16_f32 v126, v188, v189
    v_cvt_pk_bf16_f32 v127, v190, v191
    v_mfma_f32_16x16x32_bf16 v[136:139], v[220:223], v[120:123], v[136:139]
    v_add_u32 v254, 0x20000, v245
    v_add_u32 v255, 0x20000, v246
    v_mfma_f32_16x16x32_bf16 v[140:143], v[192:195], v[12:15], 0
    ds_read_b128 v[192:195], v245 offset:6144
    v_mov_b32 v236, 0
    v_mfma_f32_16x16x32_bf16 v[140:143], v[196:199], v[28:31], v[140:143]
    ds_read_b128 v[196:199], v246 offset:6144
    v_mov_b32 v237, 0
    v_mfma_f32_16x16x32_bf16 v[140:143], v[200:203], v[44:47], v[140:143]
    ds_read_b128 v[200:203], v245 offset:10240
    v_mov_b32 v238, 0
    v_mfma_f32_16x16x32_bf16 v[140:143], v[204:207], v[60:63], v[140:143]
    ds_read_b128 v[204:207], v246 offset:10240
    v_mov_b32 v239, 0
    v_mfma_f32_16x16x32_bf16 v[140:143], v[208:211], v[76:79], v[140:143]
    ds_read_b128 v[208:211], v245 offset:14336
    v_mov_b32 v176, 0
    v_mfma_f32_16x16x32_bf16 v[140:143], v[212:215], v[92:95], v[140:143]
    ds_read_b128 v[212:215], v246 offset:14336
    v_mov_b32 v177, 0
    v_mfma_f32_16x16x32_bf16 v[140:143], v[216:219], v[108:111], v[140:143]
    v_exp_f32 v136, v136
    v_mfma_f32_16x16x32_bf16 v[140:143], v[220:223], v[124:127], v[140:143]
    s_waitcnt lgkmcnt(7)
    v_exp_f32 v137, v137
    v_mfma_f32_16x16x32_bf16 v[144:147], v[224:227], v[0:3], 0
    s_waitcnt lgkmcnt(6)
    v_exp_f32 v138, v138
    v_mfma_f32_16x16x32_bf16 v[144:147], v[228:231], v[16:19], v[144:147]
    s_waitcnt lgkmcnt(5)
    v_exp_f32 v139, v139
    v_mfma_f32_16x16x32_bf16 v[144:147], v[192:195], v[32:35], v[144:147]
    s_waitcnt lgkmcnt(4)
    v_exp_f32 v140, v140
    v_mfma_f32_16x16x32_bf16 v[144:147], v[196:199], v[48:51], v[144:147]
    s_waitcnt lgkmcnt(3)
    v_exp_f32 v141, v141
    v_mfma_f32_16x16x32_bf16 v[144:147], v[200:203], v[64:67], v[144:147]
    s_waitcnt lgkmcnt(2)
    v_exp_f32 v142, v142
    v_mfma_f32_16x16x32_bf16 v[144:147], v[204:207], v[80:83], v[144:147]
    s_waitcnt lgkmcnt(1)
    v_exp_f32 v143, v143
    v_mfma_f32_16x16x32_bf16 v[144:147], v[208:211], v[96:99], v[144:147]
    s_waitcnt lgkmcnt(0)
    v_mov_b32 v178, 0
    v_mov_b32 v179, 0
    v_mfma_f32_16x16x32_bf16 v[144:147], v[212:215], v[112:115], v[144:147]
    v_mov_b32 v180, 0
    v_mov_b32 v181, 0
    v_mfma_f32_16x16x32_bf16 v[148:151], v[224:227], v[4:7], 0
    v_mov_b32 v182, 0
    v_mov_b32 v183, 0
    v_mfma_f32_16x16x32_bf16 v[148:151], v[228:231], v[20:23], v[148:151]
    v_exp_f32 v144, v144
    v_mfma_f32_16x16x32_bf16 v[148:151], v[192:195], v[36:39], v[148:151]
    v_exp_f32 v145, v145
    v_mfma_f32_16x16x32_bf16 v[148:151], v[196:199], v[52:55], v[148:151]
    v_exp_f32 v146, v146
    v_mfma_f32_16x16x32_bf16 v[148:151], v[200:203], v[68:71], v[148:151]
    v_exp_f32 v147, v147
    v_mfma_f32_16x16x32_bf16 v[148:151], v[204:207], v[84:87], v[148:151]
    ds_read_b128 v[216:219], v254 offset:28672
    v_mov_b32 v184, 0
    v_mfma_f32_16x16x32_bf16 v[148:151], v[208:211], v[100:103], v[148:151]
    ds_read_b128 v[220:223], v255 offset:28672
    v_mov_b32 v185, 0
    v_mfma_f32_16x16x32_bf16 v[148:151], v[212:215], v[116:119], v[148:151]
    v_mov_b32 v186, 0
    v_mov_b32 v187, 0
    v_mfma_f32_16x16x32_bf16 v[152:155], v[224:227], v[8:11], 0
    v_mov_b32 v188, 0
    v_mov_b32 v189, 0
    v_mfma_f32_16x16x32_bf16 v[152:155], v[228:231], v[24:27], v[152:155]
    v_exp_f32 v148, v148
    v_mfma_f32_16x16x32_bf16 v[152:155], v[192:195], v[40:43], v[152:155]
    v_exp_f32 v149, v149
    v_mfma_f32_16x16x32_bf16 v[152:155], v[196:199], v[56:59], v[152:155]
    v_exp_f32 v150, v150
    v_mfma_f32_16x16x32_bf16 v[152:155], v[200:203], v[72:75], v[152:155]
    v_exp_f32 v151, v151
    v_mfma_f32_16x16x32_bf16 v[152:155], v[204:207], v[88:91], v[152:155]
    v_mov_b32 v190, 0
    v_mov_b32 v191, 0
    v_mfma_f32_16x16x32_bf16 v[152:155], v[208:211], v[104:107], v[152:155]
    v_mbcnt_lo_u32_b32 v250, -1, 0
    v_mbcnt_hi_u32_b32 v250, -1, v250
    v_mfma_f32_16x16x32_bf16 v[152:155], v[212:215], v[120:123], v[152:155]
    v_lshrrev_b32 v247, 2, v250
    v_lshlrev_b32 v247, 7, v247
    v_mfma_f32_16x16x32_bf16 v[156:159], v[224:227], v[12:15], 0
    v_bfe_u32 v248, v250, 3, 2
    v_lshl_add_u32 v247, v248, 5, v247
    v_mfma_f32_16x16x32_bf16 v[156:159], v[228:231], v[28:31], v[156:159]
    v_exp_f32 v152, v152
    v_mfma_f32_16x16x32_bf16 v[156:159], v[192:195], v[44:47], v[156:159]
    ds_read_b128 v[192:195], v254 offset:16384
    v_and_b32 v248, 3, v250
    v_mfma_f32_16x16x32_bf16 v[156:159], v[196:199], v[60:63], v[156:159]
    ds_read_b128 v[196:199], v255 offset:16384
    v_lshl_add_u32 v247, v248, 3, v247
    v_mfma_f32_16x16x32_bf16 v[156:159], v[200:203], v[76:79], v[156:159]
    ds_read_b128 v[200:203], v254 offset:20480
    v_add_u32 v247, 0x10000, v247
    v_mfma_f32_16x16x32_bf16 v[156:159], v[204:207], v[92:95], v[156:159]
    ds_read_b128 v[204:207], v255 offset:20480
    v_xor_b32 v248, 32, v247
    v_mfma_f32_16x16x32_bf16 v[156:159], v[208:211], v[108:111], v[156:159]
    ds_read_b128 v[208:211], v254 offset:24576
    v_xor_b32 v249, 64, v247
    v_mfma_f32_16x16x32_bf16 v[156:159], v[212:215], v[124:127], v[156:159]
    ds_read_b128 v[212:215], v255 offset:24576
    v_xor_b32 v250, 0x60, v247
    v_add_f32 v240, v128, v129
    v_add_f32 v240, v240, v130
    v_add_f32 v240, v240, v131
    v_add_f32 v241, v132, v133
    v_add_f32 v241, v241, v134
    v_add_f32 v241, v241, v135
    v_add_f32 v242, v136, v137
    v_add_f32 v242, v242, v138
    v_add_f32 v242, v242, v139
    v_add_f32 v243, v140, v141
    v_add_f32 v243, v243, v142
    v_add_f32 v243, v243, v143
    v_add_f32 v240, v240, v144
    v_add_f32 v240, v240, v145
    v_add_f32 v240, v240, v146
    v_add_f32 v240, v240, v147
    v_add_f32 v241, v241, v148
    v_add_f32 v241, v241, v149
    v_add_f32 v241, v241, v150
    v_add_f32 v241, v241, v151
    v_exp_f32 v153, v153
    v_exp_f32 v154, v154
    v_exp_f32 v155, v155
    v_add_f32 v242, v242, v152
    v_add_f32 v242, v242, v153
    v_add_f32 v242, v242, v154
    v_add_f32 v242, v242, v155
    v_exp_f32 v156, v156
    v_exp_f32 v157, v157
    v_exp_f32 v158, v158
    v_exp_f32 v159, v159
    v_add_f32 v243, v243, v156
    v_add_f32 v243, v243, v157
    v_add_f32 v243, v243, v158
    v_add_f32 v243, v243, v159
    v_max3_f32 v244, v240, v241, v242
    v_max_f32 v244, v244, v243
    v_cmp_lt_f32 vcc, s7, v244
    v_min3_f32 v244, v240, v241, v242
    v_min_f32 v244, v244, v243
    v_cmp_gt_f32 s[54:55], s47, v244
    s_or_b64 vcc, vcc, s[54:55]
    v_cvt_pk_bf16_f32 v160, v128, v129
    v_cvt_pk_bf16_f32 v161, v130, v131
    s_cbranch_vccnz L_stub0
L_ret0:
L_it0:
    s_waitcnt lgkmcnt(5)
    v_mfma_f32_16x16x32_bf16 v[128:131], v[192:195], v[0:3], v[176:179]
    s_waitcnt lgkmcnt(4)
    ds_read_b128 v[224:227], v254 offset:18432
    v_cvt_pk_bf16_f32 v164, v132, v133
    v_mfma_f32_16x16x32_bf16 v[128:131], v[196:199], v[16:19], v[128:131]
    s_waitcnt lgkmcnt(4)
    ds_read_b128 v[228:231], v255 offset:18432
    v_cvt_pk_bf16_f32 v165, v134, v135
    v_mfma_f32_16x16x32_bf16 v[128:131], v[200:203], v[32:35], v[128:131]
    s_waitcnt lgkmcnt(4)
    v_cvt_pk_bf16_f32 v168, v136, v137
    v_cvt_pk_bf16_f32 v169, v138, v139
    v_mfma_f32_16x16x32_bf16 v[128:131], v[204:207], v[48:51], v[128:131]
    s_waitcnt lgkmcnt(3)
    v_cvt_pk_bf16_f32 v172, v140, v141
    v_cvt_pk_bf16_f32 v173, v142, v143
    v_mfma_f32_16x16x32_bf16 v[128:131], v[208:211], v[64:67], v[128:131]
    s_waitcnt lgkmcnt(2)
    v_cvt_pk_bf16_f32 v162, v144, v145
    v_cvt_pk_bf16_f32 v163, v146, v147
    v_mfma_f32_16x16x32_bf16 v[128:131], v[212:215], v[80:83], v[128:131]
    v_cvt_pk_bf16_f32 v166, v148, v149
    v_cvt_pk_bf16_f32 v167, v150, v151
    v_mfma_f32_16x16x32_bf16 v[128:131], v[216:219], v[96:99], v[128:131]
    v_cvt_pk_bf16_f32 v170, v152, v153
    v_cvt_pk_bf16_f32 v171, v154, v155
    v_mfma_f32_16x16x32_bf16 v[128:131], v[220:223], v[112:115], v[128:131]
    v_cvt_pk_bf16_f32 v174, v156, v157
    v_cvt_pk_bf16_f32 v175, v158, v159
    v_mfma_f32_16x16x32_bf16 v[132:135], v[192:195], v[4:7], v[180:183]
    v_add_f32 v236, v236, v240
    v_add_f32 v237, v237, v241
    v_mfma_f32_16x16x32_bf16 v[132:135], v[196:199], v[20:23], v[132:135]
    v_exp_f32 v128, v128
    v_mfma_f32_16x16x32_bf16 v[132:135], v[200:203], v[36:39], v[132:135]
    v_exp_f32 v129, v129
    v_mfma_f32_16x16x32_bf16 v[132:135], v[204:207], v[52:55], v[132:135]
    v_exp_f32 v130, v130
    v_mfma_f32_16x16x32_bf16 v[132:135], v[208:211], v[68:71], v[132:135]
    v_exp_f32 v131, v131
    v_mfma_f32_16x16x32_bf16 v[132:135], v[212:215], v[84:87], v[132:135]
    v_add_f32 v238, v238, v242
    v_add_f32 v239, v239, v243
    v_mfma_f32_16x16x32_bf16 v[132:135], v[216:219], v[100:103], v[132:135]
    v_add_f32 v240, v128, v129
    v_add_f32 v240, v240, v130
    v_mfma_f32_16x16x32_bf16 v[132:135], v[220:223], v[116:119], v[132:135]
    v_add_f32 v240, v240, v131
    v_mfma_f32_16x16x32_bf16 v[136:139], v[192:195], v[8:11], v[184:187]
    v_mfma_f32_16x16x32_bf16 v[136:139], v[196:199], v[24:27], v[136:139]
    v_exp_f32 v132, v132
    v_mfma_f32_16x16x32_bf16 v[136:139], v[200:203], v[40:43], v[136:139]
    v_exp_f32 v133, v133
    v_mfma_f32_16x16x32_bf16 v[136:139], v[204:207], v[56:59], v[136:139]
    v_exp_f32 v134, v134
    v_mfma_f32_16x16x32_bf16 v[136:139], v[208:211], v[72:75], v[136:139]
    v_exp_f32 v135, v135
    v_mfma_f32_16x16x32_bf16 v[136:139], v[212:215], v[88:91], v[136:139]
    v_add_f32 v241, v132, v133
    v_add_f32 v241, v241, v134
    v_mfma_f32_16x16x32_bf16 v[136:139], v[216:219], v[104:107], v[136:139]
    v_add_f32 v241, v241, v135
    v_mfma_f32_16x16x32_bf16 v[136:139], v[220:223], v[120:123], v[136:139]
    v_mfma_f32_16x16x32_bf16 v[140:143], v[192:195], v[12:15], v[188:191]
    ds_read_b128 v[192:195], v254 offset:22528
    v_mfma_f32_16x16x32_bf16 v[140:143], v[196:199], v[28:31], v[140:143]
    ds_read_b128 v[196:199], v255 offset:22528
    v_mfma_f32_16x16x32_bf16 v[140:143], v[200:203], v[44:47], v[140:143]
    ds_read_b128 v[200:203], v254 offset:26624
    v_mfma_f32_16x16x32_bf16 v[140:143], v[204:207], v[60:63], v[140:143]
    ds_read_b128 v[204:207], v255 offset:26624
    v_mfma_f32_16x16x32_bf16 v[140:143], v[208:211], v[76:79], v[140:143]
    ds_read_b128 v[208:211], v254 offset:30720
    v_mfma_f32_16x16x32_bf16 v[140:143], v[212:215], v[92:95], v[140:143]
    ds_read_b128 v[212:215], v255 offset:30720
    v_mfma_f32_16x16x32_bf16 v[140:143], v[216:219], v[108:111], v[140:143]
    v_exp_f32 v136, v136
    v_mfma_f32_16x16x32_bf16 v[140:143], v[220:223], v[124:127], v[140:143]
    s_waitcnt lgkmcnt(7)
    v_exp_f32 v137, v137
    v_mfma_f32_16x16x32_bf16 v[144:147], v[224:227], v[0:3], v[176:179]
    s_waitcnt lgkmcnt(6)
    v_exp_f32 v138, v138
    v_mfma_f32_16x16x32_bf16 v[144:147], v[228:231], v[16:19], v[144:147]
    s_waitcnt lgkmcnt(5)
    v_exp_f32 v139, v139
    v_mfma_f32_16x16x32_bf16 v[144:147], v[192:195], v[32:35], v[144:147]
    s_waitcnt lgkmcnt(4)
    v_exp_f32 v140, v140
    v_mfma_f32_16x16x32_bf16 v[144:147], v[196:199], v[48:51], v[144:147]
    s_waitcnt lgkmcnt(3)
    v_exp_f32 v141, v141
    v_mfma_f32_16x16x32_bf16 v[144:147], v[200:203], v[64:67], v[144:147]
    s_waitcnt lgkmcnt(2)
    v_exp_f32 v142, v142
    v_mfma_f32_16x16x32_bf16 v[144:147], v[204:207], v[80:83], v[144:147]
    s_waitcnt lgkmcnt(1)
    v_exp_f32 v143, v143
    v_mfma_f32_16x16x32_bf16 v[144:147], v[208:211], v[96:99], v[144:147]
    s_waitcnt lgkmcnt(0)
    v_add_f32 v242, v136, v137
    v_add_f32 v242, v242, v138
    v_mfma_f32_16x16x32_bf16 v[144:147], v[212:215], v[112:115], v[144:147]
    v_add_f32 v242, v242, v139
    v_add_f32 v243, v140, v141
    v_mfma_f32_16x16x32_bf16 v[148:151], v[224:227], v[4:7], v[180:183]
    v_add_f32 v243, v243, v142
    v_add_f32 v243, v243, v143
    v_mfma_f32_16x16x32_bf16 v[148:151], v[228:231], v[20:23], v[148:151]
    v_exp_f32 v144, v144
    v_mfma_f32_16x16x32_bf16 v[148:151], v[192:195], v[36:39], v[148:151]
    v_exp_f32 v145, v145
    v_mfma_f32_16x16x32_bf16 v[148:151], v[196:199], v[52:55], v[148:151]
    v_exp_f32 v146, v146
    v_mfma_f32_16x16x32_bf16 v[148:151], v[200:203], v[68:71], v[148:151]
    v_exp_f32 v147, v147
    v_mfma_f32_16x16x32_bf16 v[148:151], v[204:207], v[84:87], v[148:151]
    v_add_f32 v240, v240, v144
    v_add_f32 v240, v240, v145
    v_mfma_f32_16x16x32_bf16 v[148:151], v[208:211], v[100:103], v[148:151]
    v_add_f32 v240, v240, v146
    v_add_f32 v240, v240, v147
    v_mfma_f32_16x16x32_bf16 v[148:151], v[212:215], v[116:119], v[148:151]
    v_mfma_f32_16x16x32_bf16 v[152:155], v[224:227], v[8:11], v[184:187]
    s_waitcnt vmcnt(8)
    s_barrier
    v_mfma_f32_16x16x32_bf16 v[152:155], v[228:231], v[24:27], v[152:155]
    v_exp_f32 v148, v148
    v_mfma_f32_16x16x32_bf16 v[152:155], v[192:195], v[40:43], v[152:155]
    ds_read_b64_tr_b16 v[232:233], v247 offset:0
    ds_read_b64_tr_b16 v[234:235], v247 offset:2048
    v_mfma_f32_16x16x32_bf16 v[152:155], v[196:199], v[56:59], v[152:155]
    v_exp_f32 v149, v149
    v_mfma_f32_16x16x32_bf16 v[152:155], v[200:203], v[72:75], v[152:155]
    v_exp_f32 v150, v150
    v_mfma_f32_16x16x32_bf16 v[152:155], v[204:207], v[88:91], v[152:155]
    v_exp_f32 v151, v151
    v_mfma_f32_16x16x32_bf16 v[152:155], v[208:211], v[104:107], v[152:155]
    v_add_f32 v241, v241, v148
    v_add_f32 v241, v241, v149
    v_mfma_f32_16x16x32_bf16 v[152:155], v[212:215], v[120:123], v[152:155]
    v_add_f32 v241, v241, v150
    v_add_f32 v241, v241, v151
    v_mfma_f32_16x16x32_bf16 v[156:159], v[224:227], v[12:15], v[188:191]
    ds_read_b64_tr_b16 v[224:225], v248 offset:0
    ds_read_b64_tr_b16 v[226:227], v248 offset:2048
    v_mfma_f32_16x16x32_bf16 v[156:159], v[228:231], v[28:31], v[156:159]
    ds_read_b64_tr_b16 v[228:229], v249 offset:0
    ds_read_b64_tr_b16 v[230:231], v249 offset:2048
    v_mfma_f32_16x16x32_bf16 v[156:159], v[192:195], v[44:47], v[156:159]
    v_exp_f32 v152, v152
    v_mfma_f32_16x16x32_bf16 v[156:159], v[196:199], v[60:63], v[156:159]
    v_exp_f32 v153, v153
    v_mfma_f32_16x16x32_bf16 v[156:159], v[200:203], v[76:79], v[156:159]
    v_exp_f32 v154, v154
    v_mfma_f32_16x16x32_bf16 v[156:159], v[204:207], v[92:95], v[156:159]
    v_exp_f32 v155, v155
    v_mfma_f32_16x16x32_bf16 v[156:159], v[208:211], v[108:111], v[156:159]
    v_add_f32 v242, v242, v152
    v_add_f32 v242, v242, v153
    v_mfma_f32_16x16x32_bf16 v[156:159], v[212:215], v[124:127], v[156:159]
    s_waitcnt lgkmcnt(4)
    v_add_f32 v242, v242, v154
    v_add_f32 v242, v242, v155
    v_mfma_f32_16x16x32_bf16 a[12:15], v[232:235], v[172:175], 0
    v_mfma_f32_16x16x32_bf16 a[8:11], v[232:235], v[168:171], 0
    v_exp_f32 v156, v156
    v_mfma_f32_16x16x32_bf16 a[4:7], v[232:235], v[164:167], 0
    v_exp_f32 v157, v157
    v_mfma_f32_16x16x32_bf16 a[0:3], v[232:235], v[160:163], 0
    s_waitcnt lgkmcnt(2)
    ds_read_b64_tr_b16 v[232:233], v250 offset:0
    ds_read_b64_tr_b16 v[234:235], v250 offset:2048
    v_mfma_f32_16x16x32_bf16 a[16:19], v[224:227], v[160:163], 0
    v_exp_f32 v158, v158
    v_mfma_f32_16x16x32_bf16 a[20:23], v[224:227], v[164:167], 0
    v_exp_f32 v159, v159
    v_mfma_f32_16x16x32_bf16 a[24:27], v[224:227], v[168:171], 0
    v_add_f32 v243, v243, v156
    v_add_f32 v243, v243, v157
    v_mfma_f32_16x16x32_bf16 a[28:31], v[224:227], v[172:175], 0
    s_waitcnt lgkmcnt(2)
    ds_read_b64_tr_b16 v[224:225], v247 offset:4096
    ds_read_b64_tr_b16 v[226:227], v247 offset:6144
    v_mfma_f32_16x16x32_bf16 a[44:47], v[228:231], v[172:175], 0
    v_add_f32 v243, v243, v158
    v_add_f32 v243, v243, v159
    v_mfma_f32_16x16x32_bf16 a[40:43], v[228:231], v[168:171], 0
    v_max3_f32 v244, v240, v241, v242
    v_max_f32 v244, v244, v243
    v_mfma_f32_16x16x32_bf16 a[36:39], v[228:231], v[164:167], 0
    v_cmp_lt_f32 vcc, s7, v244
    v_mfma_f32_16x16x32_bf16 a[32:35], v[228:231], v[160:163], 0
    s_waitcnt lgkmcnt(2)
    ds_read_b64_tr_b16 v[228:229], v248 offset:4096
    ds_read_b64_tr_b16 v[230:231], v248 offset:6144
    v_mfma_f32_16x16x32_bf16 a[48:51], v[232:235], v[160:163], 0
    s_add_u32 m0, s32, 0x18000
    v_mfma_f32_16x16x32_bf16 a[52:55], v[232:235], v[164:167], 0
    buffer_load_dwordx4 v251, s[20:23], s35 offen nt lds
    v_mfma_f32_16x16x32_bf16 a[56:59], v[232:235], v[168:171], 0
    v_mfma_f32_16x16x32_bf16 a[60:63], v[232:235], v[172:175], 0
    s_waitcnt lgkmcnt(2)
    ds_read_b64_tr_b16 v[232:233], v249 offset:4096
    ds_read_b64_tr_b16 v[234:235], v249 offset:6144
    v_mfma_f32_16x16x32_bf16 a[76:79], v[224:227], v[172:175], 0
    s_add_u32 m0, s32, 0x18f80
    v_mfma_f32_16x16x32_bf16 a[72:75], v[224:227], v[168:171], 0
    buffer_load_dwordx4 v251, s[20:23], s35 offen offset:128 nt lds
    v_mfma_f32_16x16x32_bf16 a[68:71], v[224:227], v[164:167], 0
    v_mfma_f32_16x16x32_bf16 a[64:67], v[224:227], v[160:163], 0
    s_waitcnt lgkmcnt(2)
    ds_read_b64_tr_b16 v[224:225], v250 offset:4096
    ds_read_b64_tr_b16 v[226:227], v250 offset:6144
    v_mfma_f32_16x16x32_bf16 a[80:83], v[228:231], v[160:163], 0
    s_add_u32 m0, s32, 0x19f00
    v_mfma_f32_16x16x32_bf16 a[84:87], v[228:231], v[164:167], 0
    buffer_load_dwordx4 v251, s[20:23], s35 offen offset:256 nt lds
    v_mfma_f32_16x16x32_bf16 a[88:91], v[228:231], v[168:171], 0
    v_mfma_f32_16x16x32_bf16 a[92:95], v[228:231], v[172:175], 0
    s_waitcnt lgkmcnt(2)
    ds_read_b64_tr_b16 v[228:229], v247 offset:8192
    ds_read_b64_tr_b16 v[230:231], v247 offset:10240
    v_mfma_f32_16x16x32_bf16 a[108:111], v[232:235], v[172:175], 0
    s_add_u32 m0, s32, 0x1ae80
    v_mfma_f32_16x16x32_bf16 a[104:107], v[232:235], v[168:171], 0
    buffer_load_dwordx4 v251, s[20:23], s35 offen offset:384 nt lds
    v_mfma_f32_16x16x32_bf16 a[100:103], v[232:235], v[164:167], 0
    s_or_b32 s35, s35, 0x18fff
    v_mfma_f32_16x16x32_bf16 a[96:99], v[232:235], v[160:163], 0
    s_waitcnt lgkmcnt(2)
    s_add_u32 s35, s35, 1
    ds_read_b64_tr_b16 v[232:233], v248 offset:8192
    ds_read_b64_tr_b16 v[234:235], v248 offset:10240
    v_mfma_f32_16x16x32_bf16 a[112:115], v[224:227], v[160:163], 0
    s_andn2_b32 s35, s35, 0x18fff
    s_add_u32 m0, s32, 0x0
    v_mfma_f32_16x16x32_bf16 a[116:119], v[224:227], v[164:167], 0
    buffer_load_dwordx4 v251, s[16:19], s34 offen nt lds
    v_mfma_f32_16x16x32_bf16 a[120:123], v[224:227], v[168:171], 0
    v_mfma_f32_16x16x32_bf16 a[124:127], v[224:227], v[172:175], 0
    s_waitcnt lgkmcnt(2)
    ds_read_b64_tr_b16 v[224:225], v249 offset:8192
    ds_read_b64_tr_b16 v[226:227], v249 offset:10240
    v_mfma_f32_16x16x32_bf16 a[140:143], v[228:231], v[172:175], 0
    s_add_u32 m0, s32, 0xf80
    v_mfma_f32_16x16x32_bf16 a[136:139], v[228:231], v[168:171], 0
    buffer_load_dwordx4 v251, s[16:19], s34 offen offset:128 nt lds
    v_mfma_f32_16x16x32_bf16 a[132:135], v[228:231], v[164:167], 0
    v_mfma_f32_16x16x32_bf16 a[128:131], v[228:231], v[160:163], 0
    s_waitcnt lgkmcnt(2)
    ds_read_b64_tr_b16 v[228:229], v250 offset:8192
    ds_read_b64_tr_b16 v[230:231], v250 offset:10240
    v_mfma_f32_16x16x32_bf16 a[144:147], v[232:235], v[160:163], 0
    s_add_u32 m0, s32, 0x1f00
    v_mfma_f32_16x16x32_bf16 a[148:151], v[232:235], v[164:167], 0
    buffer_load_dwordx4 v251, s[16:19], s34 offen offset:256 nt lds
    v_mfma_f32_16x16x32_bf16 a[152:155], v[232:235], v[168:171], 0
    v_mfma_f32_16x16x32_bf16 a[156:159], v[232:235], v[172:175], 0
    s_waitcnt lgkmcnt(2)
    ds_read_b64_tr_b16 v[232:233], v247 offset:12288
    ds_read_b64_tr_b16 v[234:235], v247 offset:14336
    v_mfma_f32_16x16x32_bf16 a[172:175], v[224:227], v[172:175], 0
    ds_read_b128 v[192:195], v245 offset:32768
    v_mfma_f32_16x16x32_bf16 a[168:171], v[224:227], v[168:171], 0
    s_add_u32 m0, s32, 0x2e80
    ds_read_b128 v[196:199], v246 offset:32768
    v_mfma_f32_16x16x32_bf16 a[164:167], v[224:227], v[164:167], 0
    buffer_load_dwordx4 v251, s[16:19], s34 offen offset:384 nt lds
    v_mfma_f32_16x16x32_bf16 a[160:163], v[224:227], v[160:163], 0
    s_waitcnt lgkmcnt(4)
    s_or_b32 s34, s34, 0x18fff
    ds_read_b64_tr_b16 v[224:225], v248 offset:12288
    ds_read_b64_tr_b16 v[226:227], v248 offset:14336
    v_mfma_f32_16x16x32_bf16 a[176:179], v[228:231], v[160:163], 0
    s_add_u32 s34, s34, 1
    ds_read_b128 v[200:203], v245 offset:36864
    v_mfma_f32_16x16x32_bf16 a[180:183], v[228:231], v[164:167], 0
    s_andn2_b32 s34, s34, 0x18fff
    ds_read_b128 v[204:207], v246 offset:36864
    v_mfma_f32_16x16x32_bf16 a[184:187], v[228:231], v[168:171], 0
    v_mfma_f32_16x16x32_bf16 a[188:191], v[228:231], v[172:175], 0
    s_waitcnt lgkmcnt(6)
    ds_read_b64_tr_b16 v[228:229], v249 offset:12288
    ds_read_b64_tr_b16 v[230:231], v249 offset:14336
    v_mfma_f32_16x16x32_bf16 a[204:207], v[232:235], v[172:175], 0
    ds_read_b128 v[208:211], v245 offset:40960
    v_mfma_f32_16x16x32_bf16 a[200:203], v[232:235], v[168:171], 0
    ds_read_b128 v[212:215], v246 offset:40960
    v_mfma_f32_16x16x32_bf16 a[196:199], v[232:235], v[164:167], 0
    v_mfma_f32_16x16x32_bf16 a[192:195], v[232:235], v[160:163], 0
    s_waitcnt lgkmcnt(6)
    ds_read_b64_tr_b16 v[232:233], v250 offset:12288
    ds_read_b64_tr_b16 v[234:235], v250 offset:14336
    v_mfma_f32_16x16x32_bf16 a[208:211], v[224:227], v[160:163], 0
    ds_read_b128 v[216:219], v245 offset:45056
    v_mfma_f32_16x16x32_bf16 a[212:215], v[224:227], v[164:167], 0
    ds_read_b128 v[220:223], v246 offset:45056
    v_mfma_f32_16x16x32_bf16 a[216:219], v[224:227], v[168:171], 0
    v_mfma_f32_16x16x32_bf16 a[220:223], v[224:227], v[172:175], 0
    s_waitcnt lgkmcnt(6)
    v_mfma_f32_16x16x32_bf16 a[236:239], v[228:231], v[172:175], 0
    s_or_b32 s90, s90, 0x18fff
    v_mfma_f32_16x16x32_bf16 a[232:235], v[228:231], v[168:171], 0
    s_add_u32 s90, s90, 1
    v_mfma_f32_16x16x32_bf16 a[228:231], v[228:231], v[164:167], 0
    s_andn2_b32 s90, s90, 0x18fff
    v_mfma_f32_16x16x32_bf16 a[224:227], v[228:231], v[160:163], 0
    s_waitcnt lgkmcnt(2)
    v_mfma_f32_16x16x32_bf16 a[240:243], v[232:235], v[160:163], 0
    v_cvt_pk_bf16_f32 v160, v128, v129
    v_cvt_pk_bf16_f32 v161, v130, v131
    v_mfma_f32_16x16x32_bf16 a[244:247], v[232:235], v[164:167], 0
    v_mfma_f32_16x16x32_bf16 a[248:251], v[232:235], v[168:171], 0
    v_mfma_f32_16x16x32_bf16 a[252:255], v[232:235], v[172:175], 0
    s_cbranch_vccnz L_stub1
L_ret1:
    s_mov_b32 s36, 7
.p2align 6
L_loop:
    v_mfma_f32_16x16x32_bf16 v[128:131], v[192:195], v[0:3], v[176:179]
    ds_read_b128 v[224:227], v245 offset:34816
    v_cvt_pk_bf16_f32 v164, v132, v133
    v_mfma_f32_16x16x32_bf16 v[128:131], v[196:199], v[16:19], v[128:131]
    ds_read_b128 v[228:231], v246 offset:34816
    v_cvt_pk_bf16_f32 v165, v134, v135
    v_mfma_f32_16x16x32_bf16 v[128:131], v[200:203], v[32:35], v[128:131]
    v_cvt_pk_bf16_f32 v168, v136, v137
    v_cvt_pk_bf16_f32 v169, v138, v139
    v_mfma_f32_16x16x32_bf16 v[128:131], v[204:207], v[48:51], v[128:131]
    v_cvt_pk_bf16_f32 v172, v140, v141
    v_cvt_pk_bf16_f32 v173, v142, v143
    v_mfma_f32_16x16x32_bf16 v[128:131], v[208:211], v[64:67], v[128:131]
    v_cvt_pk_bf16_f32 v162, v144, v145
    v_cvt_pk_bf16_f32 v163, v146, v147
    v_mfma_f32_16x16x32_bf16 v[128:131], v[212:215], v[80:83], v[128:131]
    s_waitcnt lgkmcnt(3)
    v_cvt_pk_bf16_f32 v166, v148, v149
    v_cvt_pk_bf16_f32 v167, v150, v151
    v_mfma_f32_16x16x32_bf16 v[128:131], v[216:219], v[96:99], v[128:131]
    s_waitcnt lgkmcnt(2)
    v_cvt_pk_bf16_f32 v170, v152, v153
    v_cvt_pk_bf16_f32 v171, v154, v155
    v_mfma_f32_16x16x32_bf16 v[128:131], v[220:223], v[112:115], v[128:131]
    v_cvt_pk_bf16_f32 v174, v156, v157
    v_cvt_pk_bf16_f32 v175, v158, v159
    v_mfma_f32_16x16x32_bf16 v[132:135], v[192:195], v[4:7], v[180:183]
    v_add_f32 v236, v236, v240
    v_add_f32 v237, v237, v241
    v_mfma_f32_16x16x32_bf16 v[132:135], v[196:199], v[20:23], v[132:135]
    v_exp_f32 v128, v128
    v_mfma_f32_16x16x32_bf16 v[132:135], v[200:203], v[36:39], v[132:135]
    v_exp_f32 v129, v129
    v_mfma_f32_16x16x32_bf16 v[132:135], v[204:207], v[52:55], v[132:135]
    v_exp_f32 v130, v130
    v_mfma_f32_16x16x32_bf16 v[132:135], v[208:211], v[68:71], v[132:135]
    v_exp_f32 v131, v131
    v_mfma_f32_16x16x32_bf16 v[132:135], v[212:215], v[84:87], v[132:135]
    v_add_f32 v238, v238, v242
    v_add_f32 v239, v239, v243
    v_mfma_f32_16x16x32_bf16 v[132:135], v[216:219], v[100:103], v[132:135]
    v_add_f32 v240, v128, v129
    v_add_f32 v240, v240, v130
    v_mfma_f32_16x16x32_bf16 v[132:135], v[220:223], v[116:119], v[132:135]
    v_add_f32 v240, v240, v131
    v_mfma_f32_16x16x32_bf16 v[136:139], v[192:195], v[8:11], v[184:187]
    v_mfma_f32_16x16x32_bf16 v[136:139], v[196:199], v[24:27], v[136:139]
    v_exp_f32 v132, v132
    v_mfma_f32_16x16x32_bf16 v[136:139], v[200:203], v[40:43], v[136:139]
    v_exp_f32 v133, v133
    v_mfma_f32_16x16x32_bf16 v[136:139], v[204:207], v[56:59], v[136:139]
    v_exp_f32 v134, v134
    v_mfma_f32_16x16x32_bf16 v[136:139], v[208:211], v[72:75], v[136:139]
    v_exp_f32 v135, v135
    v_mfma_f32_16x16x32_bf16 v[136:139], v[212:215], v[88:91], v[136:139]
    v_add_f32 v241, v132, v133
    v_add_f32 v241, v241, v134
    v_mfma_f32_16x16x32_bf16 v[136:139], v[216:219], v[104:107], v[136:139]
    v_add_f32 v241, v241, v135
    v_mfma_f32_16x16x32_bf16 v[136:139], v[220:223], v[120:123], v[136:139]
    v_mfma_f32_16x16x32_bf16 v[140:143], v[192:195], v[12:15], v[188:191]
    ds_read_b128 v[192:195], v245 offset:38912
    v_mfma_f32_16x16x32_bf16 v[140:143], v[196:199], v[28:31], v[140:143]
    ds_read_b128 v[196:199], v246 offset:38912
    v_mfma_f32_16x16x32_bf16 v[140:143], v[200:203], v[44:47], v[140:143]
    ds_read_b128 v[200:203], v245 offset:43008
    v_mfma_f32_16x16x32_bf16 v[140:143], v[204:207], v[60:63], v[140:143]
    ds_read_b128 v[204:207], v246 offset:43008
    v_mfma_f32_16x16x32_bf16 v[140:143], v[208:211], v[76:79], v[140:143]
    ds_read_b128 v[208:211], v245 offset:47104
    v_mfma_f32_16x16x32_bf16 v[140:143], v[212:215], v[92:95], v[140:143]
    ds_read_b128 v[212:215], v246 offset:47104
    v_mfma_f32_16x16x32_bf16 v[140:143], v[216:219], v[108:111], v[140:143]
    v_exp_f32 v136, v136
    v_mfma_f32_16x16x32_bf16 v[140:143], v[220:223], v[124:127], v[140:143]
    s_waitcnt lgkmcnt(7)
    v_exp_f32 v137, v137
    v_mfma_f32_16x16x32_bf16 v[144:147], v[224:227], v[0:3], v[176:179]
    s_waitcnt lgkmcnt(6)
    v_exp_f32 v138, v138
    v_mfma_f32_16x16x32_bf16 v[144:147], v[228:231], v[16:19], v[144:147]
    s_waitcnt lgkmcnt(5)
    v_exp_f32 v139, v139
    v_mfma_f32_16x16x32_bf16 v[144:147], v[192:195], v[32:35], v[144:147]
    s_waitcnt lgkmcnt(4)
    v_exp_f32 v140, v140
    v_mfma_f32_16x16x32_bf16 v[144:147], v[196:199], v[48:51], v[144:147]
    s_waitcnt lgkmcnt(3)
    v_exp_f32 v141, v141
    v_mfma_f32_16x16x32_bf16 v[144:147], v[200:203], v[64:67], v[144:147]
    s_waitcnt lgkmcnt(2)
    v_exp_f32 v142, v142
    v_mfma_f32_16x16x32_bf16 v[144:147], v[204:207], v[80:83], v[144:147]
    s_waitcnt lgkmcnt(1)
    v_exp_f32 v143, v143
    v_mfma_f32_16x16x32_bf16 v[144:147], v[208:211], v[96:99], v[144:147]
    s_waitcnt lgkmcnt(0)
    v_add_f32 v242, v136, v137
    v_add_f32 v242, v242, v138
    v_mfma_f32_16x16x32_bf16 v[144:147], v[212:215], v[112:115], v[144:147]
    v_add_f32 v242, v242, v139
    v_add_f32 v243, v140, v141
    v_mfma_f32_16x16x32_bf16 v[148:151], v[224:227], v[4:7], v[180:183]
    v_add_f32 v243, v243, v142
    v_add_f32 v243, v243, v143
    v_mfma_f32_16x16x32_bf16 v[148:151], v[228:231], v[20:23], v[148:151]
    v_exp_f32 v144, v144
    v_mfma_f32_16x16x32_bf16 v[148:151], v[192:195], v[36:39], v[148:151]
    v_exp_f32 v145, v145
    v_mfma_f32_16x16x32_bf16 v[148:151], v[196:199], v[52:55], v[148:151]
    v_exp_f32 v146, v146
    v_mfma_f32_16x16x32_bf16 v[148:151], v[200:203], v[68:71], v[148:151]
    v_exp_f32 v147, v147
    v_mfma_f32_16x16x32_bf16 v[148:151], v[204:207], v[84:87], v[148:151]
    v_add_f32 v240, v240, v144
    v_add_f32 v240, v240, v145
    v_mfma_f32_16x16x32_bf16 v[148:151], v[208:211], v[100:103], v[148:151]
    v_add_f32 v240, v240, v146
    v_add_f32 v240, v240, v147
    v_mfma_f32_16x16x32_bf16 v[148:151], v[212:215], v[116:119], v[148:151]
    v_mfma_f32_16x16x32_bf16 v[152:155], v[224:227], v[8:11], v[184:187]
    s_waitcnt vmcnt(8)
    s_barrier
    v_mfma_f32_16x16x32_bf16 v[152:155], v[228:231], v[24:27], v[152:155]
    v_exp_f32 v148, v148
    v_mfma_f32_16x16x32_bf16 v[152:155], v[192:195], v[40:43], v[152:155]
    ds_read_b64_tr_b16 v[232:233], v247 offset:16384
    ds_read_b64_tr_b16 v[234:235], v247 offset:18432
    v_mfma_f32_16x16x32_bf16 v[152:155], v[196:199], v[56:59], v[152:155]
    v_exp_f32 v149, v149
    v_mfma_f32_16x16x32_bf16 v[152:155], v[200:203], v[72:75], v[152:155]
    v_exp_f32 v150, v150
    v_mfma_f32_16x16x32_bf16 v[152:155], v[204:207], v[88:91], v[152:155]
    v_exp_f32 v151, v151
    v_mfma_f32_16x16x32_bf16 v[152:155], v[208:211], v[104:107], v[152:155]
    v_add_f32 v241, v241, v148
    v_add_f32 v241, v241, v149
    v_mfma_f32_16x16x32_bf16 v[152:155], v[212:215], v[120:123], v[152:155]
    v_add_f32 v241, v241, v150
    v_add_f32 v241, v241, v151
    v_mfma_f32_16x16x32_bf16 v[156:159], v[224:227], v[12:15], v[188:191]
    ds_read_b64_tr_b16 v[224:225], v248 offset:16384
    ds_read_b64_tr_b16 v[226:227], v248 offset:18432
    v_mfma_f32_16x16x32_bf16 v[156:159], v[228:231], v[28:31], v[156:159]
    ds_read_b64_tr_b16 v[228:229], v249 offset:16384
    ds_read_b64_tr_b16 v[230:231], v249 offset:18432
    v_mfma_f32_16x16x32_bf16 v[156:159], v[192:195], v[44:47], v[156:159]
    v_exp_f32 v152, v152
    v_mfma_f32_16x16x32_bf16 v[156:159], v[196:199], v[60:63], v[156:159]
    v_exp_f32 v153, v153
    v_mfma_f32_16x16x32_bf16 v[156:159], v[200:203], v[76:79], v[156:159]
    v_exp_f32 v154, v154
    v_mfma_f32_16x16x32_bf16 v[156:159], v[204:207], v[92:95], v[156:159]
    v_exp_f32 v155, v155
    v_mfma_f32_16x16x32_bf16 v[156:159], v[208:211], v[108:111], v[156:159]
    v_add_f32 v242, v242, v152
    v_add_f32 v242, v242, v153
    v_mfma_f32_16x16x32_bf16 v[156:159], v[212:215], v[124:127], v[156:159]
    s_waitcnt lgkmcnt(4)
    v_add_f32 v242, v242, v154
    v_add_f32 v242, v242, v155
    v_mfma_f32_16x16x32_bf16 a[12:15], v[232:235], v[172:175], a[12:15]
    v_mfma_f32_16x16x32_bf16 a[8:11], v[232:235], v[168:171], a[8:11]
    v_exp_f32 v156, v156
    v_mfma_f32_16x16x32_bf16 a[4:7], v[232:235], v[164:167], a[4:7]
    v_exp_f32 v157, v157
    v_mfma_f32_16x16x32_bf16 a[0:3], v[232:235], v[160:163], a[0:3]
    s_waitcnt lgkmcnt(2)
    ds_read_b64_tr_b16 v[232:233], v250 offset:16384
    ds_read_b64_tr_b16 v[234:235], v250 offset:18432
    v_mfma_f32_16x16x32_bf16 a[16:19], v[224:227], v[160:163], a[16:19]
    v_exp_f32 v158, v158
    v_mfma_f32_16x16x32_bf16 a[20:23], v[224:227], v[164:167], a[20:23]
    v_exp_f32 v159, v159
    v_mfma_f32_16x16x32_bf16 a[24:27], v[224:227], v[168:171], a[24:27]
    v_add_f32 v243, v243, v156
    v_add_f32 v243, v243, v157
    v_mfma_f32_16x16x32_bf16 a[28:31], v[224:227], v[172:175], a[28:31]
    s_waitcnt lgkmcnt(2)
    ds_read_b64_tr_b16 v[224:225], v247 offset:20480
    ds_read_b64_tr_b16 v[226:227], v247 offset:22528
    v_mfma_f32_16x16x32_bf16 a[44:47], v[228:231], v[172:175], a[44:47]
    v_add_f32 v243, v243, v158
    v_add_f32 v243, v243, v159
    v_mfma_f32_16x16x32_bf16 a[40:43], v[228:231], v[168:171], a[40:43]
    v_max3_f32 v244, v240, v241, v242
    v_max_f32 v244, v244, v243
    v_mfma_f32_16x16x32_bf16 a[36:39], v[228:231], v[164:167], a[36:39]
    v_cmp_lt_f32 vcc, s7, v244
    v_mfma_f32_16x16x32_bf16 a[32:35], v[228:231], v[160:163], a[32:35]
    s_waitcnt lgkmcnt(2)
    ds_read_b64_tr_b16 v[228:229], v248 offset:20480
    ds_read_b64_tr_b16 v[230:231], v248 offset:22528
    v_mfma_f32_16x16x32_bf16 a[48:51], v[232:235], v[160:163], a[48:51]
    s_add_u32 m0, s32, 0x1c000
    v_mfma_f32_16x16x32_bf16 a[52:55], v[232:235], v[164:167], a[52:55]
    buffer_load_dwordx4 v251, s[20:23], s35 offen nt lds
    v_mfma_f32_16x16x32_bf16 a[56:59], v[232:235], v[168:171], a[56:59]
    v_mfma_f32_16x16x32_bf16 a[60:63], v[232:235], v[172:175], a[60:63]
    s_waitcnt lgkmcnt(2)
    ds_read_b64_tr_b16 v[232:233], v249 offset:20480
    ds_read_b64_tr_b16 v[234:235], v249 offset:22528
    v_mfma_f32_16x16x32_bf16 a[76:79], v[224:227], v[172:175], a[76:79]
    s_add_u32 m0, s32, 0x1cf80
    v_mfma_f32_16x16x32_bf16 a[72:75], v[224:227], v[168:171], a[72:75]
    buffer_load_dwordx4 v251, s[20:23], s35 offen offset:128 nt lds
    v_mfma_f32_16x16x32_bf16 a[68:71], v[224:227], v[164:167], a[68:71]
    v_mfma_f32_16x16x32_bf16 a[64:67], v[224:227], v[160:163], a[64:67]
    s_waitcnt lgkmcnt(2)
    ds_read_b64_tr_b16 v[224:225], v250 offset:20480
    ds_read_b64_tr_b16 v[226:227], v250 offset:22528
    v_mfma_f32_16x16x32_bf16 a[80:83], v[228:231], v[160:163], a[80:83]
    s_add_u32 m0, s32, 0x1df00
    v_mfma_f32_16x16x32_bf16 a[84:87], v[228:231], v[164:167], a[84:87]
    buffer_load_dwordx4 v251, s[20:23], s35 offen offset:256 nt lds
    v_mfma_f32_16x16x32_bf16 a[88:91], v[228:231], v[168:171], a[88:91]
    v_mfma_f32_16x16x32_bf16 a[92:95], v[228:231], v[172:175], a[92:95]
    s_waitcnt lgkmcnt(2)
    ds_read_b64_tr_b16 v[228:229], v247 offset:24576
    ds_read_b64_tr_b16 v[230:231], v247 offset:26624
    v_mfma_f32_16x16x32_bf16 a[108:111], v[232:235], v[172:175], a[108:111]
    s_add_u32 m0, s32, 0x1ee80
    v_mfma_f32_16x16x32_bf16 a[104:107], v[232:235], v[168:171], a[104:107]
    buffer_load_dwordx4 v251, s[20:23], s35 offen offset:384 nt lds
    v_mfma_f32_16x16x32_bf16 a[100:103], v[232:235], v[164:167], a[100:103]
    s_or_b32 s35, s35, 0x18fff
    v_mfma_f32_16x16x32_bf16 a[96:99], v[232:235], v[160:163], a[96:99]
    s_waitcnt lgkmcnt(2)
    s_add_u32 s35, s35, 1
    ds_read_b64_tr_b16 v[232:233], v248 offset:24576
    ds_read_b64_tr_b16 v[234:235], v248 offset:26624
    v_mfma_f32_16x16x32_bf16 a[112:115], v[224:227], v[160:163], a[112:115]
    s_andn2_b32 s35, s35, 0x18fff
    s_add_u32 m0, s32, 0x4000
    v_mfma_f32_16x16x32_bf16 a[116:119], v[224:227], v[164:167], a[116:119]
    buffer_load_dwordx4 v251, s[16:19], s34 offen nt lds
    v_mfma_f32_16x16x32_bf16 a[120:123], v[224:227], v[168:171], a[120:123]
    v_mfma_f32_16x16x32_bf16 a[124:127], v[224:227], v[172:175], a[124:127]
    s_waitcnt lgkmcnt(2)
    ds_read_b64_tr_b16 v[224:225], v249 offset:24576
    ds_read_b64_tr_b16 v[226:227], v249 offset:26624
    v_mfma_f32_16x16x32_bf16 a[140:143], v[228:231], v[172:175], a[140:143]
    s_add_u32 m0, s32, 0x4f80
    v_mfma_f32_16x16x32_bf16 a[136:139], v[228:231], v[168:171], a[136:139]
    buffer_load_dwordx4 v251, s[16:19], s34 offen offset:128 nt lds
    v_mfma_f32_16x16x32_bf16 a[132:135], v[228:231], v[164:167], a[132:135]
    v_mfma_f32_16x16x32_bf16 a[128:131], v[228:231], v[160:163], a[128:131]
    s_waitcnt lgkmcnt(2)
    ds_read_b64_tr_b16 v[228:229], v250 offset:24576
    ds_read_b64_tr_b16 v[230:231], v250 offset:26624
    v_mfma_f32_16x16x32_bf16 a[144:147], v[232:235], v[160:163], a[144:147]
    s_add_u32 m0, s32, 0x5f00
    v_mfma_f32_16x16x32_bf16 a[148:151], v[232:235], v[164:167], a[148:151]
    buffer_load_dwordx4 v251, s[16:19], s34 offen offset:256 nt lds
    v_mfma_f32_16x16x32_bf16 a[152:155], v[232:235], v[168:171], a[152:155]
    v_mfma_f32_16x16x32_bf16 a[156:159], v[232:235], v[172:175], a[156:159]
    s_waitcnt lgkmcnt(2)
    ds_read_b64_tr_b16 v[232:233], v247 offset:28672
    ds_read_b64_tr_b16 v[234:235], v247 offset:30720
    v_mfma_f32_16x16x32_bf16 a[172:175], v[224:227], v[172:175], a[172:175]
    ds_read_b128 v[192:195], v245 offset:49152
    v_mfma_f32_16x16x32_bf16 a[168:171], v[224:227], v[168:171], a[168:171]
    s_add_u32 m0, s32, 0x6e80
    ds_read_b128 v[196:199], v246 offset:49152
    v_mfma_f32_16x16x32_bf16 a[164:167], v[224:227], v[164:167], a[164:167]
    buffer_load_dwordx4 v251, s[16:19], s34 offen offset:384 nt lds
    v_mfma_f32_16x16x32_bf16 a[160:163], v[224:227], v[160:163], a[160:163]
    s_waitcnt lgkmcnt(4)
    s_or_b32 s34, s34, 0x18fff
    ds_read_b64_tr_b16 v[224:225], v248 offset:28672
    ds_read_b64_tr_b16 v[226:227], v248 offset:30720
    v_mfma_f32_16x16x32_bf16 a[176:179], v[228:231], v[160:163], a[176:179]
    s_add_u32 s34, s34, 1
    ds_read_b128 v[200:203], v245 offset:53248
    v_mfma_f32_16x16x32_bf16 a[180:183], v[228:231], v[164:167], a[180:183]
    s_andn2_b32 s34, s34, 0x18fff
    ds_read_b128 v[204:207], v246 offset:53248
    v_mfma_f32_16x16x32_bf16 a[184:187], v[228:231], v[168:171], a[184:187]
    v_mfma_f32_16x16x32_bf16 a[188:191], v[228:231], v[172:175], a[188:191]
    s_waitcnt lgkmcnt(6)
    ds_read_b64_tr_b16 v[228:229], v249 offset:28672
    ds_read_b64_tr_b16 v[230:231], v249 offset:30720
    v_mfma_f32_16x16x32_bf16 a[204:207], v[232:235], v[172:175], a[204:207]
    ds_read_b128 v[208:211], v245 offset:57344
    v_mfma_f32_16x16x32_bf16 a[200:203], v[232:235], v[168:171], a[200:203]
    ds_read_b128 v[212:215], v246 offset:57344
    v_mfma_f32_16x16x32_bf16 a[196:199], v[232:235], v[164:167], a[196:199]
    v_mfma_f32_16x16x32_bf16 a[192:195], v[232:235], v[160:163], a[192:195]
    s_waitcnt lgkmcnt(6)
    ds_read_b64_tr_b16 v[232:233], v250 offset:28672
    ds_read_b64_tr_b16 v[234:235], v250 offset:30720
    v_mfma_f32_16x16x32_bf16 a[208:211], v[224:227], v[160:163], a[208:211]
    ds_read_b128 v[216:219], v245 offset:61440
    v_mfma_f32_16x16x32_bf16 a[212:215], v[224:227], v[164:167], a[212:215]
    ds_read_b128 v[220:223], v246 offset:61440
    v_mfma_f32_16x16x32_bf16 a[216:219], v[224:227], v[168:171], a[216:219]
    v_mfma_f32_16x16x32_bf16 a[220:223], v[224:227], v[172:175], a[220:223]
    s_waitcnt lgkmcnt(6)
    v_mfma_f32_16x16x32_bf16 a[236:239], v[228:231], v[172:175], a[236:239]
    s_or_b32 s90, s90, 0x18fff
    v_mfma_f32_16x16x32_bf16 a[232:235], v[228:231], v[168:171], a[232:235]
    s_add_u32 s90, s90, 1
    v_mfma_f32_16x16x32_bf16 a[228:231], v[228:231], v[164:167], a[228:231]
    s_andn2_b32 s90, s90, 0x18fff
    v_mfma_f32_16x16x32_bf16 a[224:227], v[228:231], v[160:163], a[224:227]
    s_waitcnt lgkmcnt(2)
    v_mfma_f32_16x16x32_bf16 a[240:243], v[232:235], v[160:163], a[240:243]
    v_cvt_pk_bf16_f32 v160, v128, v129
    v_cvt_pk_bf16_f32 v161, v130, v131
    v_mfma_f32_16x16x32_bf16 a[244:247], v[232:235], v[164:167], a[244:247]
    v_mfma_f32_16x16x32_bf16 a[248:251], v[232:235], v[168:171], a[248:251]
    v_mfma_f32_16x16x32_bf16 a[252:255], v[232:235], v[172:175], a[252:255]
    s_cbranch_vccnz L_stub2
L_ret2:
    v_mfma_f32_16x16x32_bf16 v[128:131], v[192:195], v[0:3], v[176:179]
    ds_read_b128 v[224:227], v245 offset:51200
    v_cvt_pk_bf16_f32 v164, v132, v133
    v_mfma_f32_16x16x32_bf16 v[128:131], v[196:199], v[16:19], v[128:131]
    ds_read_b128 v[228:231], v246 offset:51200
    v_cvt_pk_bf16_f32 v165, v134, v135
    v_mfma_f32_16x16x32_bf16 v[128:131], v[200:203], v[32:35], v[128:131]
    v_cvt_pk_bf16_f32 v168, v136, v137
    v_cvt_pk_bf16_f32 v169, v138, v139
    v_mfma_f32_16x16x32_bf16 v[128:131], v[204:207], v[48:51], v[128:131]
    v_cvt_pk_bf16_f32 v172, v140, v141
    v_cvt_pk_bf16_f32 v173, v142, v143
    v_mfma_f32_16x16x32_bf16 v[128:131], v[208:211], v[64:67], v[128:131]
    v_cvt_pk_bf16_f32 v162, v144, v145
    v_cvt_pk_bf16_f32 v163, v146, v147
    v_mfma_f32_16x16x32_bf16 v[128:131], v[212:215], v[80:83], v[128:131]
    s_waitcnt lgkmcnt(3)
    v_cvt_pk_bf16_f32 v166, v148, v149
    v_cvt_pk_bf16_f32 v167, v150, v151
    v_mfma_f32_16x16x32_bf16 v[128:131], v[216:219], v[96:99], v[128:131]
    s_waitcnt lgkmcnt(2)
    v_cvt_pk_bf16_f32 v170, v152, v153
    v_cvt_pk_bf16_f32 v171, v154, v155
    v_mfma_f32_16x16x32_bf16 v[128:131], v[220:223], v[112:115], v[128:131]
    v_cvt_pk_bf16_f32 v174, v156, v157
    v_cvt_pk_bf16_f32 v175, v158, v159
    v_mfma_f32_16x16x32_bf16 v[132:135], v[192:195], v[4:7], v[180:183]
    v_add_f32 v236, v236, v240
    v_add_f32 v237, v237, v241
    v_mfma_f32_16x16x32_bf16 v[132:135], v[196:199], v[20:23], v[132:135]
    v_exp_f32 v128, v128
    v_mfma_f32_16x16x32_bf16 v[132:135], v[200:203], v[36:39], v[132:135]
    v_exp_f32 v129, v129
    v_mfma_f32_16x16x32_bf16 v[132:135], v[204:207], v[52:55], v[132:135]
    v_exp_f32 v130, v130
    v_mfma_f32_16x16x32_bf16 v[132:135], v[208:211], v[68:71], v[132:135]
    v_exp_f32 v131, v131
    v_mfma_f32_16x16x32_bf16 v[132:135], v[212:215], v[84:87], v[132:135]
    v_add_f32 v238, v238, v242
    v_add_f32 v239, v239, v243
    v_mfma_f32_16x16x32_bf16 v[132:135], v[216:219], v[100:103], v[132:135]
    v_add_f32 v240, v128, v129
    v_add_f32 v240, v240, v130
    v_mfma_f32_16x16x32_bf16 v[132:135], v[220:223], v[116:119], v[132:135]
    v_add_f32 v240, v240, v131
    v_mfma_f32_16x16x32_bf16 v[136:139], v[192:195], v[8:11], v[184:187]
    v_mfma_f32_16x16x32_bf16 v[136:139], v[196:199], v[24:27], v[136:139]
    v_exp_f32 v132, v132
    v_mfma_f32_16x16x32_bf16 v[136:139], v[200:203], v[40:43], v[136:139]
    v_exp_f32 v133, v133
    v_mfma_f32_16x16x32_bf16 v[136:139], v[204:207], v[56:59], v[136:139]
    v_exp_f32 v134, v134
    v_mfma_f32_16x16x32_bf16 v[136:139], v[208:211], v[72:75], v[136:139]
    v_exp_f32 v135, v135
    v_mfma_f32_16x16x32_bf16 v[136:139], v[212:215], v[88:91], v[136:139]
    v_add_f32 v241, v132, v133
    v_add_f32 v241, v241, v134
    v_mfma_f32_16x16x32_bf16 v[136:139], v[216:219], v[104:107], v[136:139]
    v_add_f32 v241, v241, v135
    v_mfma_f32_16x16x32_bf16 v[136:139], v[220:223], v[120:123], v[136:139]
    v_mfma_f32_16x16x32_bf16 v[140:143], v[192:195], v[12:15], v[188:191]
    ds_read_b128 v[192:195], v245 offset:55296
    v_mfma_f32_16x16x32_bf16 v[140:143], v[196:199], v[28:31], v[140:143]
    ds_read_b128 v[196:199], v246 offset:55296
    v_mfma_f32_16x16x32_bf16 v[140:143], v[200:203], v[44:47], v[140:143]
    ds_read_b128 v[200:203], v245 offset:59392
    v_mfma_f32_16x16x32_bf16 v[140:143], v[204:207], v[60:63], v[140:143]
    ds_read_b128 v[204:207], v246 offset:59392
    v_mfma_f32_16x16x32_bf16 v[140:143], v[208:211], v[76:79], v[140:143]
    ds_read_b128 v[208:211], v245 offset:63488
    v_mfma_f32_16x16x32_bf16 v[140:143], v[212:215], v[92:95], v[140:143]
    ds_read_b128 v[212:215], v246 offset:63488
    v_mfma_f32_16x16x32_bf16 v[140:143], v[216:219], v[108:111], v[140:143]
    v_exp_f32 v136, v136
    v_mfma_f32_16x16x32_bf16 v[140:143], v[220:223], v[124:127], v[140:143]
    s_waitcnt lgkmcnt(7)
    v_exp_f32 v137, v137
    v_mfma_f32_16x16x32_bf16 v[144:147], v[224:227], v[0:3], v[176:179]
    s_waitcnt lgkmcnt(6)
    v_exp_f32 v138, v138
    v_mfma_f32_16x16x32_bf16 v[144:147], v[228:231], v[16:19], v[144:147]
    s_waitcnt lgkmcnt(5)
    v_exp_f32 v139, v139
    v_mfma_f32_16x16x32_bf16 v[144:147], v[192:195], v[32:35], v[144:147]
    s_waitcnt lgkmcnt(4)
    v_exp_f32 v140, v140
    v_mfma_f32_16x16x32_bf16 v[144:147], v[196:199], v[48:51], v[144:147]
    s_waitcnt lgkmcnt(3)
    v_exp_f32 v141, v141
    v_mfma_f32_16x16x32_bf16 v[144:147], v[200:203], v[64:67], v[144:147]
    s_waitcnt lgkmcnt(2)
    v_exp_f32 v142, v142
    v_mfma_f32_16x16x32_bf16 v[144:147], v[204:207], v[80:83], v[144:147]
    s_waitcnt lgkmcnt(1)
    v_exp_f32 v143, v143
    v_mfma_f32_16x16x32_bf16 v[144:147], v[208:211], v[96:99], v[144:147]
    s_waitcnt lgkmcnt(0)
    v_add_f32 v242, v136, v137
    v_add_f32 v242, v242, v138
    v_mfma_f32_16x16x32_bf16 v[144:147], v[212:215], v[112:115], v[144:147]
    v_add_f32 v242, v242, v139
    v_add_f32 v243, v140, v141
    v_mfma_f32_16x16x32_bf16 v[148:151], v[224:227], v[4:7], v[180:183]
    v_add_f32 v243, v243, v142
    v_add_f32 v243, v243, v143
    v_mfma_f32_16x16x32_bf16 v[148:151], v[228:231], v[20:23], v[148:151]
    v_exp_f32 v144, v144
    v_mfma_f32_16x16x32_bf16 v[148:151], v[192:195], v[36:39], v[148:151]
    v_exp_f32 v145, v145
    v_mfma_f32_16x16x32_bf16 v[148:151], v[196:199], v[52:55], v[148:151]
    v_exp_f32 v146, v146
    v_mfma_f32_16x16x32_bf16 v[148:151], v[200:203], v[68:71], v[148:151]
    v_exp_f32 v147, v147
    v_mfma_f32_16x16x32_bf16 v[148:151], v[204:207], v[84:87], v[148:151]
    v_add_f32 v240, v240, v144
    v_add_f32 v240, v240, v145
    v_mfma_f32_16x16x32_bf16 v[148:151], v[208:211], v[100:103], v[148:151]
    v_add_f32 v240, v240, v146
    v_add_f32 v240, v240, v147
    v_mfma_f32_16x16x32_bf16 v[148:151], v[212:215], v[116:119], v[148:151]
    v_mfma_f32_16x16x32_bf16 v[152:155], v[224:227], v[8:11], v[184:187]
    s_waitcnt vmcnt(8)
    s_barrier
    v_mfma_f32_16x16x32_bf16 v[152:155], v[228:231], v[24:27], v[152:155]
    v_exp_f32 v148, v148
    v_mfma_f32_16x16x32_bf16 v[152:155], v[192:195], v[40:43], v[152:155]
    ds_read_b64_tr_b16 v[232:233], v247 offset:32768
    ds_read_b64_tr_b16 v[234:235], v247 offset:34816
    v_mfma_f32_16x16x32_bf16 v[152:155], v[196:199], v[56:59], v[152:155]
    v_exp_f32 v149, v149
    v_mfma_f32_16x16x32_bf16 v[152:155], v[200:203], v[72:75], v[152:155]
    v_exp_f32 v150, v150
    v_mfma_f32_16x16x32_bf16 v[152:155], v[204:207], v[88:91], v[152:155]
    v_exp_f32 v151, v151
    v_mfma_f32_16x16x32_bf16 v[152:155], v[208:211], v[104:107], v[152:155]
    v_add_f32 v241, v241, v148
    v_add_f32 v241, v241, v149
    v_mfma_f32_16x16x32_bf16 v[152:155], v[212:215], v[120:123], v[152:155]
    v_add_f32 v241, v241, v150
    v_add_f32 v241, v241, v151
    v_mfma_f32_16x16x32_bf16 v[156:159], v[224:227], v[12:15], v[188:191]
    ds_read_b64_tr_b16 v[224:225], v248 offset:32768
    ds_read_b64_tr_b16 v[226:227], v248 offset:34816
    v_mfma_f32_16x16x32_bf16 v[156:159], v[228:231], v[28:31], v[156:159]
    ds_read_b64_tr_b16 v[228:229], v249 offset:32768
    ds_read_b64_tr_b16 v[230:231], v249 offset:34816
    v_mfma_f32_16x16x32_bf16 v[156:159], v[192:195], v[44:47], v[156:159]
    v_exp_f32 v152, v152
    v_mfma_f32_16x16x32_bf16 v[156:159], v[196:199], v[60:63], v[156:159]
    v_exp_f32 v153, v153
    v_mfma_f32_16x16x32_bf16 v[156:159], v[200:203], v[76:79], v[156:159]
    v_exp_f32 v154, v154
    v_mfma_f32_16x16x32_bf16 v[156:159], v[204:207], v[92:95], v[156:159]
    v_exp_f32 v155, v155
    v_mfma_f32_16x16x32_bf16 v[156:159], v[208:211], v[108:111], v[156:159]
    v_add_f32 v242, v242, v152
    v_add_f32 v242, v242, v153
    v_mfma_f32_16x16x32_bf16 v[156:159], v[212:215], v[124:127], v[156:159]
    s_waitcnt lgkmcnt(4)
    v_add_f32 v242, v242, v154
    v_add_f32 v242, v242, v155
    v_mfma_f32_16x16x32_bf16 a[12:15], v[232:235], v[172:175], a[12:15]
    v_mfma_f32_16x16x32_bf16 a[8:11], v[232:235], v[168:171], a[8:11]
    v_exp_f32 v156, v156
    v_mfma_f32_16x16x32_bf16 a[4:7], v[232:235], v[164:167], a[4:7]
    v_exp_f32 v157, v157
    v_mfma_f32_16x16x32_bf16 a[0:3], v[232:235], v[160:163], a[0:3]
    s_waitcnt lgkmcnt(2)
    ds_read_b64_tr_b16 v[232:233], v250 offset:32768
    ds_read_b64_tr_b16 v[234:235], v250 offset:34816
    v_mfma_f32_16x16x32_bf16 a[16:19], v[224:227], v[160:163], a[16:19]
    v_exp_f32 v158, v158
    v_mfma_f32_16x16x32_bf16 a[20:23], v[224:227], v[164:167], a[20:23]
    v_exp_f32 v159, v159
    v_mfma_f32_16x16x32_bf16 a[24:27], v[224:227], v[168:171], a[24:27]
    v_add_f32 v243, v243, v156
    v_add_f32 v243, v243, v157
    v_mfma_f32_16x16x32_bf16 a[28:31], v[224:227], v[172:175], a[28:31]
    s_waitcnt lgkmcnt(2)
    ds_read_b64_tr_b16 v[224:225], v247 offset:36864
    ds_read_b64_tr_b16 v[226:227], v247 offset:38912
    v_mfma_f32_16x16x32_bf16 a[44:47], v[228:231], v[172:175], a[44:47]
    v_add_f32 v243, v243, v158
    v_add_f32 v243, v243, v159
    v_mfma_f32_16x16x32_bf16 a[40:43], v[228:231], v[168:171], a[40:43]
    v_max3_f32 v244, v240, v241, v242
    v_max_f32 v244, v244, v243
    v_mfma_f32_16x16x32_bf16 a[36:39], v[228:231], v[164:167], a[36:39]
    v_cmp_lt_f32 vcc, s7, v244
    v_mfma_f32_16x16x32_bf16 a[32:35], v[228:231], v[160:163], a[32:35]
    s_waitcnt lgkmcnt(2)
    ds_read_b64_tr_b16 v[228:229], v248 offset:36864
    ds_read_b64_tr_b16 v[230:231], v248 offset:38912
    v_mfma_f32_16x16x32_bf16 a[48:51], v[232:235], v[160:163], a[48:51]
    s_add_u32 m0, s32, 0x10000
    v_mfma_f32_16x16x32_bf16 a[52:55], v[232:235], v[164:167], a[52:55]
    buffer_load_dwordx4 v251, s[20:23], s35 offen nt lds
    v_mfma_f32_16x16x32_bf16 a[56:59], v[232:235], v[168:171], a[56:59]
    v_mfma_f32_16x16x32_bf16 a[60:63], v[232:235], v[172:175], a[60:63]
    s_waitcnt lgkmcnt(2)
    ds_read_b64_tr_b16 v[232:233], v249 offset:36864
    ds_read_b64_tr_b16 v[234:235], v249 offset:38912
    v_mfma_f32_16x16x32_bf16 a[76:79], v[224:227], v[172:175], a[76:79]
    s_add_u32 m0, s32, 0x10f80
    v_mfma_f32_16x16x32_bf16 a[72:75], v[224:227], v[168:171], a[72:75]
    buffer_load_dwordx4 v251, s[20:23], s35 offen offset:128 nt lds
    v_mfma_f32_16x16x32_bf16 a[68:71], v[224:227], v[164:167], a[68:71]
    v_mfma_f32_16x16x32_bf16 a[64:67], v[224:227], v[160:163], a[64:67]
    s_waitcnt lgkmcnt(2)
    ds_read_b64_tr_b16 v[224:225], v250 offset:36864
    ds_read_b64_tr_b16 v[226:227], v250 offset:38912
    v_mfma_f32_16x16x32_bf16 a[80:83], v[228:231], v[160:163], a[80:83]
    s_add_u32 m0, s32, 0x11f00
    v_mfma_f32_16x16x32_bf16 a[84:87], v[228:231], v[164:167], a[84:87]
    buffer_load_dwordx4 v251, s[20:23], s35 offen offset:256 nt lds
    v_mfma_f32_16x16x32_bf16 a[88:91], v[228:231], v[168:171], a[88:91]
    v_mfma_f32_16x16x32_bf16 a[92:95], v[228:231], v[172:175], a[92:95]
    s_waitcnt lgkmcnt(2)
    ds_read_b64_tr_b16 v[228:229], v247 offset:40960
    ds_read_b64_tr_b16 v[230:231], v247 offset:43008
    v_mfma_f32_16x16x32_bf16 a[108:111], v[232:235], v[172:175], a[108:111]
    s_add_u32 m0, s32, 0x12e80
    v_mfma_f32_16x16x32_bf16 a[104:107], v[232:235], v[168:171], a[104:107]
    buffer_load_dwordx4 v251, s[20:23], s35 offen offset:384 nt lds
    v_mfma_f32_16x16x32_bf16 a[100:103], v[232:235], v[164:167], a[100:103]
    s_or_b32 s35, s35, 0x18fff
    v_mfma_f32_16x16x32_bf16 a[96:99], v[232:235], v[160:163], a[96:99]
    s_waitcnt lgkmcnt(2)
    s_add_u32 s35, s35, 1
    ds_read_b64_tr_b16 v[232:233], v248 offset:40960
    ds_read_b64_tr_b16 v[234:235], v248 offset:43008
    v_mfma_f32_16x16x32_bf16 a[112:115], v[224:227], v[160:163], a[112:115]
    s_andn2_b32 s35, s35, 0x18fff
    s_add_u32 m0, s32, 0x8000
    v_mfma_f32_16x16x32_bf16 a[116:119], v[224:227], v[164:167], a[116:119]
    buffer_load_dwordx4 v251, s[16:19], s34 offen nt lds
    v_mfma_f32_16x16x32_bf16 a[120:123], v[224:227], v[168:171], a[120:123]
    v_mfma_f32_16x16x32_bf16 a[124:127], v[224:227], v[172:175], a[124:127]
    s_waitcnt lgkmcnt(2)
    ds_read_b64_tr_b16 v[224:225], v249 offset:40960
    ds_read_b64_tr_b16 v[226:227], v249 offset:43008
    v_mfma_f32_16x16x32_bf16 a[140:143], v[228:231], v[172:175], a[140:143]
    s_add_u32 m0, s32, 0x8f80
    v_mfma_f32_16x16x32_bf16 a[136:139], v[228:231], v[168:171], a[136:139]
    buffer_load_dwordx4 v251, s[16:19], s34 offen offset:128 nt lds
    v_mfma_f32_16x16x32_bf16 a[132:135], v[228:231], v[164:167], a[132:135]
    v_mfma_f32_16x16x32_bf16 a[128:131], v[228:231], v[160:163], a[128:131]
    s_waitcnt lgkmcnt(2)
    ds_read_b64_tr_b16 v[228:229], v250 offset:40960
    ds_read_b64_tr_b16 v[230:231], v250 offset:43008
    v_mfma_f32_16x16x32_bf16 a[144:147], v[232:235], v[160:163], a[144:147]
    s_add_u32 m0, s32, 0x9f00
    v_mfma_f32_16x16x32_bf16 a[148:151], v[232:235], v[164:167], a[148:151]
    buffer_load_dwordx4 v251, s[16:19], s34 offen offset:256 nt lds
    v_mfma_f32_16x16x32_bf16 a[152:155], v[232:235], v[168:171], a[152:155]
    v_mfma_f32_16x16x32_bf16 a[156:159], v[232:235], v[172:175], a[156:159]
    s_waitcnt lgkmcnt(2)
    ds_read_b64_tr_b16 v[232:233], v247 offset:45056
    ds_read_b64_tr_b16 v[234:235], v247 offset:47104
    v_mfma_f32_16x16x32_bf16 a[172:175], v[224:227], v[172:175], a[172:175]
    ds_read_b128 v[192:195], v245 offset:0
    v_mfma_f32_16x16x32_bf16 a[168:171], v[224:227], v[168:171], a[168:171]
    s_add_u32 m0, s32, 0xae80
    ds_read_b128 v[196:199], v246 offset:0
    v_mfma_f32_16x16x32_bf16 a[164:167], v[224:227], v[164:167], a[164:167]
    buffer_load_dwordx4 v251, s[16:19], s34 offen offset:384 nt lds
    v_mfma_f32_16x16x32_bf16 a[160:163], v[224:227], v[160:163], a[160:163]
    s_waitcnt lgkmcnt(4)
    s_or_b32 s34, s34, 0x18fff
    ds_read_b64_tr_b16 v[224:225], v248 offset:45056
    ds_read_b64_tr_b16 v[226:227], v248 offset:47104
    v_mfma_f32_16x16x32_bf16 a[176:179], v[228:231], v[160:163], a[176:179]
    s_add_u32 s34, s34, 1
    ds_read_b128 v[200:203], v245 offset:4096
    v_mfma_f32_16x16x32_bf16 a[180:183], v[228:231], v[164:167], a[180:183]
    s_andn2_b32 s34, s34, 0x18fff
    ds_read_b128 v[204:207], v246 offset:4096
    v_mfma_f32_16x16x32_bf16 a[184:187], v[228:231], v[168:171], a[184:187]
    v_mfma_f32_16x16x32_bf16 a[188:191], v[228:231], v[172:175], a[188:191]
    s_waitcnt lgkmcnt(6)
    ds_read_b64_tr_b16 v[228:229], v249 offset:45056
    ds_read_b64_tr_b16 v[230:231], v249 offset:47104
    v_mfma_f32_16x16x32_bf16 a[204:207], v[232:235], v[172:175], a[204:207]
    ds_read_b128 v[208:211], v245 offset:8192
    v_mfma_f32_16x16x32_bf16 a[200:203], v[232:235], v[168:171], a[200:203]
    ds_read_b128 v[212:215], v246 offset:8192
    v_mfma_f32_16x16x32_bf16 a[196:199], v[232:235], v[164:167], a[196:199]
    v_mfma_f32_16x16x32_bf16 a[192:195], v[232:235], v[160:163], a[192:195]
    s_waitcnt lgkmcnt(6)
    ds_read_b64_tr_b16 v[232:233], v250 offset:45056
    ds_read_b64_tr_b16 v[234:235], v250 offset:47104
    v_mfma_f32_16x16x32_bf16 a[208:211], v[224:227], v[160:163], a[208:211]
    ds_read_b128 v[216:219], v245 offset:12288
    v_mfma_f32_16x16x32_bf16 a[212:215], v[224:227], v[164:167], a[212:215]
    ds_read_b128 v[220:223], v246 offset:12288
    v_mfma_f32_16x16x32_bf16 a[216:219], v[224:227], v[168:171], a[216:219]
    v_mfma_f32_16x16x32_bf16 a[220:223], v[224:227], v[172:175], a[220:223]
    s_waitcnt lgkmcnt(6)
    v_mfma_f32_16x16x32_bf16 a[236:239], v[228:231], v[172:175], a[236:239]
    s_or_b32 s90, s90, 0x18fff
    v_mfma_f32_16x16x32_bf16 a[232:235], v[228:231], v[168:171], a[232:235]
    s_add_u32 s90, s90, 1
    v_mfma_f32_16x16x32_bf16 a[228:231], v[228:231], v[164:167], a[228:231]
    s_andn2_b32 s90, s90, 0x18fff
    v_mfma_f32_16x16x32_bf16 a[224:227], v[228:231], v[160:163], a[224:227]
    s_waitcnt lgkmcnt(2)
    v_mfma_f32_16x16x32_bf16 a[240:243], v[232:235], v[160:163], a[240:243]
    v_cvt_pk_bf16_f32 v160, v128, v129
    v_cvt_pk_bf16_f32 v161, v130, v131
    v_mfma_f32_16x16x32_bf16 a[244:247], v[232:235], v[164:167], a[244:247]
    v_mfma_f32_16x16x32_bf16 a[248:251], v[232:235], v[168:171], a[248:251]
    v_mfma_f32_16x16x32_bf16 a[252:255], v[232:235], v[172:175], a[252:255]
    s_cbranch_vccnz L_stub3
L_ret3:
    v_mfma_f32_16x16x32_bf16 v[128:131], v[192:195], v[0:3], v[176:179]
    ds_read_b128 v[224:227], v245 offset:2048
    v_cvt_pk_bf16_f32 v164, v132, v133
    v_mfma_f32_16x16x32_bf16 v[128:131], v[196:199], v[16:19], v[128:131]
    ds_read_b128 v[228:231], v246 offset:2048
    v_cvt_pk_bf16_f32 v165, v134, v135
    v_mfma_f32_16x16x32_bf16 v[128:131], v[200:203], v[32:35], v[128:131]
    v_cvt_pk_bf16_f32 v168, v136, v137
    v_cvt_pk_bf16_f32 v169, v138, v139
    v_mfma_f32_16x16x32_bf16 v[128:131], v[204:207], v[48:51], v[128:131]
    v_cvt_pk_bf16_f32 v172, v140, v141
    v_cvt_pk_bf16_f32 v173, v142, v143
    v_mfma_f32_16x16x32_bf16 v[128:131], v[208:211], v[64:67], v[128:131]
    v_cvt_pk_bf16_f32 v162, v144, v145
    v_cvt_pk_bf16_f32 v163, v146, v147
    v_mfma_f32_16x16x32_bf16 v[128:131], v[212:215], v[80:83], v[128:131]
    s_waitcnt lgkmcnt(3)
    v_cvt_pk_bf16_f32 v166, v148, v149
    v_cvt_pk_bf16_f32 v167, v150, v151
    v_mfma_f32_16x16x32_bf16 v[128:131], v[216:219], v[96:99], v[128:131]
    s_waitcnt lgkmcnt(2)
    v_cvt_pk_bf16_f32 v170, v152, v153
    v_cvt_pk_bf16_f32 v171, v154, v155
    v_mfma_f32_16x16x32_bf16 v[128:131], v[220:223], v[112:115], v[128:131]
    v_cvt_pk_bf16_f32 v174, v156, v157
    v_cvt_pk_bf16_f32 v175, v158, v159
    v_mfma_f32_16x16x32_bf16 v[132:135], v[192:195], v[4:7], v[180:183]
    v_add_f32 v236, v236, v240
    v_add_f32 v237, v237, v241
    v_mfma_f32_16x16x32_bf16 v[132:135], v[196:199], v[20:23], v[132:135]
    v_exp_f32 v128, v128
    v_mfma_f32_16x16x32_bf16 v[132:135], v[200:203], v[36:39], v[132:135]
    v_exp_f32 v129, v129
    v_mfma_f32_16x16x32_bf16 v[132:135], v[204:207], v[52:55], v[132:135]
    v_exp_f32 v130, v130
    v_mfma_f32_16x16x32_bf16 v[132:135], v[208:211], v[68:71], v[132:135]
    v_exp_f32 v131, v131
    v_mfma_f32_16x16x32_bf16 v[132:135], v[212:215], v[84:87], v[132:135]
    v_add_f32 v238, v238, v242
    v_add_f32 v239, v239, v243
    v_mfma_f32_16x16x32_bf16 v[132:135], v[216:219], v[100:103], v[132:135]
    v_add_f32 v240, v128, v129
    v_add_f32 v240, v240, v130
    v_mfma_f32_16x16x32_bf16 v[132:135], v[220:223], v[116:119], v[132:135]
    v_add_f32 v240, v240, v131
    v_mfma_f32_16x16x32_bf16 v[136:139], v[192:195], v[8:11], v[184:187]
    v_mfma_f32_16x16x32_bf16 v[136:139], v[196:199], v[24:27], v[136:139]
    v_exp_f32 v132, v132
    v_mfma_f32_16x16x32_bf16 v[136:139], v[200:203], v[40:43], v[136:139]
    v_exp_f32 v133, v133
    v_mfma_f32_16x16x32_bf16 v[136:139], v[204:207], v[56:59], v[136:139]
    v_exp_f32 v134, v134
    v_mfma_f32_16x16x32_bf16 v[136:139], v[208:211], v[72:75], v[136:139]
    v_exp_f32 v135, v135
    v_mfma_f32_16x16x32_bf16 v[136:139], v[212:215], v[88:91], v[136:139]
    v_add_f32 v241, v132, v133
    v_add_f32 v241, v241, v134
    v_mfma_f32_16x16x32_bf16 v[136:139], v[216:219], v[104:107], v[136:139]
    v_add_f32 v241, v241, v135
    v_mfma_f32_16x16x32_bf16 v[136:139], v[220:223], v[120:123], v[136:139]
    v_mfma_f32_16x16x32_bf16 v[140:143], v[192:195], v[12:15], v[188:191]
    ds_read_b128 v[192:195], v245 offset:6144
    v_mfma_f32_16x16x32_bf16 v[140:143], v[196:199], v[28:31], v[140:143]
    ds_read_b128 v[196:199], v246 offset:6144
    v_mfma_f32_16x16x32_bf16 v[140:143], v[200:203], v[44:47], v[140:143]
    ds_read_b128 v[200:203], v245 offset:10240
    v_mfma_f32_16x16x32_bf16 v[140:143], v[204:207], v[60:63], v[140:143]
    ds_read_b128 v[204:207], v246 offset:10240
    v_mfma_f32_16x16x32_bf16 v[140:143], v[208:211], v[76:79], v[140:143]
    ds_read_b128 v[208:211], v245 offset:14336
    v_mfma_f32_16x16x32_bf16 v[140:143], v[212:215], v[92:95], v[140:143]
    ds_read_b128 v[212:215], v246 offset:14336
    v_mfma_f32_16x16x32_bf16 v[140:143], v[216:219], v[108:111], v[140:143]
    v_exp_f32 v136, v136
    v_mfma_f32_16x16x32_bf16 v[140:143], v[220:223], v[124:127], v[140:143]
    s_waitcnt lgkmcnt(7)
    v_exp_f32 v137, v137
    v_mfma_f32_16x16x32_bf16 v[144:147], v[224:227], v[0:3], v[176:179]
    s_waitcnt lgkmcnt(6)
    v_exp_f32 v138, v138
    v_mfma_f32_16x16x32_bf16 v[144:147], v[228:231], v[16:19], v[144:147]
    s_waitcnt lgkmcnt(5)
    v_exp_f32 v139, v139
    v_mfma_f32_16x16x32_bf16 v[144:147], v[192:195], v[32:35], v[144:147]
    s_waitcnt lgkmcnt(4)
    v_exp_f32 v140, v140
    v_mfma_f32_16x16x32_bf16 v[144:147], v[196:199], v[48:51], v[144:147]
    s_waitcnt lgkmcnt(3)
    v_exp_f32 v141, v141
    v_mfma_f32_16x16x32_bf16 v[144:147], v[200:203], v[64:67], v[144:147]
    s_waitcnt lgkmcnt(2)
    v_exp_f32 v142, v142
    v_mfma_f32_16x16x32_bf16 v[144:147], v[204:207], v[80:83], v[144:147]
    s_waitcnt lgkmcnt(1)
    v_exp_f32 v143, v143
    v_mfma_f32_16x16x32_bf16 v[144:147], v[208:211], v[96:99], v[144:147]
    s_waitcnt lgkmcnt(0)
    v_add_f32 v242, v136, v137
    v_add_f32 v242, v242, v138
    v_mfma_f32_16x16x32_bf16 v[144:147], v[212:215], v[112:115], v[144:147]
    v_add_f32 v242, v242, v139
    v_add_f32 v243, v140, v141
    v_mfma_f32_16x16x32_bf16 v[148:151], v[224:227], v[4:7], v[180:183]
    v_add_f32 v243, v243, v142
    v_add_f32 v243, v243, v143
    v_mfma_f32_16x16x32_bf16 v[148:151], v[228:231], v[20:23], v[148:151]
    v_exp_f32 v144, v144
    v_mfma_f32_16x16x32_bf16 v[148:151], v[192:195], v[36:39], v[148:151]
    v_exp_f32 v145, v145
    v_mfma_f32_16x16x32_bf16 v[148:151], v[196:199], v[52:55], v[148:151]
    v_exp_f32 v146, v146
    v_mfma_f32_16x16x32_bf16 v[148:151], v[200:203], v[68:71], v[148:151]
    v_exp_f32 v147, v147
    v_mfma_f32_16x16x32_bf16 v[148:151], v[204:207], v[84:87], v[148:151]
    v_add_f32 v240, v240, v144
    v_add_f32 v240, v240, v145
    v_mfma_f32_16x16x32_bf16 v[148:151], v[208:211], v[100:103], v[148:151]
    v_add_f32 v240, v240, v146
    v_add_f32 v240, v240, v147
    v_mfma_f32_16x16x32_bf16 v[148:151], v[212:215], v[116:119], v[148:151]
    v_mfma_f32_16x16x32_bf16 v[152:155], v[224:227], v[8:11], v[184:187]
    s_waitcnt vmcnt(8)
    s_barrier
    v_mfma_f32_16x16x32_bf16 v[152:155], v[228:231], v[24:27], v[152:155]
    v_exp_f32 v148, v148
    v_mfma_f32_16x16x32_bf16 v[152:155], v[192:195], v[40:43], v[152:155]
    ds_read_b64_tr_b16 v[232:233], v247 offset:49152
    ds_read_b64_tr_b16 v[234:235], v247 offset:51200
    v_mfma_f32_16x16x32_bf16 v[152:155], v[196:199], v[56:59], v[152:155]
    v_exp_f32 v149, v149
    v_mfma_f32_16x16x32_bf16 v[152:155], v[200:203], v[72:75], v[152:155]
    v_exp_f32 v150, v150
    v_mfma_f32_16x16x32_bf16 v[152:155], v[204:207], v[88:91], v[152:155]
    v_exp_f32 v151, v151
    v_mfma_f32_16x16x32_bf16 v[152:155], v[208:211], v[104:107], v[152:155]
    v_add_f32 v241, v241, v148
    v_add_f32 v241, v241, v149
    v_mfma_f32_16x16x32_bf16 v[152:155], v[212:215], v[120:123], v[152:155]
    v_add_f32 v241, v241, v150
    v_add_f32 v241, v241, v151
    v_mfma_f32_16x16x32_bf16 v[156:159], v[224:227], v[12:15], v[188:191]
    ds_read_b64_tr_b16 v[224:225], v248 offset:49152
    ds_read_b64_tr_b16 v[226:227], v248 offset:51200
    v_mfma_f32_16x16x32_bf16 v[156:159], v[228:231], v[28:31], v[156:159]
    ds_read_b64_tr_b16 v[228:229], v249 offset:49152
    ds_read_b64_tr_b16 v[230:231], v249 offset:51200
    v_mfma_f32_16x16x32_bf16 v[156:159], v[192:195], v[44:47], v[156:159]
    v_exp_f32 v152, v152
    v_mfma_f32_16x16x32_bf16 v[156:159], v[196:199], v[60:63], v[156:159]
    v_exp_f32 v153, v153
    v_mfma_f32_16x16x32_bf16 v[156:159], v[200:203], v[76:79], v[156:159]
    v_exp_f32 v154, v154
    v_mfma_f32_16x16x32_bf16 v[156:159], v[204:207], v[92:95], v[156:159]
    v_exp_f32 v155, v155
    v_mfma_f32_16x16x32_bf16 v[156:159], v[208:211], v[108:111], v[156:159]
    v_add_f32 v242, v242, v152
    v_add_f32 v242, v242, v153
    v_mfma_f32_16x16x32_bf16 v[156:159], v[212:215], v[124:127], v[156:159]
    s_waitcnt lgkmcnt(4)
    v_add_f32 v242, v242, v154
    v_add_f32 v242, v242, v155
    v_mfma_f32_16x16x32_bf16 a[12:15], v[232:235], v[172:175], a[12:15]
    v_mfma_f32_16x16x32_bf16 a[8:11], v[232:235], v[168:171], a[8:11]
    v_exp_f32 v156, v156
    v_mfma_f32_16x16x32_bf16 a[4:7], v[232:235], v[164:167], a[4:7]
    v_exp_f32 v157, v157
    v_mfma_f32_16x16x32_bf16 a[0:3], v[232:235], v[160:163], a[0:3]
    s_waitcnt lgkmcnt(2)
    ds_read_b64_tr_b16 v[232:233], v250 offset:49152
    ds_read_b64_tr_b16 v[234:235], v250 offset:51200
    v_mfma_f32_16x16x32_bf16 a[16:19], v[224:227], v[160:163], a[16:19]
    v_exp_f32 v158, v158
    v_mfma_f32_16x16x32_bf16 a[20:23], v[224:227], v[164:167], a[20:23]
    v_exp_f32 v159, v159
    v_mfma_f32_16x16x32_bf16 a[24:27], v[224:227], v[168:171], a[24:27]
    v_add_f32 v243, v243, v156
    v_add_f32 v243, v243, v157
    v_mfma_f32_16x16x32_bf16 a[28:31], v[224:227], v[172:175], a[28:31]
    s_waitcnt lgkmcnt(2)
    ds_read_b64_tr_b16 v[224:225], v247 offset:53248
    ds_read_b64_tr_b16 v[226:227], v247 offset:55296
    v_mfma_f32_16x16x32_bf16 a[44:47], v[228:231], v[172:175], a[44:47]
    v_add_f32 v243, v243, v158
    v_add_f32 v243, v243, v159
    v_mfma_f32_16x16x32_bf16 a[40:43], v[228:231], v[168:171], a[40:43]
    v_max3_f32 v244, v240, v241, v242
    v_max_f32 v244, v244, v243
    v_mfma_f32_16x16x32_bf16 a[36:39], v[228:231], v[164:167], a[36:39]
    v_cmp_lt_f32 vcc, s7, v244
    v_mfma_f32_16x16x32_bf16 a[32:35], v[228:231], v[160:163], a[32:35]
    s_waitcnt lgkmcnt(2)
    ds_read_b64_tr_b16 v[228:229], v248 offset:53248
    ds_read_b64_tr_b16 v[230:231], v248 offset:55296
    v_mfma_f32_16x16x32_bf16 a[48:51], v[232:235], v[160:163], a[48:51]
    s_add_u32 m0, s32, 0x14000
    v_mfma_f32_16x16x32_bf16 a[52:55], v[232:235], v[164:167], a[52:55]
    buffer_load_dwordx4 v251, s[20:23], s35 offen nt lds
    v_mfma_f32_16x16x32_bf16 a[56:59], v[232:235], v[168:171], a[56:59]
    v_mfma_f32_16x16x32_bf16 a[60:63], v[232:235], v[172:175], a[60:63]
    s_waitcnt lgkmcnt(2)
    ds_read_b64_tr_b16 v[232:233], v249 offset:53248
    ds_read_b64_tr_b16 v[234:235], v249 offset:55296
    v_mfma_f32_16x16x32_bf16 a[76:79], v[224:227], v[172:175], a[76:79]
    s_add_u32 m0, s32, 0x14f80
    v_mfma_f32_16x16x32_bf16 a[72:75], v[224:227], v[168:171], a[72:75]
    buffer_load_dwordx4 v251, s[20:23], s35 offen offset:128 nt lds
    v_mfma_f32_16x16x32_bf16 a[68:71], v[224:227], v[164:167], a[68:71]
    v_mfma_f32_16x16x32_bf16 a[64:67], v[224:227], v[160:163], a[64:67]
    s_waitcnt lgkmcnt(2)
    ds_read_b64_tr_b16 v[224:225], v250 offset:53248
    ds_read_b64_tr_b16 v[226:227], v250 offset:55296
    v_mfma_f32_16x16x32_bf16 a[80:83], v[228:231], v[160:163], a[80:83]
    s_add_u32 m0, s32, 0x15f00
    v_mfma_f32_16x16x32_bf16 a[84:87], v[228:231], v[164:167], a[84:87]
    buffer_load_dwordx4 v251, s[20:23], s35 offen offset:256 nt lds
    v_mfma_f32_16x16x32_bf16 a[88:91], v[228:231], v[168:171], a[88:91]
    v_mfma_f32_16x16x32_bf16 a[92:95], v[228:231], v[172:175], a[92:95]
    s_waitcnt lgkmcnt(2)
    ds_read_b64_tr_b16 v[228:229], v247 offset:57344
    ds_read_b64_tr_b16 v[230:231], v247 offset:59392
    v_mfma_f32_16x16x32_bf16 a[108:111], v[232:235], v[172:175], a[108:111]
    s_add_u32 m0, s32, 0x16e80
    v_mfma_f32_16x16x32_bf16 a[104:107], v[232:235], v[168:171], a[104:107]
    buffer_load_dwordx4 v251, s[20:23], s35 offen offset:384 nt lds
    v_mfma_f32_16x16x32_bf16 a[100:103], v[232:235], v[164:167], a[100:103]
    s_or_b32 s35, s35, 0x18fff
    v_mfma_f32_16x16x32_bf16 a[96:99], v[232:235], v[160:163], a[96:99]
    s_waitcnt lgkmcnt(2)
    s_add_u32 s35, s35, 1
    ds_read_b64_tr_b16 v[232:233], v248 offset:57344
    ds_read_b64_tr_b16 v[234:235], v248 offset:59392
    v_mfma_f32_16x16x32_bf16 a[112:115], v[224:227], v[160:163], a[112:115]
    s_andn2_b32 s35, s35, 0x18fff
    s_add_u32 m0, s32, 0xc000
    v_mfma_f32_16x16x32_bf16 a[116:119], v[224:227], v[164:167], a[116:119]
    buffer_load_dwordx4 v251, s[16:19], s34 offen nt lds
    v_mfma_f32_16x16x32_bf16 a[120:123], v[224:227], v[168:171], a[120:123]
    v_mfma_f32_16x16x32_bf16 a[124:127], v[224:227], v[172:175], a[124:127]
    s_waitcnt lgkmcnt(2)
    ds_read_b64_tr_b16 v[224:225], v249 offset:57344
    ds_read_b64_tr_b16 v[226:227], v249 offset:59392
    v_mfma_f32_16x16x32_bf16 a[140:143], v[228:231], v[172:175], a[140:143]
    s_add_u32 m0, s32, 0xcf80
    v_mfma_f32_16x16x32_bf16 a[136:139], v[228:231], v[168:171], a[136:139]
    buffer_load_dwordx4 v251, s[16:19], s34 offen offset:128 nt lds
    v_mfma_f32_16x16x32_bf16 a[132:135], v[228:231], v[164:167], a[132:135]
    v_mfma_f32_16x16x32_bf16 a[128:131], v[228:231], v[160:163], a[128:131]
    s_waitcnt lgkmcnt(2)
    ds_read_b64_tr_b16 v[228:229], v250 offset:57344
    ds_read_b64_tr_b16 v[230:231], v250 offset:59392
    v_mfma_f32_16x16x32_bf16 a[144:147], v[232:235], v[160:163], a[144:147]
    s_add_u32 m0, s32, 0xdf00
    v_mfma_f32_16x16x32_bf16 a[148:151], v[232:235], v[164:167], a[148:151]
    buffer_load_dwordx4 v251, s[16:19], s34 offen offset:256 nt lds
    v_mfma_f32_16x16x32_bf16 a[152:155], v[232:235], v[168:171], a[152:155]
    v_mfma_f32_16x16x32_bf16 a[156:159], v[232:235], v[172:175], a[156:159]
    s_waitcnt lgkmcnt(2)
    ds_read_b64_tr_b16 v[232:233], v247 offset:61440
    ds_read_b64_tr_b16 v[234:235], v247 offset:63488
    v_mfma_f32_16x16x32_bf16 a[172:175], v[224:227], v[172:175], a[172:175]
    ds_read_b128 v[192:195], v245 offset:16384
    v_mfma_f32_16x16x32_bf16 a[168:171], v[224:227], v[168:171], a[168:171]
    s_add_u32 m0, s32, 0xee80
    ds_read_b128 v[196:199], v246 offset:16384
    v_mfma_f32_16x16x32_bf16 a[164:167], v[224:227], v[164:167], a[164:167]
    buffer_load_dwordx4 v251, s[16:19], s34 offen offset:384 nt lds
    v_mfma_f32_16x16x32_bf16 a[160:163], v[224:227], v[160:163], a[160:163]
    s_waitcnt lgkmcnt(4)
    s_or_b32 s34, s34, 0x18fff
    ds_read_b64_tr_b16 v[224:225], v248 offset:61440
    ds_read_b64_tr_b16 v[226:227], v248 offset:63488
    v_mfma_f32_16x16x32_bf16 a[176:179], v[228:231], v[160:163], a[176:179]
    s_add_u32 s34, s34, 1
    ds_read_b128 v[200:203], v245 offset:20480
    v_mfma_f32_16x16x32_bf16 a[180:183], v[228:231], v[164:167], a[180:183]
    s_andn2_b32 s34, s34, 0x18fff
    ds_read_b128 v[204:207], v246 offset:20480
    v_mfma_f32_16x16x32_bf16 a[184:187], v[228:231], v[168:171], a[184:187]
    v_mfma_f32_16x16x32_bf16 a[188:191], v[228:231], v[172:175], a[188:191]
    s_waitcnt lgkmcnt(6)
    ds_read_b64_tr_b16 v[228:229], v249 offset:61440
    ds_read_b64_tr_b16 v[230:231], v249 offset:63488
    v_mfma_f32_16x16x32_bf16 a[204:207], v[232:235], v[172:175], a[204:207]
    ds_read_b128 v[208:211], v245 offset:24576
    v_mfma_f32_16x16x32_bf16 a[200:203], v[232:235], v[168:171], a[200:203]
    ds_read_b128 v[212:215], v246 offset:24576
    v_mfma_f32_16x16x32_bf16 a[196:199], v[232:235], v[164:167], a[196:199]
    v_mfma_f32_16x16x32_bf16 a[192:195], v[232:235], v[160:163], a[192:195]
    s_waitcnt lgkmcnt(6)
    ds_read_b64_tr_b16 v[232:233], v250 offset:61440
    ds_read_b64_tr_b16 v[234:235], v250 offset:63488
    v_mfma_f32_16x16x32_bf16 a[208:211], v[224:227], v[160:163], a[208:211]
    ds_read_b128 v[216:219], v245 offset:28672
    v_mfma_f32_16x16x32_bf16 a[212:215], v[224:227], v[164:167], a[212:215]
    ds_read_b128 v[220:223], v246 offset:28672
    v_mfma_f32_16x16x32_bf16 a[216:219], v[224:227], v[168:171], a[216:219]
    v_mfma_f32_16x16x32_bf16 a[220:223], v[224:227], v[172:175], a[220:223]
    s_waitcnt lgkmcnt(6)
    v_mfma_f32_16x16x32_bf16 a[236:239], v[228:231], v[172:175], a[236:239]
    s_or_b32 s90, s90, 0x18fff
    v_mfma_f32_16x16x32_bf16 a[232:235], v[228:231], v[168:171], a[232:235]
    s_add_u32 s90, s90, 1
    v_mfma_f32_16x16x32_bf16 a[228:231], v[228:231], v[164:167], a[228:231]
    s_andn2_b32 s90, s90, 0x18fff
    v_mfma_f32_16x16x32_bf16 a[224:227], v[228:231], v[160:163], a[224:227]
    s_waitcnt lgkmcnt(2)
    v_mfma_f32_16x16x32_bf16 a[240:243], v[232:235], v[160:163], a[240:243]
    v_cvt_pk_bf16_f32 v160, v128, v129
    v_cvt_pk_bf16_f32 v161, v130, v131
    v_mfma_f32_16x16x32_bf16 a[244:247], v[232:235], v[164:167], a[244:247]
    v_mfma_f32_16x16x32_bf16 a[248:251], v[232:235], v[168:171], a[248:251]
    v_mfma_f32_16x16x32_bf16 a[252:255], v[232:235], v[172:175], a[252:255]
    s_cbranch_vccnz L_stub4
L_ret4:
    v_mfma_f32_16x16x32_bf16 v[128:131], v[192:195], v[0:3], v[176:179]
    ds_read_b128 v[224:227], v245 offset:18432
    v_cvt_pk_bf16_f32 v164, v132, v133
    v_mfma_f32_16x16x32_bf16 v[128:131], v[196:199], v[16:19], v[128:131]
    ds_read_b128 v[228:231], v246 offset:18432
    v_cvt_pk_bf16_f32 v165, v134, v135
    v_mfma_f32_16x16x32_bf16 v[128:131], v[200:203], v[32:35], v[128:131]
    v_cvt_pk_bf16_f32 v168, v136, v137
    v_cvt_pk_bf16_f32 v169, v138, v139
    v_mfma_f32_16x16x32_bf16 v[128:131], v[204:207], v[48:51], v[128:131]
    v_cvt_pk_bf16_f32 v172, v140, v141
    v_cvt_pk_bf16_f32 v173, v142, v143
    v_mfma_f32_16x16x32_bf16 v[128:131], v[208:211], v[64:67], v[128:131]
    v_cvt_pk_bf16_f32 v162, v144, v145
    v_cvt_pk_bf16_f32 v163, v146, v147
    v_mfma_f32_16x16x32_bf16 v[128:131], v[212:215], v[80:83], v[128:131]
    s_waitcnt lgkmcnt(3)
    v_cvt_pk_bf16_f32 v166, v148, v149
    v_cvt_pk_bf16_f32 v167, v150, v151
    v_mfma_f32_16x16x32_bf16 v[128:131], v[216:219], v[96:99], v[128:131]
    s_waitcnt lgkmcnt(2)
    v_cvt_pk_bf16_f32 v170, v152, v153
    v_cvt_pk_bf16_f32 v171, v154, v155
    v_mfma_f32_16x16x32_bf16 v[128:131], v[220:223], v[112:115], v[128:131]
    v_cvt_pk_bf16_f32 v174, v156, v157
    v_cvt_pk_bf16_f32 v175, v158, v159
    v_mfma_f32_16x16x32_bf16 v[132:135], v[192:195], v[4:7], v[180:183]
    v_add_f32 v236, v236, v240
    v_add_f32 v237, v237, v241
    v_mfma_f32_16x16x32_bf16 v[132:135], v[196:199], v[20:23], v[132:135]
    v_exp_f32 v128, v128
    v_mfma_f32_16x16x32_bf16 v[132:135], v[200:203], v[36:39], v[132:135]
    v_exp_f32 v129, v129
    v_mfma_f32_16x16x32_bf16 v[132:135], v[204:207], v[52:55], v[132:135]
    v_exp_f32 v130, v130
    v_mfma_f32_16x16x32_bf16 v[132:135], v[208:211], v[68:71], v[132:135]
    v_exp_f32 v131, v131
    v_mfma_f32_16x16x32_bf16 v[132:135], v[212:215], v[84:87], v[132:135]
    v_add_f32 v238, v238, v242
    v_add_f32 v239, v239, v243
    v_mfma_f32_16x16x32_bf16 v[132:135], v[216:219], v[100:103], v[132:135]
    v_add_f32 v240, v128, v129
    v_add_f32 v240, v240, v130
    v_mfma_f32_16x16x32_bf16 v[132:135], v[220:223], v[116:119], v[132:135]
    v_add_f32 v240, v240, v131
    v_mfma_f32_16x16x32_bf16 v[136:139], v[192:195], v[8:11], v[184:187]
    v_mfma_f32_16x16x32_bf16 v[136:139], v[196:199], v[24:27], v[136:139]
    v_exp_f32 v132, v132
    v_mfma_f32_16x16x32_bf16 v[136:139], v[200:203], v[40:43], v[136:139]
    v_exp_f32 v133, v133
    v_mfma_f32_16x16x32_bf16 v[136:139], v[204:207], v[56:59], v[136:139]
    v_exp_f32 v134, v134
    v_mfma_f32_16x16x32_bf16 v[136:139], v[208:211], v[72:75], v[136:139]
    v_exp_f32 v135, v135
    v_mfma_f32_16x16x32_bf16 v[136:139], v[212:215], v[88:91], v[136:139]
    v_add_f32 v241, v132, v133
    v_add_f32 v241, v241, v134
    v_mfma_f32_16x16x32_bf16 v[136:139], v[216:219], v[104:107], v[136:139]
    v_add_f32 v241, v241, v135
    v_mfma_f32_16x16x32_bf16 v[136:139], v[220:223], v[120:123], v[136:139]
    v_mfma_f32_16x16x32_bf16 v[140:143], v[192:195], v[12:15], v[188:191]
    ds_read_b128 v[192:195], v245 offset:22528
    v_mfma_f32_16x16x32_bf16 v[140:143], v[196:199], v[28:31], v[140:143]
    ds_read_b128 v[196:199], v246 offset:22528
    v_mfma_f32_16x16x32_bf16 v[140:143], v[200:203], v[44:47], v[140:143]
    ds_read_b128 v[200:203], v245 offset:26624
    v_mfma_f32_16x16x32_bf16 v[140:143], v[204:207], v[60:63], v[140:143]
    ds_read_b128 v[204:207], v246 offset:26624
    v_mfma_f32_16x16x32_bf16 v[140:143], v[208:211], v[76:79], v[140:143]
    ds_read_b128 v[208:211], v245 offset:30720
    v_mfma_f32_16x16x32_bf16 v[140:143], v[212:215], v[92:95], v[140:143]
    ds_read_b128 v[212:215], v246 offset:30720
    v_mfma_f32_16x16x32_bf16 v[140:143], v[216:219], v[108:111], v[140:143]
    v_exp_f32 v136, v136
    v_mfma_f32_16x16x32_bf16 v[140:143], v[220:223], v[124:127], v[140:143]
    s_waitcnt lgkmcnt(7)
    v_exp_f32 v137, v137
    v_mfma_f32_16x16x32_bf16 v[144:147], v[224:227], v[0:3], v[176:179]
    s_waitcnt lgkmcnt(6)
    v_exp_f32 v138, v138
    v_mfma_f32_16x16x32_bf16 v[144:147], v[228:231], v[16:19], v[144:147]
    s_waitcnt lgkmcnt(5)
    v_exp_f32 v139, v139
    v_mfma_f32_16x16x32_bf16 v[144:147], v[192:195], v[32:35], v[144:147]
    s_waitcnt lgkmcnt(4)
    v_exp_f32 v140, v140
    v_mfma_f32_16x16x32_bf16 v[144:147], v[196:199], v[48:51], v[144:147]
    s_waitcnt lgkmcnt(3)
    v_exp_f32 v141, v141
    v_mfma_f32_16x16x32_bf16 v[144:147], v[200:203], v[64:67], v[144:147]
    s_waitcnt lgkmcnt(2)
    v_exp_f32 v142, v142
    v_mfma_f32_16x16x32_bf16 v[144:147], v[204:207], v[80:83], v[144:147]
    s_waitcnt lgkmcnt(1)
    v_exp_f32 v143, v143
    v_mfma_f32_16x16x32_bf16 v[144:147], v[208:211], v[96:99], v[144:147]
    s_waitcnt lgkmcnt(0)
    v_add_f32 v242, v136, v137
    v_add_f32 v242, v242, v138
    v_mfma_f32_16x16x32_bf16 v[144:147], v[212:215], v[112:115], v[144:147]
    v_add_f32 v242, v242, v139
    v_add_f32 v243, v140, v141
    v_mfma_f32_16x16x32_bf16 v[148:151], v[224:227], v[4:7], v[180:183]
    v_add_f32 v243, v243, v142
    v_add_f32 v243, v243, v143
    v_mfma_f32_16x16x32_bf16 v[148:151], v[228:231], v[20:23], v[148:151]
    v_exp_f32 v144, v144
    v_mfma_f32_16x16x32_bf16 v[148:151], v[192:195], v[36:39], v[148:151]
    v_exp_f32 v145, v145
    v_mfma_f32_16x16x32_bf16 v[148:151], v[196:199], v[52:55], v[148:151]
    v_exp_f32 v146, v146
    v_mfma_f32_16x16x32_bf16 v[148:151], v[200:203], v[68:71], v[148:151]
    v_exp_f32 v147, v147
    v_mfma_f32_16x16x32_bf16 v[148:151], v[204:207], v[84:87], v[148:151]
    v_add_f32 v240, v240, v144
    v_add_f32 v240, v240, v145
    v_mfma_f32_16x16x32_bf16 v[148:151], v[208:211], v[100:103], v[148:151]
    v_add_f32 v240, v240, v146
    v_add_f32 v240, v240, v147
    v_mfma_f32_16x16x32_bf16 v[148:151], v[212:215], v[116:119], v[148:151]
    v_mfma_f32_16x16x32_bf16 v[152:155], v[224:227], v[8:11], v[184:187]
    s_waitcnt vmcnt(8)
    s_barrier
    v_mfma_f32_16x16x32_bf16 v[152:155], v[228:231], v[24:27], v[152:155]
    v_exp_f32 v148, v148
    v_mfma_f32_16x16x32_bf16 v[152:155], v[192:195], v[40:43], v[152:155]
    ds_read_b64_tr_b16 v[232:233], v247 offset:0
    ds_read_b64_tr_b16 v[234:235], v247 offset:2048
    v_mfma_f32_16x16x32_bf16 v[152:155], v[196:199], v[56:59], v[152:155]
    v_exp_f32 v149, v149
    v_mfma_f32_16x16x32_bf16 v[152:155], v[200:203], v[72:75], v[152:155]
    v_exp_f32 v150, v150
    v_mfma_f32_16x16x32_bf16 v[152:155], v[204:207], v[88:91], v[152:155]
    v_exp_f32 v151, v151
    v_mfma_f32_16x16x32_bf16 v[152:155], v[208:211], v[104:107], v[152:155]
    v_add_f32 v241, v241, v148
    v_add_f32 v241, v241, v149
    v_mfma_f32_16x16x32_bf16 v[152:155], v[212:215], v[120:123], v[152:155]
    v_add_f32 v241, v241, v150
    v_add_f32 v241, v241, v151
    v_mfma_f32_16x16x32_bf16 v[156:159], v[224:227], v[12:15], v[188:191]
    ds_read_b64_tr_b16 v[224:225], v248 offset:0
    ds_read_b64_tr_b16 v[226:227], v248 offset:2048
    v_mfma_f32_16x16x32_bf16 v[156:159], v[228:231], v[28:31], v[156:159]
    ds_read_b64_tr_b16 v[228:229], v249 offset:0
    ds_read_b64_tr_b16 v[230:231], v249 offset:2048
    v_mfma_f32_16x16x32_bf16 v[156:159], v[192:195], v[44:47], v[156:159]
    v_exp_f32 v152, v152
    v_mfma_f32_16x16x32_bf16 v[156:159], v[196:199], v[60:63], v[156:159]
    v_exp_f32 v153, v153
    v_mfma_f32_16x16x32_bf16 v[156:159], v[200:203], v[76:79], v[156:159]
    v_exp_f32 v154, v154
    v_mfma_f32_16x16x32_bf16 v[156:159], v[204:207], v[92:95], v[156:159]
    v_exp_f32 v155, v155
    v_mfma_f32_16x16x32_bf16 v[156:159], v[208:211], v[108:111], v[156:159]
    v_add_f32 v242, v242, v152
    v_add_f32 v242, v242, v153
    v_mfma_f32_16x16x32_bf16 v[156:159], v[212:215], v[124:127], v[156:159]
    s_waitcnt lgkmcnt(4)
    v_add_f32 v242, v242, v154
    v_add_f32 v242, v242, v155
    v_mfma_f32_16x16x32_bf16 a[12:15], v[232:235], v[172:175], a[12:15]
    v_mfma_f32_16x16x32_bf16 a[8:11], v[232:235], v[168:171], a[8:11]
    v_exp_f32 v156, v156
    v_mfma_f32_16x16x32_bf16 a[4:7], v[232:235], v[164:167], a[4:7]
    v_exp_f32 v157, v157
    v_mfma_f32_16x16x32_bf16 a[0:3], v[232:235], v[160:163], a[0:3]
    s_waitcnt lgkmcnt(2)
    ds_read_b64_tr_b16 v[232:233], v250 offset:0
    ds_read_b64_tr_b16 v[234:235], v250 offset:2048
    v_mfma_f32_16x16x32_bf16 a[16:19], v[224:227], v[160:163], a[16:19]
    v_exp_f32 v158, v158
    v_mfma_f32_16x16x32_bf16 a[20:23], v[224:227], v[164:167], a[20:23]
    v_exp_f32 v159, v159
    v_mfma_f32_16x16x32_bf16 a[24:27], v[224:227], v[168:171], a[24:27]
    v_add_f32 v243, v243, v156
    v_add_f32 v243, v243, v157
    v_mfma_f32_16x16x32_bf16 a[28:31], v[224:227], v[172:175], a[28:31]
    s_waitcnt lgkmcnt(2)
    ds_read_b64_tr_b16 v[224:225], v247 offset:4096
    ds_read_b64_tr_b16 v[226:227], v247 offset:6144
    v_mfma_f32_16x16x32_bf16 a[44:47], v[228:231], v[172:175], a[44:47]
    v_add_f32 v243, v243, v158
    v_add_f32 v243, v243, v159
    v_mfma_f32_16x16x32_bf16 a[40:43], v[228:231], v[168:171], a[40:43]
    v_max3_f32 v244, v240, v241, v242
    v_max_f32 v244, v244, v243
    v_mfma_f32_16x16x32_bf16 a[36:39], v[228:231], v[164:167], a[36:39]
    v_cmp_lt_f32 vcc, s7, v244
    v_mfma_f32_16x16x32_bf16 a[32:35], v[228:231], v[160:163], a[32:35]
    s_waitcnt lgkmcnt(2)
    ds_read_b64_tr_b16 v[228:229], v248 offset:4096
    ds_read_b64_tr_b16 v[230:231], v248 offset:6144
    v_mfma_f32_16x16x32_bf16 a[48:51], v[232:235], v[160:163], a[48:51]
    s_add_u32 m0, s32, 0x18000
    v_mfma_f32_16x16x32_bf16 a[52:55], v[232:235], v[164:167], a[52:55]
    buffer_load_dwordx4 v251, s[20:23], s35 offen nt lds
    v_mfma_f32_16x16x32_bf16 a[56:59], v[232:235], v[168:171], a[56:59]
    v_mfma_f32_16x16x32_bf16 a[60:63], v[232:235], v[172:175], a[60:63]
    s_waitcnt lgkmcnt(2)
    ds_read_b64_tr_b16 v[232:233], v249 offset:4096
    ds_read_b64_tr_b16 v[234:235], v249 offset:6144
    v_mfma_f32_16x16x32_bf16 a[76:79], v[224:227], v[172:175], a[76:79]
    s_add_u32 m0, s32, 0x18f80
    v_mfma_f32_16x16x32_bf16 a[72:75], v[224:227], v[168:171], a[72:75]
    buffer_load_dwordx4 v251, s[20:23], s35 offen offset:128 nt lds
    v_mfma_f32_16x16x32_bf16 a[68:71], v[224:227], v[164:167], a[68:71]
    v_mfma_f32_16x16x32_bf16 a[64:67], v[224:227], v[160:163], a[64:67]
    s_waitcnt lgkmcnt(2)
    ds_read_b64_tr_b16 v[224:225], v250 offset:4096
    ds_read_b64_tr_b16 v[226:227], v250 offset:6144
    v_mfma_f32_16x16x32_bf16 a[80:83], v[228:231], v[160:163], a[80:83]
    s_add_u32 m0, s32, 0x19f00
    v_mfma_f32_16x16x32_bf16 a[84:87], v[228:231], v[164:167], a[84:87]
    buffer_load_dwordx4 v251, s[20:23], s35 offen offset:256 nt lds
    v_mfma_f32_16x16x32_bf16 a[88:91], v[228:231], v[168:171], a[88:91]
    v_mfma_f32_16x16x32_bf16 a[92:95], v[228:231], v[172:175], a[92:95]
    s_waitcnt lgkmcnt(2)
    ds_read_b64_tr_b16 v[228:229], v247 offset:8192
    ds_read_b64_tr_b16 v[230:231], v247 offset:10240
    v_mfma_f32_16x16x32_bf16 a[108:111], v[232:235], v[172:175], a[108:111]
    s_add_u32 m0, s32, 0x1ae80
    v_mfma_f32_16x16x32_bf16 a[104:107], v[232:235], v[168:171], a[104:107]
    buffer_load_dwordx4 v251, s[20:23], s35 offen offset:384 nt lds
    v_mfma_f32_16x16x32_bf16 a[100:103], v[232:235], v[164:167], a[100:103]
    s_or_b32 s35, s35, 0x18fff
    v_mfma_f32_16x16x32_bf16 a[96:99], v[232:235], v[160:163], a[96:99]
    s_waitcnt lgkmcnt(2)
    s_add_u32 s35, s35, 1
    ds_read_b64_tr_b16 v[232:233], v248 offset:8192
    ds_read_b64_tr_b16 v[234:235], v248 offset:10240
    v_mfma_f32_16x16x32_bf16 a[112:115], v[224:227], v[160:163], a[112:115]
    s_andn2_b32 s35, s35, 0x18fff
    s_add_u32 m0, s32, 0x0
    v_mfma_f32_16x16x32_bf16 a[116:119], v[224:227], v[164:167], a[116:119]
    buffer_load_dwordx4 v251, s[16:19], s34 offen nt lds
    v_mfma_f32_16x16x32_bf16 a[120:123], v[224:227], v[168:171], a[120:123]
    v_mfma_f32_16x16x32_bf16 a[124:127], v[224:227], v[172:175], a[124:127]
    s_waitcnt lgkmcnt(2)
    ds_read_b64_tr_b16 v[224:225], v249 offset:8192
    ds_read_b64_tr_b16 v[226:227], v249 offset:10240
    v_mfma_f32_16x16x32_bf16 a[140:143], v[228:231], v[172:175], a[140:143]
    s_add_u32 m0, s32, 0xf80
    v_mfma_f32_16x16x32_bf16 a[136:139], v[228:231], v[168:171], a[136:139]
    buffer_load_dwordx4 v251, s[16:19], s34 offen offset:128 nt lds
    v_mfma_f32_16x16x32_bf16 a[132:135], v[228:231], v[164:167], a[132:135]
    v_mfma_f32_16x16x32_bf16 a[128:131], v[228:231], v[160:163], a[128:131]
    s_waitcnt lgkmcnt(2)
    ds_read_b64_tr_b16 v[228:229], v250 offset:8192
    ds_read_b64_tr_b16 v[230:231], v250 offset:10240
    v_mfma_f32_16x16x32_bf16 a[144:147], v[232:235], v[160:163], a[144:147]
    s_add_u32 m0, s32, 0x1f00
    v_mfma_f32_16x16x32_bf16 a[148:151], v[232:235], v[164:167], a[148:151]
    buffer_load_dwordx4 v251, s[16:19], s34 offen offset:256 nt lds
    v_mfma_f32_16x16x32_bf16 a[152:155], v[232:235], v[168:171], a[152:155]
    v_mfma_f32_16x16x32_bf16 a[156:159], v[232:235], v[172:175], a[156:159]
    s_waitcnt lgkmcnt(2)
    ds_read_b64_tr_b16 v[232:233], v247 offset:12288
    ds_read_b64_tr_b16 v[234:235], v247 offset:14336
    v_mfma_f32_16x16x32_bf16 a[172:175], v[224:227], v[172:175], a[172:175]
    ds_read_b128 v[192:195], v245 offset:32768
    v_mfma_f32_16x16x32_bf16 a[168:171], v[224:227], v[168:171], a[168:171]
    s_add_u32 m0, s32, 0x2e80
    ds_read_b128 v[196:199], v246 offset:32768
    v_mfma_f32_16x16x32_bf16 a[164:167], v[224:227], v[164:167], a[164:167]
    buffer_load_dwordx4 v251, s[16:19], s34 offen offset:384 nt lds
    v_mfma_f32_16x16x32_bf16 a[160:163], v[224:227], v[160:163], a[160:163]
    s_waitcnt lgkmcnt(4)
    s_or_b32 s34, s34, 0x18fff
    ds_read_b64_tr_b16 v[224:225], v248 offset:12288
    ds_read_b64_tr_b16 v[226:227], v248 offset:14336
    v_mfma_f32_16x16x32_bf16 a[176:179], v[228:231], v[160:163], a[176:179]
    s_add_u32 s34, s34, 1
    ds_read_b128 v[200:203], v245 offset:36864
    v_mfma_f32_16x16x32_bf16 a[180:183], v[228:231], v[164:167], a[180:183]
    s_andn2_b32 s34, s34, 0x18fff
    ds_read_b128 v[204:207], v246 offset:36864
    v_mfma_f32_16x16x32_bf16 a[184:187], v[228:231], v[168:171], a[184:187]
    v_mfma_f32_16x16x32_bf16 a[188:191], v[228:231], v[172:175], a[188:191]
    s_waitcnt lgkmcnt(6)
    ds_read_b64_tr_b16 v[228:229], v249 offset:12288
    ds_read_b64_tr_b16 v[230:231], v249 offset:14336
    v_mfma_f32_16x16x32_bf16 a[204:207], v[232:235], v[172:175], a[204:207]
    ds_read_b128 v[208:211], v245 offset:40960
    v_mfma_f32_16x16x32_bf16 a[200:203], v[232:235], v[168:171], a[200:203]
    ds_read_b128 v[212:215], v246 offset:40960
    v_mfma_f32_16x16x32_bf16 a[196:199], v[232:235], v[164:167], a[196:199]
    v_mfma_f32_16x16x32_bf16 a[192:195], v[232:235], v[160:163], a[192:195]
    s_waitcnt lgkmcnt(6)
    ds_read_b64_tr_b16 v[232:233], v250 offset:12288
    ds_read_b64_tr_b16 v[234:235], v250 offset:14336
    v_mfma_f32_16x16x32_bf16 a[208:211], v[224:227], v[160:163], a[208:211]
    ds_read_b128 v[216:219], v245 offset:45056
    v_mfma_f32_16x16x32_bf16 a[212:215], v[224:227], v[164:167], a[212:215]
    ds_read_b128 v[220:223], v246 offset:45056
    v_mfma_f32_16x16x32_bf16 a[216:219], v[224:227], v[168:171], a[216:219]
    v_mfma_f32_16x16x32_bf16 a[220:223], v[224:227], v[172:175], a[220:223]
    s_waitcnt lgkmcnt(6)
    v_mfma_f32_16x16x32_bf16 a[236:239], v[228:231], v[172:175], a[236:239]
    s_or_b32 s90, s90, 0x18fff
    v_mfma_f32_16x16x32_bf16 a[232:235], v[228:231], v[168:171], a[232:235]
    s_add_u32 s90, s90, 1
    v_mfma_f32_16x16x32_bf16 a[228:231], v[228:231], v[164:167], a[228:231]
    s_andn2_b32 s90, s90, 0x18fff
    v_mfma_f32_16x16x32_bf16 a[224:227], v[228:231], v[160:163], a[224:227]
    s_waitcnt lgkmcnt(2)
    v_mfma_f32_16x16x32_bf16 a[240:243], v[232:235], v[160:163], a[240:243]
    v_cvt_pk_bf16_f32 v160, v128, v129
    v_cvt_pk_bf16_f32 v161, v130, v131
    v_mfma_f32_16x16x32_bf16 a[244:247], v[232:235], v[164:167], a[244:247]
    v_mfma_f32_16x16x32_bf16 a[248:251], v[232:235], v[168:171], a[248:251]
    v_mfma_f32_16x16x32_bf16 a[252:255], v[232:235], v[172:175], a[252:255]
    s_cbranch_vccnz L_stub5
L_ret5:
    s_sub_u32 s36, s36, 1
    s_cmp_lg_u32 s36, 0
    s_cbranch_scc1 L_loop
    v_mfma_f32_16x16x32_bf16 v[128:131], v[192:195], v[0:3], v[176:179]
    ds_read_b128 v[224:227], v245 offset:34816
    v_cvt_pk_bf16_f32 v164, v132, v133
    v_mfma_f32_16x16x32_bf16 v[128:131], v[196:199], v[16:19], v[128:131]
    ds_read_b128 v[228:231], v246 offset:34816
    v_cvt_pk_bf16_f32 v165, v134, v135
    v_mfma_f32_16x16x32_bf16 v[128:131], v[200:203], v[32:35], v[128:131]
    v_cvt_pk_bf16_f32 v168, v136, v137
    v_cvt_pk_bf16_f32 v169, v138, v139
    v_mfma_f32_16x16x32_bf16 v[128:131], v[204:207], v[48:51], v[128:131]
    v_cvt_pk_bf16_f32 v172, v140, v141
    v_cvt_pk_bf16_f32 v173, v142, v143
    v_mfma_f32_16x16x32_bf16 v[128:131], v[208:211], v[64:67], v[128:131]
    s_add_u32 m0, s32, 0x1c000
    v_cvt_pk_bf16_f32 v162, v144, v145
    v_cvt_pk_bf16_f32 v163, v146, v147
    v_mfma_f32_16x16x32_bf16 v[128:131], v[212:215], v[80:83], v[128:131]
    s_waitcnt lgkmcnt(3)
    buffer_load_dwordx4 v251, s[20:23], s35 offen nt lds
    v_cvt_pk_bf16_f32 v166, v148, v149
    v_mfma_f32_16x16x32_bf16 v[128:131], v[216:219], v[96:99], v[128:131]
    s_waitcnt lgkmcnt(2)
    v_cvt_pk_bf16_f32 v167, v150, v151
    v_cvt_pk_bf16_f32 v170, v152, v153
    v_mfma_f32_16x16x32_bf16 v[128:131], v[220:223], v[112:115], v[128:131]
    v_cvt_pk_bf16_f32 v171, v154, v155
    v_cvt_pk_bf16_f32 v174, v156, v157
    v_mfma_f32_16x16x32_bf16 v[132:135], v[192:195], v[4:7], v[180:183]
    v_cvt_pk_bf16_f32 v175, v158, v159
    v_add_f32 v236, v236, v240
    v_mfma_f32_16x16x32_bf16 v[132:135], v[196:199], v[20:23], v[132:135]
    v_exp_f32 v128, v128
    v_mfma_f32_16x16x32_bf16 v[132:135], v[200:203], v[36:39], v[132:135]
    v_exp_f32 v129, v129
    v_mfma_f32_16x16x32_bf16 v[132:135], v[204:207], v[52:55], v[132:135]
    v_exp_f32 v130, v130
    v_mfma_f32_16x16x32_bf16 v[132:135], v[208:211], v[68:71], v[132:135]
    s_add_u32 m0, s32, 0x1cf80
    v_exp_f32 v131, v131
    v_mfma_f32_16x16x32_bf16 v[132:135], v[212:215], v[84:87], v[132:135]
    buffer_load_dwordx4 v251, s[20:23], s35 offen offset:128 nt lds
    v_mbcnt_lo_u32_b32 v255, -1, 0
    v_mfma_f32_16x16x32_bf16 v[132:135], v[216:219], v[100:103], v[132:135]
    v_mbcnt_hi_u32_b32 v255, -1, v255
    v_lshlrev_b32 v255, 7, v255
    v_mfma_f32_16x16x32_bf16 v[132:135], v[220:223], v[116:119], v[132:135]
    v_add_f32 v237, v237, v241
    v_add_f32 v238, v238, v242
    v_mfma_f32_16x16x32_bf16 v[136:139], v[192:195], v[8:11], v[184:187]
    v_add_f32 v239, v239, v243
    v_add_f32 v240, v128, v129
    v_mfma_f32_16x16x32_bf16 v[136:139], v[196:199], v[24:27], v[136:139]
    v_exp_f32 v132, v132
    v_mfma_f32_16x16x32_bf16 v[136:139], v[200:203], v[40:43], v[136:139]
    v_exp_f32 v133, v133
    v_mfma_f32_16x16x32_bf16 v[136:139], v[204:207], v[56:59], v[136:139]
    v_exp_f32 v134, v134
    v_mfma_f32_16x16x32_bf16 v[136:139], v[208:211], v[72:75], v[136:139]
    s_add_u32 m0, s32, 0x1df00
    v_exp_f32 v135, v135
    v_mfma_f32_16x16x32_bf16 v[136:139], v[212:215], v[88:91], v[136:139]
    buffer_load_dwordx4 v251, s[20:23], s35 offen offset:256 nt lds
    v_add_f32 v240, v240, v130
    v_mfma_f32_16x16x32_bf16 v[136:139], v[216:219], v[104:107], v[136:139]
    v_add_f32 v240, v240, v131
    v_add_f32 v241, v132, v133
    v_mfma_f32_16x16x32_bf16 v[136:139], v[220:223], v[120:123], v[136:139]
    v_add_f32 v241, v241, v134
    v_add_f32 v241, v241, v135
    v_mfma_f32_16x16x32_bf16 v[140:143], v[192:195], v[12:15], v[188:191]
    ds_read_b128 v[192:195], v245 offset:38912
    v_mfma_f32_16x16x32_bf16 v[140:143], v[196:199], v[28:31], v[140:143]
    ds_read_b128 v[196:199], v246 offset:38912
    v_mfma_f32_16x16x32_bf16 v[140:143], v[200:203], v[44:47], v[140:143]
    ds_read_b128 v[200:203], v245 offset:43008
    v_mfma_f32_16x16x32_bf16 v[140:143], v[204:207], v[60:63], v[140:143]
    ds_read_b128 v[204:207], v246 offset:43008
    v_mfma_f32_16x16x32_bf16 v[140:143], v[208:211], v[76:79], v[140:143]
    ds_read_b128 v[208:211], v245 offset:47104
    v_mfma_f32_16x16x32_bf16 v[140:143], v[212:215], v[92:95], v[140:143]
    ds_read_b128 v[212:215], v246 offset:47104
    v_mfma_f32_16x16x32_bf16 v[140:143], v[216:219], v[108:111], v[140:143]
    v_exp_f32 v136, v136
    v_mfma_f32_16x16x32_bf16 v[140:143], v[220:223], v[124:127], v[140:143]
    s_waitcnt lgkmcnt(7)
    v_exp_f32 v137, v137
    v_mfma_f32_16x16x32_bf16 v[144:147], v[224:227], v[0:3], v[176:179]
    s_waitcnt lgkmcnt(6)
    s_add_u32 m0, s32, 0x1ee80
    s_and_b32 s64, s3, 3
    v_exp_f32 v138, v138
    v_mfma_f32_16x16x32_bf16 v[144:147], v[228:231], v[16:19], v[144:147]
    s_waitcnt lgkmcnt(5)
    s_lshl_b32 s64, s64, 13
    buffer_load_dwordx4 v251, s[20:23], s35 offen offset:384 nt lds
    v_add_f32 v242, v136, v137
    v_mfma_f32_16x16x32_bf16 v[144:147], v[192:195], v[32:35], v[144:147]
    s_waitcnt lgkmcnt(4)
    s_or_b32 s35, s35, 0x18fff
    s_getpc_b64 s[62:63]
    L_pcb:
    v_exp_f32 v139, v139
    v_mfma_f32_16x16x32_bf16 v[144:147], v[196:199], v[48:51], v[144:147]
    s_waitcnt lgkmcnt(3)
    s_add_u32 s35, s35, 1
    s_add_u32 s64, s64, L_it30-L_pcb
    v_exp_f32 v140, v140
    v_mfma_f32_16x16x32_bf16 v[144:147], v[200:203], v[64:67], v[144:147]
    s_waitcnt lgkmcnt(2)
    s_andn2_b32 s35, s35, 0x18fff
    v_exp_f32 v141, v141
    v_mfma_f32_16x16x32_bf16 v[144:147], v[204:207], v[80:83], v[144:147]
    s_waitcnt lgkmcnt(1)
    v_exp_f32 v142, v142
    v_mfma_f32_16x16x32_bf16 v[144:147], v[208:211], v[96:99], v[144:147]
    s_waitcnt lgkmcnt(0)
    v_exp_f32 v143, v143
    v_mfma_f32_16x16x32_bf16 v[144:147], v[212:215], v[112:115], v[144:147]
    v_add_u32 v255, s64, v255
    v_min_u32 v255, L_code_end-L_pcb-4, v255
    v_mfma_f32_16x16x32_bf16 v[148:151], v[224:227], v[4:7], v[180:183]
    global_load_dword v254, v255, s[62:63]
    v_add_f32 v242, v242, v138
    v_mfma_f32_16x16x32_bf16 v[148:151], v[228:231], v[20:23], v[148:151]
    v_exp_f32 v144, v144
    v_mfma_f32_16x16x32_bf16 v[148:151], v[192:195], v[36:39], v[148:151]
    v_exp_f32 v145, v145
    v_mfma_f32_16x16x32_bf16 v[148:151], v[196:199], v[52:55], v[148:151]
    v_exp_f32 v146, v146
    v_mfma_f32_16x16x32_bf16 v[148:151], v[200:203], v[68:71], v[148:151]
    v_exp_f32 v147, v147
    v_mfma_f32_16x16x32_bf16 v[148:151], v[204:207], v[84:87], v[148:151]
    v_add_f32 v242, v242, v139
    v_add_f32 v243, v140, v141
    v_mfma_f32_16x16x32_bf16 v[148:151], v[208:211], v[100:103], v[148:151]
    v_add_f32 v243, v243, v142
    v_add_f32 v243, v243, v143
    v_mfma_f32_16x16x32_bf16 v[148:151], v[212:215], v[116:119], v[148:151]
    v_add_f32 v240, v240, v144
    v_add_f32 v240, v240, v145
    v_mfma_f32_16x16x32_bf16 v[152:155], v[224:227], v[8:11], v[184:187]
    s_waitcnt vmcnt(13)
    s_barrier
    v_add_f32 v240, v240, v146
    v_add_f32 v240, v240, v147
    v_mfma_f32_16x16x32_bf16 v[152:155], v[228:231], v[24:27], v[152:155]
    v_exp_f32 v148, v148
    v_mfma_f32_16x16x32_bf16 v[152:155], v[192:195], v[40:43], v[152:155]
    ds_read_b64_tr_b16 v[232:233], v247 offset:16384
    ds_read_b64_tr_b16 v[234:235], v247 offset:18432
    v_mfma_f32_16x16x32_bf16 v[152:155], v[196:199], v[56:59], v[152:155]
    v_exp_f32 v149, v149
    v_mfma_f32_16x16x32_bf16 v[152:155], v[200:203], v[72:75], v[152:155]
    v_exp_f32 v150, v150
    v_mfma_f32_16x16x32_bf16 v[152:155], v[204:207], v[88:91], v[152:155]
    v_exp_f32 v151, v151
    v_mfma_f32_16x16x32_bf16 v[152:155], v[208:211], v[104:107], v[152:155]
    v_add_f32 v241, v241, v148
    v_add_f32 v241, v241, v149
    v_mfma_f32_16x16x32_bf16 v[152:155], v[212:215], v[120:123], v[152:155]
    v_add_f32 v241, v241, v150
    v_add_f32 v241, v241, v151
    v_mfma_f32_16x16x32_bf16 v[156:159], v[224:227], v[12:15], v[188:191]
    ds_read_b64_tr_b16 v[224:225], v248 offset:16384
    ds_read_b64_tr_b16 v[226:227], v248 offset:18432
    v_mfma_f32_16x16x32_bf16 v[156:159], v[228:231], v[28:31], v[156:159]
    ds_read_b64_tr_b16 v[228:229], v249 offset:16384
    ds_read_b64_tr_b16 v[230:231], v249 offset:18432
    v_mfma_f32_16x16x32_bf16 v[156:159], v[192:195], v[44:47], v[156:159]
    v_exp_f32 v152, v152
    v_mfma_f32_16x16x32_bf16 v[156:159], v[196:199], v[60:63], v[156:159]
    v_exp_f32 v153, v153
    v_mfma_f32_16x16x32_bf16 v[156:159], v[200:203], v[76:79], v[156:159]
    v_exp_f32 v154, v154
    v_mfma_f32_16x16x32_bf16 v[156:159], v[204:207], v[92:95], v[156:159]
    v_exp_f32 v155, v155
    v_mfma_f32_16x16x32_bf16 v[156:159], v[208:211], v[108:111], v[156:159]
    v_add_f32 v242, v242, v152
    v_add_f32 v242, v242, v153
    v_mfma_f32_16x16x32_bf16 v[156:159], v[212:215], v[124:127], v[156:159]
    s_waitcnt lgkmcnt(4)
    v_add_f32 v242, v242, v154
    v_add_f32 v242, v242, v155
    v_mfma_f32_16x16x32_bf16 a[12:15], v[232:235], v[172:175], a[12:15]
    v_mfma_f32_16x16x32_bf16 a[8:11], v[232:235], v[168:171], a[8:11]
    v_exp_f32 v156, v156
    v_mfma_f32_16x16x32_bf16 a[4:7], v[232:235], v[164:167], a[4:7]
    v_exp_f32 v157, v157
    v_mfma_f32_16x16x32_bf16 a[0:3], v[232:235], v[160:163], a[0:3]
    s_waitcnt lgkmcnt(2)
    ds_read_b64_tr_b16 v[232:233], v250 offset:16384
    ds_read_b64_tr_b16 v[234:235], v250 offset:18432
    v_mfma_f32_16x16x32_bf16 a[16:19], v[224:227], v[160:163], a[16:19]
    v_exp_f32 v158, v158
    v_mfma_f32_16x16x32_bf16 a[20:23], v[224:227], v[164:167], a[20:23]
    v_exp_f32 v159, v159
    v_mfma_f32_16x16x32_bf16 a[24:27], v[224:227], v[168:171], a[24:27]
    v_add_f32 v243, v243, v156
    v_add_f32 v243, v243, v157
    v_mfma_f32_16x16x32_bf16 a[28:31], v[224:227], v[172:175], a[28:31]
    s_waitcnt lgkmcnt(2)
    ds_read_b64_tr_b16 v[224:225], v247 offset:20480
    ds_read_b64_tr_b16 v[226:227], v247 offset:22528
    v_mfma_f32_16x16x32_bf16 a[44:47], v[228:231], v[172:175], a[44:47]
    v_add_f32 v243, v243, v158
    v_add_f32 v243, v243, v159
    v_mfma_f32_16x16x32_bf16 a[40:43], v[228:231], v[168:171], a[40:43]
    v_max3_f32 v244, v240, v241, v242
    v_max_f32 v244, v244, v243
    v_mfma_f32_16x16x32_bf16 a[36:39], v[228:231], v[164:167], a[36:39]
    v_cmp_lt_f32 vcc, s7, v244
    v_mfma_f32_16x16x32_bf16 a[32:35], v[228:231], v[160:163], a[32:35]
    s_waitcnt lgkmcnt(2)
    ds_read_b64_tr_b16 v[228:229], v248 offset:20480
    ds_read_b64_tr_b16 v[230:231], v248 offset:22528
    v_mfma_f32_16x16x32_bf16 a[48:51], v[232:235], v[160:163], a[48:51]
    s_add_u32 m0, s32, 0x20000
    v_mfma_f32_16x16x32_bf16 a[52:55], v[232:235], v[164:167], a[52:55]
    buffer_load_dwordx4 v252, s[24:27], 0 offen lds
    v_mfma_f32_16x16x32_bf16 a[56:59], v[232:235], v[168:171], a[56:59]
    v_mfma_f32_16x16x32_bf16 a[60:63], v[232:235], v[172:175], a[60:63]
    s_waitcnt lgkmcnt(2)
    ds_read_b64_tr_b16 v[232:233], v249 offset:20480
    ds_read_b64_tr_b16 v[234:235], v249 offset:22528
    v_mfma_f32_16x16x32_bf16 a[76:79], v[224:227], v[172:175], a[76:79]
    s_add_u32 m0, s32, 0x21000
    v_mfma_f32_16x16x32_bf16 a[72:75], v[224:227], v[168:171], a[72:75]
    buffer_load_dwordx4 v252, s[24:27], s40 offen lds
    v_mfma_f32_16x16x32_bf16 a[68:71], v[224:227], v[164:167], a[68:71]
    v_mfma_f32_16x16x32_bf16 a[64:67], v[224:227], v[160:163], a[64:67]
    s_waitcnt lgkmcnt(2)
    ds_read_b64_tr_b16 v[224:225], v250 offset:20480
    ds_read_b64_tr_b16 v[226:227], v250 offset:22528
    v_mfma_f32_16x16x32_bf16 a[80:83], v[228:231], v[160:163], a[80:83]
    s_add_u32 m0, s32, 0x22000
    v_mfma_f32_16x16x32_bf16 a[84:87], v[228:231], v[164:167], a[84:87]
    buffer_load_dwordx4 v252, s[24:27], s41 offen lds
    v_mfma_f32_16x16x32_bf16 a[88:91], v[228:231], v[168:171], a[88:91]
    v_mfma_f32_16x16x32_bf16 a[92:95], v[228:231], v[172:175], a[92:95]
    s_waitcnt lgkmcnt(2)
    ds_read_b64_tr_b16 v[228:229], v247 offset:24576
    ds_read_b64_tr_b16 v[230:231], v247 offset:26624
    v_mfma_f32_16x16x32_bf16 a[108:111], v[232:235], v[172:175], a[108:111]
    s_add_u32 m0, s32, 0x23000
    v_mfma_f32_16x16x32_bf16 a[104:107], v[232:235], v[168:171], a[104:107]
    buffer_load_dwordx4 v252, s[24:27], s42 offen lds
    v_mfma_f32_16x16x32_bf16 a[100:103], v[232:235], v[164:167], a[100:103]
    v_mfma_f32_16x16x32_bf16 a[96:99], v[232:235], v[160:163], a[96:99]
    s_waitcnt lgkmcnt(2)
    ds_read_b64_tr_b16 v[232:233], v248 offset:24576
    ds_read_b64_tr_b16 v[234:235], v248 offset:26624
    v_mfma_f32_16x16x32_bf16 a[112:115], v[224:227], v[160:163], a[112:115]
    s_add_u32 m0, s32, 0x24000
    v_mfma_f32_16x16x32_bf16 a[116:119], v[224:227], v[164:167], a[116:119]
    buffer_load_dwordx4 v252, s[24:27], s43 offen lds
    v_mfma_f32_16x16x32_bf16 a[120:123], v[224:227], v[168:171], a[120:123]
    v_mfma_f32_16x16x32_bf16 a[124:127], v[224:227], v[172:175], a[124:127]
    s_waitcnt lgkmcnt(2)
    ds_read_b64_tr_b16 v[224:225], v249 offset:24576
    ds_read_b64_tr_b16 v[226:227], v249 offset:26624
    v_mfma_f32_16x16x32_bf16 a[140:143], v[228:231], v[172:175], a[140:143]
    s_add_u32 m0, s32, 0x25000
    v_mfma_f32_16x16x32_bf16 a[136:139], v[228:231], v[168:171], a[136:139]
    buffer_load_dwordx4 v252, s[24:27], s44 offen lds
    v_mfma_f32_16x16x32_bf16 a[132:135], v[228:231], v[164:167], a[132:135]
    v_mfma_f32_16x16x32_bf16 a[128:131], v[228:231], v[160:163], a[128:131]
    s_waitcnt lgkmcnt(2)
    ds_read_b64_tr_b16 v[228:229], v250 offset:24576
    ds_read_b64_tr_b16 v[230:231], v250 offset:26624
    v_mfma_f32_16x16x32_bf16 a[144:147], v[232:235], v[160:163], a[144:147]
    s_add_u32 m0, s32, 0x26000
    v_mfma_f32_16x16x32_bf16 a[148:151], v[232:235], v[164:167], a[148:151]
    buffer_load_dwordx4 v252, s[24:27], s45 offen lds
    v_mfma_f32_16x16x32_bf16 a[152:155], v[232:235], v[168:171], a[152:155]
    v_mfma_f32_16x16x32_bf16 a[156:159], v[232:235], v[172:175], a[156:159]
    s_waitcnt lgkmcnt(2)
    ds_read_b64_tr_b16 v[232:233], v247 offset:28672
    ds_read_b64_tr_b16 v[234:235], v247 offset:30720
    v_mfma_f32_16x16x32_bf16 a[172:175], v[224:227], v[172:175], a[172:175]
    ds_read_b128 v[192:195], v245 offset:49152
    v_mfma_f32_16x16x32_bf16 a[168:171], v[224:227], v[168:171], a[168:171]
    s_add_u32 m0, s32, 0x27000
    ds_read_b128 v[196:199], v246 offset:49152
    v_mfma_f32_16x16x32_bf16 a[164:167], v[224:227], v[164:167], a[164:167]
    buffer_load_dwordx4 v252, s[24:27], s46 offen lds
    v_mfma_f32_16x16x32_bf16 a[160:163], v[224:227], v[160:163], a[160:163]
    s_waitcnt lgkmcnt(4)
    s_add_u32 s24, s24, 128
    s_addc_u32 s25, s25, 0
    ds_read_b64_tr_b16 v[224:225], v248 offset:28672
    ds_read_b64_tr_b16 v[226:227], v248 offset:30720
    v_mfma_f32_16x16x32_bf16 a[176:179], v[228:231], v[160:163], a[176:179]
    s_sub_u32 s26, s26, 128
    ds_read_b128 v[200:203], v245 offset:53248
    v_mfma_f32_16x16x32_bf16 a[180:183], v[228:231], v[164:167], a[180:183]
    ds_read_b128 v[204:207], v246 offset:53248
    v_mfma_f32_16x16x32_bf16 a[184:187], v[228:231], v[168:171], a[184:187]
    v_mfma_f32_16x16x32_bf16 a[188:191], v[228:231], v[172:175], a[188:191]
    s_waitcnt lgkmcnt(6)
    ds_read_b64_tr_b16 v[228:229], v249 offset:28672
    ds_read_b64_tr_b16 v[230:231], v249 offset:30720
    v_mfma_f32_16x16x32_bf16 a[204:207], v[232:235], v[172:175], a[204:207]
    ds_read_b128 v[208:211], v245 offset:57344
    v_mfma_f32_16x16x32_bf16 a[200:203], v[232:235], v[168:171], a[200:203]
    ds_read_b128 v[212:215], v246 offset:57344
    v_mfma_f32_16x16x32_bf16 a[196:199], v[232:235], v[164:167], a[196:199]
    v_mfma_f32_16x16x32_bf16 a[192:195], v[232:235], v[160:163], a[192:195]
    s_waitcnt lgkmcnt(6)
    ds_read_b64_tr_b16 v[232:233], v250 offset:28672
    ds_read_b64_tr_b16 v[234:235], v250 offset:30720
    v_mfma_f32_16x16x32_bf16 a[208:211], v[224:227], v[160:163], a[208:211]
    ds_read_b128 v[216:219], v245 offset:61440
    v_mfma_f32_16x16x32_bf16 a[212:215], v[224:227], v[164:167], a[212:215]
    ds_read_b128 v[220:223], v246 offset:61440
    v_mfma_f32_16x16x32_bf16 a[216:219], v[224:227], v[168:171], a[216:219]
    v_mfma_f32_16x16x32_bf16 a[220:223], v[224:227], v[172:175], a[220:223]
    s_waitcnt lgkmcnt(6)
    v_mfma_f32_16x16x32_bf16 a[236:239], v[228:231], v[172:175], a[236:239]
    s_or_b32 s90, s90, 0x18fff
    v_mfma_f32_16x16x32_bf16 a[232:235], v[228:231], v[168:171], a[232:235]
    s_add_u32 s90, s90, 1
    v_mfma_f32_16x16x32_bf16 a[228:231], v[228:231], v[164:167], a[228:231]
    s_andn2_b32 s90, s90, 0x18fff
    v_mfma_f32_16x16x32_bf16 a[224:227], v[228:231], v[160:163], a[224:227]
    s_waitcnt lgkmcnt(2)
    v_mfma_f32_16x16x32_bf16 a[240:243], v[232:235], v[160:163], a[240:243]
    v_cvt_pk_bf16_f32 v160, v128, v129
    v_cvt_pk_bf16_f32 v161, v130, v131
    v_mfma_f32_16x16x32_bf16 a[244:247], v[232:235], v[164:167], a[244:247]
    v_mfma_f32_16x16x32_bf16 a[248:251], v[232:235], v[168:171], a[248:251]
    v_mfma_f32_16x16x32_bf16 a[252:255], v[232:235], v[172:175], a[252:255]
    s_cbranch_vccnz L_stub6
L_ret6:
L_it30:
    v_mfma_f32_16x16x32_bf16 v[128:131], v[192:195], v[0:3], v[176:179]
    ds_read_b128 v[224:227], v245 offset:51200
    v_cvt_pk_bf16_f32 v164, v132, v133
    v_mfma_f32_16x16x32_bf16 v[128:131], v[196:199], v[16:19], v[128:131]
    ds_read_b128 v[228:231], v246 offset:51200
    v_cvt_pk_bf16_f32 v165, v134, v135
    v_mfma_f32_16x16x32_bf16 v[128:131], v[200:203], v[32:35], v[128:131]
    v_cvt_pk_bf16_f32 v168, v136, v137
    v_cvt_pk_bf16_f32 v169, v138, v139
    v_mfma_f32_16x16x32_bf16 v[128:131], v[204:207], v[48:51], v[128:131]
    v_cvt_pk_bf16_f32 v172, v140, v141
    v_cvt_pk_bf16_f32 v173, v142, v143
    v_mfma_f32_16x16x32_bf16 v[128:131], v[208:211], v[64:67], v[128:131]
    s_add_u32 m0, s32, 0x0
    v_cvt_pk_bf16_f32 v162, v144, v145
    v_cvt_pk_bf16_f32 v163, v146, v147
    v_mfma_f32_16x16x32_bf16 v[128:131], v[212:215], v[80:83], v[128:131]
    s_waitcnt lgkmcnt(3)
    buffer_load_dwordx4 v252, s[24:27], 0 offen lds
    v_cvt_pk_bf16_f32 v166, v148, v149
    v_mfma_f32_16x16x32_bf16 v[128:131], v[216:219], v[96:99], v[128:131]
    s_waitcnt lgkmcnt(2)
    v_cvt_pk_bf16_f32 v167, v150, v151
    v_cvt_pk_bf16_f32 v170, v152, v153
    v_mfma_f32_16x16x32_bf16 v[128:131], v[220:223], v[112:115], v[128:131]
    v_cvt_pk_bf16_f32 v171, v154, v155
    v_cvt_pk_bf16_f32 v174, v156, v157
    v_mfma_f32_16x16x32_bf16 v[132:135], v[192:195], v[4:7], v[180:183]
    v_cvt_pk_bf16_f32 v175, v158, v159
    v_add_f32 v236, v236, v240
    v_mfma_f32_16x16x32_bf16 v[132:135], v[196:199], v[20:23], v[132:135]
    v_exp_f32 v128, v128
    v_mfma_f32_16x16x32_bf16 v[132:135], v[200:203], v[36:39], v[132:135]
    v_exp_f32 v129, v129
    v_mfma_f32_16x16x32_bf16 v[132:135], v[204:207], v[52:55], v[132:135]
    v_exp_f32 v130, v130
    v_mfma_f32_16x16x32_bf16 v[132:135], v[208:211], v[68:71], v[132:135]
    s_add_u32 m0, s32, 0x1000
    v_exp_f32 v131, v131
    v_mfma_f32_16x16x32_bf16 v[132:135], v[212:215], v[84:87], v[132:135]
    buffer_load_dwordx4 v252, s[24:27], s40 offen lds
    v_add_f32 v237, v237, v241
    v_mfma_f32_16x16x32_bf16 v[132:135], v[216:219], v[100:103], v[132:135]
    v_add_f32 v238, v238, v242
    v_add_f32 v239, v239, v243
    v_mfma_f32_16x16x32_bf16 v[132:135], v[220:223], v[116:119], v[132:135]
    v_add_f32 v240, v128, v129
    v_add_f32 v240, v240, v130
    v_mfma_f32_16x16x32_bf16 v[136:139], v[192:195], v[8:11], v[184:187]
    v_add_f32 v240, v240, v131
    v_mfma_f32_16x16x32_bf16 v[136:139], v[196:199], v[24:27], v[136:139]
    v_exp_f32 v132, v132
    v_mfma_f32_16x16x32_bf16 v[136:139], v[200:203], v[40:43], v[136:139]
    v_exp_f32 v133, v133
    v_mfma_f32_16x16x32_bf16 v[136:139], v[204:207], v[56:59], v[136:139]
    v_exp_f32 v134, v134
    v_mfma_f32_16x16x32_bf16 v[136:139], v[208:211], v[72:75], v[136:139]
    s_add_u32 m0, s32, 0x2000
    v_exp_f32 v135, v135
    v_mfma_f32_16x16x32_bf16 v[136:139], v[212:215], v[88:91], v[136:139]
    buffer_load_dwordx4 v252, s[24:27], s41 offen lds
    v_add_f32 v241, v132, v133
    v_mfma_f32_16x16x32_bf16 v[136:139], v[216:219], v[104:107], v[136:139]
    v_add_f32 v241, v241, v134
    v_add_f32 v241, v241, v135
    v_mfma_f32_16x16x32_bf16 v[136:139], v[220:223], v[120:123], v[136:139]
    v_mfma_f32_16x16x32_bf16 v[140:143], v[192:195], v[12:15], v[188:191]
    ds_read_b128 v[192:195], v245 offset:55296
    v_mfma_f32_16x16x32_bf16 v[140:143], v[196:199], v[28:31], v[140:143]
    ds_read_b128 v[196:199], v246 offset:55296
    v_mfma_f32_16x16x32_bf16 v[140:143], v[200:203], v[44:47], v[140:143]
    ds_read_b128 v[200:203], v245 offset:59392
    v_mfma_f32_16x16x32_bf16 v[140:143], v[204:207], v[60:63], v[140:143]
    ds_read_b128 v[204:207], v246 offset:59392
    v_mfma_f32_16x16x32_bf16 v[140:143], v[208:211], v[76:79], v[140:143]
    ds_read_b128 v[208:211], v245 offset:63488
    v_mfma_f32_16x16x32_bf16 v[140:143], v[212:215], v[92:95], v[140:143]
    ds_read_b128 v[212:215], v246 offset:63488
    v_mfma_f32_16x16x32_bf16 v[140:143], v[216:219], v[108:111], v[140:143]
    v_exp_f32 v136, v136
    v_mfma_f32_16x16x32_bf16 v[140:143], v[220:223], v[124:127], v[140:143]
    s_waitcnt lgkmcnt(7)
    v_exp_f32 v137, v137
    v_mfma_f32_16x16x32_bf16 v[144:147], v[224:227], v[0:3], v[176:179]
    s_waitcnt lgkmcnt(6)
    s_add_u32 m0, s32, 0x3000
    v_exp_f32 v138, v138
    v_mfma_f32_16x16x32_bf16 v[144:147], v[228:231], v[16:19], v[144:147]
    s_waitcnt lgkmcnt(5)
    buffer_load_dwordx4 v252, s[24:27], s42 offen lds
    v_add_f32 v242, v136, v137
    v_mfma_f32_16x16x32_bf16 v[144:147], v[192:195], v[32:35], v[144:147]
    s_waitcnt lgkmcnt(4)
    v_exp_f32 v139, v139
    v_mfma_f32_16x16x32_bf16 v[144:147], v[196:199], v[48:51], v[144:147]
    s_waitcnt lgkmcnt(3)
    v_exp_f32 v140, v140
    v_mfma_f32_16x16x32_bf16 v[144:147], v[200:203], v[64:67], v[144:147]
    s_waitcnt lgkmcnt(2)
    v_exp_f32 v141, v141
    v_mfma_f32_16x16x32_bf16 v[144:147], v[204:207], v[80:83], v[144:147]
    s_waitcnt lgkmcnt(1)
    s_add_u32 m0, s32, 0x4000
    v_exp_f32 v142, v142
    v_mfma_f32_16x16x32_bf16 v[144:147], v[208:211], v[96:99], v[144:147]
    s_waitcnt lgkmcnt(0)
    buffer_load_dwordx4 v252, s[24:27], s43 offen lds
    v_add_f32 v242, v242, v138
    v_mfma_f32_16x16x32_bf16 v[144:147], v[212:215], v[112:115], v[144:147]
    v_exp_f32 v143, v143
    v_mfma_f32_16x16x32_bf16 v[148:151], v[224:227], v[4:7], v[180:183]
    v_add_f32 v242, v242, v139
    v_add_f32 v243, v140, v141
    v_mfma_f32_16x16x32_bf16 v[148:151], v[228:231], v[20:23], v[148:151]
    v_exp_f32 v144, v144
    v_mfma_f32_16x16x32_bf16 v[148:151], v[192:195], v[36:39], v[148:151]
    v_exp_f32 v145, v145
    v_mfma_f32_16x16x32_bf16 v[148:151], v[196:199], v[52:55], v[148:151]
    v_exp_f32 v146, v146
    v_mfma_f32_16x16x32_bf16 v[148:151], v[200:203], v[68:71], v[148:151]
    v_exp_f32 v147, v147
    v_mfma_f32_16x16x32_bf16 v[148:151], v[204:207], v[84:87], v[148:151]
    s_add_u32 m0, s32, 0x5000
    v_add_f32 v243, v243, v142
    v_add_f32 v243, v243, v143
    v_mfma_f32_16x16x32_bf16 v[148:151], v[208:211], v[100:103], v[148:151]
    buffer_load_dwordx4 v252, s[24:27], s44 offen lds
    v_add_f32 v240, v240, v144
    v_mfma_f32_16x16x32_bf16 v[148:151], v[212:215], v[116:119], v[148:151]
    v_add_f32 v240, v240, v145
    v_add_f32 v240, v240, v146
    v_mfma_f32_16x16x32_bf16 v[152:155], v[224:227], v[8:11], v[184:187]
    s_waitcnt vmcnt(15)
    s_barrier
    v_add_f32 v240, v240, v147
    v_mfma_f32_16x16x32_bf16 v[152:155], v[228:231], v[24:27], v[152:155]
    v_exp_f32 v148, v148
    v_mfma_f32_16x16x32_bf16 v[152:155], v[192:195], v[40:43], v[152:155]
    ds_read_b64_tr_b16 v[232:233], v247 offset:32768
    ds_read_b64_tr_b16 v[234:235], v247 offset:34816
    v_mfma_f32_16x16x32_bf16 v[152:155], v[196:199], v[56:59], v[152:155]
    v_exp_f32 v149, v149
    v_mfma_f32_16x16x32_bf16 v[152:155], v[200:203], v[72:75], v[152:155]
    v_exp_f32 v150, v150
    v_mfma_f32_16x16x32_bf16 v[152:155], v[204:207], v[88:91], v[152:155]
    s_add_u32 m0, s32, 0x6000
    v_exp_f32 v151, v151
    v_mfma_f32_16x16x32_bf16 v[152:155], v[208:211], v[104:107], v[152:155]
    buffer_load_dwordx4 v252, s[24:27], s45 offen lds
    v_add_f32 v241, v241, v148
    v_mfma_f32_16x16x32_bf16 v[152:155], v[212:215], v[120:123], v[152:155]
    v_add_f32 v241, v241, v149
    v_add_f32 v241, v241, v150
    v_mfma_f32_16x16x32_bf16 v[156:159], v[224:227], v[12:15], v[188:191]
    ds_read_b64_tr_b16 v[224:225], v248 offset:32768
    ds_read_b64_tr_b16 v[226:227], v248 offset:34816
    v_mfma_f32_16x16x32_bf16 v[156:159], v[228:231], v[28:31], v[156:159]
    ds_read_b64_tr_b16 v[228:229], v249 offset:32768
    ds_read_b64_tr_b16 v[230:231], v249 offset:34816
    v_mfma_f32_16x16x32_bf16 v[156:159], v[192:195], v[44:47], v[156:159]
    v_exp_f32 v152, v152
    v_mfma_f32_16x16x32_bf16 v[156:159], v[196:199], v[60:63], v[156:159]
    v_exp_f32 v153, v153
    v_mfma_f32_16x16x32_bf16 v[156:159], v[200:203], v[76:79], v[156:159]
    v_exp_f32 v154, v154
    v_mfma_f32_16x16x32_bf16 v[156:159], v[204:207], v[92:95], v[156:159]
    s_add_u32 m0, s32, 0x7000
    v_exp_f32 v155, v155
    v_mfma_f32_16x16x32_bf16 v[156:159], v[208:211], v[108:111], v[156:159]
    buffer_load_dwordx4 v252, s[24:27], s46 offen lds
    v_add_f32 v241, v241, v151
    v_mfma_f32_16x16x32_bf16 v[156:159], v[212:215], v[124:127], v[156:159]
    s_waitcnt lgkmcnt(4)
    s_add_u32 s24, s24, 128
    s_addc_u32 s25, s25, 0
    v_add_f32 v242, v242, v152
    v_add_f32 v242, v242, v153
    v_mfma_f32_16x16x32_bf16 a[12:15], v[232:235], v[172:175], a[12:15]
    s_sub_u32 s26, s26, 128
    v_add_f32 v242, v242, v154
    v_add_f32 v242, v242, v155
    v_mfma_f32_16x16x32_bf16 a[8:11], v[232:235], v[168:171], a[8:11]
    v_exp_f32 v156, v156
    v_mfma_f32_16x16x32_bf16 a[4:7], v[232:235], v[164:167], a[4:7]
    v_exp_f32 v157, v157
    v_mfma_f32_16x16x32_bf16 a[0:3], v[232:235], v[160:163], a[0:3]
    s_waitcnt lgkmcnt(2)
    ds_read_b64_tr_b16 v[232:233], v250 offset:32768
    ds_read_b64_tr_b16 v[234:235], v250 offset:34816
    v_mfma_f32_16x16x32_bf16 a[16:19], v[224:227], v[160:163], a[16:19]
    v_exp_f32 v158, v158
    v_mfma_f32_16x16x32_bf16 a[20:23], v[224:227], v[164:167], a[20:23]
    v_exp_f32 v159, v159
    v_mfma_f32_16x16x32_bf16 a[24:27], v[224:227], v[168:171], a[24:27]
    v_add_f32 v243, v243, v156
    v_add_f32 v243, v243, v157
    v_mfma_f32_16x16x32_bf16 a[28:31], v[224:227], v[172:175], a[28:31]
    s_waitcnt lgkmcnt(2)
    ds_read_b64_tr_b16 v[224:225], v247 offset:36864
    ds_read_b64_tr_b16 v[226:227], v247 offset:38912
    v_mfma_f32_16x16x32_bf16 a[44:47], v[228:231], v[172:175], a[44:47]
    v_add_f32 v243, v243, v158
    v_add_f32 v243, v243, v159
    v_mfma_f32_16x16x32_bf16 a[40:43], v[228:231], v[168:171], a[40:43]
    v_max3_f32 v244, v240, v241, v242
    v_max_f32 v244, v244, v243
    v_mfma_f32_16x16x32_bf16 a[36:39], v[228:231], v[164:167], a[36:39]
    v_cmp_lt_f32 vcc, s7, v244
    v_cvt_pk_bf16_f32 v192, v128, v129
    v_mfma_f32_16x16x32_bf16 a[32:35], v[228:231], v[160:163], a[32:35]
    s_waitcnt lgkmcnt(2)
    ds_read_b64_tr_b16 v[228:229], v248 offset:36864
    ds_read_b64_tr_b16 v[230:231], v248 offset:38912
    v_mfma_f32_16x16x32_bf16 a[48:51], v[232:235], v[160:163], a[48:51]
    s_add_u32 m0, s32, 0x8000
    v_cvt_pk_bf16_f32 v193, v130, v131
    v_cvt_pk_bf16_f32 v196, v132, v133
    v_mfma_f32_16x16x32_bf16 a[52:55], v[232:235], v[164:167], a[52:55]
    buffer_load_dwordx4 v252, s[24:27], 0 offen lds
    v_cvt_pk_bf16_f32 v197, v134, v135
    v_mfma_f32_16x16x32_bf16 a[56:59], v[232:235], v[168:171], a[56:59]
    v_cvt_pk_bf16_f32 v200, v136, v137
    v_cvt_pk_bf16_f32 v201, v138, v139
    v_mfma_f32_16x16x32_bf16 a[60:63], v[232:235], v[172:175], a[60:63]
    s_waitcnt lgkmcnt(2)
    ds_read_b64_tr_b16 v[232:233], v249 offset:36864
    ds_read_b64_tr_b16 v[234:235], v249 offset:38912
    v_mfma_f32_16x16x32_bf16 a[76:79], v[224:227], v[172:175], a[76:79]
    s_add_u32 m0, s32, 0x9000
    v_cvt_pk_bf16_f32 v204, v140, v141
    v_cvt_pk_bf16_f32 v205, v142, v143
    v_mfma_f32_16x16x32_bf16 a[72:75], v[224:227], v[168:171], a[72:75]
    buffer_load_dwordx4 v252, s[24:27], s40 offen lds
    v_cvt_pk_bf16_f32 v194, v144, v145
    v_mfma_f32_16x16x32_bf16 a[68:71], v[224:227], v[164:167], a[68:71]
    v_cvt_pk_bf16_f32 v195, v146, v147
    v_cvt_pk_bf16_f32 v198, v148, v149
    v_mfma_f32_16x16x32_bf16 a[64:67], v[224:227], v[160:163], a[64:67]
    s_waitcnt lgkmcnt(2)
    ds_read_b64_tr_b16 v[224:225], v250 offset:36864
    ds_read_b64_tr_b16 v[226:227], v250 offset:38912
    v_mfma_f32_16x16x32_bf16 a[80:83], v[228:231], v[160:163], a[80:83]
    s_add_u32 m0, s32, 0xa000
    v_cvt_pk_bf16_f32 v199, v150, v151
    v_cvt_pk_bf16_f32 v202, v152, v153
    v_mfma_f32_16x16x32_bf16 a[84:87], v[228:231], v[164:167], a[84:87]
    buffer_load_dwordx4 v252, s[24:27], s41 offen lds
    v_cvt_pk_bf16_f32 v203, v154, v155
    v_mfma_f32_16x16x32_bf16 a[88:91], v[228:231], v[168:171], a[88:91]
    v_cvt_pk_bf16_f32 v206, v156, v157
    v_cvt_pk_bf16_f32 v207, v158, v159
    v_mfma_f32_16x16x32_bf16 a[92:95], v[228:231], v[172:175], a[92:95]
    s_waitcnt lgkmcnt(2)
    ds_read_b64_tr_b16 v[228:229], v247 offset:40960
    ds_read_b64_tr_b16 v[230:231], v247 offset:43008
    v_mfma_f32_16x16x32_bf16 a[108:111], v[232:235], v[172:175], a[108:111]
    s_add_u32 m0, s32, 0xb000
    v_mfma_f32_16x16x32_bf16 a[104:107], v[232:235], v[168:171], a[104:107]
    buffer_load_dwordx4 v252, s[24:27], s42 offen lds
    v_mfma_f32_16x16x32_bf16 a[100:103], v[232:235], v[164:167], a[100:103]
    v_mfma_f32_16x16x32_bf16 a[96:99], v[232:235], v[160:163], a[96:99]
    s_waitcnt lgkmcnt(2)
    ds_read_b64_tr_b16 v[232:233], v248 offset:40960
    ds_read_b64_tr_b16 v[234:235], v248 offset:43008
    v_mfma_f32_16x16x32_bf16 a[112:115], v[224:227], v[160:163], a[112:115]
    s_add_u32 m0, s32, 0xc000
    v_mfma_f32_16x16x32_bf16 a[116:119], v[224:227], v[164:167], a[116:119]
    buffer_load_dwordx4 v252, s[24:27], s43 offen lds
    v_mfma_f32_16x16x32_bf16 a[120:123], v[224:227], v[168:171], a[120:123]
    v_mfma_f32_16x16x32_bf16 a[124:127], v[224:227], v[172:175], a[124:127]
    s_waitcnt lgkmcnt(2)
    ds_read_b64_tr_b16 v[224:225], v249 offset:40960
    ds_read_b64_tr_b16 v[226:227], v249 offset:43008
    v_mfma_f32_16x16x32_bf16 a[140:143], v[228:231], v[172:175], a[140:143]
    s_add_u32 m0, s32, 0xd000
    v_mfma_f32_16x16x32_bf16 a[136:139], v[228:231], v[168:171], a[136:139]
    buffer_load_dwordx4 v252, s[24:27], s44 offen lds
    v_mfma_f32_16x16x32_bf16 a[132:135], v[228:231], v[164:167], a[132:135]
    v_mfma_f32_16x16x32_bf16 a[128:131], v[228:231], v[160:163], a[128:131]
    s_waitcnt lgkmcnt(2)
    ds_read_b64_tr_b16 v[228:229], v250 offset:40960
    ds_read_b64_tr_b16 v[230:231], v250 offset:43008
    v_mfma_f32_16x16x32_bf16 a[144:147], v[232:235], v[160:163], a[144:147]
    s_add_u32 m0, s32, 0xe000
    v_mfma_f32_16x16x32_bf16 a[148:151], v[232:235], v[164:167], a[148:151]
    buffer_load_dwordx4 v252, s[24:27], s45 offen lds
    v_mfma_f32_16x16x32_bf16 a[152:155], v[232:235], v[168:171], a[152:155]
    v_mfma_f32_16x16x32_bf16 a[156:159], v[232:235], v[172:175], a[156:159]
    s_waitcnt lgkmcnt(2)
    ds_read_b64_tr_b16 v[232:233], v247 offset:45056
    ds_read_b64_tr_b16 v[234:235], v247 offset:47104
    v_mfma_f32_16x16x32_bf16 a[172:175], v[224:227], v[172:175], a[172:175]
    v_mfma_f32_16x16x32_bf16 a[168:171], v[224:227], v[168:171], a[168:171]
    s_add_u32 m0, s32, 0xf000
    v_mfma_f32_16x16x32_bf16 a[164:167], v[224:227], v[164:167], a[164:167]
    buffer_load_dwordx4 v252, s[24:27], s46 offen lds
    v_mfma_f32_16x16x32_bf16 a[160:163], v[224:227], v[160:163], a[160:163]
    s_waitcnt lgkmcnt(2)
    s_add_u32 s24, s24, 128
    s_addc_u32 s25, s25, 0
    ds_read_b64_tr_b16 v[224:225], v248 offset:45056
    ds_read_b64_tr_b16 v[226:227], v248 offset:47104
    v_mfma_f32_16x16x32_bf16 a[176:179], v[228:231], v[160:163], a[176:179]
    s_sub_u32 s26, s26, 128
    v_mfma_f32_16x16x32_bf16 a[180:183], v[228:231], v[164:167], a[180:183]
    v_mfma_f32_16x16x32_bf16 a[184:187], v[228:231], v[168:171], a[184:187]
    v_mfma_f32_16x16x32_bf16 a[188:191], v[228:231], v[172:175], a[188:191]
    s_waitcnt lgkmcnt(2)
    ds_read_b64_tr_b16 v[228:229], v249 offset:45056
    ds_read_b64_tr_b16 v[230:231], v249 offset:47104
    v_mfma_f32_16x16x32_bf16 a[204:207], v[232:235], v[172:175], a[204:207]
    v_mfma_f32_16x16x32_bf16 a[200:203], v[232:235], v[168:171], a[200:203]
    v_mfma_f32_16x16x32_bf16 a[196:199], v[232:235], v[164:167], a[196:199]
    v_mfma_f32_16x16x32_bf16 a[192:195], v[232:235], v[160:163], a[192:195]
    s_waitcnt lgkmcnt(2)
    ds_read_b64_tr_b16 v[232:233], v250 offset:45056
    ds_read_b64_tr_b16 v[234:235], v250 offset:47104
    v_mfma_f32_16x16x32_bf16 a[208:211], v[224:227], v[160:163], a[208:211]
    v_mfma_f32_16x16x32_bf16 a[212:215], v[224:227], v[164:167], a[212:215]
    v_mfma_f32_16x16x32_bf16 a[216:219], v[224:227], v[168:171], a[216:219]
    v_mfma_f32_16x16x32_bf16 a[220:223], v[224:227], v[172:175], a[220:223]
    s_waitcnt lgkmcnt(2)
    ds_read_b64_tr_b16 v[224:225], v247 offset:49152
    ds_read_b64_tr_b16 v[226:227], v247 offset:51200
    v_mfma_f32_16x16x32_bf16 a[236:239], v[228:231], v[172:175], a[236:239]
    s_or_b32 s90, s90, 0x18fff
    v_mfma_f32_16x16x32_bf16 a[232:235], v[228:231], v[168:171], a[232:235]
    s_add_u32 s90, s90, 1
    v_mfma_f32_16x16x32_bf16 a[228:231], v[228:231], v[164:167], a[228:231]
    s_andn2_b32 s90, s90, 0x18fff
    v_mfma_f32_16x16x32_bf16 a[224:227], v[228:231], v[160:163], a[224:227]
    s_waitcnt lgkmcnt(2)
    ds_read_b64_tr_b16 v[228:229], v248 offset:49152
    ds_read_b64_tr_b16 v[230:231], v248 offset:51200
    v_mfma_f32_16x16x32_bf16 a[240:243], v[232:235], v[160:163], a[240:243]
    v_mfma_f32_16x16x32_bf16 a[244:247], v[232:235], v[164:167], a[244:247]
    v_mfma_f32_16x16x32_bf16 a[248:251], v[232:235], v[168:171], a[248:251]
    v_mfma_f32_16x16x32_bf16 a[252:255], v[232:235], v[172:175], a[252:255]
    ds_read_b64_tr_b16 v[232:233], v249 offset:49152
    ds_read_b64_tr_b16 v[234:235], v249 offset:51200
    s_cbranch_vccnz L_stub7
L_ret7:
    s_waitcnt lgkmcnt(4)
    v_mfma_f32_16x16x32_bf16 a[12:15], v[224:227], v[204:207], a[12:15]
    s_add_u32 m0, s32, 0x10000
    v_mbcnt_lo_u32_b32 v255, -1, 0
    v_mbcnt_hi_u32_b32 v255, -1, v255
    v_mfma_f32_16x16x32_bf16 a[8:11], v[224:227], v[200:203], a[8:11]
    buffer_load_dwordx4 v252, s[24:27], 0 offen lds
    s_waitcnt vmcnt(25)
    v_and_b32 v254, 1, v255
    v_mfma_f32_16x16x32_bf16 a[4:7], v[224:227], v[196:199], a[4:7]
    v_lshlrev_b32 v254, 7, v254
    v_lshrrev_b32 v255, 1, v255
    v_mfma_f32_16x16x32_bf16 a[0:3], v[224:227], v[192:195], a[0:3]
    s_waitcnt lgkmcnt(2)
    ds_read_b64_tr_b16 v[224:225], v250 offset:49152
    ds_read_b64_tr_b16 v[226:227], v250 offset:51200
    v_mfma_f32_16x16x32_bf16 a[16:19], v[228:231], v[192:195], a[16:19]
    s_add_u32 m0, s32, 0x11000
    v_lshl_add_u32 v254, v255, 12, v254
    v_lshrrev_b32 v255, 3, v255
    v_mfma_f32_16x16x32_bf16 a[20:23], v[228:231], v[196:199], a[20:23]
    buffer_load_dwordx4 v252, s[24:27], s40 offen lds
    v_lshl_add_u32 v255, v255, 15, v254
    v_mfma_f32_16x16x32_bf16 a[24:27], v[228:231], v[200:203], a[24:27]
    v_accvgpr_read_b32 v208, a12
    v_accvgpr_read_b32 v209, a13
    v_mfma_f32_16x16x32_bf16 a[28:31], v[228:231], v[204:207], a[28:31]
    s_waitcnt lgkmcnt(2)
    ds_read_b64_tr_b16 v[228:229], v247 offset:53248
    ds_read_b64_tr_b16 v[230:231], v247 offset:55296
    v_mfma_f32_16x16x32_bf16 a[44:47], v[232:235], v[204:207], a[44:47]
    s_add_u32 m0, s32, 0x12000
    v_accvgpr_read_b32 v210, a14
    v_accvgpr_read_b32 v211, a15
    v_mfma_f32_16x16x32_bf16 a[40:43], v[232:235], v[200:203], a[40:43]
    buffer_load_dwordx4 v252, s[24:27], s41 offen lds
    v_cvt_pk_bf16_f32 v12, v208, v209
    v_mfma_f32_16x16x32_bf16 a[36:39], v[232:235], v[196:199], a[36:39]
    v_cvt_pk_bf16_f32 v13, v210, v211
    v_accvgpr_read_b32 v212, a8
    v_mfma_f32_16x16x32_bf16 a[32:35], v[232:235], v[192:195], a[32:35]
    s_waitcnt lgkmcnt(2)
    ds_read_b64_tr_b16 v[232:233], v248 offset:53248
    ds_read_b64_tr_b16 v[234:235], v248 offset:55296
    v_mfma_f32_16x16x32_bf16 a[48:51], v[224:227], v[192:195], a[48:51]
    s_add_u32 m0, s32, 0x13000
    v_accvgpr_read_b32 v213, a9
    v_accvgpr_read_b32 v214, a10
    v_mfma_f32_16x16x32_bf16 a[52:55], v[224:227], v[196:199], a[52:55]
    buffer_load_dwordx4 v252, s[24:27], s42 offen lds
    v_accvgpr_read_b32 v215, a11
    v_mfma_f32_16x16x32_bf16 a[56:59], v[224:227], v[200:203], a[56:59]
    v_cvt_pk_bf16_f32 v8, v212, v213
    v_cvt_pk_bf16_f32 v9, v214, v215
    v_mfma_f32_16x16x32_bf16 a[60:63], v[224:227], v[204:207], a[60:63]
    s_waitcnt lgkmcnt(2)
    ds_read_b64_tr_b16 v[224:225], v249 offset:53248
    ds_read_b64_tr_b16 v[226:227], v249 offset:55296
    v_mfma_f32_16x16x32_bf16 a[76:79], v[228:231], v[204:207], a[76:79]
    s_add_u32 m0, s32, 0x14000
    v_accvgpr_read_b32 v216, a4
    v_accvgpr_read_b32 v217, a5
    v_mfma_f32_16x16x32_bf16 a[72:75], v[228:231], v[200:203], a[72:75]
    buffer_load_dwordx4 v252, s[24:27], s43 offen lds
    v_accvgpr_read_b32 v218, a6
    v_mfma_f32_16x16x32_bf16 a[68:71], v[228:231], v[196:199], a[68:71]
    v_accvgpr_read_b32 v219, a7
    v_cvt_pk_bf16_f32 v4, v216, v217
    v_mfma_f32_16x16x32_bf16 a[64:67], v[228:231], v[192:195], a[64:67]
    s_waitcnt lgkmcnt(2)
    ds_read_b64_tr_b16 v[228:229], v250 offset:53248
    ds_read_b64_tr_b16 v[230:231], v250 offset:55296
    v_mfma_f32_16x16x32_bf16 a[80:83], v[232:235], v[192:195], a[80:83]
    s_add_u32 m0, s32, 0x15000
    v_cvt_pk_bf16_f32 v5, v218, v219
    v_accvgpr_read_b32 v220, a0
    v_mfma_f32_16x16x32_bf16 a[84:87], v[232:235], v[196:199], a[84:87]
    buffer_load_dwordx4 v252, s[24:27], s44 offen lds
    v_accvgpr_read_b32 v221, a1
    v_mfma_f32_16x16x32_bf16 a[88:91], v[232:235], v[200:203], a[88:91]
    v_accvgpr_read_b32 v222, a2
    v_accvgpr_read_b32 v223, a3
    v_mfma_f32_16x16x32_bf16 a[92:95], v[232:235], v[204:207], a[92:95]
    s_waitcnt lgkmcnt(2)
    ds_read_b64_tr_b16 v[232:233], v247 offset:57344
    ds_read_b64_tr_b16 v[234:235], v247 offset:59392
    v_mfma_f32_16x16x32_bf16 a[108:111], v[224:227], v[204:207], a[108:111]
    s_add_u32 m0, s32, 0x16000
    v_cvt_pk_bf16_f32 v0, v220, v221
    v_cvt_pk_bf16_f32 v1, v222, v223
    v_mfma_f32_16x16x32_bf16 a[104:107], v[224:227], v[200:203], a[104:107]
    buffer_load_dwordx4 v252, s[24:27], s45 offen lds
    v_accvgpr_read_b32 v208, a16
    v_mfma_f32_16x16x32_bf16 a[100:103], v[224:227], v[196:199], a[100:103]
    v_accvgpr_read_b32 v209, a17
    v_accvgpr_read_b32 v210, a18
    v_mfma_f32_16x16x32_bf16 a[96:99], v[224:227], v[192:195], a[96:99]
    s_waitcnt lgkmcnt(2)
    ds_read_b64_tr_b16 v[224:225], v248 offset:57344
    ds_read_b64_tr_b16 v[226:227], v248 offset:59392
    v_mfma_f32_16x16x32_bf16 a[112:115], v[228:231], v[192:195], a[112:115]
    s_add_u32 m0, s32, 0x17000
    v_accvgpr_read_b32 v211, a19
    v_cvt_pk_bf16_f32 v2, v208, v209
    v_mfma_f32_16x16x32_bf16 a[116:119], v[228:231], v[196:199], a[116:119]
    buffer_load_dwordx4 v252, s[24:27], s46 offen lds
    v_cvt_pk_bf16_f32 v3, v210, v211
    v_mfma_f32_16x16x32_bf16 a[120:123], v[228:231], v[200:203], a[120:123]
    s_add_u32 s24, s24, 128
    s_addc_u32 s25, s25, 0
    v_accvgpr_read_b32 v212, a20
    v_accvgpr_read_b32 v213, a21
    v_mfma_f32_16x16x32_bf16 a[124:127], v[228:231], v[204:207], a[124:127]
    s_waitcnt lgkmcnt(2)
    s_sub_u32 s26, s26, 128
    ds_read_b64_tr_b16 v[228:229], v249 offset:57344
    ds_read_b64_tr_b16 v[230:231], v249 offset:59392
    v_mfma_f32_16x16x32_bf16 a[140:143], v[232:235], v[204:207], a[140:143]
    v_accvgpr_read_b32 v214, a22
    v_accvgpr_read_b32 v215, a23
    v_mfma_f32_16x16x32_bf16 a[136:139], v[232:235], v[200:203], a[136:139]
    v_cvt_pk_bf16_f32 v6, v212, v213
    v_cvt_pk_bf16_f32 v7, v214, v215
    v_mfma_f32_16x16x32_bf16 a[132:135], v[232:235], v[196:199], a[132:135]
    v_accvgpr_read_b32 v216, a24
    v_accvgpr_read_b32 v217, a25
    v_mfma_f32_16x16x32_bf16 a[128:131], v[232:235], v[192:195], a[128:131]
    s_waitcnt lgkmcnt(2)
    ds_read_b64_tr_b16 v[232:233], v250 offset:57344
    ds_read_b64_tr_b16 v[234:235], v250 offset:59392
    v_mfma_f32_16x16x32_bf16 a[144:147], v[224:227], v[192:195], a[144:147]
    v_accvgpr_read_b32 v218, a26
    v_accvgpr_read_b32 v219, a27
    v_mfma_f32_16x16x32_bf16 a[148:151], v[224:227], v[196:199], a[148:151]
    v_cvt_pk_bf16_f32 v10, v216, v217
    v_cvt_pk_bf16_f32 v11, v218, v219
    v_mfma_f32_16x16x32_bf16 a[152:155], v[224:227], v[200:203], a[152:155]
    v_accvgpr_read_b32 v220, a28
    v_accvgpr_read_b32 v221, a29
    v_mfma_f32_16x16x32_bf16 a[156:159], v[224:227], v[204:207], a[156:159]
    s_waitcnt lgkmcnt(2)
    ds_read_b64_tr_b16 v[224:225], v247 offset:61440
    ds_read_b64_tr_b16 v[226:227], v247 offset:63488
    v_mfma_f32_16x16x32_bf16 a[172:175], v[228:231], v[204:207], a[172:175]
    v_add_u32 v247, 0x10000, v247
    v_accvgpr_read_b32 v222, a30
    v_mfma_f32_16x16x32_bf16 a[168:171], v[228:231], v[200:203], a[168:171]
    v_accvgpr_read_b32 v223, a31
    v_cvt_pk_bf16_f32 v14, v220, v221
    v_mfma_f32_16x16x32_bf16 a[164:167], v[228:231], v[196:199], a[164:167]
    v_cvt_pk_bf16_f32 v15, v222, v223
    v_accvgpr_read_b32 v208, a44
    v_mfma_f32_16x16x32_bf16 a[160:163], v[228:231], v[192:195], a[160:163]
    s_waitcnt lgkmcnt(2)
    ds_read_b64_tr_b16 v[228:229], v248 offset:61440
    ds_read_b64_tr_b16 v[230:231], v248 offset:63488
    v_mfma_f32_16x16x32_bf16 a[176:179], v[232:235], v[192:195], a[176:179]
    buffer_load_dword v246, v255, s[28:31], 0 offen
    v_add_u32 v248, 0x10000, v248
    v_mfma_f32_16x16x32_bf16 a[180:183], v[232:235], v[196:199], a[180:183]
    v_add_u32 v255, 0x8000, v255
    v_accvgpr_read_b32 v209, a45
    v_mfma_f32_16x16x32_bf16 a[184:187], v[232:235], v[200:203], a[184:187]
    v_accvgpr_read_b32 v210, a46
    v_accvgpr_read_b32 v211, a47
    v_mfma_f32_16x16x32_bf16 a[188:191], v[232:235], v[204:207], a[188:191]
    s_waitcnt lgkmcnt(2)
    ds_read_b64_tr_b16 v[232:233], v249 offset:61440
    ds_read_b64_tr_b16 v[234:235], v249 offset:63488
    v_mfma_f32_16x16x32_bf16 a[204:207], v[224:227], v[204:207], a[204:207]
    v_add_u32 v249, 0x10000, v249
    v_cvt_pk_bf16_f32 v28, v208, v209
    v_mfma_f32_16x16x32_bf16 a[200:203], v[224:227], v[200:203], a[200:203]
    v_cvt_pk_bf16_f32 v29, v210, v211
    v_accvgpr_read_b32 v212, a40
    v_mfma_f32_16x16x32_bf16 a[196:199], v[224:227], v[196:199], a[196:199]
    v_accvgpr_read_b32 v213, a41
    v_accvgpr_read_b32 v214, a42
    v_mfma_f32_16x16x32_bf16 a[192:195], v[224:227], v[192:195], a[192:195]
    s_waitcnt lgkmcnt(2)
    ds_read_b64_tr_b16 v[224:225], v250 offset:61440
    ds_read_b64_tr_b16 v[226:227], v250 offset:63488
    v_mfma_f32_16x16x32_bf16 a[208:211], v[228:231], v[192:195], a[208:211]
    v_add_u32 v250, 0x10000, v250
    v_accvgpr_read_b32 v215, a43
    v_mfma_f32_16x16x32_bf16 a[212:215], v[228:231], v[196:199], a[212:215]
    s_waitcnt vmcnt(25)
    s_barrier
    v_cvt_pk_bf16_f32 v24, v212, v213
    v_cvt_pk_bf16_f32 v25, v214, v215
    v_mfma_f32_16x16x32_bf16 a[216:219], v[228:231], v[200:203], a[216:219]
    v_accvgpr_read_b32 v216, a36
    v_accvgpr_read_b32 v217, a37
    v_mfma_f32_16x16x32_bf16 a[220:223], v[228:231], v[204:207], a[220:223]
    s_waitcnt lgkmcnt(2)
    ds_read_b64_tr_b16 v[228:229], v247 offset:0
    ds_read_b64_tr_b16 v[230:231], v247 offset:2048
    v_mfma_f32_16x16x32_bf16 a[236:239], v[232:235], v[204:207], a[236:239]
    v_accvgpr_read_b32 v218, a38
    v_accvgpr_read_b32 v219, a39
    v_mfma_f32_16x16x32_bf16 a[232:235], v[232:235], v[200:203], a[232:235]
    v_cvt_pk_bf16_f32 v20, v216, v217
    v_cvt_pk_bf16_f32 v21, v218, v219
    v_mfma_f32_16x16x32_bf16 a[228:231], v[232:235], v[196:199], a[228:231]
    v_accvgpr_read_b32 v220, a32
    v_accvgpr_read_b32 v221, a33
    v_mfma_f32_16x16x32_bf16 a[224:227], v[232:235], v[192:195], a[224:227]
    s_waitcnt lgkmcnt(2)
    ds_read_b64_tr_b16 v[232:233], v248 offset:0
    ds_read_b64_tr_b16 v[234:235], v248 offset:2048
    v_mfma_f32_16x16x32_bf16 a[240:243], v[224:227], v[192:195], a[240:243]
    buffer_load_dword v246, v255, s[28:31], 0 offen
    v_accvgpr_read_b32 v222, a34
    v_mfma_f32_16x16x32_bf16 a[244:247], v[224:227], v[196:199], a[244:247]
    v_accvgpr_read_b32 v223, a35
    v_cvt_pk_bf16_f32 v16, v220, v221
    v_mfma_f32_16x16x32_bf16 a[248:251], v[224:227], v[200:203], a[248:251]
    v_cvt_pk_bf16_f32 v17, v222, v223
    v_accvgpr_read_b32 v208, a48
    v_mfma_f32_16x16x32_bf16 a[252:255], v[224:227], v[204:207], a[252:255]
    s_waitcnt lgkmcnt(2)
    ds_read_b64_tr_b16 v[224:225], v249 offset:0
    ds_read_b64_tr_b16 v[226:227], v249 offset:2048
    v_mfma_f32_16x16x32_bf16 v[140:143], v[228:231], v[12:15], 0
    v_accvgpr_read_b32 v209, a49
    v_accvgpr_read_b32 v210, a50
    v_mfma_f32_16x16x32_bf16 v[136:139], v[228:231], v[8:11], 0
    v_accvgpr_read_b32 v211, a51
    v_cvt_pk_bf16_f32 v18, v208, v209
    v_mfma_f32_16x16x32_bf16 v[132:135], v[228:231], v[4:7], 0
    v_cvt_pk_bf16_f32 v19, v210, v211
    v_accvgpr_read_b32 v212, a52
    v_mfma_f32_16x16x32_bf16 v[128:131], v[228:231], v[0:3], 0
    s_waitcnt lgkmcnt(2)
    ds_read_b64_tr_b16 v[228:229], v250 offset:0
    ds_read_b64_tr_b16 v[230:231], v250 offset:2048
    v_mfma_f32_16x16x32_bf16 v[144:147], v[232:235], v[0:3], 0
    v_accvgpr_read_b32 v213, a53
    v_accvgpr_read_b32 v214, a54
    v_mfma_f32_16x16x32_bf16 v[148:151], v[232:235], v[4:7], 0
    v_accvgpr_read_b32 v215, a55
    v_cvt_pk_bf16_f32 v22, v212, v213
    v_mfma_f32_16x16x32_bf16 v[152:155], v[232:235], v[8:11], 0
    v_cvt_pk_bf16_f32 v23, v214, v215
    v_accvgpr_read_b32 v216, a56
    v_mfma_f32_16x16x32_bf16 v[156:159], v[232:235], v[12:15], 0
    s_waitcnt lgkmcnt(2)
    ds_read_b64_tr_b16 v[232:233], v247 offset:4096
    ds_read_b64_tr_b16 v[234:235], v247 offset:6144
    v_mfma_f32_16x16x32_bf16 v[172:175], v[224:227], v[12:15], 0
    v_accvgpr_read_b32 v217, a57
    v_accvgpr_read_b32 v218, a58
    v_mfma_f32_16x16x32_bf16 v[168:171], v[224:227], v[8:11], 0
    v_accvgpr_read_b32 v219, a59
    v_cvt_pk_bf16_f32 v26, v216, v217
    v_mfma_f32_16x16x32_bf16 v[164:167], v[224:227], v[4:7], 0
    v_cvt_pk_bf16_f32 v27, v218, v219
    v_accvgpr_read_b32 v220, a60
    v_mfma_f32_16x16x32_bf16 v[160:163], v[224:227], v[0:3], 0
    s_waitcnt lgkmcnt(2)
    ds_read_b64_tr_b16 v[224:225], v248 offset:4096
    ds_read_b64_tr_b16 v[226:227], v248 offset:6144
    v_mfma_f32_16x16x32_bf16 v[176:179], v[228:231], v[0:3], 0
    v_accvgpr_read_b32 v221, a61
    v_accvgpr_read_b32 v222, a62
    v_mfma_f32_16x16x32_bf16 v[180:183], v[228:231], v[4:7], 0
    v_accvgpr_read_b32 v223, a63
    v_cvt_pk_bf16_f32 v30, v220, v221
    v_mfma_f32_16x16x32_bf16 v[184:187], v[228:231], v[8:11], 0
    v_cvt_pk_bf16_f32 v31, v222, v223
    v_accvgpr_read_b32 v208, a76
    v_mfma_f32_16x16x32_bf16 v[188:191], v[228:231], v[12:15], 0
    s_waitcnt lgkmcnt(2)
    ds_read_b64_tr_b16 v[228:229], v249 offset:4096
    ds_read_b64_tr_b16 v[230:231], v249 offset:6144
    v_mfma_f32_16x16x32_bf16 v[140:143], v[232:235], v[28:31], v[140:143]
    v_accvgpr_read_b32 v209, a77
    v_accvgpr_read_b32 v210, a78
    v_mfma_f32_16x16x32_bf16 v[136:139], v[232:235], v[24:27], v[136:139]
    v_accvgpr_read_b32 v211, a79
    v_cvt_pk_bf16_f32 v44, v208, v209
    v_mfma_f32_16x16x32_bf16 v[132:135], v[232:235], v[20:23], v[132:135]
    v_cvt_pk_bf16_f32 v45, v210, v211
    v_accvgpr_read_b32 v212, a72
    v_mfma_f32_16x16x32_bf16 v[128:131], v[232:235], v[16:19], v[128:131]
    s_waitcnt lgkmcnt(2)
    ds_read_b64_tr_b16 v[232:233], v250 offset:4096
    ds_read_b64_tr_b16 v[234:235], v250 offset:6144
    v_mfma_f32_16x16x32_bf16 v[144:147], v[224:227], v[16:19], v[144:147]
    v_accvgpr_read_b32 v213, a73
    v_accvgpr_read_b32 v214, a74
    v_mfma_f32_16x16x32_bf16 v[148:151], v[224:227], v[20:23], v[148:151]
    v_accvgpr_read_b32 v215, a75
    v_cvt_pk_bf16_f32 v40, v212, v213
    v_mfma_f32_16x16x32_bf16 v[152:155], v[224:227], v[24:27], v[152:155]
    v_cvt_pk_bf16_f32 v41, v214, v215
    v_accvgpr_read_b32 v216, a68
    v_mfma_f32_16x16x32_bf16 v[156:159], v[224:227], v[28:31], v[156:159]
    s_waitcnt lgkmcnt(2)
    ds_read_b64_tr_b16 v[224:225], v247 offset:8192
    ds_read_b64_tr_b16 v[226:227], v247 offset:10240
    v_mfma_f32_16x16x32_bf16 v[172:175], v[228:231], v[28:31], v[172:175]
    v_accvgpr_read_b32 v217, a69
    v_accvgpr_read_b32 v218, a70
    v_mfma_f32_16x16x32_bf16 v[168:171], v[228:231], v[24:27], v[168:171]
    v_accvgpr_read_b32 v219, a71
    v_cvt_pk_bf16_f32 v36, v216, v217
    v_mfma_f32_16x16x32_bf16 v[164:167], v[228:231], v[20:23], v[164:167]
    v_cvt_pk_bf16_f32 v37, v218, v219
    v_accvgpr_read_b32 v220, a64
    v_mfma_f32_16x16x32_bf16 v[160:163], v[228:231], v[16:19], v[160:163]
    s_waitcnt lgkmcnt(2)
    ds_read_b64_tr_b16 v[228:229], v248 offset:8192
    ds_read_b64_tr_b16 v[230:231], v248 offset:10240
    v_mfma_f32_16x16x32_bf16 v[176:179], v[232:235], v[16:19], v[176:179]
    v_accvgpr_read_b32 v221, a65
    v_accvgpr_read_b32 v222, a66
    v_mfma_f32_16x16x32_bf16 v[180:183], v[232:235], v[20:23], v[180:183]
    v_accvgpr_read_b32 v223, a67
    v_cvt_pk_bf16_f32 v32, v220, v221
    v_mfma_f32_16x16x32_bf16 v[184:187], v[232:235], v[24:27], v[184:187]
    v_cvt_pk_bf16_f32 v33, v222, v223
    v_accvgpr_read_b32 v208, a80
    v_accvgpr_read_b32 v209, a81
    v_accvgpr_read_b32 v210, a82
    v_accvgpr_read_b32 v211, a83
    v_cvt_pk_bf16_f32 v34, v208, v209
    v_cvt_pk_bf16_f32 v35, v210, v211
    v_accvgpr_read_b32 v212, a84
    v_accvgpr_read_b32 v213, a85
    v_accvgpr_read_b32 v214, a86
    v_accvgpr_read_b32 v215, a87
    v_cvt_pk_bf16_f32 v38, v212, v213
    v_cvt_pk_bf16_f32 v39, v214, v215
    v_accvgpr_read_b32 v216, a88
    v_accvgpr_read_b32 v217, a89
    v_accvgpr_read_b32 v218, a90
    v_accvgpr_read_b32 v219, a91
    v_cvt_pk_bf16_f32 v42, v216, v217
    v_cvt_pk_bf16_f32 v43, v218, v219
    v_accvgpr_read_b32 v220, a92
    v_accvgpr_read_b32 v221, a93
    v_accvgpr_read_b32 v222, a94
    v_accvgpr_read_b32 v223, a95
    v_cvt_pk_bf16_f32 v46, v220, v221
    v_cvt_pk_bf16_f32 v47, v222, v223
    v_mfma_f32_16x16x32_bf16 v[188:191], v[232:235], v[28:31], v[188:191]
    s_waitcnt lgkmcnt(2)
    ds_read_b64_tr_b16 v[232:233], v249 offset:8192
    ds_read_b64_tr_b16 v[234:235], v249 offset:10240
    v_mfma_f32_16x16x32_bf16 v[140:143], v[224:227], v[44:47], v[140:143]
    v_accvgpr_read_b32 v208, a108
    v_accvgpr_read_b32 v209, a109
    v_mfma_f32_16x16x32_bf16 v[136:139], v[224:227], v[40:43], v[136:139]
    v_accvgpr_read_b32 v210, a110
    v_accvgpr_read_b32 v211, a111
    v_mfma_f32_16x16x32_bf16 v[132:135], v[224:227], v[36:39], v[132:135]
    v_cvt_pk_bf16_f32 v60, v208, v209
    v_cvt_pk_bf16_f32 v61, v210, v211
    v_mfma_f32_16x16x32_bf16 v[128:131], v[224:227], v[32:35], v[128:131]
    s_waitcnt lgkmcnt(2)
    ds_read_b64_tr_b16 v[224:225], v250 offset:8192
    ds_read_b64_tr_b16 v[226:227], v250 offset:10240
    v_mfma_f32_16x16x32_bf16 v[144:147], v[228:231], v[32:35], v[144:147]
    v_accvgpr_read_b32 v212, a104
    v_accvgpr_read_b32 v213, a105
    v_mfma_f32_16x16x32_bf16 v[148:151], v[228:231], v[36:39], v[148:151]
    v_accvgpr_read_b32 v214, a106
    v_accvgpr_read_b32 v215, a107
    v_mfma_f32_16x16x32_bf16 v[152:155], v[228:231], v[40:43], v[152:155]
    v_cvt_pk_bf16_f32 v56, v212, v213
    v_cvt_pk_bf16_f32 v57, v214, v215
    v_mfma_f32_16x16x32_bf16 v[156:159], v[228:231], v[44:47], v[156:159]
    s_waitcnt lgkmcnt(2)
    ds_read_b64_tr_b16 v[228:229], v247 offset:12288
    ds_read_b64_tr_b16 v[230:231], v247 offset:14336
    v_mfma_f32_16x16x32_bf16 v[172:175], v[232:235], v[44:47], v[172:175]
    s_waitcnt vmcnt(18)
    s_barrier
    v_accvgpr_read_b32 v216, a100
    v_accvgpr_read_b32 v217, a101
    v_mfma_f32_16x16x32_bf16 v[168:171], v[232:235], v[40:43], v[168:171]
    v_accvgpr_read_b32 v218, a102
    v_accvgpr_read_b32 v219, a103
    v_mfma_f32_16x16x32_bf16 v[164:167], v[232:235], v[36:39], v[164:167]
    v_cvt_pk_bf16_f32 v52, v216, v217
    v_cvt_pk_bf16_f32 v53, v218, v219
    v_mfma_f32_16x16x32_bf16 v[160:163], v[232:235], v[32:35], v[160:163]
    s_waitcnt lgkmcnt(2)
    ds_read_b64_tr_b16 v[232:233], v248 offset:12288
    ds_read_b64_tr_b16 v[234:235], v248 offset:14336
    v_mfma_f32_16x16x32_bf16 v[176:179], v[224:227], v[32:35], v[176:179]
    s_add_u32 m0, s32, 0x18000
    v_accvgpr_read_b32 v220, a96
    v_accvgpr_read_b32 v221, a97
    v_mfma_f32_16x16x32_bf16 v[180:183], v[224:227], v[36:39], v[180:183]
    buffer_load_dwordx4 v252, s[24:27], 0 offen lds
    v_accvgpr_read_b32 v222, a98
    v_mfma_f32_16x16x32_bf16 v[184:187], v[224:227], v[40:43], v[184:187]
    v_accvgpr_read_b32 v223, a99
    v_cvt_pk_bf16_f32 v48, v220, v221
    v_cvt_pk_bf16_f32 v49, v222, v223
    v_accvgpr_read_b32 v208, a112
    v_accvgpr_read_b32 v209, a113
    v_accvgpr_read_b32 v210, a114
    v_accvgpr_read_b32 v211, a115
    v_cvt_pk_bf16_f32 v50, v208, v209
    v_cvt_pk_bf16_f32 v51, v210, v211
    v_accvgpr_read_b32 v212, a116
    v_accvgpr_read_b32 v213, a117
    v_accvgpr_read_b32 v214, a118
    v_accvgpr_read_b32 v215, a119
    v_cvt_pk_bf16_f32 v54, v212, v213
    v_cvt_pk_bf16_f32 v55, v214, v215
    v_accvgpr_read_b32 v216, a120
    v_accvgpr_read_b32 v217, a121
    v_accvgpr_read_b32 v218, a122
    v_accvgpr_read_b32 v219, a123
    v_cvt_pk_bf16_f32 v58, v216, v217
    v_cvt_pk_bf16_f32 v59, v218, v219
    v_accvgpr_read_b32 v220, a124
    v_accvgpr_read_b32 v221, a125
    v_accvgpr_read_b32 v222, a126
    v_accvgpr_read_b32 v223, a127
    v_cvt_pk_bf16_f32 v62, v220, v221
    v_cvt_pk_bf16_f32 v63, v222, v223
    v_mfma_f32_16x16x32_bf16 v[188:191], v[224:227], v[44:47], v[188:191]
    s_waitcnt lgkmcnt(2)
    ds_read_b64_tr_b16 v[224:225], v249 offset:12288
    ds_read_b64_tr_b16 v[226:227], v249 offset:14336
    v_mfma_f32_16x16x32_bf16 v[140:143], v[228:231], v[60:63], v[140:143]
    s_add_u32 m0, s32, 0x19000
    v_accvgpr_read_b32 v208, a140
    v_accvgpr_read_b32 v209, a141
    v_mfma_f32_16x16x32_bf16 v[136:139], v[228:231], v[56:59], v[136:139]
    buffer_load_dwordx4 v252, s[24:27], s40 offen lds
    v_accvgpr_read_b32 v210, a142
    v_mfma_f32_16x16x32_bf16 v[132:135], v[228:231], v[52:55], v[132:135]
    v_accvgpr_read_b32 v211, a143
    v_cvt_pk_bf16_f32 v76, v208, v209
    v_mfma_f32_16x16x32_bf16 v[128:131], v[228:231], v[48:51], v[128:131]
    s_waitcnt lgkmcnt(2)
    ds_read_b64_tr_b16 v[228:229], v250 offset:12288
    ds_read_b64_tr_b16 v[230:231], v250 offset:14336
    v_mfma_f32_16x16x32_bf16 v[144:147], v[232:235], v[48:51], v[144:147]
    s_add_u32 m0, s32, 0x1a000
    v_cvt_pk_bf16_f32 v77, v210, v211
    v_accvgpr_read_b32 v212, a136
    v_mfma_f32_16x16x32_bf16 v[148:151], v[232:235], v[52:55], v[148:151]
    buffer_load_dwordx4 v252, s[24:27], s41 offen lds
    v_accvgpr_read_b32 v213, a137
    v_mfma_f32_16x16x32_bf16 v[152:155], v[232:235], v[56:59], v[152:155]
    v_accvgpr_read_b32 v214, a138
    v_accvgpr_read_b32 v215, a139
    v_mfma_f32_16x16x32_bf16 v[156:159], v[232:235], v[60:63], v[156:159]
    s_waitcnt lgkmcnt(2)
    ds_read_b64_tr_b16 v[232:233], v247 offset:16384
    ds_read_b64_tr_b16 v[234:235], v247 offset:18432
    v_mfma_f32_16x16x32_bf16 v[172:175], v[224:227], v[60:63], v[172:175]
    s_add_u32 m0, s32, 0x1b000
    v_cvt_pk_bf16_f32 v72, v212, v213
    v_cvt_pk_bf16_f32 v73, v214, v215
    v_mfma_f32_16x16x32_bf16 v[168:171], v[224:227], v[56:59], v[168:171]
    buffer_load_dwordx4 v252, s[24:27], s42 offen lds
    v_accvgpr_read_b32 v216, a132
    v_mfma_f32_16x16x32_bf16 v[164:167], v[224:227], v[52:55], v[164:167]
    v_accvgpr_read_b32 v217, a133
    v_accvgpr_read_b32 v218, a134
    v_mfma_f32_16x16x32_bf16 v[160:163], v[224:227], v[48:51], v[160:163]
    s_waitcnt lgkmcnt(2)
    ds_read_b64_tr_b16 v[224:225], v248 offset:16384
    ds_read_b64_tr_b16 v[226:227], v248 offset:18432
    v_mfma_f32_16x16x32_bf16 v[176:179], v[228:231], v[48:51], v[176:179]
    s_add_u32 m0, s32, 0x1c000
    v_accvgpr_read_b32 v219, a135
    v_cvt_pk_bf16_f32 v68, v216, v217
    v_mfma_f32_16x16x32_bf16 v[180:183], v[228:231], v[52:55], v[180:183]
    buffer_load_dwordx4 v252, s[24:27], s43 offen lds
    v_cvt_pk_bf16_f32 v69, v218, v219
    v_mfma_f32_16x16x32_bf16 v[184:187], v[228:231], v[56:59], v[184:187]
    s_lshl_b32 s54, s4, 10
    v_accvgpr_read_b32 v220, a128
    v_accvgpr_read_b32 v221, a129
    v_accvgpr_read_b32 v222, a130
    v_accvgpr_read_b32 v223, a131
    v_cvt_pk_bf16_f32 v64, v220, v221
    v_cvt_pk_bf16_f32 v65, v222, v223
    v_accvgpr_read_b32 v208, a144
    v_accvgpr_read_b32 v209, a145
    v_accvgpr_read_b32 v210, a146
    v_accvgpr_read_b32 v211, a147
    v_cvt_pk_bf16_f32 v66, v208, v209
    v_cvt_pk_bf16_f32 v67, v210, v211
    v_accvgpr_read_b32 v212, a148
    v_accvgpr_read_b32 v213, a149
    v_accvgpr_read_b32 v214, a150
    v_accvgpr_read_b32 v215, a151
    v_cvt_pk_bf16_f32 v70, v212, v213
    v_cvt_pk_bf16_f32 v71, v214, v215
    v_accvgpr_read_b32 v216, a152
    v_accvgpr_read_b32 v217, a153
    v_accvgpr_read_b32 v218, a154
    v_accvgpr_read_b32 v219, a155
    v_cvt_pk_bf16_f32 v74, v216, v217
    v_cvt_pk_bf16_f32 v75, v218, v219
    v_accvgpr_read_b32 v220, a156
    v_accvgpr_read_b32 v221, a157
    v_accvgpr_read_b32 v222, a158
    v_accvgpr_read_b32 v223, a159
    v_cvt_pk_bf16_f32 v78, v220, v221
    v_cvt_pk_bf16_f32 v79, v222, v223
    v_mfma_f32_16x16x32_bf16 v[188:191], v[228:231], v[60:63], v[188:191]
    s_waitcnt lgkmcnt(2)
    ds_read_b64_tr_b16 v[228:229], v249 offset:16384
    ds_read_b64_tr_b16 v[230:231], v249 offset:18432
    v_mfma_f32_16x16x32_bf16 v[140:143], v[232:235], v[76:79], v[140:143]
    s_add_u32 m0, s32, 0x1d000
    v_accvgpr_read_b32 v208, a172
    v_accvgpr_read_b32 v209, a173
    v_mfma_f32_16x16x32_bf16 v[136:139], v[232:235], v[72:75], v[136:139]
    buffer_load_dwordx4 v252, s[24:27], s44 offen lds
    v_accvgpr_read_b32 v210, a174
    v_mfma_f32_16x16x32_bf16 v[132:135], v[232:235], v[68:71], v[132:135]
    s_add_u32 s54, s54, 0x16400000
    v_accvgpr_read_b32 v211, a175
    v_cvt_pk_bf16_f32 v92, v208, v209
    v_mfma_f32_16x16x32_bf16 v[128:131], v[232:235], v[64:67], v[128:131]
    s_waitcnt lgkmcnt(2)
    ds_read_b64_tr_b16 v[232:233], v250 offset:16384
    ds_read_b64_tr_b16 v[234:235], v250 offset:18432
    v_mfma_f32_16x16x32_bf16 v[144:147], v[224:227], v[64:67], v[144:147]
    s_add_u32 m0, s32, 0x1e000
    v_cvt_pk_bf16_f32 v93, v210, v211
    v_accvgpr_read_b32 v212, a168
    v_mfma_f32_16x16x32_bf16 v[148:151], v[224:227], v[68:71], v[148:151]
    buffer_load_dwordx4 v252, s[24:27], s45 offen lds
    v_accvgpr_read_b32 v213, a169
    v_mfma_f32_16x16x32_bf16 v[152:155], v[224:227], v[72:75], v[152:155]
    s_add_u32 s8, s70, s54
    s_addc_u32 s9, s71, 0
    v_accvgpr_read_b32 v214, a170
    v_accvgpr_read_b32 v215, a171
    v_mfma_f32_16x16x32_bf16 v[156:159], v[224:227], v[76:79], v[156:159]
    s_waitcnt lgkmcnt(2)
    ds_read_b64_tr_b16 v[224:225], v247 offset:20480
    ds_read_b64_tr_b16 v[226:227], v247 offset:22528
    v_mfma_f32_16x16x32_bf16 v[172:175], v[228:231], v[76:79], v[172:175]
    s_add_u32 m0, s32, 0x1f000
    v_cvt_pk_bf16_f32 v88, v212, v213
    v_cvt_pk_bf16_f32 v89, v214, v215
    v_mfma_f32_16x16x32_bf16 v[168:171], v[228:231], v[72:75], v[168:171]
    buffer_load_dwordx4 v252, s[24:27], s46 offen lds
    v_accvgpr_read_b32 v216, a164
    v_mfma_f32_16x16x32_bf16 v[164:167], v[228:231], v[68:71], v[164:167]
    s_add_u32 s24, s24, 128
    s_addc_u32 s25, s25, 0
    s_mov_b32 s10, 0x100
    v_accvgpr_read_b32 v217, a165
    v_accvgpr_read_b32 v218, a166
    v_mfma_f32_16x16x32_bf16 v[160:163], v[228:231], v[64:67], v[160:163]
    s_waitcnt lgkmcnt(2)
    s_sub_u32 s26, s26, 128
    ds_read_b64_tr_b16 v[228:229], v248 offset:20480
    ds_read_b64_tr_b16 v[230:231], v248 offset:22528
    v_mfma_f32_16x16x32_bf16 v[176:179], v[232:235], v[64:67], v[176:179]
    v_accvgpr_read_b32 v219, a167
    v_cvt_pk_bf16_f32 v84, v216, v217
    v_mfma_f32_16x16x32_bf16 v[180:183], v[232:235], v[68:71], v[180:183]
    v_cvt_pk_bf16_f32 v85, v218, v219
    v_accvgpr_read_b32 v220, a160
    v_mfma_f32_16x16x32_bf16 v[184:187], v[232:235], v[72:75], v[184:187]
    s_lshl_b32 s54, s4, 4
    v_accvgpr_read_b32 v221, a161
    v_accvgpr_read_b32 v222, a162
    v_accvgpr_read_b32 v223, a163
    v_cvt_pk_bf16_f32 v80, v220, v221
    v_cvt_pk_bf16_f32 v81, v222, v223
    v_accvgpr_read_b32 v208, a176
    v_accvgpr_read_b32 v209, a177
    v_accvgpr_read_b32 v210, a178
    v_accvgpr_read_b32 v211, a179
    v_cvt_pk_bf16_f32 v82, v208, v209
    v_cvt_pk_bf16_f32 v83, v210, v211
    v_accvgpr_read_b32 v212, a180
    v_accvgpr_read_b32 v213, a181
    v_accvgpr_read_b32 v214, a182
    v_accvgpr_read_b32 v215, a183
    v_cvt_pk_bf16_f32 v86, v212, v213
    v_cvt_pk_bf16_f32 v87, v214, v215
    v_accvgpr_read_b32 v216, a184
    v_accvgpr_read_b32 v217, a185
    v_accvgpr_read_b32 v218, a186
    v_accvgpr_read_b32 v219, a187
    v_cvt_pk_bf16_f32 v90, v216, v217
    v_cvt_pk_bf16_f32 v91, v218, v219
    v_accvgpr_read_b32 v220, a188
    v_accvgpr_read_b32 v221, a189
    v_accvgpr_read_b32 v222, a190
    v_accvgpr_read_b32 v223, a191
    v_cvt_pk_bf16_f32 v94, v220, v221
    v_cvt_pk_bf16_f32 v95, v222, v223
    v_mfma_f32_16x16x32_bf16 v[188:191], v[232:235], v[76:79], v[188:191]
    s_waitcnt lgkmcnt(2)
    ds_read_b64_tr_b16 v[232:233], v249 offset:20480
    ds_read_b64_tr_b16 v[234:235], v249 offset:22528
    v_mfma_f32_16x16x32_bf16 v[140:143], v[224:227], v[92:95], v[140:143]
    v_accvgpr_read_b32 v208, a204
    v_accvgpr_read_b32 v209, a205
    v_mfma_f32_16x16x32_bf16 v[136:139], v[224:227], v[88:91], v[136:139]
    v_accvgpr_read_b32 v210, a206
    v_accvgpr_read_b32 v211, a207
    v_mfma_f32_16x16x32_bf16 v[132:135], v[224:227], v[84:87], v[132:135]
    s_add_u32 s54, s54, s5
    v_cvt_pk_bf16_f32 v108, v208, v209
    v_cvt_pk_bf16_f32 v109, v210, v211
    v_mfma_f32_16x16x32_bf16 v[128:131], v[224:227], v[80:83], v[128:131]
    s_waitcnt lgkmcnt(2)
    ds_read_b64_tr_b16 v[224:225], v250 offset:20480
    ds_read_b64_tr_b16 v[226:227], v250 offset:22528
    v_mfma_f32_16x16x32_bf16 v[144:147], v[228:231], v[80:83], v[144:147]
    v_accvgpr_read_b32 v212, a200
    v_accvgpr_read_b32 v213, a201
    v_mfma_f32_16x16x32_bf16 v[148:151], v[228:231], v[84:87], v[148:151]
    v_accvgpr_read_b32 v214, a202
    v_accvgpr_read_b32 v215, a203
    v_mfma_f32_16x16x32_bf16 v[152:155], v[228:231], v[88:91], v[152:155]
    s_lshl_b32 s54, s54, 16
    v_cvt_pk_bf16_f32 v104, v212, v213
    v_cvt_pk_bf16_f32 v105, v214, v215
    v_mfma_f32_16x16x32_bf16 v[156:159], v[228:231], v[92:95], v[156:159]
    s_waitcnt lgkmcnt(2)
    ds_read_b64_tr_b16 v[228:229], v247 offset:24576
    ds_read_b64_tr_b16 v[230:231], v247 offset:26624
    v_mfma_f32_16x16x32_bf16 v[172:175], v[232:235], v[92:95], v[172:175]
    v_accvgpr_read_b32 v216, a196
    v_accvgpr_read_b32 v217, a197
    v_mfma_f32_16x16x32_bf16 v[168:171], v[232:235], v[88:91], v[168:171]
    v_accvgpr_read_b32 v218, a198
    v_accvgpr_read_b32 v219, a199
    v_mfma_f32_16x16x32_bf16 v[164:167], v[232:235], v[84:87], v[164:167]
    s_lshl_b32 s55, s3, 12
    v_cvt_pk_bf16_f32 v100, v216, v217
    v_cvt_pk_bf16_f32 v101, v218, v219
    v_mfma_f32_16x16x32_bf16 v[160:163], v[232:235], v[80:83], v[160:163]
    s_waitcnt lgkmcnt(2)
    ds_read_b64_tr_b16 v[232:233], v248 offset:24576
    ds_read_b64_tr_b16 v[234:235], v248 offset:26624
    v_mfma_f32_16x16x32_bf16 v[176:179], v[224:227], v[80:83], v[176:179]
    v_accvgpr_read_b32 v220, a192
    v_accvgpr_read_b32 v221, a193
    v_mfma_f32_16x16x32_bf16 v[180:183], v[224:227], v[84:87], v[180:183]
    v_accvgpr_read_b32 v222, a194
    v_accvgpr_read_b32 v223, a195
    v_mfma_f32_16x16x32_bf16 v[184:187], v[224:227], v[88:91], v[184:187]
    s_add_u32 s54, s54, s55
    v_cvt_pk_bf16_f32 v96, v220, v221
    v_cvt_pk_bf16_f32 v97, v222, v223
    v_accvgpr_read_b32 v208, a208
    v_accvgpr_read_b32 v209, a209
    v_accvgpr_read_b32 v210, a210
    v_accvgpr_read_b32 v211, a211
    v_cvt_pk_bf16_f32 v98, v208, v209
    v_cvt_pk_bf16_f32 v99, v210, v211
    v_accvgpr_read_b32 v212, a212
    v_accvgpr_read_b32 v213, a213
    v_accvgpr_read_b32 v214, a214
    v_accvgpr_read_b32 v215, a215
    v_cvt_pk_bf16_f32 v102, v212, v213
    v_cvt_pk_bf16_f32 v103, v214, v215
    v_accvgpr_read_b32 v216, a216
    v_accvgpr_read_b32 v217, a217
    v_accvgpr_read_b32 v218, a218
    v_accvgpr_read_b32 v219, a219
    v_cvt_pk_bf16_f32 v106, v216, v217
    v_cvt_pk_bf16_f32 v107, v218, v219
    v_accvgpr_read_b32 v220, a220
    v_accvgpr_read_b32 v221, a221
    v_accvgpr_read_b32 v222, a222
    v_accvgpr_read_b32 v223, a223
    v_cvt_pk_bf16_f32 v110, v220, v221
    v_cvt_pk_bf16_f32 v111, v222, v223
    v_mfma_f32_16x16x32_bf16 v[188:191], v[224:227], v[92:95], v[188:191]
    s_waitcnt lgkmcnt(2)
    ds_read_b64_tr_b16 v[224:225], v249 offset:24576
    ds_read_b64_tr_b16 v[226:227], v249 offset:26624
    v_mfma_f32_16x16x32_bf16 v[140:143], v[228:231], v[108:111], v[140:143]
    v_accvgpr_read_b32 v208, a236
    v_accvgpr_read_b32 v209, a237
    v_mfma_f32_16x16x32_bf16 v[136:139], v[228:231], v[104:107], v[136:139]
    v_accvgpr_read_b32 v210, a238
    v_accvgpr_read_b32 v211, a239
    v_mfma_f32_16x16x32_bf16 v[132:135], v[228:231], v[100:103], v[132:135]
    s_add_u32 s54, s54, 0x12c00000
    v_cvt_pk_bf16_f32 v124, v208, v209
    v_cvt_pk_bf16_f32 v125, v210, v211
    v_mfma_f32_16x16x32_bf16 v[128:131], v[228:231], v[96:99], v[128:131]
    s_waitcnt lgkmcnt(2)
    ds_read_b64_tr_b16 v[228:229], v250 offset:24576
    ds_read_b64_tr_b16 v[230:231], v250 offset:26624
    v_mfma_f32_16x16x32_bf16 v[144:147], v[232:235], v[96:99], v[144:147]
    v_accvgpr_read_b32 v212, a232
    v_accvgpr_read_b32 v213, a233
    v_mfma_f32_16x16x32_bf16 v[148:151], v[232:235], v[100:103], v[148:151]
    v_accvgpr_read_b32 v214, a234
    v_accvgpr_read_b32 v215, a235
    v_mfma_f32_16x16x32_bf16 v[152:155], v[232:235], v[104:107], v[152:155]
    s_add_u32 s12, s70, s54
    s_addc_u32 s13, s71, 0
    v_cvt_pk_bf16_f32 v120, v212, v213
    v_cvt_pk_bf16_f32 v121, v214, v215
    v_mfma_f32_16x16x32_bf16 v[156:159], v[232:235], v[108:111], v[156:159]
    s_waitcnt lgkmcnt(2)
    ds_read_b64_tr_b16 v[232:233], v247 offset:28672
    ds_read_b64_tr_b16 v[234:235], v247 offset:30720
    v_mfma_f32_16x16x32_bf16 v[172:175], v[224:227], v[108:111], v[172:175]
    v_accvgpr_read_b32 v216, a228
    v_accvgpr_read_b32 v217, a229
    v_mfma_f32_16x16x32_bf16 v[168:171], v[224:227], v[104:107], v[168:171]
    v_accvgpr_read_b32 v218, a230
    v_accvgpr_read_b32 v219, a231
    v_mfma_f32_16x16x32_bf16 v[164:167], v[224:227], v[100:103], v[164:167]
    s_mov_b32 s79, 0
    v_cvt_pk_bf16_f32 v116, v216, v217
    v_cvt_pk_bf16_f32 v117, v218, v219
    v_mfma_f32_16x16x32_bf16 v[160:163], v[224:227], v[96:99], v[160:163]
    s_waitcnt lgkmcnt(2)
    ds_read_b64_tr_b16 v[224:225], v248 offset:28672
    ds_read_b64_tr_b16 v[226:227], v248 offset:30720
    v_mfma_f32_16x16x32_bf16 v[176:179], v[228:231], v[96:99], v[176:179]
    v_accvgpr_read_b32 v220, a224
    v_accvgpr_read_b32 v221, a225
    v_mfma_f32_16x16x32_bf16 v[180:183], v[228:231], v[100:103], v[180:183]
    v_accvgpr_read_b32 v222, a226
    v_accvgpr_read_b32 v223, a227
    v_mfma_f32_16x16x32_bf16 v[184:187], v[228:231], v[104:107], v[184:187]
    s_mov_b32 s14, 0xd000
    v_cvt_pk_bf16_f32 v112, v220, v221
    v_cvt_pk_bf16_f32 v113, v222, v223
    v_accvgpr_read_b32 v208, a240
    v_accvgpr_read_b32 v209, a241
    v_accvgpr_read_b32 v210, a242
    v_accvgpr_read_b32 v211, a243
    v_cvt_pk_bf16_f32 v114, v208, v209
    v_cvt_pk_bf16_f32 v115, v210, v211
    v_accvgpr_read_b32 v212, a244
    v_accvgpr_read_b32 v213, a245
    v_accvgpr_read_b32 v214, a246
    v_accvgpr_read_b32 v215, a247
    v_cvt_pk_bf16_f32 v118, v212, v213
    v_cvt_pk_bf16_f32 v119, v214, v215
    v_accvgpr_read_b32 v216, a248
    v_accvgpr_read_b32 v217, a249
    v_accvgpr_read_b32 v218, a250
    v_accvgpr_read_b32 v219, a251
    v_cvt_pk_bf16_f32 v122, v216, v217
    v_cvt_pk_bf16_f32 v123, v218, v219
    v_accvgpr_read_b32 v220, a252
    v_accvgpr_read_b32 v221, a253
    v_accvgpr_read_b32 v222, a254
    v_accvgpr_read_b32 v223, a255
    v_cvt_pk_bf16_f32 v126, v220, v221
    v_cvt_pk_bf16_f32 v127, v222, v223
    v_mfma_f32_16x16x32_bf16 v[188:191], v[228:231], v[108:111], v[188:191]
    s_waitcnt lgkmcnt(2)
    ds_read_b64_tr_b16 v[228:229], v249 offset:28672
    ds_read_b64_tr_b16 v[230:231], v249 offset:30720
    v_mfma_f32_16x16x32_bf16 v[140:143], v[232:235], v[124:127], v[140:143]
    v_subrev_u32 v247, 0x20000, v247
    v_add_f32 v236, v236, v240
    v_mfma_f32_16x16x32_bf16 v[136:139], v[232:235], v[120:123], v[136:139]
    v_add_f32 v237, v237, v241
    v_add_f32 v238, v238, v242
    v_mfma_f32_16x16x32_bf16 v[132:135], v[232:235], v[116:119], v[132:135]
    s_add_u32 s73, s72, 1
    v_add_f32 v239, v239, v243
    v_mov_b32 v240, v236
    v_mfma_f32_16x16x32_bf16 v[128:131], v[232:235], v[112:115], v[128:131]
    s_waitcnt lgkmcnt(2)
    ds_read_b64_tr_b16 v[232:233], v250 offset:28672
    ds_read_b64_tr_b16 v[234:235], v250 offset:30720
    v_mfma_f32_16x16x32_bf16 v[144:147], v[224:227], v[112:115], v[144:147]
    v_mov_b32 v241, v237
    v_mov_b32 v242, v238
    v_mfma_f32_16x16x32_bf16 v[148:151], v[224:227], v[116:119], v[148:151]
    v_mov_b32 v243, v239
    v_permlane32_swap_b32 v236, v240
    v_mfma_f32_16x16x32_bf16 v[152:155], v[224:227], v[120:123], v[152:155]
    s_add_u32 s88, s88, s3
    v_permlane32_swap_b32 v237, v241
    v_permlane32_swap_b32 v238, v242
    v_mfma_f32_16x16x32_bf16 v[156:159], v[224:227], v[124:127], v[156:159]
    s_waitcnt lgkmcnt(2)
    ds_read_b64_tr_b16 v[224:225], v247 offset:0
    ds_read_b64_tr_b16 v[226:227], v247 offset:2048
    v_mfma_f32_16x16x32_bf16 v[172:175], v[228:231], v[124:127], v[172:175]
    v_permlane32_swap_b32 v239, v243
    v_add_f32 v236, v236, v240
    v_mfma_f32_16x16x32_bf16 v[168:171], v[228:231], v[120:123], v[168:171]
    v_add_f32 v237, v237, v241
    v_add_f32 v238, v238, v242
    v_mfma_f32_16x16x32_bf16 v[164:167], v[228:231], v[116:119], v[164:167]
    s_lshl_b32 s88, s88, 2
    v_add_f32 v239, v239, v243
    v_mov_b32 v240, v236
    v_mfma_f32_16x16x32_bf16 v[160:163], v[228:231], v[112:115], v[160:163]
    s_waitcnt lgkmcnt(2)
    ds_read_b64_tr_b16 v[228:229], v247 offset:4096
    ds_read_b64_tr_b16 v[230:231], v247 offset:6144
    v_mfma_f32_16x16x32_bf16 v[176:179], v[232:235], v[112:115], v[176:179]
    v_mov_b32 v241, v237
    v_mov_b32 v242, v238
    v_mfma_f32_16x16x32_bf16 v[180:183], v[232:235], v[116:119], v[180:183]
    v_mov_b32 v243, v239
    v_permlane16_swap_b32 v236, v240
    v_mfma_f32_16x16x32_bf16 v[184:187], v[232:235], v[120:123], v[184:187]
    v_permlane16_swap_b32 v237, v241
    v_permlane16_swap_b32 v238, v242
    v_mfma_f32_16x16x32_bf16 v[188:191], v[232:235], v[124:127], v[188:191]
    s_waitcnt lgkmcnt(2)
    ds_read_b64_tr_b16 v[232:233], v247 offset:8192
    ds_read_b64_tr_b16 v[234:235], v247 offset:10240
    v_permlane16_swap_b32 v239, v243
    v_add_f32 v236, v236, v240
    v_add_f32 v237, v237, v241
    v_add_f32 v238, v238, v242
    v_add_f32 v239, v239, v243
    v_rcp_f32 v236, v236
    v_rcp_f32 v237, v237
    v_rcp_f32 v238, v238
    v_rcp_f32 v239, v239
    v_mbcnt_lo_u32_b32 v242, -1, 0
    v_mbcnt_hi_u32_b32 v242, -1, v242
    v_lshlrev_b32 v241, 12, v242
    v_lshlrev_b32 v240, 2, v242
    v_and_b32 v245, 3, v242
    v_mul_u32_u24 v245, 0x380, v245
    v_lshrrev_b32 v243, 4, v242
    v_lshl_add_u32 v245, v243, 5, v245
    v_bfe_u32 v243, v242, 2, 2
    v_lshl_add_u32 v245, v243, 3, v245
    v_lshlrev_b32 v242, 4, v242
    v_mov_b32 v251, s72
    v_mfma_f32_16x16x32_bf16 v[204:207], v[224:227], v[12:15], 0
    v_subrev_u32 v248, 0x20000, v248
    v_mul_f32 v140, v239, v140
    v_mfma_f32_16x16x32_bf16 v[200:203], v[224:227], v[8:11], 0
    v_mul_f32 v141, v239, v141
    v_mul_f32 v142, v239, v142
    v_mfma_f32_16x16x32_bf16 v[196:199], v[224:227], v[4:7], 0
    v_mul_f32 v143, v239, v143
    v_cvt_pk_bf16_f32 v140, v140, v141
    v_mfma_f32_16x16x32_bf16 v[192:195], v[224:227], v[0:3], 0
    s_waitcnt lgkmcnt(2)
    ds_read_b64_tr_b16 v[224:225], v247 offset:12288
    ds_read_b64_tr_b16 v[226:227], v247 offset:14336
    v_mfma_f32_16x16x32_bf16 v[192:195], v[228:231], v[16:19], v[192:195]
    v_cvt_pk_bf16_f32 v141, v142, v143
    v_mul_f32 v136, v238, v136
    v_mfma_f32_16x16x32_bf16 v[196:199], v[228:231], v[20:23], v[196:199]
    v_mul_f32 v137, v238, v137
    v_mul_f32 v138, v238, v138
    v_mfma_f32_16x16x32_bf16 v[200:203], v[228:231], v[24:27], v[200:203]
    v_mul_f32 v139, v238, v139
    v_cvt_pk_bf16_f32 v136, v136, v137
    v_mfma_f32_16x16x32_bf16 v[204:207], v[228:231], v[28:31], v[204:207]
    s_waitcnt lgkmcnt(2)
    ds_read_b64_tr_b16 v[228:229], v247 offset:16384
    ds_read_b64_tr_b16 v[230:231], v247 offset:18432
    v_mfma_f32_16x16x32_bf16 v[204:207], v[232:235], v[44:47], v[204:207]
    v_cvt_pk_bf16_f32 v137, v138, v139
    v_mul_f32 v132, v237, v132
    v_mfma_f32_16x16x32_bf16 v[200:203], v[232:235], v[40:43], v[200:203]
    v_mul_f32 v133, v237, v133
    v_mul_f32 v134, v237, v134
    v_mfma_f32_16x16x32_bf16 v[196:199], v[232:235], v[36:39], v[196:199]
    v_mul_f32 v135, v237, v135
    v_cvt_pk_bf16_f32 v132, v132, v133
    v_mfma_f32_16x16x32_bf16 v[192:195], v[232:235], v[32:35], v[192:195]
    s_waitcnt lgkmcnt(2)
    ds_read_b64_tr_b16 v[232:233], v247 offset:20480
    ds_read_b64_tr_b16 v[234:235], v247 offset:22528
    v_mfma_f32_16x16x32_bf16 v[192:195], v[224:227], v[48:51], v[192:195]
    v_cvt_pk_bf16_f32 v133, v134, v135
    v_mul_f32 v128, v236, v128
    v_mfma_f32_16x16x32_bf16 v[196:199], v[224:227], v[52:55], v[196:199]
    v_mul_f32 v129, v236, v129
    v_mul_f32 v130, v236, v130
    v_mfma_f32_16x16x32_bf16 v[200:203], v[224:227], v[56:59], v[200:203]
    v_mul_f32 v131, v236, v131
    v_cvt_pk_bf16_f32 v128, v128, v129
    v_mfma_f32_16x16x32_bf16 v[204:207], v[224:227], v[60:63], v[204:207]
    s_waitcnt lgkmcnt(2)
    ds_read_b64_tr_b16 v[224:225], v247 offset:24576
    ds_read_b64_tr_b16 v[226:227], v247 offset:26624
    v_mfma_f32_16x16x32_bf16 v[204:207], v[228:231], v[76:79], v[204:207]
    v_cvt_pk_bf16_f32 v129, v130, v131
    v_mul_f32 v144, v236, v144
    v_mfma_f32_16x16x32_bf16 v[200:203], v[228:231], v[72:75], v[200:203]
    v_mul_f32 v145, v236, v145
    v_mul_f32 v146, v236, v146
    v_mfma_f32_16x16x32_bf16 v[196:199], v[228:231], v[68:71], v[196:199]
    s_waitcnt vmcnt(18)
    s_barrier
    v_mul_f32 v147, v236, v147
    v_cvt_pk_bf16_f32 v130, v144, v145
    v_mfma_f32_16x16x32_bf16 v[192:195], v[228:231], v[64:67], v[192:195]
    s_waitcnt lgkmcnt(2)
    s_add_u32 m0, s32, 0x20000
    ds_read_b64_tr_b16 v[228:229], v247 offset:28672
    ds_read_b64_tr_b16 v[230:231], v247 offset:30720
    v_mfma_f32_16x16x32_bf16 v[192:195], v[232:235], v[80:83], v[192:195]
    buffer_load_dwordx4 v252, s[24:27], 0 offen lds
    v_cvt_pk_bf16_f32 v131, v146, v147
    v_mfma_f32_16x16x32_bf16 v[196:199], v[232:235], v[84:87], v[196:199]
    s_add_u32 m0, s32, 0x21000
    buffer_store_dwordx4 v[128:131], v253, s[28:31], s48 offen
    s_xor_b32 s48, s48, 0x4000
    v_mul_f32 v148, v237, v148
    v_mfma_f32_16x16x32_bf16 v[200:203], v[232:235], v[88:91], v[200:203]
    buffer_load_dwordx4 v252, s[24:27], s40 offen lds
    v_mul_f32 v149, v237, v149
    v_mfma_f32_16x16x32_bf16 v[204:207], v[232:235], v[92:95], v[204:207]
    s_waitcnt lgkmcnt(2)
    ds_read_b64_tr_b16 v[232:233], v248 offset:0
    ds_read_b64_tr_b16 v[234:235], v248 offset:2048
    v_mfma_f32_16x16x32_bf16 v[204:207], v[224:227], v[108:111], v[204:207]
    s_add_u32 m0, s32, 0x22000
    v_mul_f32 v150, v237, v150
    v_mul_f32 v151, v237, v151
    v_mfma_f32_16x16x32_bf16 v[200:203], v[224:227], v[104:107], v[200:203]
    buffer_load_dwordx4 v252, s[24:27], s41 offen lds
    v_cvt_pk_bf16_f32 v134, v148, v149
    v_mfma_f32_16x16x32_bf16 v[196:199], v[224:227], v[100:103], v[196:199]
    v_cvt_pk_bf16_f32 v135, v150, v151
    buffer_store_dwordx4 v[132:135], v253, s[28:31], s49 offen
    s_xor_b32 s49, s49, 0x4000
    v_mfma_f32_16x16x32_bf16 v[192:195], v[224:227], v[96:99], v[192:195]
    s_waitcnt lgkmcnt(2)
    s_add_u32 m0, s32, 0x23000
    ds_read_b64_tr_b16 v[224:225], v248 offset:4096
    ds_read_b64_tr_b16 v[226:227], v248 offset:6144
    v_mfma_f32_16x16x32_bf16 v[192:195], v[228:231], v[112:115], v[192:195]
    buffer_load_dwordx4 v252, s[24:27], s42 offen lds
    v_mul_f32 v152, v238, v152
    v_mfma_f32_16x16x32_bf16 v[196:199], v[228:231], v[116:119], v[196:199]
    s_add_u32 m0, s32, 0x24000
    v_mul_f32 v153, v238, v153
    v_mul_f32 v154, v238, v154
    v_mfma_f32_16x16x32_bf16 v[200:203], v[228:231], v[120:123], v[200:203]
    buffer_load_dwordx4 v252, s[24:27], s43 offen lds
    v_mul_f32 v155, v238, v155
    v_mfma_f32_16x16x32_bf16 v[204:207], v[228:231], v[124:127], v[204:207]
    s_waitcnt lgkmcnt(2)
    ds_read_b64_tr_b16 v[228:229], v248 offset:8192
    ds_read_b64_tr_b16 v[230:231], v248 offset:10240
    v_cvt_pk_bf16_f32 v138, v152, v153
    v_cvt_pk_bf16_f32 v139, v154, v155
    buffer_store_dwordx4 v[136:139], v253, s[28:31], s50 offen
    s_xor_b32 s50, s50, 0x4000
    v_mul_f32 v156, v239, v156
    v_mul_f32 v157, v239, v157
    v_mul_f32 v158, v239, v158
    v_mul_f32 v159, v239, v159
    v_cvt_pk_bf16_f32 v142, v156, v157
    v_cvt_pk_bf16_f32 v143, v158, v159
    buffer_store_dwordx4 v[140:143], v253, s[28:31], s51 offen
    s_xor_b32 s51, s51, 0x4000
    v_mfma_f32_16x16x32_bf16 v[156:159], v[232:235], v[12:15], 0
    s_add_u32 m0, s32, 0x25000
    v_subrev_u32 v249, 0x20000, v249
    v_mul_f32 v172, v239, v172
    v_mfma_f32_16x16x32_bf16 v[152:155], v[232:235], v[8:11], 0
    buffer_load_dwordx4 v252, s[24:27], s44 offen lds
    v_mul_f32 v173, v239, v173
    v_mfma_f32_16x16x32_bf16 v[148:151], v[232:235], v[4:7], 0
    v_mul_f32 v174, v239, v174
    v_mul_f32 v175, v239, v175
    v_mfma_f32_16x16x32_bf16 v[144:147], v[232:235], v[0:3], 0
    s_waitcnt lgkmcnt(2)
    s_add_u32 m0, s32, 0x26000
    ds_read_b64_tr_b16 v[232:233], v248 offset:12288
    ds_read_b64_tr_b16 v[234:235], v248 offset:14336
    v_mfma_f32_16x16x32_bf16 v[144:147], v[224:227], v[16:19], v[144:147]
    buffer_load_dwordx4 v252, s[24:27], s45 offen lds
    v_cvt_pk_bf16_f32 v172, v172, v173
    v_mfma_f32_16x16x32_bf16 v[148:151], v[224:227], v[20:23], v[148:151]
    s_add_u32 m0, s32, 0x27000
    v_cvt_pk_bf16_f32 v173, v174, v175
    v_mul_f32 v168, v238, v168
    v_mfma_f32_16x16x32_bf16 v[152:155], v[224:227], v[24:27], v[152:155]
    buffer_load_dwordx4 v252, s[24:27], s46 offen lds
    v_mul_f32 v169, v238, v169
    v_mfma_f32_16x16x32_bf16 v[156:159], v[224:227], v[28:31], v[156:159]
    s_waitcnt lgkmcnt(2)
    s_add_u32 s24, s24, 128
    s_addc_u32 s25, s25, 0
    ds_read_b64_tr_b16 v[224:225], v248 offset:16384
    ds_read_b64_tr_b16 v[226:227], v248 offset:18432
    v_mfma_f32_16x16x32_bf16 v[156:159], v[228:231], v[44:47], v[156:159]
    s_sub_u32 s26, s26, 128
    v_mul_f32 v170, v238, v170
    v_mul_f32 v171, v238, v171
    v_mfma_f32_16x16x32_bf16 v[152:155], v[228:231], v[40:43], v[152:155]
    v_cvt_pk_bf16_f32 v168, v168, v169
    v_cvt_pk_bf16_f32 v169, v170, v171
    v_mfma_f32_16x16x32_bf16 v[148:151], v[228:231], v[36:39], v[148:151]
    v_mul_f32 v164, v237, v164
    v_mul_f32 v165, v237, v165
    v_mfma_f32_16x16x32_bf16 v[144:147], v[228:231], v[32:35], v[144:147]
    s_waitcnt lgkmcnt(2)
    ds_read_b64_tr_b16 v[228:229], v248 offset:20480
    ds_read_b64_tr_b16 v[230:231], v248 offset:22528
    v_mfma_f32_16x16x32_bf16 v[144:147], v[232:235], v[48:51], v[144:147]
    v_mul_f32 v166, v237, v166
    v_mul_f32 v167, v237, v167
    v_mfma_f32_16x16x32_bf16 v[148:151], v[232:235], v[52:55], v[148:151]
    v_cvt_pk_bf16_f32 v164, v164, v165
    v_cvt_pk_bf16_f32 v165, v166, v167
    v_mfma_f32_16x16x32_bf16 v[152:155], v[232:235], v[56:59], v[152:155]
    v_mul_f32 v160, v236, v160
    v_mul_f32 v161, v236, v161
    v_mfma_f32_16x16x32_bf16 v[156:159], v[232:235], v[60:63], v[156:159]
    s_waitcnt lgkmcnt(2)
    ds_read_b64_tr_b16 v[232:233], v248 offset:24576
    ds_read_b64_tr_b16 v[234:235], v248 offset:26624
    v_mfma_f32_16x16x32_bf16 v[156:159], v[224:227], v[76:79], v[156:159]
    v_mul_f32 v162, v236, v162
    v_mul_f32 v163, v236, v163
    v_mfma_f32_16x16x32_bf16 v[152:155], v[224:227], v[72:75], v[152:155]
    v_cvt_pk_bf16_f32 v160, v160, v161
    v_cvt_pk_bf16_f32 v161, v162, v163
    v_mfma_f32_16x16x32_bf16 v[148:151], v[224:227], v[68:71], v[148:151]
    v_mul_f32 v176, v236, v176
    v_mul_f32 v177, v236, v177
    v_mfma_f32_16x16x32_bf16 v[144:147], v[224:227], v[64:67], v[144:147]
    s_waitcnt lgkmcnt(2)
    ds_read_b64_tr_b16 v[224:225], v248 offset:28672
    ds_read_b64_tr_b16 v[226:227], v248 offset:30720
    v_mfma_f32_16x16x32_bf16 v[144:147], v[228:231], v[80:83], v[144:147]
    v_mul_f32 v178, v236, v178
    v_mul_f32 v179, v236, v179
    v_mfma_f32_16x16x32_bf16 v[148:151], v[228:231], v[84:87], v[148:151]
    v_cvt_pk_bf16_f32 v162, v176, v177
    v_cvt_pk_bf16_f32 v163, v178, v179
    v_mfma_f32_16x16x32_bf16 v[152:155], v[228:231], v[88:91], v[152:155]
    buffer_store_dwordx4 v[160:163], v253, s[28:31], s48 offen
    s_xor_b32 s48, s48, 0xc000
    v_mul_f32 v180, v237, v180
    v_mfma_f32_16x16x32_bf16 v[156:159], v[228:231], v[92:95], v[156:159]
    s_waitcnt lgkmcnt(2)
    ds_read_b64_tr_b16 v[228:229], v249 offset:0
    ds_read_b64_tr_b16 v[230:231], v249 offset:2048
    v_mfma_f32_16x16x32_bf16 v[156:159], v[232:235], v[108:111], v[156:159]
    v_mul_f32 v181, v237, v181
    v_mul_f32 v182, v237, v182
    v_mfma_f32_16x16x32_bf16 v[152:155], v[232:235], v[104:107], v[152:155]
    v_mul_f32 v183, v237, v183
    v_cvt_pk_bf16_f32 v166, v180, v181
    v_mfma_f32_16x16x32_bf16 v[148:151], v[232:235], v[100:103], v[148:151]
    v_cvt_pk_bf16_f32 v167, v182, v183
    buffer_store_dwordx4 v[164:167], v253, s[28:31], s49 offen
    s_xor_b32 s49, s49, 0xc000
    v_mfma_f32_16x16x32_bf16 v[144:147], v[232:235], v[96:99], v[144:147]
    s_waitcnt lgkmcnt(2)
    ds_read_b64_tr_b16 v[232:233], v249 offset:4096
    ds_read_b64_tr_b16 v[234:235], v249 offset:6144
    v_mfma_f32_16x16x32_bf16 v[144:147], v[224:227], v[112:115], v[144:147]
    v_mul_f32 v184, v238, v184
    v_mul_f32 v185, v238, v185
    v_mfma_f32_16x16x32_bf16 v[148:151], v[224:227], v[116:119], v[148:151]
    v_mul_f32 v186, v238, v186
    v_mul_f32 v187, v238, v187
    v_mfma_f32_16x16x32_bf16 v[152:155], v[224:227], v[120:123], v[152:155]
    v_cvt_pk_bf16_f32 v170, v184, v185
    v_cvt_pk_bf16_f32 v171, v186, v187
    v_mfma_f32_16x16x32_bf16 v[156:159], v[224:227], v[124:127], v[156:159]
    s_waitcnt lgkmcnt(2)
    ds_read_b64_tr_b16 v[224:225], v249 offset:8192
    ds_read_b64_tr_b16 v[226:227], v249 offset:10240
    buffer_store_dwordx4 v[168:171], v253, s[28:31], s50 offen
    s_xor_b32 s50, s50, 0xc000
    v_mul_f32 v188, v239, v188
    v_mul_f32 v189, v239, v189
    v_mul_f32 v190, v239, v190
    v_mul_f32 v191, v239, v191
    v_cvt_pk_bf16_f32 v174, v188, v189
    v_cvt_pk_bf16_f32 v175, v190, v191
    buffer_store_dwordx4 v[172:175], v253, s[28:31], s51 offen
    s_xor_b32 s51, s51, 0xc000
    v_mul_f32 v192, v236, v192
    v_mul_f32 v193, v236, v193
    v_mul_f32 v194, v236, v194
    v_mul_f32 v195, v236, v195
    v_cvt_pk_bf16_f32 v128, v192, v193
    v_cvt_pk_bf16_f32 v129, v194, v195
    v_mul_f32 v196, v237, v196
    v_mul_f32 v197, v237, v197
    v_mul_f32 v198, v237, v198
    v_mul_f32 v199, v237, v199
    v_cvt_pk_bf16_f32 v132, v196, v197
    v_cvt_pk_bf16_f32 v133, v198, v199
    v_mul_f32 v200, v238, v200
    v_mul_f32 v201, v238, v201
    v_mul_f32 v202, v238, v202
    v_mul_f32 v203, v238, v203
    v_cvt_pk_bf16_f32 v136, v200, v201
    v_cvt_pk_bf16_f32 v137, v202, v203
    v_mul_f32 v204, v239, v204
    v_mul_f32 v205, v239, v205
    v_mul_f32 v206, v239, v206
    v_mul_f32 v207, v239, v207
    v_cvt_pk_bf16_f32 v140, v204, v205
    v_cvt_pk_bf16_f32 v141, v206, v207
    v_mfma_f32_16x16x32_bf16 v[204:207], v[228:231], v[12:15], 0
    v_mul_f32 v144, v236, v144
    v_mul_f32 v145, v236, v145
    v_mfma_f32_16x16x32_bf16 v[200:203], v[228:231], v[8:11], 0
    v_mul_f32 v146, v236, v146
    v_mul_f32 v147, v236, v147
    v_mfma_f32_16x16x32_bf16 v[196:199], v[228:231], v[4:7], 0
    v_cvt_pk_bf16_f32 v130, v144, v145
    v_cvt_pk_bf16_f32 v131, v146, v147
    v_mfma_f32_16x16x32_bf16 v[192:195], v[228:231], v[0:3], 0
    s_waitcnt lgkmcnt(2)
    ds_read_b64_tr_b16 v[228:229], v249 offset:12288
    ds_read_b64_tr_b16 v[230:231], v249 offset:14336
    v_mfma_f32_16x16x32_bf16 v[192:195], v[232:235], v[16:19], v[192:195]
    v_add_u32 v251, 1, v251
    v_mul_f32 v148, v237, v148
    v_mfma_f32_16x16x32_bf16 v[196:199], v[232:235], v[20:23], v[196:199]
    v_mul_f32 v149, v237, v149
    v_mul_f32 v150, v237, v150
    v_mfma_f32_16x16x32_bf16 v[200:203], v[232:235], v[24:27], v[200:203]
    v_mul_f32 v151, v237, v151
    v_cvt_pk_bf16_f32 v134, v148, v149
    v_mfma_f32_16x16x32_bf16 v[204:207], v[232:235], v[28:31], v[204:207]
    s_waitcnt lgkmcnt(2)
    ds_read_b64_tr_b16 v[232:233], v249 offset:16384
    ds_read_b64_tr_b16 v[234:235], v249 offset:18432
    v_mfma_f32_16x16x32_bf16 v[204:207], v[224:227], v[44:47], v[204:207]
    buffer_store_dwordx4 v[128:131], v253, s[28:31], s48 offen
    v_cvt_pk_bf16_f32 v135, v150, v151
    v_mfma_f32_16x16x32_bf16 v[200:203], v[224:227], v[40:43], v[200:203]
    s_xor_b32 s48, s48, 0x4000
    v_subrev_u32 v250, 0x20000, v250
    v_mul_f32 v152, v238, v152
    v_mfma_f32_16x16x32_bf16 v[196:199], v[224:227], v[36:39], v[196:199]
    v_mul_f32 v153, v238, v153
    v_mul_f32 v154, v238, v154
    v_mfma_f32_16x16x32_bf16 v[192:195], v[224:227], v[32:35], v[192:195]
    s_waitcnt lgkmcnt(2)
    ds_read_b64_tr_b16 v[224:225], v249 offset:20480
    ds_read_b64_tr_b16 v[226:227], v249 offset:22528
    v_mfma_f32_16x16x32_bf16 v[192:195], v[228:231], v[48:51], v[192:195]
    v_mul_f32 v155, v238, v155
    v_cvt_pk_bf16_f32 v138, v152, v153
    v_mfma_f32_16x16x32_bf16 v[196:199], v[228:231], v[52:55], v[196:199]
    v_cvt_pk_bf16_f32 v139, v154, v155
    v_mul_f32 v156, v239, v156
    v_mfma_f32_16x16x32_bf16 v[200:203], v[228:231], v[56:59], v[200:203]
    v_mul_f32 v157, v239, v157
    v_mul_f32 v158, v239, v158
    v_mfma_f32_16x16x32_bf16 v[204:207], v[228:231], v[60:63], v[204:207]
    s_waitcnt lgkmcnt(2)
    ds_read_b64_tr_b16 v[228:229], v249 offset:24576
    ds_read_b64_tr_b16 v[230:231], v249 offset:26624
    v_mfma_f32_16x16x32_bf16 v[204:207], v[232:235], v[76:79], v[204:207]
    v_mul_f32 v159, v239, v159
    v_cvt_pk_bf16_f32 v142, v156, v157
    v_mfma_f32_16x16x32_bf16 v[200:203], v[232:235], v[72:75], v[200:203]
    v_cvt_pk_bf16_f32 v143, v158, v159
    v_bfe_u32 v181, v242, 4, 1
    v_mfma_f32_16x16x32_bf16 v[196:199], v[232:235], v[68:71], v[196:199]
    s_waitcnt vmcnt(1)
    s_cmp_lg_u32 s76, 0
    s_cbranch_scc1 L_fb1_
    buffer_store_dword v251, v241, s[8:11], s88 offen
L_fbr1_:
    v_lshlrev_b32 v181, 4, v181
    v_mov_b32 v182, 0x3f80
    v_mfma_f32_16x16x32_bf16 v[192:195], v[232:235], v[64:67], v[192:195]
    s_waitcnt lgkmcnt(2)
    ds_read_b64_tr_b16 v[232:233], v249 offset:28672
    ds_read_b64_tr_b16 v[234:235], v249 offset:30720
    v_mfma_f32_16x16x32_bf16 v[192:195], v[224:227], v[80:83], v[192:195]
    v_lshlrev_b32 v181, v181, v182
    v_bfe_u32 v180, v242, 5, 3
    v_mfma_f32_16x16x32_bf16 v[196:199], v[224:227], v[84:87], v[196:199]
    v_cmp_eq_u32 s[54:55], 0, v180
    v_cmp_eq_u32 s[56:57], 1, v180
    v_mfma_f32_16x16x32_bf16 v[200:203], v[224:227], v[88:91], v[200:203]
    buffer_store_dwordx4 v[132:135], v253, s[28:31], s49 offen
    v_cmp_eq_u32 s[58:59], 2, v180
    v_mfma_f32_16x16x32_bf16 v[204:207], v[224:227], v[92:95], v[204:207]
    s_waitcnt lgkmcnt(2)
    s_xor_b32 s49, s49, 0x4000
    ds_read_b64_tr_b16 v[224:225], v250 offset:0
    ds_read_b64_tr_b16 v[226:227], v250 offset:2048
    v_mfma_f32_16x16x32_bf16 v[204:207], v[228:231], v[108:111], v[204:207]
    v_cmp_eq_u32 s[74:75], 3, v180
    v_cndmask_b32 v176, 0, v181, s[54:55]
    v_mfma_f32_16x16x32_bf16 v[200:203], v[228:231], v[104:107], v[200:203]
    v_cndmask_b32 v177, 0, v181, s[56:57]
    v_cndmask_b32 v178, 0, v181, s[58:59]
    v_mfma_f32_16x16x32_bf16 v[196:199], v[228:231], v[100:103], v[196:199]
    v_cndmask_b32 v179, 0, v181, s[74:75]
    v_cmp_eq_u32 s[54:55], 4, v180
    v_mfma_f32_16x16x32_bf16 v[192:195], v[228:231], v[96:99], v[192:195]
    s_waitcnt lgkmcnt(2)
    ds_read_b64_tr_b16 v[228:229], v250 offset:4096
    ds_read_b64_tr_b16 v[230:231], v250 offset:6144
    v_mfma_f32_16x16x32_bf16 v[192:195], v[232:235], v[112:115], v[192:195]
    v_cmp_eq_u32 s[56:57], 5, v180
    v_cmp_eq_u32 s[58:59], 6, v180
    v_mfma_f32_16x16x32_bf16 v[196:199], v[232:235], v[116:119], v[196:199]
    v_cmp_eq_u32 s[74:75], 7, v180
    v_cndmask_b32 v188, 0, v181, s[54:55]
    v_mfma_f32_16x16x32_bf16 v[200:203], v[232:235], v[120:123], v[200:203]
    v_cndmask_b32 v189, 0, v181, s[56:57]
    v_cndmask_b32 v190, 0, v181, s[58:59]
    v_mfma_f32_16x16x32_bf16 v[204:207], v[232:235], v[124:127], v[204:207]
    s_waitcnt lgkmcnt(2)
    ds_read_b64_tr_b16 v[232:233], v250 offset:8192
    ds_read_b64_tr_b16 v[234:235], v250 offset:10240
    v_mfma_f32_16x16x32_bf16 v[156:159], v[224:227], v[12:15], 0
    v_cndmask_b32 v191, 0, v181, s[74:75]
    v_mul_f32 v192, v236, v192
    v_mfma_f32_16x16x32_bf16 v[152:155], v[224:227], v[8:11], 0
    v_mul_f32 v193, v236, v193
    v_mul_f32 v194, v236, v194
    v_mfma_f32_16x16x32_bf16 v[148:151], v[224:227], v[4:7], 0
    v_mul_f32 v195, v236, v195
    v_cvt_pk_bf16_f32 v160, v192, v193
    v_mfma_f32_16x16x32_bf16 v[144:147], v[224:227], v[0:3], 0
    s_waitcnt lgkmcnt(2)
    ds_read_b64_tr_b16 v[224:225], v250 offset:12288
    ds_read_b64_tr_b16 v[226:227], v250 offset:14336
    v_mfma_f32_16x16x32_bf16 v[144:147], v[228:231], v[16:19], v[144:147]
    buffer_store_dwordx4 v[136:139], v253, s[28:31], s50 offen
    v_cvt_pk_bf16_f32 v161, v194, v195
    v_mfma_f32_16x16x32_bf16 v[148:151], v[228:231], v[20:23], v[148:151]
    s_xor_b32 s50, s50, 0x4000
    v_mul_f32 v196, v237, v196
    v_mul_f32 v197, v237, v197
    v_mfma_f32_16x16x32_bf16 v[152:155], v[228:231], v[24:27], v[152:155]
    v_mul_f32 v198, v237, v198
    v_mul_f32 v199, v237, v199
    v_mfma_f32_16x16x32_bf16 v[156:159], v[228:231], v[28:31], v[156:159]
    s_waitcnt lgkmcnt(2)
    ds_read_b64_tr_b16 v[228:229], v250 offset:16384
    ds_read_b64_tr_b16 v[230:231], v250 offset:18432
    v_mfma_f32_16x16x32_bf16 v[156:159], v[232:235], v[44:47], v[156:159]
    buffer_load_dword v246, v240, s[8:11], 0 offen sc1
    v_cvt_pk_bf16_f32 v164, v196, v197
    v_mfma_f32_16x16x32_bf16 v[152:155], v[232:235], v[40:43], v[152:155]
    v_cvt_pk_bf16_f32 v165, v198, v199
    v_mul_f32 v200, v238, v200
    v_mfma_f32_16x16x32_bf16 v[148:151], v[232:235], v[36:39], v[148:151]
    v_mul_f32 v201, v238, v201
    v_mul_f32 v202, v238, v202
    v_mfma_f32_16x16x32_bf16 v[144:147], v[232:235], v[32:35], v[144:147]
    s_waitcnt lgkmcnt(2)
    ds_read_b64_tr_b16 v[232:233], v250 offset:20480
    ds_read_b64_tr_b16 v[234:235], v250 offset:22528
    v_mfma_f32_16x16x32_bf16 v[144:147], v[224:227], v[48:51], v[144:147]
    v_mul_f32 v203, v238, v203
    v_cvt_pk_bf16_f32 v168, v200, v201
    v_mfma_f32_16x16x32_bf16 v[148:151], v[224:227], v[52:55], v[148:151]
    v_cvt_pk_bf16_f32 v169, v202, v203
    v_mul_f32 v204, v239, v204
    v_mfma_f32_16x16x32_bf16 v[152:155], v[224:227], v[56:59], v[152:155]
    v_mul_f32 v205, v239, v205
    v_mul_f32 v206, v239, v206
    v_mfma_f32_16x16x32_bf16 v[156:159], v[224:227], v[60:63], v[156:159]
    s_waitcnt lgkmcnt(2)
    ds_read_b64_tr_b16 v[224:225], v250 offset:24576
    ds_read_b64_tr_b16 v[226:227], v250 offset:26624
    v_mfma_f32_16x16x32_bf16 v[156:159], v[228:231], v[76:79], v[156:159]
    v_mul_f32 v207, v239, v207
    v_cvt_pk_bf16_f32 v172, v204, v205
    v_mfma_f32_16x16x32_bf16 v[152:155], v[228:231], v[72:75], v[152:155]
    v_cvt_pk_bf16_f32 v173, v206, v207
    v_mfma_f32_16x16x32_bf16 v[148:151], v[228:231], v[68:71], v[148:151]
    buffer_store_dwordx4 v[140:143], v253, s[28:31], s51 offen
    v_mfma_f32_16x16x32_bf16 v[144:147], v[228:231], v[64:67], v[144:147]
    s_waitcnt lgkmcnt(2)
    s_xor_b32 s51, s51, 0x4000
    ds_read_b64_tr_b16 v[228:229], v250 offset:28672
    ds_read_b64_tr_b16 v[230:231], v250 offset:30720
    v_mfma_f32_16x16x32_bf16 v[144:147], v[232:235], v[80:83], v[144:147]
    v_mfma_f32_16x16x32_bf16 v[148:151], v[232:235], v[84:87], v[148:151]
    v_mfma_f32_16x16x32_bf16 v[152:155], v[232:235], v[88:91], v[152:155]
    v_mfma_f32_16x16x32_bf16 v[156:159], v[232:235], v[92:95], v[156:159]
    s_waitcnt lgkmcnt(2)
    ds_read_b64_tr_b16 v[232:233], v247 offset:32768
    ds_read_b64_tr_b16 v[234:235], v247 offset:34816
    v_mfma_f32_16x16x32_bf16 v[156:159], v[224:227], v[108:111], v[156:159]
    v_mfma_f32_16x16x32_bf16 v[152:155], v[224:227], v[104:107], v[152:155]
    v_mfma_f32_16x16x32_bf16 v[148:151], v[224:227], v[100:103], v[148:151]
    v_mfma_f32_16x16x32_bf16 v[144:147], v[224:227], v[96:99], v[144:147]
    s_waitcnt lgkmcnt(2)
    ds_read_b64_tr_b16 v[224:225], v247 offset:36864
    ds_read_b64_tr_b16 v[226:227], v247 offset:38912
    v_mfma_f32_16x16x32_bf16 v[144:147], v[228:231], v[112:115], v[144:147]
    v_mfma_f32_16x16x32_bf16 v[148:151], v[228:231], v[116:119], v[148:151]
    v_mfma_f32_16x16x32_bf16 v[152:155], v[228:231], v[120:123], v[152:155]
    s_waitcnt vmcnt(1)
    v_subrev_u32 v254, s73, v246
    v_cmp_lt_u32 vcc, 11, v254
    v_mfma_f32_16x16x32_bf16 v[156:159], v[228:231], v[124:127], v[156:159]
    s_waitcnt lgkmcnt(2)
    ds_read_b64_tr_b16 v[228:229], v247 offset:40960
    ds_read_b64_tr_b16 v[230:231], v247 offset:43008
    v_mfma_f32_16x16x32_bf16 v[204:207], v[232:235], v[12:15], 0
    s_or_b64 vcc, vcc, s[76:77]
    s_cbranch_vccnz L_sp1_
L_spr1_:
    s_add_u32 s73, s73, 1
    v_mul_f32 v144, v236, v144
    v_mul_f32 v145, v236, v145
    v_mfma_f32_16x16x32_bf16 v[200:203], v[232:235], v[8:11], 0
    buffer_load_dwordx4 a[0:3], v242, s[12:15], s79 offen sc1
    v_mul_f32 v146, v236, v146
    v_mfma_f32_16x16x32_bf16 v[196:199], v[232:235], v[4:7], 0
    v_mul_f32 v147, v236, v147
    v_cvt_pk_bf16_f32 v162, v144, v145
    v_mfma_f32_16x16x32_bf16 v[192:195], v[232:235], v[0:3], 0
    s_waitcnt lgkmcnt(2)
    ds_read_b64_tr_b16 v[232:233], v247 offset:45056
    ds_read_b64_tr_b16 v[234:235], v247 offset:47104
    v_mfma_f32_16x16x32_bf16 v[192:195], v[224:227], v[16:19], v[192:195]
    buffer_load_dwordx4 a[4:7], v242, s[12:15], s79 offen offset:1024 sc1
    v_cvt_pk_bf16_f32 v163, v146, v147
    v_mfma_f32_16x16x32_bf16 v[196:199], v[224:227], v[20:23], v[196:199]
    v_mul_f32 v148, v237, v148
    v_mul_f32 v149, v237, v149
    v_mfma_f32_16x16x32_bf16 v[200:203], v[224:227], v[24:27], v[200:203]
    buffer_load_dwordx4 a[8:11], v242, s[12:15], s79 offen offset:2048 sc1
    v_mul_f32 v150, v237, v150
    v_mfma_f32_16x16x32_bf16 v[204:207], v[224:227], v[28:31], v[204:207]
    s_waitcnt lgkmcnt(2)
    ds_read_b64_tr_b16 v[224:225], v247 offset:49152
    ds_read_b64_tr_b16 v[226:227], v247 offset:51200
    v_mfma_f32_16x16x32_bf16 v[204:207], v[228:231], v[44:47], v[204:207]
    buffer_load_dwordx4 a[12:15], v242, s[12:15], s79 offen offset:3072 sc1
    buffer_store_dwordx4 v[160:163], v253, s[28:31], s48 offen
    v_mfma_f32_16x16x32_bf16 v[200:203], v[228:231], v[40:43], v[200:203]
    s_xor_b32 s79, s79, 0x4000
    s_xor_b32 s48, s48, 0xc000
    v_mul_f32 v151, v237, v151
    v_cvt_pk_bf16_f32 v166, v148, v149
    v_mfma_f32_16x16x32_bf16 v[196:199], v[228:231], v[36:39], v[196:199]
    buffer_load_dwordx4 a[16:19], v242, s[12:15], s79 offen sc1
    v_cvt_pk_bf16_f32 v167, v150, v151
    v_mfma_f32_16x16x32_bf16 v[192:195], v[228:231], v[32:35], v[192:195]
    s_waitcnt lgkmcnt(2)
    ds_read_b64_tr_b16 v[228:229], v247 offset:53248
    ds_read_b64_tr_b16 v[230:231], v247 offset:55296
    v_mfma_f32_16x16x32_bf16 v[192:195], v[232:235], v[48:51], v[192:195]
    v_mul_f32 v152, v238, v152
    v_mul_f32 v153, v238, v153
    v_mfma_f32_16x16x32_bf16 v[196:199], v[232:235], v[52:55], v[196:199]
    v_mul_f32 v154, v238, v154
    v_mul_f32 v155, v238, v155
    v_mfma_f32_16x16x32_bf16 v[200:203], v[232:235], v[56:59], v[200:203]
    v_cvt_pk_bf16_f32 v170, v152, v153
    v_cvt_pk_bf16_f32 v171, v154, v155
    v_mfma_f32_16x16x32_bf16 v[204:207], v[232:235], v[60:63], v[204:207]
    s_waitcnt lgkmcnt(2)
    ds_read_b64_tr_b16 v[232:233], v247 offset:57344
    ds_read_b64_tr_b16 v[234:235], v247 offset:59392
    v_mfma_f32_16x16x32_bf16 v[204:207], v[224:227], v[76:79], v[204:207]
    v_mul_f32 v156, v239, v156
    v_mul_f32 v157, v239, v157
    v_mfma_f32_16x16x32_bf16 v[200:203], v[224:227], v[72:75], v[200:203]
    v_mul_f32 v158, v239, v158
    v_mul_f32 v159, v239, v159
    v_mfma_f32_16x16x32_bf16 v[196:199], v[224:227], v[68:71], v[196:199]
    v_cvt_pk_bf16_f32 v174, v156, v157
    v_cvt_pk_bf16_f32 v175, v158, v159
    v_mfma_f32_16x16x32_bf16 v[192:195], v[224:227], v[64:67], v[192:195]
    s_waitcnt lgkmcnt(2)
    ds_read_b64_tr_b16 v[224:225], v247 offset:61440
    ds_read_b64_tr_b16 v[226:227], v247 offset:63488
    v_mfma_f32_16x16x32_bf16 v[192:195], v[228:231], v[80:83], v[192:195]
    v_add_u32 v251, 1, v251
    v_add_u32 v247, 0x10000, v247
    v_mfma_f32_16x16x32_bf16 v[196:199], v[228:231], v[84:87], v[196:199]
    v_mfma_f32_16x16x32_bf16 v[200:203], v[228:231], v[88:91], v[200:203]
    buffer_store_dwordx4 v[164:167], v253, s[28:31], s49 offen
    v_mfma_f32_16x16x32_bf16 v[204:207], v[228:231], v[92:95], v[204:207]
    s_waitcnt lgkmcnt(2)
    s_xor_b32 s49, s49, 0xc000
    ds_read_b64_tr_b16 v[228:229], v248 offset:32768
    ds_read_b64_tr_b16 v[230:231], v248 offset:34816
    v_mfma_f32_16x16x32_bf16 v[204:207], v[232:235], v[108:111], v[204:207]
    buffer_load_dwordx4 a[20:23], v242, s[12:15], s79 offen offset:1024 sc1
    v_mfma_f32_16x16x32_bf16 v[200:203], v[232:235], v[104:107], v[200:203]
    v_mfma_f32_16x16x32_bf16 v[196:199], v[232:235], v[100:103], v[196:199]
    v_mfma_f32_16x16x32_bf16 v[192:195], v[232:235], v[96:99], v[192:195]
    s_waitcnt lgkmcnt(2)
    ds_read_b64_tr_b16 v[232:233], v248 offset:36864
    ds_read_b64_tr_b16 v[234:235], v248 offset:38912
    v_mfma_f32_16x16x32_bf16 v[192:195], v[224:227], v[112:115], v[192:195]
    v_mfma_f32_16x16x32_bf16 v[196:199], v[224:227], v[116:119], v[196:199]
    v_mfma_f32_16x16x32_bf16 v[200:203], v[224:227], v[120:123], v[200:203]
    v_mul_f32 v192, v236, v192
    v_mul_f32 v193, v236, v193
    v_mfma_f32_16x16x32_bf16 v[204:207], v[224:227], v[124:127], v[204:207]
    s_waitcnt lgkmcnt(2)
    ds_read_b64_tr_b16 v[224:225], v248 offset:40960
    ds_read_b64_tr_b16 v[226:227], v248 offset:43008
    v_mfma_f32_16x16x32_bf16 v[156:159], v[228:231], v[12:15], 0
    v_mul_f32 v194, v236, v194
    v_mul_f32 v195, v236, v195
    v_mfma_f32_16x16x32_bf16 v[152:155], v[228:231], v[8:11], 0
    v_cvt_pk_bf16_f32 v128, v192, v193
    v_cvt_pk_bf16_f32 v129, v194, v195
    v_mfma_f32_16x16x32_bf16 v[148:151], v[228:231], v[4:7], 0
    v_mul_f32 v196, v237, v196
    v_mul_f32 v197, v237, v197
    v_mfma_f32_16x16x32_bf16 v[144:147], v[228:231], v[0:3], 0
    s_waitcnt lgkmcnt(2)
    ds_read_b64_tr_b16 v[228:229], v248 offset:45056
    ds_read_b64_tr_b16 v[230:231], v248 offset:47104
    v_mfma_f32_16x16x32_bf16 v[144:147], v[232:235], v[16:19], v[144:147]
    buffer_store_dwordx4 v[168:171], v253, s[28:31], s50 offen
    v_mul_f32 v198, v237, v198
    v_mfma_f32_16x16x32_bf16 v[148:151], v[232:235], v[20:23], v[148:151]
    s_xor_b32 s50, s50, 0xc000
    v_mul_f32 v199, v237, v199
    v_cvt_pk_bf16_f32 v132, v196, v197
    v_mfma_f32_16x16x32_bf16 v[152:155], v[232:235], v[24:27], v[152:155]
    s_waitcnt vmcnt(5)
    s_cmp_lg_u32 s76, 0
    s_cbranch_scc1 L_fb2_
    buffer_store_dword v251, v241, s[8:11], s88 offen
L_fbr2_:
    s_barrier
    buffer_load_dwordx4 a[24:27], v242, s[12:15], s79 offen offset:2048 sc1
    v_cvt_pk_bf16_f32 v133, v198, v199
    v_mfma_f32_16x16x32_bf16 v[156:159], v[232:235], v[28:31], v[156:159]
    s_waitcnt lgkmcnt(2)
    ds_read_b64_tr_b16 v[232:233], v248 offset:49152
    ds_read_b64_tr_b16 v[234:235], v248 offset:51200
    v_mfma_f32_16x16x32_bf16 v[156:159], v[224:227], v[44:47], v[156:159]
    v_mul_f32 v200, v238, v200
    v_mul_f32 v201, v238, v201
    v_mfma_f32_16x16x32_bf16 v[152:155], v[224:227], v[40:43], v[152:155]
    v_mul_f32 v202, v238, v202
    v_mul_f32 v203, v238, v203
    v_mfma_f32_16x16x32_bf16 v[148:151], v[224:227], v[36:39], v[148:151]
    v_cvt_pk_bf16_f32 v136, v200, v201
    v_cvt_pk_bf16_f32 v137, v202, v203
    v_mfma_f32_16x16x32_bf16 v[144:147], v[224:227], v[32:35], v[144:147]
    s_waitcnt lgkmcnt(2)
    ds_read_b64_tr_b16 v[224:225], v248 offset:53248
    ds_read_b64_tr_b16 v[226:227], v248 offset:55296
    v_mfma_f32_16x16x32_bf16 v[144:147], v[228:231], v[48:51], v[144:147]
    v_mul_f32 v204, v239, v204
    v_mul_f32 v205, v239, v205
    v_mfma_f32_16x16x32_bf16 v[148:151], v[228:231], v[52:55], v[148:151]
    v_mul_f32 v206, v239, v206
    v_mul_f32 v207, v239, v207
    v_mfma_f32_16x16x32_bf16 v[152:155], v[228:231], v[56:59], v[152:155]
    v_cvt_pk_bf16_f32 v140, v204, v205
    v_cvt_pk_bf16_f32 v141, v206, v207
    v_mfma_f32_16x16x32_bf16 v[156:159], v[228:231], v[60:63], v[156:159]
    s_waitcnt lgkmcnt(2)
    ds_read_b64_tr_b16 v[228:229], v248 offset:57344
    ds_read_b64_tr_b16 v[230:231], v248 offset:59392
    v_mfma_f32_16x16x32_bf16 v[156:159], v[232:235], v[76:79], v[156:159]
    v_mfma_f32_16x16x32_bf16 v[152:155], v[232:235], v[72:75], v[152:155]
    v_mfma_f32_16x16x32_bf16 v[148:151], v[232:235], v[68:71], v[148:151]
    buffer_store_dwordx4 v[172:175], v253, s[28:31], s51 offen
    v_mfma_f32_16x16x32_bf16 v[144:147], v[232:235], v[64:67], v[144:147]
    s_waitcnt lgkmcnt(2)
    s_xor_b32 s51, s51, 0xc000
    ds_read_b64_tr_b16 v[232:233], v248 offset:61440
    ds_read_b64_tr_b16 v[234:235], v248 offset:63488
    v_mfma_f32_16x16x32_bf16 v[144:147], v[224:227], v[80:83], v[144:147]
    buffer_load_dwordx4 a[28:31], v242, s[12:15], s79 offen offset:3072 sc1
    v_add_u32 v251, 1, v251
    v_mfma_f32_16x16x32_bf16 v[148:151], v[224:227], v[84:87], v[148:151]
    s_xor_b32 s79, s79, 0xc000
    v_add_u32 v248, 0x10000, v248
    v_mfma_f32_16x16x32_bf16 v[152:155], v[224:227], v[88:91], v[152:155]
    v_mfma_f32_16x16x32_bf16 v[156:159], v[224:227], v[92:95], v[156:159]
    s_waitcnt lgkmcnt(2)
    ds_read_b64_tr_b16 v[224:225], v249 offset:32768
    ds_read_b64_tr_b16 v[226:227], v249 offset:34816
    v_mfma_f32_16x16x32_bf16 v[156:159], v[228:231], v[108:111], v[156:159]
    v_mfma_f32_16x16x32_bf16 v[152:155], v[228:231], v[104:107], v[152:155]
    v_mfma_f32_16x16x32_bf16 v[148:151], v[228:231], v[100:103], v[148:151]
    v_mfma_f32_16x16x32_bf16 v[144:147], v[228:231], v[96:99], v[144:147]
    s_waitcnt lgkmcnt(2)
    ds_read_b64_tr_b16 v[228:229], v249 offset:36864
    ds_read_b64_tr_b16 v[230:231], v249 offset:38912
    v_mfma_f32_16x16x32_bf16 v[144:147], v[232:235], v[112:115], v[144:147]
    buffer_load_dword v246, v240, s[8:11], 0 offen sc1
    v_mfma_f32_16x16x32_bf16 v[148:151], v[232:235], v[116:119], v[148:151]
    s_add_u32 m0, s32, 0x0
    v_mfma_f32_16x16x32_bf16 v[152:155], v[232:235], v[120:123], v[152:155]
    buffer_load_dwordx4 v252, s[24:27], 0 offen lds
    v_mul_f32 v144, v236, v144
    v_mfma_f32_16x16x32_bf16 v[156:159], v[232:235], v[124:127], v[156:159]
    s_waitcnt lgkmcnt(2)
    ds_read_b64_tr_b16 v[232:233], v249 offset:40960
    ds_read_b64_tr_b16 v[234:235], v249 offset:43008
    v_mfma_f32_16x16x32_bf16 v[204:207], v[224:227], v[12:15], 0
    s_add_u32 m0, s32, 0x1000
    v_mul_f32 v145, v236, v145
    v_mul_f32 v146, v236, v146
    v_mfma_f32_16x16x32_bf16 v[200:203], v[224:227], v[8:11], 0
    buffer_load_dwordx4 v252, s[24:27], s40 offen lds
    v_mul_f32 v147, v236, v147
    v_mfma_f32_16x16x32_bf16 v[196:199], v[224:227], v[4:7], 0
    v_cvt_pk_bf16_f32 v130, v144, v145
    v_cvt_pk_bf16_f32 v131, v146, v147
    v_mfma_f32_16x16x32_bf16 v[192:195], v[224:227], v[0:3], 0
    s_waitcnt lgkmcnt(2)
    s_add_u32 m0, s32, 0x2000
    ds_read_b64_tr_b16 v[224:225], v249 offset:45056
    ds_read_b64_tr_b16 v[226:227], v249 offset:47104
    v_mfma_f32_16x16x32_bf16 v[192:195], v[228:231], v[16:19], v[192:195]
    buffer_load_dwordx4 v252, s[24:27], s41 offen lds
    v_mul_f32 v148, v237, v148
    v_mfma_f32_16x16x32_bf16 v[196:199], v[228:231], v[20:23], v[196:199]
    s_add_u32 m0, s32, 0x3000
    v_mul_f32 v149, v237, v149
    v_mul_f32 v150, v237, v150
    v_mfma_f32_16x16x32_bf16 v[200:203], v[228:231], v[24:27], v[200:203]
    buffer_load_dwordx4 v252, s[24:27], s42 offen lds
    v_mul_f32 v151, v237, v151
    v_mfma_f32_16x16x32_bf16 v[204:207], v[228:231], v[28:31], v[204:207]
    s_waitcnt lgkmcnt(2)
    ds_read_b64_tr_b16 v[228:229], v249 offset:49152
    ds_read_b64_tr_b16 v[230:231], v249 offset:51200
    v_mfma_f32_16x16x32_bf16 v[204:207], v[232:235], v[44:47], v[204:207]
    s_add_u32 m0, s32, 0x4000
    v_cvt_pk_bf16_f32 v134, v148, v149
    v_cvt_pk_bf16_f32 v135, v150, v151
    v_mfma_f32_16x16x32_bf16 v[200:203], v[232:235], v[40:43], v[200:203]
    buffer_load_dwordx4 v252, s[24:27], s43 offen lds
    v_mul_f32 v152, v238, v152
    v_mfma_f32_16x16x32_bf16 v[196:199], v[232:235], v[36:39], v[196:199]
    v_mul_f32 v153, v238, v153
    v_mul_f32 v154, v238, v154
    v_mfma_f32_16x16x32_bf16 v[192:195], v[232:235], v[32:35], v[192:195]
    s_waitcnt lgkmcnt(2)
    s_add_u32 m0, s32, 0x5000
    ds_read_b64_tr_b16 v[232:233], v249 offset:53248
    ds_read_b64_tr_b16 v[234:235], v249 offset:55296
    v_mfma_f32_16x16x32_bf16 v[192:195], v[224:227], v[48:51], v[192:195]
    buffer_load_dwordx4 v252, s[24:27], s44 offen lds
    v_mul_f32 v155, v238, v155
    v_mfma_f32_16x16x32_bf16 v[196:199], v[224:227], v[52:55], v[196:199]
    s_add_u32 m0, s32, 0x6000
    v_cvt_pk_bf16_f32 v138, v152, v153
    v_cvt_pk_bf16_f32 v139, v154, v155
    v_mfma_f32_16x16x32_bf16 v[200:203], v[224:227], v[56:59], v[200:203]
    buffer_load_dwordx4 v252, s[24:27], s45 offen lds
    v_mul_f32 v156, v239, v156
    v_mfma_f32_16x16x32_bf16 v[204:207], v[224:227], v[60:63], v[204:207]
    s_waitcnt lgkmcnt(2)
    s_add_u32 m0, s32, 0x7000
    v_mul_f32 v157, v239, v157
    v_mul_f32 v158, v239, v158
    v_mfma_f32_16x16x32_bf16 v[204:207], v[228:231], v[76:79], v[204:207]
    buffer_load_dwordx4 v252, s[24:27], s46 offen lds
    v_mul_f32 v159, v239, v159
    v_mfma_f32_16x16x32_bf16 v[200:203], v[228:231], v[72:75], v[200:203]
    s_add_u32 s24, s24, 128
    s_addc_u32 s25, s25, 0
    v_cvt_pk_bf16_f32 v142, v156, v157
    v_cvt_pk_bf16_f32 v143, v158, v159
    v_mfma_f32_16x16x32_bf16 v[196:199], v[228:231], v[68:71], v[196:199]
    s_sub_u32 s26, s26, 128
    s_waitcnt vmcnt(9)
    s_cmp_lg_u32 s76, 0
    s_cbranch_scc1 L_fb3_
    buffer_store_dword v251, v241, s[8:11], s88 offen
L_fbr3_:
    s_waitcnt vmcnt(9)
    v_subrev_u32 v254, s73, v246
    v_cmp_lt_u32 vcc, 10, v254
    v_mfma_f32_16x16x32_bf16 v[192:195], v[228:231], v[64:67], v[192:195]
    s_waitcnt lgkmcnt(0)
    v_mfma_f32_16x16x32_bf16 v[192:195], v[232:235], v[80:83], v[192:195]
    s_or_b64 vcc, vcc, s[76:77]
    s_cbranch_vccnz L_sp2_
L_spr2_:
    s_add_u32 s73, s73, 1
    v_mfma_f32_16x16x32_bf16 v[196:199], v[232:235], v[84:87], v[196:199]
    buffer_load_dwordx4 a[32:35], v242, s[12:15], s79 offen sc1
    buffer_store_dwordx4 v[128:131], v253, s[28:31], s48 offen
    v_mfma_f32_16x16x32_bf16 v[200:203], v[232:235], v[88:91], v[200:203]
    s_xor_b32 s48, s48, 0x4000
    v_mfma_f32_16x16x32_bf16 v[204:207], v[232:235], v[92:95], v[204:207]
    ds_read_b64_tr_b16 v[224:225], v249 offset:57344
    ds_read_b64_tr_b16 v[226:227], v249 offset:59392
    v_mfma_f32_16x16x32_bf16 v[180:183], v[176:179], a[0:3], 0
    v_mfma_f32_16x16x32_bf16 v[180:183], v[176:179], a[4:7], v[180:183]
    v_mfma_f32_16x16x32_bf16 v[180:183], v[176:179], a[8:11], v[180:183]
    v_mfma_f32_16x16x32_bf16 v[180:183], v[176:179], a[12:15], v[180:183]
    ds_read_b64_tr_b16 v[228:229], v249 offset:61440
    ds_read_b64_tr_b16 v[230:231], v249 offset:63488
    v_mfma_f32_16x16x32_bf16 v[180:183], v[188:191], a[16:19], v[180:183]
    v_add_u32 v249, 0x10000, v249
    v_mfma_f32_16x16x32_bf16 v[180:183], v[188:191], a[20:23], v[180:183]
    v_mfma_f32_16x16x32_bf16 v[180:183], v[188:191], a[24:27], v[180:183]
    v_mfma_f32_16x16x32_bf16 v[180:183], v[188:191], a[28:31], v[180:183]
    s_waitcnt lgkmcnt(2)
    ds_read_b64_tr_b16 v[232:233], v250 offset:32768
    ds_read_b64_tr_b16 v[234:235], v250 offset:34816
    v_mfma_f32_16x16x32_bf16 v[204:207], v[224:227], v[108:111], v[204:207]
    v_mfma_f32_16x16x32_bf16 v[200:203], v[224:227], v[104:107], v[200:203]
    v_cvt_pk_bf16_f32 v184, v180, v181
    v_cvt_pk_bf16_f32 v185, v182, v183
    v_mfma_f32_16x16x32_bf16 v[196:199], v[224:227], v[100:103], v[196:199]
    v_mfma_f32_16x16x32_bf16 v[192:195], v[224:227], v[96:99], v[192:195]
    s_waitcnt lgkmcnt(2)
    ds_read_b64_tr_b16 v[224:225], v250 offset:36864
    ds_read_b64_tr_b16 v[226:227], v250 offset:38912
    v_mfma_f32_16x16x32_bf16 v[192:195], v[228:231], v[112:115], v[192:195]
    buffer_load_dwordx4 a[36:39], v242, s[12:15], s79 offen offset:1024 sc1
    buffer_store_dwordx4 v[132:135], v253, s[28:31], s49 offen
    v_mfma_f32_16x16x32_bf16 v[196:199], v[228:231], v[116:119], v[196:199]
    s_xor_b32 s49, s49, 0x4000
    v_mfma_f32_16x16x32_bf16 v[200:203], v[228:231], v[120:123], v[200:203]
    v_mul_f32 v192, v236, v192
    v_mul_f32 v193, v236, v193
    v_mfma_f32_16x16x32_bf16 v[204:207], v[228:231], v[124:127], v[204:207]
    s_waitcnt lgkmcnt(2)
    ds_read_b64_tr_b16 v[228:229], v250 offset:40960
    ds_read_b64_tr_b16 v[230:231], v250 offset:43008
    v_mfma_f32_16x16x32_bf16 v[156:159], v[232:235], v[12:15], 0
    buffer_load_dword v246, v240, s[8:11], 0 offen sc1
    v_mul_f32 v194, v236, v194
    v_mfma_f32_16x16x32_bf16 v[152:155], v[232:235], v[8:11], 0
    v_mul_f32 v195, v236, v195
    v_cvt_pk_bf16_f32 v160, v192, v193
    v_mfma_f32_16x16x32_bf16 v[148:151], v[232:235], v[4:7], 0
    v_cvt_pk_bf16_f32 v161, v194, v195
    v_mul_f32 v196, v237, v196
    v_mfma_f32_16x16x32_bf16 v[144:147], v[232:235], v[0:3], 0
    s_waitcnt lgkmcnt(2)
    ds_read_b64_tr_b16 v[232:233], v250 offset:45056
    ds_read_b64_tr_b16 v[234:235], v250 offset:47104
    v_mfma_f32_16x16x32_bf16 v[144:147], v[224:227], v[16:19], v[144:147]
    buffer_store_dwordx2 v[184:185], v245, s[80:83], 0 offen
    v_mul_f32 v197, v237, v197
    v_mfma_f32_16x16x32_bf16 v[148:151], v[224:227], v[20:23], v[148:151]
    v_mul_f32 v198, v237, v198
    v_mul_f32 v199, v237, v199
    v_mfma_f32_16x16x32_bf16 v[152:155], v[224:227], v[24:27], v[152:155]
    v_cvt_pk_bf16_f32 v164, v196, v197
    v_cvt_pk_bf16_f32 v165, v198, v199
    v_mfma_f32_16x16x32_bf16 v[156:159], v[224:227], v[28:31], v[156:159]
    s_waitcnt lgkmcnt(2)
    ds_read_b64_tr_b16 v[224:225], v250 offset:49152
    ds_read_b64_tr_b16 v[226:227], v250 offset:51200
    v_mfma_f32_16x16x32_bf16 v[156:159], v[228:231], v[44:47], v[156:159]
    v_mul_f32 v200, v238, v200
    v_mul_f32 v201, v238, v201
    v_mfma_f32_16x16x32_bf16 v[152:155], v[228:231], v[40:43], v[152:155]
    buffer_store_dwordx4 v[136:139], v253, s[28:31], s50 offen
    v_mul_f32 v202, v238, v202
    v_mfma_f32_16x16x32_bf16 v[148:151], v[228:231], v[36:39], v[148:151]
    s_xor_b32 s50, s50, 0x4000
    buffer_load_dwordx4 a[40:43], v242, s[12:15], s79 offen offset:2048 sc1
    v_mul_f32 v203, v238, v203
    v_mfma_f32_16x16x32_bf16 v[144:147], v[228:231], v[32:35], v[144:147]
    s_waitcnt lgkmcnt(2)
    ds_read_b64_tr_b16 v[228:229], v250 offset:53248
    ds_read_b64_tr_b16 v[230:231], v250 offset:55296
    v_mfma_f32_16x16x32_bf16 v[144:147], v[232:235], v[48:51], v[144:147]
    v_cvt_pk_bf16_f32 v168, v200, v201
    v_cvt_pk_bf16_f32 v169, v202, v203
    v_mfma_f32_16x16x32_bf16 v[148:151], v[232:235], v[52:55], v[148:151]
    v_mul_f32 v204, v239, v204
    v_mul_f32 v205, v239, v205
    v_mfma_f32_16x16x32_bf16 v[152:155], v[232:235], v[56:59], v[152:155]
    v_mul_f32 v206, v239, v206
    v_mul_f32 v207, v239, v207
    v_mfma_f32_16x16x32_bf16 v[156:159], v[232:235], v[60:63], v[156:159]
    s_waitcnt lgkmcnt(2)
    ds_read_b64_tr_b16 v[232:233], v250 offset:57344
    ds_read_b64_tr_b16 v[234:235], v250 offset:59392
    v_mfma_f32_16x16x32_bf16 v[156:159], v[224:227], v[76:79], v[156:159]
    v_cvt_pk_bf16_f32 v172, v204, v205
    v_cvt_pk_bf16_f32 v173, v206, v207
    v_mfma_f32_16x16x32_bf16 v[152:155], v[224:227], v[72:75], v[152:155]
    v_mfma_f32_16x16x32_bf16 v[148:151], v[224:227], v[68:71], v[148:151]
    v_mfma_f32_16x16x32_bf16 v[144:147], v[224:227], v[64:67], v[144:147]
    s_waitcnt lgkmcnt(2)
    ds_read_b64_tr_b16 v[224:225], v250 offset:61440
    ds_read_b64_tr_b16 v[226:227], v250 offset:63488
    v_mfma_f32_16x16x32_bf16 v[144:147], v[228:231], v[80:83], v[144:147]
    v_add_u32 v251, 1, v251
    v_add_u32 v250, 0x10000, v250
    v_mfma_f32_16x16x32_bf16 v[148:151], v[228:231], v[84:87], v[148:151]
    v_mfma_f32_16x16x32_bf16 v[152:155], v[228:231], v[88:91], v[152:155]
    s_waitcnt vmcnt(3)
    v_subrev_u32 v254, s73, v246
    v_cmp_lt_u32 vcc, 9, v254
    v_mfma_f32_16x16x32_bf16 v[156:159], v[228:231], v[92:95], v[156:159]
    s_waitcnt lgkmcnt(2)
    ds_read_b64_tr_b16 v[228:229], v247 offset:0
    ds_read_b64_tr_b16 v[230:231], v247 offset:2048
    v_mfma_f32_16x16x32_bf16 v[156:159], v[232:235], v[108:111], v[156:159]
    s_or_b64 vcc, vcc, s[76:77]
    s_cbranch_vccnz L_sp3_
L_spr3_:
    s_add_u32 s73, s73, 1
    buffer_load_dwordx4 a[44:47], v242, s[12:15], s79 offen offset:3072 sc1
    buffer_store_dwordx4 v[140:143], v253, s[28:31], s51 offen
    v_mfma_f32_16x16x32_bf16 v[152:155], v[232:235], v[104:107], v[152:155]
    s_xor_b32 s79, s79, 0x4000
    s_xor_b32 s51, s51, 0x4000
    buffer_load_dwordx4 a[48:51], v242, s[12:15], s79 offen sc1
    v_mfma_f32_16x16x32_bf16 v[148:151], v[232:235], v[100:103], v[148:151]
    v_mfma_f32_16x16x32_bf16 v[144:147], v[232:235], v[96:99], v[144:147]
    s_waitcnt lgkmcnt(2)
    ds_read_b64_tr_b16 v[232:233], v247 offset:4096
    ds_read_b64_tr_b16 v[234:235], v247 offset:6144
    v_mfma_f32_16x16x32_bf16 v[144:147], v[224:227], v[112:115], v[144:147]
    v_mfma_f32_16x16x32_bf16 v[148:151], v[224:227], v[116:119], v[148:151]
    v_mfma_f32_16x16x32_bf16 v[152:155], v[224:227], v[120:123], v[152:155]
    v_mul_f32 v144, v236, v144
    v_mul_f32 v145, v236, v145
    v_mfma_f32_16x16x32_bf16 v[156:159], v[224:227], v[124:127], v[156:159]
    s_waitcnt lgkmcnt(2)
    ds_read_b64_tr_b16 v[224:225], v247 offset:8192
    ds_read_b64_tr_b16 v[226:227], v247 offset:10240
    v_mfma_f32_16x16x32_bf16 v[204:207], v[228:231], v[12:15], 0
    v_mul_f32 v146, v236, v146
    v_mul_f32 v147, v236, v147
    v_mfma_f32_16x16x32_bf16 v[200:203], v[228:231], v[8:11], 0
    v_cvt_pk_bf16_f32 v162, v144, v145
    v_cvt_pk_bf16_f32 v163, v146, v147
    v_mfma_f32_16x16x32_bf16 v[196:199], v[228:231], v[4:7], 0
    v_mul_f32 v148, v237, v148
    v_mul_f32 v149, v237, v149
    v_mfma_f32_16x16x32_bf16 v[192:195], v[228:231], v[0:3], 0
    s_waitcnt lgkmcnt(2)
    ds_read_b64_tr_b16 v[228:229], v247 offset:12288
    ds_read_b64_tr_b16 v[230:231], v247 offset:14336
    v_mfma_f32_16x16x32_bf16 v[192:195], v[232:235], v[16:19], v[192:195]
    v_mul_f32 v150, v237, v150
    v_mul_f32 v151, v237, v151
    v_mfma_f32_16x16x32_bf16 v[196:199], v[232:235], v[20:23], v[196:199]
    v_cvt_pk_bf16_f32 v166, v148, v149
    v_cvt_pk_bf16_f32 v167, v150, v151
    v_mfma_f32_16x16x32_bf16 v[200:203], v[232:235], v[24:27], v[200:203]
    v_mul_f32 v152, v238, v152
    v_mul_f32 v153, v238, v153
    v_mfma_f32_16x16x32_bf16 v[204:207], v[232:235], v[28:31], v[204:207]
    s_waitcnt lgkmcnt(2)
    ds_read_b64_tr_b16 v[232:233], v247 offset:16384
    ds_read_b64_tr_b16 v[234:235], v247 offset:18432
    v_mfma_f32_16x16x32_bf16 v[204:207], v[224:227], v[44:47], v[204:207]
    buffer_load_dwordx4 a[52:55], v242, s[12:15], s79 offen offset:1024 sc1
    buffer_store_dwordx4 v[160:163], v253, s[28:31], s48 offen
    v_mfma_f32_16x16x32_bf16 v[200:203], v[224:227], v[40:43], v[200:203]
    s_xor_b32 s48, s48, 0xc000
    v_mul_f32 v154, v238, v154
    v_mul_f32 v155, v238, v155
    v_mfma_f32_16x16x32_bf16 v[196:199], v[224:227], v[36:39], v[196:199]
    v_cvt_pk_bf16_f32 v170, v152, v153
    v_cvt_pk_bf16_f32 v171, v154, v155
    v_mfma_f32_16x16x32_bf16 v[192:195], v[224:227], v[32:35], v[192:195]
    s_waitcnt lgkmcnt(2)
    ds_read_b64_tr_b16 v[224:225], v247 offset:20480
    ds_read_b64_tr_b16 v[226:227], v247 offset:22528
    v_mfma_f32_16x16x32_bf16 v[192:195], v[228:231], v[48:51], v[192:195]
    v_mul_f32 v156, v239, v156
    v_mul_f32 v157, v239, v157
    v_mfma_f32_16x16x32_bf16 v[196:199], v[228:231], v[52:55], v[196:199]
    v_mul_f32 v158, v239, v158
    v_mul_f32 v159, v239, v159
    v_mfma_f32_16x16x32_bf16 v[200:203], v[228:231], v[56:59], v[200:203]
    v_cvt_pk_bf16_f32 v174, v156, v157
    v_cvt_pk_bf16_f32 v175, v158, v159
    v_mfma_f32_16x16x32_bf16 v[204:207], v[228:231], v[60:63], v[204:207]
    s_waitcnt lgkmcnt(2)
    ds_read_b64_tr_b16 v[228:229], v247 offset:24576
    ds_read_b64_tr_b16 v[230:231], v247 offset:26624
    v_mfma_f32_16x16x32_bf16 v[204:207], v[232:235], v[76:79], v[204:207]
    v_mfma_f32_16x16x32_bf16 v[200:203], v[232:235], v[72:75], v[200:203]
    v_mfma_f32_16x16x32_bf16 v[196:199], v[232:235], v[68:71], v[196:199]
    s_waitcnt vmcnt(3)
    s_cmp_lg_u32 s76, 0
    s_cbranch_scc1 L_fb4_
    buffer_store_dword v251, v241, s[8:11], s88 offen
L_fbr4_:
    s_barrier
    v_mfma_f32_16x16x32_bf16 v[192:195], v[232:235], v[64:67], v[192:195]
    s_waitcnt lgkmcnt(2)
    ds_read_b64_tr_b16 v[232:233], v247 offset:28672
    ds_read_b64_tr_b16 v[234:235], v247 offset:30720
    v_mfma_f32_16x16x32_bf16 v[192:195], v[224:227], v[80:83], v[192:195]
    v_mfma_f32_16x16x32_bf16 v[196:199], v[224:227], v[84:87], v[196:199]
    v_mfma_f32_16x16x32_bf16 v[200:203], v[224:227], v[88:91], v[200:203]
    buffer_load_dwordx4 a[56:59], v242, s[12:15], s79 offen offset:2048 sc1
    buffer_store_dwordx4 v[164:167], v253, s[28:31], s49 offen
    v_mfma_f32_16x16x32_bf16 v[204:207], v[224:227], v[92:95], v[204:207]
    s_waitcnt lgkmcnt(2)
    s_xor_b32 s49, s49, 0xc000
    ds_read_b64_tr_b16 v[224:225], v248 offset:0
    ds_read_b64_tr_b16 v[226:227], v248 offset:2048
    v_mfma_f32_16x16x32_bf16 v[204:207], v[228:231], v[108:111], v[204:207]
    v_mfma_f32_16x16x32_bf16 v[200:203], v[228:231], v[104:107], v[200:203]
    v_mfma_f32_16x16x32_bf16 v[196:199], v[228:231], v[100:103], v[196:199]
    v_mfma_f32_16x16x32_bf16 v[192:195], v[228:231], v[96:99], v[192:195]
    s_waitcnt lgkmcnt(2)
    ds_read_b64_tr_b16 v[228:229], v248 offset:4096
    ds_read_b64_tr_b16 v[230:231], v248 offset:6144
    v_mfma_f32_16x16x32_bf16 v[192:195], v[232:235], v[112:115], v[192:195]
    v_mfma_f32_16x16x32_bf16 v[196:199], v[232:235], v[116:119], v[196:199]
    v_mfma_f32_16x16x32_bf16 v[200:203], v[232:235], v[120:123], v[200:203]
    v_mul_f32 v192, v236, v192
    v_mul_f32 v193, v236, v193
    v_mfma_f32_16x16x32_bf16 v[204:207], v[232:235], v[124:127], v[204:207]
    s_waitcnt lgkmcnt(2)
    ds_read_b64_tr_b16 v[232:233], v248 offset:8192
    ds_read_b64_tr_b16 v[234:235], v248 offset:10240
    v_mfma_f32_16x16x32_bf16 v[156:159], v[224:227], v[12:15], 0
    v_mul_f32 v194, v236, v194
    v_mul_f32 v195, v236, v195
    v_mfma_f32_16x16x32_bf16 v[152:155], v[224:227], v[8:11], 0
    v_cvt_pk_bf16_f32 v128, v192, v193
    v_cvt_pk_bf16_f32 v129, v194, v195
    v_mfma_f32_16x16x32_bf16 v[148:151], v[224:227], v[4:7], 0
    v_mul_f32 v196, v237, v196
    v_mul_f32 v197, v237, v197
    v_mfma_f32_16x16x32_bf16 v[144:147], v[224:227], v[0:3], 0
    s_waitcnt lgkmcnt(2)
    ds_read_b64_tr_b16 v[224:225], v248 offset:12288
    ds_read_b64_tr_b16 v[226:227], v248 offset:14336
    v_mfma_f32_16x16x32_bf16 v[144:147], v[228:231], v[16:19], v[144:147]
    buffer_load_dwordx4 a[60:63], v242, s[12:15], s79 offen offset:3072 sc1
    buffer_store_dwordx4 v[168:171], v253, s[28:31], s50 offen
    v_mfma_f32_16x16x32_bf16 v[148:151], v[228:231], v[20:23], v[148:151]
    s_xor_b32 s79, s79, 0xc000
    s_xor_b32 s50, s50, 0xc000
    v_mul_f32 v198, v237, v198
    v_mul_f32 v199, v237, v199
    v_mfma_f32_16x16x32_bf16 v[152:155], v[228:231], v[24:27], v[152:155]
    v_cvt_pk_bf16_f32 v132, v196, v197
    v_cvt_pk_bf16_f32 v133, v198, v199
    v_mfma_f32_16x16x32_bf16 v[156:159], v[228:231], v[28:31], v[156:159]
    s_waitcnt lgkmcnt(2)
    ds_read_b64_tr_b16 v[228:229], v248 offset:16384
    ds_read_b64_tr_b16 v[230:231], v248 offset:18432
    v_mfma_f32_16x16x32_bf16 v[156:159], v[232:235], v[44:47], v[156:159]
    buffer_load_dword v246, v240, s[8:11], 0 offen sc1
    v_mul_f32 v200, v238, v200
    v_mfma_f32_16x16x32_bf16 v[152:155], v[232:235], v[40:43], v[152:155]
    v_mul_f32 v201, v238, v201
    v_mul_f32 v202, v238, v202
    v_mfma_f32_16x16x32_bf16 v[148:151], v[232:235], v[36:39], v[148:151]
    v_mul_f32 v203, v238, v203
    v_cvt_pk_bf16_f32 v136, v200, v201
    v_mfma_f32_16x16x32_bf16 v[144:147], v[232:235], v[32:35], v[144:147]
    s_waitcnt lgkmcnt(2)
    ds_read_b64_tr_b16 v[232:233], v248 offset:20480
    ds_read_b64_tr_b16 v[234:235], v248 offset:22528
    v_mfma_f32_16x16x32_bf16 v[144:147], v[224:227], v[48:51], v[144:147]
    v_cvt_pk_bf16_f32 v137, v202, v203
    v_mul_f32 v204, v239, v204
    v_mfma_f32_16x16x32_bf16 v[148:151], v[224:227], v[52:55], v[148:151]
    v_mul_f32 v205, v239, v205
    v_mul_f32 v206, v239, v206
    v_mfma_f32_16x16x32_bf16 v[152:155], v[224:227], v[56:59], v[152:155]
    v_mul_f32 v207, v239, v207
    v_cvt_pk_bf16_f32 v140, v204, v205
    v_mfma_f32_16x16x32_bf16 v[156:159], v[224:227], v[60:63], v[156:159]
    s_waitcnt lgkmcnt(2)
    ds_read_b64_tr_b16 v[224:225], v248 offset:24576
    ds_read_b64_tr_b16 v[226:227], v248 offset:26624
    v_mfma_f32_16x16x32_bf16 v[156:159], v[228:231], v[76:79], v[156:159]
    v_cvt_pk_bf16_f32 v141, v206, v207
    v_mfma_f32_16x16x32_bf16 v[152:155], v[228:231], v[72:75], v[152:155]
    v_mfma_f32_16x16x32_bf16 v[148:151], v[228:231], v[68:71], v[148:151]
    buffer_store_dwordx4 v[172:175], v253, s[28:31], s51 offen
    v_mfma_f32_16x16x32_bf16 v[144:147], v[228:231], v[64:67], v[144:147]
    s_waitcnt lgkmcnt(2)
    s_xor_b32 s51, s51, 0xc000
    ds_read_b64_tr_b16 v[228:229], v248 offset:28672
    ds_read_b64_tr_b16 v[230:231], v248 offset:30720
    v_mfma_f32_16x16x32_bf16 v[144:147], v[232:235], v[80:83], v[144:147]
    v_add_u32 v251, 1, v251
    v_mfma_f32_16x16x32_bf16 v[148:151], v[232:235], v[84:87], v[148:151]
    v_mfma_f32_16x16x32_bf16 v[152:155], v[232:235], v[88:91], v[152:155]
    v_mfma_f32_16x16x32_bf16 v[156:159], v[232:235], v[92:95], v[156:159]
    s_waitcnt lgkmcnt(2)
    ds_read_b64_tr_b16 v[232:233], v249 offset:0
    ds_read_b64_tr_b16 v[234:235], v249 offset:2048
    v_mfma_f32_16x16x32_bf16 v[156:159], v[224:227], v[108:111], v[156:159]
    v_mfma_f32_16x16x32_bf16 v[152:155], v[224:227], v[104:107], v[152:155]
    v_mfma_f32_16x16x32_bf16 v[148:151], v[224:227], v[100:103], v[148:151]
    v_mfma_f32_16x16x32_bf16 v[144:147], v[224:227], v[96:99], v[144:147]
    s_waitcnt lgkmcnt(2)
    ds_read_b64_tr_b16 v[224:225], v249 offset:4096
    ds_read_b64_tr_b16 v[226:227], v249 offset:6144
    v_mfma_f32_16x16x32_bf16 v[144:147], v[228:231], v[112:115], v[144:147]
    v_mfma_f32_16x16x32_bf16 v[148:151], v[228:231], v[116:119], v[148:151]
    v_mfma_f32_16x16x32_bf16 v[152:155], v[228:231], v[120:123], v[152:155]
    s_waitcnt vmcnt(1)
    v_subrev_u32 v254, s73, v246
    v_cmp_lt_u32 vcc, 8, v254
    v_mfma_f32_16x16x32_bf16 v[156:159], v[228:231], v[124:127], v[156:159]
    s_waitcnt lgkmcnt(2)
    ds_read_b64_tr_b16 v[228:229], v249 offset:8192
    ds_read_b64_tr_b16 v[230:231], v249 offset:10240
    v_mfma_f32_16x16x32_bf16 v[204:207], v[232:235], v[12:15], 0
    s_or_b64 vcc, vcc, s[76:77]
    s_cbranch_vccnz L_sp4_
L_spr4_:
    s_add_u32 s73, s73, 1
    v_mul_f32 v144, v236, v144
    v_mul_f32 v145, v236, v145
    v_mfma_f32_16x16x32_bf16 v[200:203], v[232:235], v[8:11], 0
    buffer_load_dwordx4 a[64:67], v242, s[12:15], s79 offen sc1
    v_mul_f32 v146, v236, v146
    v_mfma_f32_16x16x32_bf16 v[196:199], v[232:235], v[4:7], 0
    v_mul_f32 v147, v236, v147
    v_cvt_pk_bf16_f32 v130, v144, v145
    v_mfma_f32_16x16x32_bf16 v[192:195], v[232:235], v[0:3], 0
    s_waitcnt lgkmcnt(2)
    ds_read_b64_tr_b16 v[232:233], v249 offset:12288
    ds_read_b64_tr_b16 v[234:235], v249 offset:14336
    v_mfma_f32_16x16x32_bf16 v[192:195], v[224:227], v[16:19], v[192:195]
    v_cvt_pk_bf16_f32 v131, v146, v147
    v_mul_f32 v148, v237, v148
    v_mfma_f32_16x16x32_bf16 v[196:199], v[224:227], v[20:23], v[196:199]
    v_mul_f32 v149, v237, v149
    v_mul_f32 v150, v237, v150
    v_mfma_f32_16x16x32_bf16 v[200:203], v[224:227], v[24:27], v[200:203]
    v_mul_f32 v151, v237, v151
    v_cvt_pk_bf16_f32 v134, v148, v149
    v_mfma_f32_16x16x32_bf16 v[204:207], v[224:227], v[28:31], v[204:207]
    s_waitcnt lgkmcnt(2)
    ds_read_b64_tr_b16 v[224:225], v249 offset:16384
    ds_read_b64_tr_b16 v[226:227], v249 offset:18432
    v_mfma_f32_16x16x32_bf16 v[204:207], v[228:231], v[44:47], v[204:207]
    buffer_store_dwordx4 v[128:131], v253, s[28:31], s48 offen
    v_cvt_pk_bf16_f32 v135, v150, v151
    v_mfma_f32_16x16x32_bf16 v[200:203], v[228:231], v[40:43], v[200:203]
    s_xor_b32 s48, s48, 0x4000
    v_mul_f32 v152, v238, v152
    v_mul_f32 v153, v238, v153
    v_mfma_f32_16x16x32_bf16 v[196:199], v[228:231], v[36:39], v[196:199]
    v_mul_f32 v154, v238, v154
    v_mul_f32 v155, v238, v155
    v_mfma_f32_16x16x32_bf16 v[192:195], v[228:231], v[32:35], v[192:195]
    s_waitcnt lgkmcnt(2)
    ds_read_b64_tr_b16 v[228:229], v249 offset:20480
    ds_read_b64_tr_b16 v[230:231], v249 offset:22528
    v_mfma_f32_16x16x32_bf16 v[192:195], v[232:235], v[48:51], v[192:195]
    v_cvt_pk_bf16_f32 v138, v152, v153
    v_cvt_pk_bf16_f32 v139, v154, v155
    v_mfma_f32_16x16x32_bf16 v[196:199], v[232:235], v[52:55], v[196:199]
    v_mul_f32 v156, v239, v156
    v_mul_f32 v157, v239, v157
    v_mfma_f32_16x16x32_bf16 v[200:203], v[232:235], v[56:59], v[200:203]
    v_mul_f32 v158, v239, v158
    v_mul_f32 v159, v239, v159
    v_mfma_f32_16x16x32_bf16 v[204:207], v[232:235], v[60:63], v[204:207]
    s_waitcnt lgkmcnt(2)
    buffer_load_dwordx4 a[68:71], v242, s[12:15], s79 offen offset:1024 sc1
    v_cvt_pk_bf16_f32 v142, v156, v157
    v_mfma_f32_16x16x32_bf16 v[204:207], v[224:227], v[76:79], v[204:207]
    v_cvt_pk_bf16_f32 v143, v158, v159
    v_mfma_f32_16x16x32_bf16 v[200:203], v[224:227], v[72:75], v[200:203]
    v_mfma_f32_16x16x32_bf16 v[196:199], v[224:227], v[68:71], v[196:199]
    s_waitcnt vmcnt(3)
    s_cmp_lg_u32 s76, 0
    s_cbranch_scc1 L_fb5_
    buffer_store_dword v251, v241, s[8:11], s88 offen
L_fbr5_:
    v_mfma_f32_16x16x32_bf16 v[192:195], v[224:227], v[64:67], v[192:195]
    s_waitcnt lgkmcnt(0)
    v_mfma_f32_16x16x32_bf16 v[192:195], v[228:231], v[80:83], v[192:195]
    v_mfma_f32_16x16x32_bf16 v[196:199], v[228:231], v[84:87], v[196:199]
    v_mfma_f32_16x16x32_bf16 v[200:203], v[228:231], v[88:91], v[200:203]
    buffer_store_dwordx4 v[132:135], v253, s[28:31], s49 offen
    v_mfma_f32_16x16x32_bf16 v[204:207], v[228:231], v[92:95], v[204:207]
    s_xor_b32 s49, s49, 0x4000
    ds_read_b64_tr_b16 v[232:233], v249 offset:24576
    ds_read_b64_tr_b16 v[234:235], v249 offset:26624
    v_mfma_f32_16x16x32_bf16 v[180:183], v[176:179], a[32:35], 0
    v_mfma_f32_16x16x32_bf16 v[180:183], v[176:179], a[36:39], v[180:183]
    v_mfma_f32_16x16x32_bf16 v[180:183], v[176:179], a[40:43], v[180:183]
    v_mfma_f32_16x16x32_bf16 v[180:183], v[176:179], a[44:47], v[180:183]
    ds_read_b64_tr_b16 v[224:225], v249 offset:28672
    ds_read_b64_tr_b16 v[226:227], v249 offset:30720
    v_mfma_f32_16x16x32_bf16 v[180:183], v[188:191], a[48:51], v[180:183]
    v_mfma_f32_16x16x32_bf16 v[180:183], v[188:191], a[52:55], v[180:183]
    buffer_load_dwordx4 a[72:75], v242, s[12:15], s79 offen offset:2048 sc1
    v_mfma_f32_16x16x32_bf16 v[180:183], v[188:191], a[56:59], v[180:183]
    v_mfma_f32_16x16x32_bf16 v[180:183], v[188:191], a[60:63], v[180:183]
    s_waitcnt lgkmcnt(2)
    ds_read_b64_tr_b16 v[228:229], v250 offset:0
    ds_read_b64_tr_b16 v[230:231], v250 offset:2048
    v_mfma_f32_16x16x32_bf16 v[204:207], v[232:235], v[108:111], v[204:207]
    v_mfma_f32_16x16x32_bf16 v[200:203], v[232:235], v[104:107], v[200:203]
    v_cvt_pk_bf16_f32 v184, v180, v181
    v_cvt_pk_bf16_f32 v185, v182, v183
    v_mfma_f32_16x16x32_bf16 v[196:199], v[232:235], v[100:103], v[196:199]
    v_mfma_f32_16x16x32_bf16 v[192:195], v[232:235], v[96:99], v[192:195]
    s_waitcnt lgkmcnt(2)
    ds_read_b64_tr_b16 v[232:233], v250 offset:4096
    ds_read_b64_tr_b16 v[234:235], v250 offset:6144
    v_mfma_f32_16x16x32_bf16 v[192:195], v[224:227], v[112:115], v[192:195]
    buffer_store_dwordx4 v[136:139], v253, s[28:31], s50 offen
    v_mfma_f32_16x16x32_bf16 v[196:199], v[224:227], v[116:119], v[196:199]
    s_xor_b32 s50, s50, 0x4000
    v_mfma_f32_16x16x32_bf16 v[200:203], v[224:227], v[120:123], v[200:203]
    v_mul_f32 v192, v236, v192
    v_mul_f32 v193, v236, v193
    v_mfma_f32_16x16x32_bf16 v[204:207], v[224:227], v[124:127], v[204:207]
    s_waitcnt lgkmcnt(2)
    ds_read_b64_tr_b16 v[224:225], v250 offset:8192
    ds_read_b64_tr_b16 v[226:227], v250 offset:10240
    v_mfma_f32_16x16x32_bf16 v[156:159], v[228:231], v[12:15], 0
    buffer_load_dword v246, v240, s[8:11], 0 offen sc1
    v_mul_f32 v194, v236, v194
    v_mfma_f32_16x16x32_bf16 v[152:155], v[228:231], v[8:11], 0
    v_mul_f32 v195, v236, v195
    v_cvt_pk_bf16_f32 v160, v192, v193
    v_mfma_f32_16x16x32_bf16 v[148:151], v[228:231], v[4:7], 0
    v_cvt_pk_bf16_f32 v161, v194, v195
    v_mul_f32 v196, v237, v196
    v_mfma_f32_16x16x32_bf16 v[144:147], v[228:231], v[0:3], 0
    s_waitcnt lgkmcnt(2)
    ds_read_b64_tr_b16 v[228:229], v250 offset:12288
    ds_read_b64_tr_b16 v[230:231], v250 offset:14336
    v_mfma_f32_16x16x32_bf16 v[144:147], v[232:235], v[16:19], v[144:147]
    buffer_load_dwordx4 a[76:79], v242, s[12:15], s79 offen offset:3072 sc1
    buffer_store_dwordx2 v[184:185], v245, s[80:83], 0 offen offset:128
    v_mfma_f32_16x16x32_bf16 v[148:151], v[232:235], v[20:23], v[148:151]
    s_xor_b32 s79, s79, 0x4000
    v_mul_f32 v197, v237, v197
    v_mul_f32 v198, v237, v198
    v_mfma_f32_16x16x32_bf16 v[152:155], v[232:235], v[24:27], v[152:155]
    v_mul_f32 v199, v237, v199
    v_cvt_pk_bf16_f32 v164, v196, v197
    v_mfma_f32_16x16x32_bf16 v[156:159], v[232:235], v[28:31], v[156:159]
    s_waitcnt lgkmcnt(2)
    ds_read_b64_tr_b16 v[232:233], v250 offset:16384
    ds_read_b64_tr_b16 v[234:235], v250 offset:18432
    v_mfma_f32_16x16x32_bf16 v[156:159], v[224:227], v[44:47], v[156:159]
    v_cvt_pk_bf16_f32 v165, v198, v199
    v_mul_f32 v200, v238, v200
    v_mfma_f32_16x16x32_bf16 v[152:155], v[224:227], v[40:43], v[152:155]
    v_mul_f32 v201, v238, v201
    v_mul_f32 v202, v238, v202
    v_mfma_f32_16x16x32_bf16 v[148:151], v[224:227], v[36:39], v[148:151]
    buffer_store_dwordx4 v[140:143], v253, s[28:31], s51 offen
    v_mul_f32 v203, v238, v203
    v_mfma_f32_16x16x32_bf16 v[144:147], v[224:227], v[32:35], v[144:147]
    s_waitcnt lgkmcnt(2)
    s_xor_b32 s51, s51, 0x4000
    ds_read_b64_tr_b16 v[224:225], v250 offset:20480
    ds_read_b64_tr_b16 v[226:227], v250 offset:22528
    v_mfma_f32_16x16x32_bf16 v[144:147], v[228:231], v[48:51], v[144:147]
    v_cvt_pk_bf16_f32 v168, v200, v201
    v_cvt_pk_bf16_f32 v169, v202, v203
    v_mfma_f32_16x16x32_bf16 v[148:151], v[228:231], v[52:55], v[148:151]
    v_mul_f32 v204, v239, v204
    v_mul_f32 v205, v239, v205
    v_mfma_f32_16x16x32_bf16 v[152:155], v[228:231], v[56:59], v[152:155]
    v_mul_f32 v206, v239, v206
    v_mul_f32 v207, v239, v207
    v_mfma_f32_16x16x32_bf16 v[156:159], v[228:231], v[60:63], v[156:159]
    s_waitcnt lgkmcnt(2)
    ds_read_b64_tr_b16 v[228:229], v250 offset:24576
    ds_read_b64_tr_b16 v[230:231], v250 offset:26624
    v_mfma_f32_16x16x32_bf16 v[156:159], v[232:235], v[76:79], v[156:159]
    v_cvt_pk_bf16_f32 v172, v204, v205
    v_cvt_pk_bf16_f32 v173, v206, v207
    v_mfma_f32_16x16x32_bf16 v[152:155], v[232:235], v[72:75], v[152:155]
    v_mfma_f32_16x16x32_bf16 v[148:151], v[232:235], v[68:71], v[148:151]
    v_mfma_f32_16x16x32_bf16 v[144:147], v[232:235], v[64:67], v[144:147]
    s_waitcnt lgkmcnt(2)
    ds_read_b64_tr_b16 v[232:233], v250 offset:28672
    ds_read_b64_tr_b16 v[234:235], v250 offset:30720
    v_mfma_f32_16x16x32_bf16 v[144:147], v[224:227], v[80:83], v[144:147]
    v_add_u32 v251, 1, v251
    v_mfma_f32_16x16x32_bf16 v[148:151], v[224:227], v[84:87], v[148:151]
    v_mfma_f32_16x16x32_bf16 v[152:155], v[224:227], v[88:91], v[152:155]
    s_waitcnt vmcnt(3)
    v_subrev_u32 v254, s73, v246
    v_cmp_lt_u32 vcc, 7, v254
    v_mfma_f32_16x16x32_bf16 v[156:159], v[224:227], v[92:95], v[156:159]
    s_waitcnt lgkmcnt(2)
    ds_read_b64_tr_b16 v[224:225], v247 offset:32768
    ds_read_b64_tr_b16 v[226:227], v247 offset:34816
    v_mfma_f32_16x16x32_bf16 v[156:159], v[228:231], v[108:111], v[156:159]
    s_or_b64 vcc, vcc, s[76:77]
    s_cbranch_vccnz L_sp5_
L_spr5_:
    s_add_u32 s73, s73, 1
    v_mfma_f32_16x16x32_bf16 v[152:155], v[228:231], v[104:107], v[152:155]
    buffer_load_dwordx4 a[80:83], v242, s[12:15], s79 offen sc1
    v_mfma_f32_16x16x32_bf16 v[148:151], v[228:231], v[100:103], v[148:151]
    v_mfma_f32_16x16x32_bf16 v[144:147], v[228:231], v[96:99], v[144:147]
    s_waitcnt lgkmcnt(2)
    ds_read_b64_tr_b16 v[228:229], v247 offset:36864
    ds_read_b64_tr_b16 v[230:231], v247 offset:38912
    v_mfma_f32_16x16x32_bf16 v[144:147], v[232:235], v[112:115], v[144:147]
    v_mfma_f32_16x16x32_bf16 v[148:151], v[232:235], v[116:119], v[148:151]
    v_mfma_f32_16x16x32_bf16 v[152:155], v[232:235], v[120:123], v[152:155]
    v_mul_f32 v144, v236, v144
    v_mul_f32 v145, v236, v145
    v_mfma_f32_16x16x32_bf16 v[156:159], v[232:235], v[124:127], v[156:159]
    s_waitcnt lgkmcnt(2)
    ds_read_b64_tr_b16 v[232:233], v247 offset:40960
    ds_read_b64_tr_b16 v[234:235], v247 offset:43008
    v_mfma_f32_16x16x32_bf16 v[204:207], v[224:227], v[12:15], 0
    v_mul_f32 v146, v236, v146
    v_mul_f32 v147, v236, v147
    v_mfma_f32_16x16x32_bf16 v[200:203], v[224:227], v[8:11], 0
    v_cvt_pk_bf16_f32 v162, v144, v145
    v_cvt_pk_bf16_f32 v163, v146, v147
    v_mfma_f32_16x16x32_bf16 v[196:199], v[224:227], v[4:7], 0
    v_mul_f32 v148, v237, v148
    v_mul_f32 v149, v237, v149
    v_mfma_f32_16x16x32_bf16 v[192:195], v[224:227], v[0:3], 0
    s_waitcnt lgkmcnt(2)
    ds_read_b64_tr_b16 v[224:225], v247 offset:45056
    ds_read_b64_tr_b16 v[226:227], v247 offset:47104
    v_mfma_f32_16x16x32_bf16 v[192:195], v[228:231], v[16:19], v[192:195]
    v_mul_f32 v150, v237, v150
    v_mul_f32 v151, v237, v151
    v_mfma_f32_16x16x32_bf16 v[196:199], v[228:231], v[20:23], v[196:199]
    v_cvt_pk_bf16_f32 v166, v148, v149
    v_cvt_pk_bf16_f32 v167, v150, v151
    v_mfma_f32_16x16x32_bf16 v[200:203], v[228:231], v[24:27], v[200:203]
    v_mul_f32 v152, v238, v152
    v_mul_f32 v153, v238, v153
    v_mfma_f32_16x16x32_bf16 v[204:207], v[228:231], v[28:31], v[204:207]
    s_waitcnt lgkmcnt(2)
    ds_read_b64_tr_b16 v[228:229], v247 offset:49152
    ds_read_b64_tr_b16 v[230:231], v247 offset:51200
    v_mfma_f32_16x16x32_bf16 v[204:207], v[232:235], v[44:47], v[204:207]
    buffer_load_dwordx4 a[84:87], v242, s[12:15], s79 offen offset:1024 sc1
    buffer_store_dwordx4 v[160:163], v253, s[28:31], s48 offen
    v_mfma_f32_16x16x32_bf16 v[200:203], v[232:235], v[40:43], v[200:203]
    s_xor_b32 s48, s48, 0xc000
    v_mul_f32 v154, v238, v154
    v_mul_f32 v155, v238, v155
    v_mfma_f32_16x16x32_bf16 v[196:199], v[232:235], v[36:39], v[196:199]
    v_cvt_pk_bf16_f32 v170, v152, v153
    v_cvt_pk_bf16_f32 v171, v154, v155
    v_mfma_f32_16x16x32_bf16 v[192:195], v[232:235], v[32:35], v[192:195]
    s_waitcnt lgkmcnt(2)
    ds_read_b64_tr_b16 v[232:233], v247 offset:53248
    ds_read_b64_tr_b16 v[234:235], v247 offset:55296
    v_mfma_f32_16x16x32_bf16 v[192:195], v[224:227], v[48:51], v[192:195]
    v_mul_f32 v156, v239, v156
    v_mul_f32 v157, v239, v157
    v_mfma_f32_16x16x32_bf16 v[196:199], v[224:227], v[52:55], v[196:199]
    v_mul_f32 v158, v239, v158
    v_mul_f32 v159, v239, v159
    v_mfma_f32_16x16x32_bf16 v[200:203], v[224:227], v[56:59], v[200:203]
    v_cvt_pk_bf16_f32 v174, v156, v157
    v_cvt_pk_bf16_f32 v175, v158, v159
    v_mfma_f32_16x16x32_bf16 v[204:207], v[224:227], v[60:63], v[204:207]
    s_waitcnt lgkmcnt(2)
    ds_read_b64_tr_b16 v[224:225], v247 offset:57344
    ds_read_b64_tr_b16 v[226:227], v247 offset:59392
    v_mfma_f32_16x16x32_bf16 v[204:207], v[228:231], v[76:79], v[204:207]
    v_mfma_f32_16x16x32_bf16 v[200:203], v[228:231], v[72:75], v[200:203]
    v_mfma_f32_16x16x32_bf16 v[196:199], v[228:231], v[68:71], v[196:199]
    s_waitcnt vmcnt(3)
    s_cmp_lg_u32 s76, 0
    s_cbranch_scc1 L_fb6_
    buffer_store_dword v251, v241, s[8:11], s88 offen
L_fbr6_:
    s_barrier
    v_mfma_f32_16x16x32_bf16 v[192:195], v[228:231], v[64:67], v[192:195]
    s_waitcnt lgkmcnt(2)
    ds_read_b64_tr_b16 v[228:229], v247 offset:61440
    ds_read_b64_tr_b16 v[230:231], v247 offset:63488
    v_mfma_f32_16x16x32_bf16 v[192:195], v[232:235], v[80:83], v[192:195]
    v_add_u32 v247, 0x10000, v247
    v_mfma_f32_16x16x32_bf16 v[196:199], v[232:235], v[84:87], v[196:199]
    v_mfma_f32_16x16x32_bf16 v[200:203], v[232:235], v[88:91], v[200:203]
    buffer_load_dwordx4 a[88:91], v242, s[12:15], s79 offen offset:2048 sc1
    buffer_store_dwordx4 v[164:167], v253, s[28:31], s49 offen
    v_mfma_f32_16x16x32_bf16 v[204:207], v[232:235], v[92:95], v[204:207]
    s_waitcnt lgkmcnt(2)
    s_xor_b32 s49, s49, 0xc000
    ds_read_b64_tr_b16 v[232:233], v248 offset:32768
    ds_read_b64_tr_b16 v[234:235], v248 offset:34816
    v_mfma_f32_16x16x32_bf16 v[204:207], v[224:227], v[108:111], v[204:207]
    v_mfma_f32_16x16x32_bf16 v[200:203], v[224:227], v[104:107], v[200:203]
    v_mfma_f32_16x16x32_bf16 v[196:199], v[224:227], v[100:103], v[196:199]
    v_mfma_f32_16x16x32_bf16 v[192:195], v[224:227], v[96:99], v[192:195]
    s_waitcnt lgkmcnt(2)
    ds_read_b64_tr_b16 v[224:225], v248 offset:36864
    ds_read_b64_tr_b16 v[226:227], v248 offset:38912
    v_mfma_f32_16x16x32_bf16 v[192:195], v[228:231], v[112:115], v[192:195]
    v_mfma_f32_16x16x32_bf16 v[196:199], v[228:231], v[116:119], v[196:199]
    v_mfma_f32_16x16x32_bf16 v[200:203], v[228:231], v[120:123], v[200:203]
    v_mul_f32 v192, v236, v192
    v_mul_f32 v193, v236, v193
    v_mfma_f32_16x16x32_bf16 v[204:207], v[228:231], v[124:127], v[204:207]
    s_waitcnt lgkmcnt(2)
    ds_read_b64_tr_b16 v[228:229], v248 offset:40960
    ds_read_b64_tr_b16 v[230:231], v248 offset:43008
    v_mfma_f32_16x16x32_bf16 v[156:159], v[232:235], v[12:15], 0
    v_mul_f32 v194, v236, v194
    v_mul_f32 v195, v236, v195
    v_mfma_f32_16x16x32_bf16 v[152:155], v[232:235], v[8:11], 0
    v_cvt_pk_bf16_f32 v128, v192, v193
    v_cvt_pk_bf16_f32 v129, v194, v195
    v_mfma_f32_16x16x32_bf16 v[148:151], v[232:235], v[4:7], 0
    v_mul_f32 v196, v237, v196
    v_mul_f32 v197, v237, v197
    v_mfma_f32_16x16x32_bf16 v[144:147], v[232:235], v[0:3], 0
    s_waitcnt lgkmcnt(2)
    ds_read_b64_tr_b16 v[232:233], v248 offset:45056
    ds_read_b64_tr_b16 v[234:235], v248 offset:47104
    v_mfma_f32_16x16x32_bf16 v[144:147], v[224:227], v[16:19], v[144:147]
    buffer_load_dwordx4 a[92:95], v242, s[12:15], s79 offen offset:3072 sc1
    buffer_store_dwordx4 v[168:171], v253, s[28:31], s50 offen
    v_mfma_f32_16x16x32_bf16 v[148:151], v[224:227], v[20:23], v[148:151]
    s_xor_b32 s79, s79, 0xc000
    s_xor_b32 s50, s50, 0xc000
    v_mul_f32 v198, v237, v198
    v_mul_f32 v199, v237, v199
    v_mfma_f32_16x16x32_bf16 v[152:155], v[224:227], v[24:27], v[152:155]
    v_cvt_pk_bf16_f32 v132, v196, v197
    v_cvt_pk_bf16_f32 v133, v198, v199
    v_mfma_f32_16x16x32_bf16 v[156:159], v[224:227], v[28:31], v[156:159]
    s_waitcnt lgkmcnt(2)
    ds_read_b64_tr_b16 v[224:225], v248 offset:49152
    ds_read_b64_tr_b16 v[226:227], v248 offset:51200
    v_mfma_f32_16x16x32_bf16 v[156:159], v[228:231], v[44:47], v[156:159]
    buffer_load_dword v246, v240, s[8:11], 0 offen sc1
    v_mul_f32 v200, v238, v200
    v_mfma_f32_16x16x32_bf16 v[152:155], v[228:231], v[40:43], v[152:155]
    v_mul_f32 v201, v238, v201
    v_mul_f32 v202, v238, v202
    v_mfma_f32_16x16x32_bf16 v[148:151], v[228:231], v[36:39], v[148:151]
    v_mul_f32 v203, v238, v203
    v_cvt_pk_bf16_f32 v136, v200, v201
    v_mfma_f32_16x16x32_bf16 v[144:147], v[228:231], v[32:35], v[144:147]
    s_waitcnt lgkmcnt(2)
    ds_read_b64_tr_b16 v[228:229], v248 offset:53248
    ds_read_b64_tr_b16 v[230:231], v248 offset:55296
    v_mfma_f32_16x16x32_bf16 v[144:147], v[232:235], v[48:51], v[144:147]
    v_cvt_pk_bf16_f32 v137, v202, v203
    v_mul_f32 v204, v239, v204
    v_mfma_f32_16x16x32_bf16 v[148:151], v[232:235], v[52:55], v[148:151]
    v_mul_f32 v205, v239, v205
    v_mul_f32 v206, v239, v206
    v_mfma_f32_16x16x32_bf16 v[152:155], v[232:235], v[56:59], v[152:155]
    v_mul_f32 v207, v239, v207
    v_cvt_pk_bf16_f32 v140, v204, v205
    v_mfma_f32_16x16x32_bf16 v[156:159], v[232:235], v[60:63], v[156:159]
    s_waitcnt lgkmcnt(2)
    ds_read_b64_tr_b16 v[232:233], v248 offset:57344
    ds_read_b64_tr_b16 v[234:235], v248 offset:59392
    v_mfma_f32_16x16x32_bf16 v[156:159], v[224:227], v[76:79], v[156:159]
    v_cvt_pk_bf16_f32 v141, v206, v207
    v_mfma_f32_16x16x32_bf16 v[152:155], v[224:227], v[72:75], v[152:155]
    v_mfma_f32_16x16x32_bf16 v[148:151], v[224:227], v[68:71], v[148:151]
    buffer_store_dwordx4 v[172:175], v253, s[28:31], s51 offen
    v_mfma_f32_16x16x32_bf16 v[144:147], v[224:227], v[64:67], v[144:147]
    s_waitcnt lgkmcnt(2)
    s_xor_b32 s51, s51, 0xc000
    ds_read_b64_tr_b16 v[224:225], v248 offset:61440
    ds_read_b64_tr_b16 v[226:227], v248 offset:63488
    v_mfma_f32_16x16x32_bf16 v[144:147], v[228:231], v[80:83], v[144:147]
    v_add_u32 v251, 1, v251
    v_add_u32 v248, 0x10000, v248
    v_mfma_f32_16x16x32_bf16 v[148:151], v[228:231], v[84:87], v[148:151]
    v_mfma_f32_16x16x32_bf16 v[152:155], v[228:231], v[88:91], v[152:155]
    v_mfma_f32_16x16x32_bf16 v[156:159], v[228:231], v[92:95], v[156:159]
    s_waitcnt lgkmcnt(2)
    ds_read_b64_tr_b16 v[228:229], v249 offset:32768
    ds_read_b64_tr_b16 v[230:231], v249 offset:34816
    v_mfma_f32_16x16x32_bf16 v[156:159], v[232:235], v[108:111], v[156:159]
    v_mfma_f32_16x16x32_bf16 v[152:155], v[232:235], v[104:107], v[152:155]
    v_mfma_f32_16x16x32_bf16 v[148:151], v[232:235], v[100:103], v[148:151]
    v_mfma_f32_16x16x32_bf16 v[144:147], v[232:235], v[96:99], v[144:147]
    s_waitcnt lgkmcnt(2)
    ds_read_b64_tr_b16 v[232:233], v249 offset:36864
    ds_read_b64_tr_b16 v[234:235], v249 offset:38912
    v_mfma_f32_16x16x32_bf16 v[144:147], v[224:227], v[112:115], v[144:147]
    v_mfma_f32_16x16x32_bf16 v[148:151], v[224:227], v[116:119], v[148:151]
    v_mfma_f32_16x16x32_bf16 v[152:155], v[224:227], v[120:123], v[152:155]
    s_waitcnt vmcnt(1)
    v_subrev_u32 v254, s73, v246
    v_cmp_lt_u32 vcc, 6, v254
    v_mfma_f32_16x16x32_bf16 v[156:159], v[224:227], v[124:127], v[156:159]
    s_waitcnt lgkmcnt(2)
    ds_read_b64_tr_b16 v[224:225], v249 offset:40960
    ds_read_b64_tr_b16 v[226:227], v249 offset:43008
    v_mfma_f32_16x16x32_bf16 v[204:207], v[228:231], v[12:15], 0
    s_or_b64 vcc, vcc, s[76:77]
    s_cbranch_vccnz L_sp6_
L_spr6_:
    s_add_u32 s73, s73, 1
    v_mul_f32 v144, v236, v144
    v_mul_f32 v145, v236, v145
    v_mfma_f32_16x16x32_bf16 v[200:203], v[228:231], v[8:11], 0
    buffer_load_dwordx4 a[96:99], v242, s[12:15], s79 offen sc1
    v_mul_f32 v146, v236, v146
    v_mfma_f32_16x16x32_bf16 v[196:199], v[228:231], v[4:7], 0
    v_mul_f32 v147, v236, v147
    v_cvt_pk_bf16_f32 v130, v144, v145
    v_mfma_f32_16x16x32_bf16 v[192:195], v[228:231], v[0:3], 0
    s_waitcnt lgkmcnt(2)
    ds_read_b64_tr_b16 v[228:229], v249 offset:45056
    ds_read_b64_tr_b16 v[230:231], v249 offset:47104
    v_mfma_f32_16x16x32_bf16 v[192:195], v[232:235], v[16:19], v[192:195]
    v_cvt_pk_bf16_f32 v131, v146, v147
    v_mul_f32 v148, v237, v148
    v_mfma_f32_16x16x32_bf16 v[196:199], v[232:235], v[20:23], v[196:199]
    v_mul_f32 v149, v237, v149
    v_mul_f32 v150, v237, v150
    v_mfma_f32_16x16x32_bf16 v[200:203], v[232:235], v[24:27], v[200:203]
    v_mul_f32 v151, v237, v151
    v_cvt_pk_bf16_f32 v134, v148, v149
    v_mfma_f32_16x16x32_bf16 v[204:207], v[232:235], v[28:31], v[204:207]
    s_waitcnt lgkmcnt(2)
    ds_read_b64_tr_b16 v[232:233], v249 offset:49152
    ds_read_b64_tr_b16 v[234:235], v249 offset:51200
    v_mfma_f32_16x16x32_bf16 v[204:207], v[224:227], v[44:47], v[204:207]
    buffer_store_dwordx4 v[128:131], v253, s[28:31], s48 offen
    v_cvt_pk_bf16_f32 v135, v150, v151
    v_mfma_f32_16x16x32_bf16 v[200:203], v[224:227], v[40:43], v[200:203]
    s_xor_b32 s48, s48, 0x4000
    v_mul_f32 v152, v238, v152
    v_mul_f32 v153, v238, v153
    v_mfma_f32_16x16x32_bf16 v[196:199], v[224:227], v[36:39], v[196:199]
    v_mul_f32 v154, v238, v154
    v_mul_f32 v155, v238, v155
    v_mfma_f32_16x16x32_bf16 v[192:195], v[224:227], v[32:35], v[192:195]
    s_waitcnt lgkmcnt(2)
    ds_read_b64_tr_b16 v[224:225], v249 offset:53248
    ds_read_b64_tr_b16 v[226:227], v249 offset:55296
    v_mfma_f32_16x16x32_bf16 v[192:195], v[228:231], v[48:51], v[192:195]
    v_cvt_pk_bf16_f32 v138, v152, v153
    v_cvt_pk_bf16_f32 v139, v154, v155
    v_mfma_f32_16x16x32_bf16 v[196:199], v[228:231], v[52:55], v[196:199]
    v_mul_f32 v156, v239, v156
    v_mul_f32 v157, v239, v157
    v_mfma_f32_16x16x32_bf16 v[200:203], v[228:231], v[56:59], v[200:203]
    v_mul_f32 v158, v239, v158
    v_mul_f32 v159, v239, v159
    v_mfma_f32_16x16x32_bf16 v[204:207], v[228:231], v[60:63], v[204:207]
    s_waitcnt lgkmcnt(2)
    buffer_load_dwordx4 a[100:103], v242, s[12:15], s79 offen offset:1024 sc1
    v_cvt_pk_bf16_f32 v142, v156, v157
    v_mfma_f32_16x16x32_bf16 v[204:207], v[232:235], v[76:79], v[204:207]
    v_cvt_pk_bf16_f32 v143, v158, v159
    v_mfma_f32_16x16x32_bf16 v[200:203], v[232:235], v[72:75], v[200:203]
    v_mfma_f32_16x16x32_bf16 v[196:199], v[232:235], v[68:71], v[196:199]
    s_waitcnt vmcnt(3)
    s_cmp_lg_u32 s76, 0
    s_cbranch_scc1 L_fb7_
    buffer_store_dword v251, v241, s[8:11], s88 offen
L_fbr7_:
    v_mfma_f32_16x16x32_bf16 v[192:195], v[232:235], v[64:67], v[192:195]
    s_waitcnt lgkmcnt(0)
    v_mfma_f32_16x16x32_bf16 v[192:195], v[224:227], v[80:83], v[192:195]
    v_mfma_f32_16x16x32_bf16 v[196:199], v[224:227], v[84:87], v[196:199]
    v_mfma_f32_16x16x32_bf16 v[200:203], v[224:227], v[88:91], v[200:203]
    buffer_store_dwordx4 v[132:135], v253, s[28:31], s49 offen
    v_mfma_f32_16x16x32_bf16 v[204:207], v[224:227], v[92:95], v[204:207]
    s_xor_b32 s49, s49, 0x4000
    ds_read_b64_tr_b16 v[228:229], v249 offset:57344
    ds_read_b64_tr_b16 v[230:231], v249 offset:59392
    v_mfma_f32_16x16x32_bf16 v[180:183], v[176:179], a[64:67], 0
    v_mfma_f32_16x16x32_bf16 v[180:183], v[176:179], a[68:71], v[180:183]
    v_mfma_f32_16x16x32_bf16 v[180:183], v[176:179], a[72:75], v[180:183]
    v_mfma_f32_16x16x32_bf16 v[180:183], v[176:179], a[76:79], v[180:183]
    ds_read_b64_tr_b16 v[232:233], v249 offset:61440
    ds_read_b64_tr_b16 v[234:235], v249 offset:63488
    v_mfma_f32_16x16x32_bf16 v[180:183], v[188:191], a[80:83], v[180:183]
    v_add_u32 v249, 0x10000, v249
    v_mfma_f32_16x16x32_bf16 v[180:183], v[188:191], a[84:87], v[180:183]
    buffer_load_dwordx4 a[104:107], v242, s[12:15], s79 offen offset:2048 sc1
    v_mfma_f32_16x16x32_bf16 v[180:183], v[188:191], a[88:91], v[180:183]
    v_mfma_f32_16x16x32_bf16 v[180:183], v[188:191], a[92:95], v[180:183]
    s_waitcnt lgkmcnt(2)
    ds_read_b64_tr_b16 v[224:225], v250 offset:32768
    ds_read_b64_tr_b16 v[226:227], v250 offset:34816
    v_mfma_f32_16x16x32_bf16 v[204:207], v[228:231], v[108:111], v[204:207]
    v_mfma_f32_16x16x32_bf16 v[200:203], v[228:231], v[104:107], v[200:203]
    v_cvt_pk_bf16_f32 v184, v180, v181
    v_cvt_pk_bf16_f32 v185, v182, v183
    v_mfma_f32_16x16x32_bf16 v[196:199], v[228:231], v[100:103], v[196:199]
    v_mfma_f32_16x16x32_bf16 v[192:195], v[228:231], v[96:99], v[192:195]
    s_waitcnt lgkmcnt(2)
    ds_read_b64_tr_b16 v[228:229], v250 offset:36864
    ds_read_b64_tr_b16 v[230:231], v250 offset:38912
    v_mfma_f32_16x16x32_bf16 v[192:195], v[232:235], v[112:115], v[192:195]
    buffer_store_dwordx4 v[136:139], v253, s[28:31], s50 offen
    v_mfma_f32_16x16x32_bf16 v[196:199], v[232:235], v[116:119], v[196:199]
    s_xor_b32 s50, s50, 0x4000
    v_mfma_f32_16x16x32_bf16 v[200:203], v[232:235], v[120:123], v[200:203]
    v_mul_f32 v192, v236, v192
    v_mul_f32 v193, v236, v193
    v_mfma_f32_16x16x32_bf16 v[204:207], v[232:235], v[124:127], v[204:207]
    s_waitcnt lgkmcnt(2)
    ds_read_b64_tr_b16 v[232:233], v250 offset:40960
    ds_read_b64_tr_b16 v[234:235], v250 offset:43008
    v_mfma_f32_16x16x32_bf16 v[156:159], v[224:227], v[12:15], 0
    buffer_load_dword v246, v240, s[8:11], 0 offen sc1
    v_mul_f32 v194, v236, v194
    v_mfma_f32_16x16x32_bf16 v[152:155], v[224:227], v[8:11], 0
    v_mul_f32 v195, v236, v195
    v_cvt_pk_bf16_f32 v160, v192, v193
    v_mfma_f32_16x16x32_bf16 v[148:151], v[224:227], v[4:7], 0
    v_cvt_pk_bf16_f32 v161, v194, v195
    v_mul_f32 v196, v237, v196
    v_mfma_f32_16x16x32_bf16 v[144:147], v[224:227], v[0:3], 0
    s_waitcnt lgkmcnt(2)
    ds_read_b64_tr_b16 v[224:225], v250 offset:45056
    ds_read_b64_tr_b16 v[226:227], v250 offset:47104
    v_mfma_f32_16x16x32_bf16 v[144:147], v[228:231], v[16:19], v[144:147]
    buffer_load_dwordx4 a[108:111], v242, s[12:15], s79 offen offset:3072 sc1
    buffer_store_dwordx2 v[184:185], v245, s[80:83], 0 offen offset:256
    v_mfma_f32_16x16x32_bf16 v[148:151], v[228:231], v[20:23], v[148:151]
    s_xor_b32 s79, s79, 0x4000
    v_mul_f32 v197, v237, v197
    v_mul_f32 v198, v237, v198
    v_mfma_f32_16x16x32_bf16 v[152:155], v[228:231], v[24:27], v[152:155]
    v_mul_f32 v199, v237, v199
    v_cvt_pk_bf16_f32 v164, v196, v197
    v_mfma_f32_16x16x32_bf16 v[156:159], v[228:231], v[28:31], v[156:159]
    s_waitcnt lgkmcnt(2)
    ds_read_b64_tr_b16 v[228:229], v250 offset:49152
    ds_read_b64_tr_b16 v[230:231], v250 offset:51200
    v_mfma_f32_16x16x32_bf16 v[156:159], v[232:235], v[44:47], v[156:159]
    v_cvt_pk_bf16_f32 v165, v198, v199
    v_mul_f32 v200, v238, v200
    v_mfma_f32_16x16x32_bf16 v[152:155], v[232:235], v[40:43], v[152:155]
    v_mul_f32 v201, v238, v201
    v_mul_f32 v202, v238, v202
    v_mfma_f32_16x16x32_bf16 v[148:151], v[232:235], v[36:39], v[148:151]
    buffer_store_dwordx4 v[140:143], v253, s[28:31], s51 offen
    v_mul_f32 v203, v238, v203
    v_mfma_f32_16x16x32_bf16 v[144:147], v[232:235], v[32:35], v[144:147]
    s_waitcnt lgkmcnt(2)
    s_xor_b32 s51, s51, 0x4000
    ds_read_b64_tr_b16 v[232:233], v250 offset:53248
    ds_read_b64_tr_b16 v[234:235], v250 offset:55296
    v_mfma_f32_16x16x32_bf16 v[144:147], v[224:227], v[48:51], v[144:147]
    v_cvt_pk_bf16_f32 v168, v200, v201
    v_cvt_pk_bf16_f32 v169, v202, v203
    v_mfma_f32_16x16x32_bf16 v[148:151], v[224:227], v[52:55], v[148:151]
    v_mul_f32 v204, v239, v204
    v_mul_f32 v205, v239, v205
    v_mfma_f32_16x16x32_bf16 v[152:155], v[224:227], v[56:59], v[152:155]
    v_mul_f32 v206, v239, v206
    v_mul_f32 v207, v239, v207
    v_mfma_f32_16x16x32_bf16 v[156:159], v[224:227], v[60:63], v[156:159]
    s_waitcnt lgkmcnt(2)
    ds_read_b64_tr_b16 v[224:225], v250 offset:57344
    ds_read_b64_tr_b16 v[226:227], v250 offset:59392
    v_mfma_f32_16x16x32_bf16 v[156:159], v[228:231], v[76:79], v[156:159]
    v_cvt_pk_bf16_f32 v172, v204, v205
    v_cvt_pk_bf16_f32 v173, v206, v207
    v_mfma_f32_16x16x32_bf16 v[152:155], v[228:231], v[72:75], v[152:155]
    v_mfma_f32_16x16x32_bf16 v[148:151], v[228:231], v[68:71], v[148:151]
    v_mfma_f32_16x16x32_bf16 v[144:147], v[228:231], v[64:67], v[144:147]
    s_waitcnt lgkmcnt(2)
    ds_read_b64_tr_b16 v[228:229], v250 offset:61440
    ds_read_b64_tr_b16 v[230:231], v250 offset:63488
    v_mfma_f32_16x16x32_bf16 v[144:147], v[232:235], v[80:83], v[144:147]
    v_add_u32 v251, 1, v251
    v_add_u32 v250, 0x10000, v250
    v_mfma_f32_16x16x32_bf16 v[148:151], v[232:235], v[84:87], v[148:151]
    v_mfma_f32_16x16x32_bf16 v[152:155], v[232:235], v[88:91], v[152:155]
    s_waitcnt vmcnt(3)
    v_subrev_u32 v254, s73, v246
    v_cmp_lt_u32 vcc, 5, v254
    v_mfma_f32_16x16x32_bf16 v[156:159], v[232:235], v[92:95], v[156:159]
    s_waitcnt lgkmcnt(2)
    ds_read_b64_tr_b16 v[232:233], v247 offset:0
    ds_read_b64_tr_b16 v[234:235], v247 offset:2048
    v_mfma_f32_16x16x32_bf16 v[156:159], v[224:227], v[108:111], v[156:159]
    s_or_b64 vcc, vcc, s[76:77]
    s_cbranch_vccnz L_sp7_
L_spr7_:
    s_add_u32 s73, s73, 1
    v_mfma_f32_16x16x32_bf16 v[152:155], v[224:227], v[104:107], v[152:155]
    buffer_load_dwordx4 a[112:115], v242, s[12:15], s79 offen sc1
    v_mfma_f32_16x16x32_bf16 v[148:151], v[224:227], v[100:103], v[148:151]
    v_mfma_f32_16x16x32_bf16 v[144:147], v[224:227], v[96:99], v[144:147]
    s_waitcnt lgkmcnt(2)
    ds_read_b64_tr_b16 v[224:225], v247 offset:4096
    ds_read_b64_tr_b16 v[226:227], v247 offset:6144
    v_mfma_f32_16x16x32_bf16 v[144:147], v[228:231], v[112:115], v[144:147]
    v_mfma_f32_16x16x32_bf16 v[148:151], v[228:231], v[116:119], v[148:151]
    v_mfma_f32_16x16x32_bf16 v[152:155], v[228:231], v[120:123], v[152:155]
    v_mul_f32 v144, v236, v144
    v_mul_f32 v145, v236, v145
    v_mfma_f32_16x16x32_bf16 v[156:159], v[228:231], v[124:127], v[156:159]
    s_waitcnt lgkmcnt(2)
    ds_read_b64_tr_b16 v[228:229], v247 offset:8192
    ds_read_b64_tr_b16 v[230:231], v247 offset:10240
    v_mfma_f32_16x16x32_bf16 v[204:207], v[232:235], v[12:15], 0
    v_mul_f32 v146, v236, v146
    v_mul_f32 v147, v236, v147
    v_mfma_f32_16x16x32_bf16 v[200:203], v[232:235], v[8:11], 0
    v_cvt_pk_bf16_f32 v162, v144, v145
    v_cvt_pk_bf16_f32 v163, v146, v147
    v_mfma_f32_16x16x32_bf16 v[196:199], v[232:235], v[4:7], 0
    v_mul_f32 v148, v237, v148
    v_mul_f32 v149, v237, v149
    v_mfma_f32_16x16x32_bf16 v[192:195], v[232:235], v[0:3], 0
    s_waitcnt lgkmcnt(2)
    ds_read_b64_tr_b16 v[232:233], v247 offset:12288
    ds_read_b64_tr_b16 v[234:235], v247 offset:14336
    v_mfma_f32_16x16x32_bf16 v[192:195], v[224:227], v[16:19], v[192:195]
    v_mul_f32 v150, v237, v150
    v_mul_f32 v151, v237, v151
    v_mfma_f32_16x16x32_bf16 v[196:199], v[224:227], v[20:23], v[196:199]
    v_cvt_pk_bf16_f32 v166, v148, v149
    v_cvt_pk_bf16_f32 v167, v150, v151
    v_mfma_f32_16x16x32_bf16 v[200:203], v[224:227], v[24:27], v[200:203]
    v_mul_f32 v152, v238, v152
    v_mul_f32 v153, v238, v153
    v_mfma_f32_16x16x32_bf16 v[204:207], v[224:227], v[28:31], v[204:207]
    s_waitcnt lgkmcnt(2)
    ds_read_b64_tr_b16 v[224:225], v247 offset:16384
    ds_read_b64_tr_b16 v[226:227], v247 offset:18432
    v_mfma_f32_16x16x32_bf16 v[204:207], v[228:231], v[44:47], v[204:207]
    buffer_load_dwordx4 a[116:119], v242, s[12:15], s79 offen offset:1024 sc1
    buffer_store_dwordx4 v[160:163], v253, s[28:31], s48 offen
    v_mfma_f32_16x16x32_bf16 v[200:203], v[228:231], v[40:43], v[200:203]
    s_xor_b32 s48, s48, 0xc000
    v_mul_f32 v154, v238, v154
    v_mul_f32 v155, v238, v155
    v_mfma_f32_16x16x32_bf16 v[196:199], v[228:231], v[36:39], v[196:199]
    v_cvt_pk_bf16_f32 v170, v152, v153
    v_cvt_pk_bf16_f32 v171, v154, v155
    v_mfma_f32_16x16x32_bf16 v[192:195], v[228:231], v[32:35], v[192:195]
    s_waitcnt lgkmcnt(2)
    ds_read_b64_tr_b16 v[228:229], v247 offset:20480
    ds_read_b64_tr_b16 v[230:231], v247 offset:22528
    v_mfma_f32_16x16x32_bf16 v[192:195], v[232:235], v[48:51], v[192:195]
    v_mul_f32 v156, v239, v156
    v_mul_f32 v157, v239, v157
    v_mfma_f32_16x16x32_bf16 v[196:199], v[232:235], v[52:55], v[196:199]
    v_mul_f32 v158, v239, v158
    v_mul_f32 v159, v239, v159
    v_mfma_f32_16x16x32_bf16 v[200:203], v[232:235], v[56:59], v[200:203]
    v_cvt_pk_bf16_f32 v174, v156, v157
    v_cvt_pk_bf16_f32 v175, v158, v159
    v_mfma_f32_16x16x32_bf16 v[204:207], v[232:235], v[60:63], v[204:207]
    s_waitcnt lgkmcnt(2)
    ds_read_b64_tr_b16 v[232:233], v247 offset:24576
    ds_read_b64_tr_b16 v[234:235], v247 offset:26624
    v_mfma_f32_16x16x32_bf16 v[204:207], v[224:227], v[76:79], v[204:207]
    v_mfma_f32_16x16x32_bf16 v[200:203], v[224:227], v[72:75], v[200:203]
    v_mfma_f32_16x16x32_bf16 v[196:199], v[224:227], v[68:71], v[196:199]
    s_waitcnt vmcnt(3)
    s_cmp_lg_u32 s76, 0
    s_cbranch_scc1 L_fb8_
    buffer_store_dword v251, v241, s[8:11], s88 offen
L_fbr8_:
    s_barrier
    v_mfma_f32_16x16x32_bf16 v[192:195], v[224:227], v[64:67], v[192:195]
    s_waitcnt lgkmcnt(2)
    ds_read_b64_tr_b16 v[224:225], v247 offset:28672
    ds_read_b64_tr_b16 v[226:227], v247 offset:30720
    v_mfma_f32_16x16x32_bf16 v[192:195], v[228:231], v[80:83], v[192:195]
    v_subrev_u32 v247, 0x20000, v247
    v_mfma_f32_16x16x32_bf16 v[196:199], v[228:231], v[84:87], v[196:199]
    v_mfma_f32_16x16x32_bf16 v[200:203], v[228:231], v[88:91], v[200:203]
    buffer_load_dwordx4 a[120:123], v242, s[12:15], s79 offen offset:2048 sc1
    buffer_store_dwordx4 v[164:167], v253, s[28:31], s49 offen
    v_mfma_f32_16x16x32_bf16 v[204:207], v[228:231], v[92:95], v[204:207]
    s_waitcnt lgkmcnt(2)
    s_xor_b32 s49, s49, 0xc000
    ds_read_b64_tr_b16 v[228:229], v248 offset:0
    ds_read_b64_tr_b16 v[230:231], v248 offset:2048
    v_mfma_f32_16x16x32_bf16 v[204:207], v[232:235], v[108:111], v[204:207]
    v_mfma_f32_16x16x32_bf16 v[200:203], v[232:235], v[104:107], v[200:203]
    v_mfma_f32_16x16x32_bf16 v[196:199], v[232:235], v[100:103], v[196:199]
    v_mfma_f32_16x16x32_bf16 v[192:195], v[232:235], v[96:99], v[192:195]
    s_waitcnt lgkmcnt(2)
    ds_read_b64_tr_b16 v[232:233], v248 offset:4096
    ds_read_b64_tr_b16 v[234:235], v248 offset:6144
    v_mfma_f32_16x16x32_bf16 v[192:195], v[224:227], v[112:115], v[192:195]
    v_mfma_f32_16x16x32_bf16 v[196:199], v[224:227], v[116:119], v[196:199]
    v_mfma_f32_16x16x32_bf16 v[200:203], v[224:227], v[120:123], v[200:203]
    v_mul_f32 v192, v236, v192
    v_mul_f32 v193, v236, v193
    v_mfma_f32_16x16x32_bf16 v[204:207], v[224:227], v[124:127], v[204:207]
    s_waitcnt lgkmcnt(2)
    ds_read_b64_tr_b16 v[224:225], v248 offset:8192
    ds_read_b64_tr_b16 v[226:227], v248 offset:10240
    v_mfma_f32_16x16x32_bf16 v[156:159], v[228:231], v[12:15], 0
    v_mul_f32 v194, v236, v194
    v_mul_f32 v195, v236, v195
    v_mfma_f32_16x16x32_bf16 v[152:155], v[228:231], v[8:11], 0
    v_cvt_pk_bf16_f32 v128, v192, v193
    v_cvt_pk_bf16_f32 v129, v194, v195
    v_mfma_f32_16x16x32_bf16 v[148:151], v[228:231], v[4:7], 0
    v_mul_f32 v196, v237, v196
    v_mul_f32 v197, v237, v197
    v_mfma_f32_16x16x32_bf16 v[144:147], v[228:231], v[0:3], 0
    s_waitcnt lgkmcnt(2)
    ds_read_b64_tr_b16 v[228:229], v248 offset:12288
    ds_read_b64_tr_b16 v[230:231], v248 offset:14336
    v_mfma_f32_16x16x32_bf16 v[144:147], v[232:235], v[16:19], v[144:147]
    buffer_load_dwordx4 a[124:127], v242, s[12:15], s79 offen offset:3072 sc1
    buffer_store_dwordx4 v[168:171], v253, s[28:31], s50 offen
    v_mfma_f32_16x16x32_bf16 v[148:151], v[232:235], v[20:23], v[148:151]
    s_xor_b32 s79, s79, 0xc000
    s_xor_b32 s50, s50, 0xc000
    v_mul_f32 v198, v237, v198
    v_mul_f32 v199, v237, v199
    v_mfma_f32_16x16x32_bf16 v[152:155], v[232:235], v[24:27], v[152:155]
    v_cvt_pk_bf16_f32 v132, v196, v197
    v_cvt_pk_bf16_f32 v133, v198, v199
    v_mfma_f32_16x16x32_bf16 v[156:159], v[232:235], v[28:31], v[156:159]
    s_waitcnt lgkmcnt(2)
    ds_read_b64_tr_b16 v[232:233], v248 offset:16384
    ds_read_b64_tr_b16 v[234:235], v248 offset:18432
    v_mfma_f32_16x16x32_bf16 v[156:159], v[224:227], v[44:47], v[156:159]
    buffer_load_dword v246, v240, s[8:11], 0 offen sc1
    v_mul_f32 v200, v238, v200
    v_mfma_f32_16x16x32_bf16 v[152:155], v[224:227], v[40:43], v[152:155]
    v_mul_f32 v201, v238, v201
    v_mul_f32 v202, v238, v202
    v_mfma_f32_16x16x32_bf16 v[148:151], v[224:227], v[36:39], v[148:151]
    v_mul_f32 v203, v238, v203
    v_cvt_pk_bf16_f32 v136, v200, v201
    v_mfma_f32_16x16x32_bf16 v[144:147], v[224:227], v[32:35], v[144:147]
    s_waitcnt lgkmcnt(2)
    ds_read_b64_tr_b16 v[224:225], v248 offset:20480
    ds_read_b64_tr_b16 v[226:227], v248 offset:22528
    v_mfma_f32_16x16x32_bf16 v[144:147], v[228:231], v[48:51], v[144:147]
    v_cvt_pk_bf16_f32 v137, v202, v203
    v_mul_f32 v204, v239, v204
    v_mfma_f32_16x16x32_bf16 v[148:151], v[228:231], v[52:55], v[148:151]
    v_mul_f32 v205, v239, v205
    v_mul_f32 v206, v239, v206
    v_mfma_f32_16x16x32_bf16 v[152:155], v[228:231], v[56:59], v[152:155]
    v_mul_f32 v207, v239, v207
    v_cvt_pk_bf16_f32 v140, v204, v205
    v_mfma_f32_16x16x32_bf16 v[156:159], v[228:231], v[60:63], v[156:159]
    s_waitcnt lgkmcnt(2)
    ds_read_b64_tr_b16 v[228:229], v248 offset:24576
    ds_read_b64_tr_b16 v[230:231], v248 offset:26624
    v_mfma_f32_16x16x32_bf16 v[156:159], v[232:235], v[76:79], v[156:159]
    v_cvt_pk_bf16_f32 v141, v206, v207
    v_mfma_f32_16x16x32_bf16 v[152:155], v[232:235], v[72:75], v[152:155]
    v_mfma_f32_16x16x32_bf16 v[148:151], v[232:235], v[68:71], v[148:151]
    buffer_store_dwordx4 v[172:175], v253, s[28:31], s51 offen
    v_mfma_f32_16x16x32_bf16 v[144:147], v[232:235], v[64:67], v[144:147]
    s_waitcnt lgkmcnt(2)
    s_xor_b32 s51, s51, 0xc000
    ds_read_b64_tr_b16 v[232:233], v248 offset:28672
    ds_read_b64_tr_b16 v[234:235], v248 offset:30720
    v_mfma_f32_16x16x32_bf16 v[144:147], v[224:227], v[80:83], v[144:147]
    v_add_u32 v251, 1, v251
    v_subrev_u32 v248, 0x20000, v248
    v_mfma_f32_16x16x32_bf16 v[148:151], v[224:227], v[84:87], v[148:151]
    v_mfma_f32_16x16x32_bf16 v[152:155], v[224:227], v[88:91], v[152:155]
    v_mfma_f32_16x16x32_bf16 v[156:159], v[224:227], v[92:95], v[156:159]
    s_waitcnt lgkmcnt(2)
    ds_read_b64_tr_b16 v[224:225], v249 offset:0
    ds_read_b64_tr_b16 v[226:227], v249 offset:2048
    v_mfma_f32_16x16x32_bf16 v[156:159], v[228:231], v[108:111], v[156:159]
    v_mfma_f32_16x16x32_bf16 v[152:155], v[228:231], v[104:107], v[152:155]
    v_mfma_f32_16x16x32_bf16 v[148:151], v[228:231], v[100:103], v[148:151]
    v_mfma_f32_16x16x32_bf16 v[144:147], v[228:231], v[96:99], v[144:147]
    s_waitcnt lgkmcnt(2)
    ds_read_b64_tr_b16 v[228:229], v249 offset:4096
    ds_read_b64_tr_b16 v[230:231], v249 offset:6144
    v_mfma_f32_16x16x32_bf16 v[144:147], v[232:235], v[112:115], v[144:147]
    v_mfma_f32_16x16x32_bf16 v[148:151], v[232:235], v[116:119], v[148:151]
    v_mfma_f32_16x16x32_bf16 v[152:155], v[232:235], v[120:123], v[152:155]
    s_waitcnt vmcnt(1)
    v_subrev_u32 v254, s73, v246
    v_cmp_lt_u32 vcc, 4, v254
    v_mfma_f32_16x16x32_bf16 v[156:159], v[232:235], v[124:127], v[156:159]
    s_waitcnt lgkmcnt(2)
    ds_read_b64_tr_b16 v[232:233], v249 offset:8192
    ds_read_b64_tr_b16 v[234:235], v249 offset:10240
    v_mfma_f32_16x16x32_bf16 v[204:207], v[224:227], v[12:15], 0
    s_or_b64 vcc, vcc, s[76:77]
    s_cbranch_vccnz L_sp8_
L_spr8_:
    s_add_u32 s73, s73, 1
    v_mul_f32 v144, v236, v144
    v_mul_f32 v145, v236, v145
    v_mfma_f32_16x16x32_bf16 v[200:203], v[224:227], v[8:11], 0
    buffer_load_dwordx4 a[128:131], v242, s[12:15], s79 offen sc1
    v_mul_f32 v146, v236, v146
    v_mfma_f32_16x16x32_bf16 v[196:199], v[224:227], v[4:7], 0
    v_mul_f32 v147, v236, v147
    v_cvt_pk_bf16_f32 v130, v144, v145
    v_mfma_f32_16x16x32_bf16 v[192:195], v[224:227], v[0:3], 0
    s_waitcnt lgkmcnt(2)
    ds_read_b64_tr_b16 v[224:225], v249 offset:12288
    ds_read_b64_tr_b16 v[226:227], v249 offset:14336
    v_mfma_f32_16x16x32_bf16 v[192:195], v[228:231], v[16:19], v[192:195]
    v_cvt_pk_bf16_f32 v131, v146, v147
    v_mul_f32 v148, v237, v148
    v_mfma_f32_16x16x32_bf16 v[196:199], v[228:231], v[20:23], v[196:199]
    v_mul_f32 v149, v237, v149
    v_mul_f32 v150, v237, v150
    v_mfma_f32_16x16x32_bf16 v[200:203], v[228:231], v[24:27], v[200:203]
    v_mul_f32 v151, v237, v151
    v_cvt_pk_bf16_f32 v134, v148, v149
    v_mfma_f32_16x16x32_bf16 v[204:207], v[228:231], v[28:31], v[204:207]
    s_waitcnt lgkmcnt(2)
    ds_read_b64_tr_b16 v[228:229], v249 offset:16384
    ds_read_b64_tr_b16 v[230:231], v249 offset:18432
    v_mfma_f32_16x16x32_bf16 v[204:207], v[232:235], v[44:47], v[204:207]
    buffer_store_dwordx4 v[128:131], v253, s[28:31], s48 offen
    v_cvt_pk_bf16_f32 v135, v150, v151
    v_mfma_f32_16x16x32_bf16 v[200:203], v[232:235], v[40:43], v[200:203]
    s_xor_b32 s48, s48, 0x4000
    v_mul_f32 v152, v238, v152
    v_mul_f32 v153, v238, v153
    v_mfma_f32_16x16x32_bf16 v[196:199], v[232:235], v[36:39], v[196:199]
    v_mul_f32 v154, v238, v154
    v_mul_f32 v155, v238, v155
    v_mfma_f32_16x16x32_bf16 v[192:195], v[232:235], v[32:35], v[192:195]
    s_waitcnt lgkmcnt(2)
    ds_read_b64_tr_b16 v[232:233], v249 offset:20480
    ds_read_b64_tr_b16 v[234:235], v249 offset:22528
    v_mfma_f32_16x16x32_bf16 v[192:195], v[224:227], v[48:51], v[192:195]
    v_cvt_pk_bf16_f32 v138, v152, v153
    v_cvt_pk_bf16_f32 v139, v154, v155
    v_mfma_f32_16x16x32_bf16 v[196:199], v[224:227], v[52:55], v[196:199]
    v_mul_f32 v156, v239, v156
    v_mul_f32 v157, v239, v157
    v_mfma_f32_16x16x32_bf16 v[200:203], v[224:227], v[56:59], v[200:203]
    v_mul_f32 v158, v239, v158
    v_mul_f32 v159, v239, v159
    v_mfma_f32_16x16x32_bf16 v[204:207], v[224:227], v[60:63], v[204:207]
    s_waitcnt lgkmcnt(2)
    buffer_load_dwordx4 a[132:135], v242, s[12:15], s79 offen offset:1024 sc1
    v_cvt_pk_bf16_f32 v142, v156, v157
    v_mfma_f32_16x16x32_bf16 v[204:207], v[228:231], v[76:79], v[204:207]
    v_cvt_pk_bf16_f32 v143, v158, v159
    v_mfma_f32_16x16x32_bf16 v[200:203], v[228:231], v[72:75], v[200:203]
    v_mfma_f32_16x16x32_bf16 v[196:199], v[228:231], v[68:71], v[196:199]
    s_waitcnt vmcnt(3)
    s_cmp_lg_u32 s76, 0
    s_cbranch_scc1 L_fb9_
    buffer_store_dword v251, v241, s[8:11], s88 offen
L_fbr9_:
    v_mfma_f32_16x16x32_bf16 v[192:195], v[228:231], v[64:67], v[192:195]
    s_waitcnt lgkmcnt(0)
    v_mfma_f32_16x16x32_bf16 v[192:195], v[232:235], v[80:83], v[192:195]
    v_mfma_f32_16x16x32_bf16 v[196:199], v[232:235], v[84:87], v[196:199]
    v_mfma_f32_16x16x32_bf16 v[200:203], v[232:235], v[88:91], v[200:203]
    buffer_store_dwordx4 v[132:135], v253, s[28:31], s49 offen
    v_mfma_f32_16x16x32_bf16 v[204:207], v[232:235], v[92:95], v[204:207]
    s_xor_b32 s49, s49, 0x4000
    ds_read_b64_tr_b16 v[224:225], v249 offset:24576
    ds_read_b64_tr_b16 v[226:227], v249 offset:26624
    v_mfma_f32_16x16x32_bf16 v[180:183], v[176:179], a[96:99], 0
    v_mfma_f32_16x16x32_bf16 v[180:183], v[176:179], a[100:103], v[180:183]
    v_mfma_f32_16x16x32_bf16 v[180:183], v[176:179], a[104:107], v[180:183]
    v_mfma_f32_16x16x32_bf16 v[180:183], v[176:179], a[108:111], v[180:183]
    ds_read_b64_tr_b16 v[228:229], v249 offset:28672
    ds_read_b64_tr_b16 v[230:231], v249 offset:30720
    v_mfma_f32_16x16x32_bf16 v[180:183], v[188:191], a[112:115], v[180:183]
    v_subrev_u32 v249, 0x20000, v249
    v_mfma_f32_16x16x32_bf16 v[180:183], v[188:191], a[116:119], v[180:183]
    buffer_load_dwordx4 a[136:139], v242, s[12:15], s79 offen offset:2048 sc1
    v_mfma_f32_16x16x32_bf16 v[180:183], v[188:191], a[120:123], v[180:183]
    v_mfma_f32_16x16x32_bf16 v[180:183], v[188:191], a[124:127], v[180:183]
    s_waitcnt lgkmcnt(2)
    ds_read_b64_tr_b16 v[232:233], v250 offset:0
    ds_read_b64_tr_b16 v[234:235], v250 offset:2048
    v_mfma_f32_16x16x32_bf16 v[204:207], v[224:227], v[108:111], v[204:207]
    v_mfma_f32_16x16x32_bf16 v[200:203], v[224:227], v[104:107], v[200:203]
    v_cvt_pk_bf16_f32 v184, v180, v181
    v_cvt_pk_bf16_f32 v185, v182, v183
    v_mfma_f32_16x16x32_bf16 v[196:199], v[224:227], v[100:103], v[196:199]
    v_mfma_f32_16x16x32_bf16 v[192:195], v[224:227], v[96:99], v[192:195]
    s_waitcnt lgkmcnt(2)
    ds_read_b64_tr_b16 v[224:225], v250 offset:4096
    ds_read_b64_tr_b16 v[226:227], v250 offset:6144
    v_mfma_f32_16x16x32_bf16 v[192:195], v[228:231], v[112:115], v[192:195]
    buffer_store_dwordx4 v[136:139], v253, s[28:31], s50 offen
    v_mfma_f32_16x16x32_bf16 v[196:199], v[228:231], v[116:119], v[196:199]
    s_xor_b32 s50, s50, 0x4000
    v_mfma_f32_16x16x32_bf16 v[200:203], v[228:231], v[120:123], v[200:203]
    v_mul_f32 v192, v236, v192
    v_mul_f32 v193, v236, v193
    v_mfma_f32_16x16x32_bf16 v[204:207], v[228:231], v[124:127], v[204:207]
    s_waitcnt lgkmcnt(2)
    ds_read_b64_tr_b16 v[228:229], v250 offset:8192
    ds_read_b64_tr_b16 v[230:231], v250 offset:10240
    v_mfma_f32_16x16x32_bf16 v[156:159], v[232:235], v[12:15], 0
    buffer_load_dword v246, v240, s[8:11], 0 offen sc1
    v_mul_f32 v194, v236, v194
    v_mfma_f32_16x16x32_bf16 v[152:155], v[232:235], v[8:11], 0
    v_mul_f32 v195, v236, v195
    v_cvt_pk_bf16_f32 v160, v192, v193
    v_mfma_f32_16x16x32_bf16 v[148:151], v[232:235], v[4:7], 0
    v_cvt_pk_bf16_f32 v161, v194, v195
    v_mul_f32 v196, v237, v196
    v_mfma_f32_16x16x32_bf16 v[144:147], v[232:235], v[0:3], 0
    s_waitcnt lgkmcnt(2)
    ds_read_b64_tr_b16 v[232:233], v250 offset:12288
    ds_read_b64_tr_b16 v[234:235], v250 offset:14336
    v_mfma_f32_16x16x32_bf16 v[144:147], v[224:227], v[16:19], v[144:147]
    buffer_load_dwordx4 a[140:143], v242, s[12:15], s79 offen offset:3072 sc1
    buffer_store_dwordx2 v[184:185], v245, s[80:83], 0 offen offset:384
    v_mfma_f32_16x16x32_bf16 v[148:151], v[224:227], v[20:23], v[148:151]
    s_xor_b32 s79, s79, 0x4000
    v_mul_f32 v197, v237, v197
    v_mul_f32 v198, v237, v198
    v_mfma_f32_16x16x32_bf16 v[152:155], v[224:227], v[24:27], v[152:155]
    v_mul_f32 v199, v237, v199
    v_cvt_pk_bf16_f32 v164, v196, v197
    v_mfma_f32_16x16x32_bf16 v[156:159], v[224:227], v[28:31], v[156:159]
    s_waitcnt lgkmcnt(2)
    ds_read_b64_tr_b16 v[224:225], v250 offset:16384
    ds_read_b64_tr_b16 v[226:227], v250 offset:18432
    v_mfma_f32_16x16x32_bf16 v[156:159], v[228:231], v[44:47], v[156:159]
    v_cvt_pk_bf16_f32 v165, v198, v199
    v_mul_f32 v200, v238, v200
    v_mfma_f32_16x16x32_bf16 v[152:155], v[228:231], v[40:43], v[152:155]
    v_mul_f32 v201, v238, v201
    v_mul_f32 v202, v238, v202
    v_mfma_f32_16x16x32_bf16 v[148:151], v[228:231], v[36:39], v[148:151]
    buffer_store_dwordx4 v[140:143], v253, s[28:31], s51 offen
    v_mul_f32 v203, v238, v203
    v_mfma_f32_16x16x32_bf16 v[144:147], v[228:231], v[32:35], v[144:147]
    s_waitcnt lgkmcnt(2)
    s_xor_b32 s51, s51, 0x4000
    ds_read_b64_tr_b16 v[228:229], v250 offset:20480
    ds_read_b64_tr_b16 v[230:231], v250 offset:22528
    v_mfma_f32_16x16x32_bf16 v[144:147], v[232:235], v[48:51], v[144:147]
    v_cvt_pk_bf16_f32 v168, v200, v201
    v_cvt_pk_bf16_f32 v169, v202, v203
    v_mfma_f32_16x16x32_bf16 v[148:151], v[232:235], v[52:55], v[148:151]
    v_mul_f32 v204, v239, v204
    v_mul_f32 v205, v239, v205
    v_mfma_f32_16x16x32_bf16 v[152:155], v[232:235], v[56:59], v[152:155]
    v_mul_f32 v206, v239, v206
    v_mul_f32 v207, v239, v207
    v_mfma_f32_16x16x32_bf16 v[156:159], v[232:235], v[60:63], v[156:159]
    s_waitcnt lgkmcnt(2)
    ds_read_b64_tr_b16 v[232:233], v250 offset:24576
    ds_read_b64_tr_b16 v[234:235], v250 offset:26624
    v_mfma_f32_16x16x32_bf16 v[156:159], v[224:227], v[76:79], v[156:159]
    v_cvt_pk_bf16_f32 v172, v204, v205
    v_cvt_pk_bf16_f32 v173, v206, v207
    v_mfma_f32_16x16x32_bf16 v[152:155], v[224:227], v[72:75], v[152:155]
    v_mfma_f32_16x16x32_bf16 v[148:151], v[224:227], v[68:71], v[148:151]
    v_mfma_f32_16x16x32_bf16 v[144:147], v[224:227], v[64:67], v[144:147]
    s_waitcnt lgkmcnt(2)
    ds_read_b64_tr_b16 v[224:225], v250 offset:28672
    ds_read_b64_tr_b16 v[226:227], v250 offset:30720
    v_mfma_f32_16x16x32_bf16 v[144:147], v[228:231], v[80:83], v[144:147]
    v_add_u32 v251, 1, v251
    v_subrev_u32 v250, 0x20000, v250
    v_mfma_f32_16x16x32_bf16 v[148:151], v[228:231], v[84:87], v[148:151]
    v_mfma_f32_16x16x32_bf16 v[152:155], v[228:231], v[88:91], v[152:155]
    s_waitcnt vmcnt(3)
    v_subrev_u32 v254, s73, v246
    v_cmp_lt_u32 vcc, 3, v254
    v_mfma_f32_16x16x32_bf16 v[156:159], v[228:231], v[92:95], v[156:159]
    s_waitcnt lgkmcnt(2)
    ds_read_b64_tr_b16 v[228:229], v247 offset:0
    ds_read_b64_tr_b16 v[230:231], v247 offset:2048
    v_mfma_f32_16x16x32_bf16 v[156:159], v[232:235], v[108:111], v[156:159]
    s_or_b64 vcc, vcc, s[76:77]
    s_cbranch_vccnz L_sp9_
L_spr9_:
    s_add_u32 s73, s73, 1
    v_mfma_f32_16x16x32_bf16 v[152:155], v[232:235], v[104:107], v[152:155]
    buffer_load_dwordx4 a[144:147], v242, s[12:15], s79 offen sc1
    v_mfma_f32_16x16x32_bf16 v[148:151], v[232:235], v[100:103], v[148:151]
    v_mfma_f32_16x16x32_bf16 v[144:147], v[232:235], v[96:99], v[144:147]
    s_waitcnt lgkmcnt(2)
    ds_read_b64_tr_b16 v[232:233], v247 offset:4096
    ds_read_b64_tr_b16 v[234:235], v247 offset:6144
    v_mfma_f32_16x16x32_bf16 v[144:147], v[224:227], v[112:115], v[144:147]
    v_mfma_f32_16x16x32_bf16 v[148:151], v[224:227], v[116:119], v[148:151]
    v_mfma_f32_16x16x32_bf16 v[152:155], v[224:227], v[120:123], v[152:155]
    v_mul_f32 v144, v236, v144
    v_mul_f32 v145, v236, v145
    v_mfma_f32_16x16x32_bf16 v[156:159], v[224:227], v[124:127], v[156:159]
    s_waitcnt lgkmcnt(2)
    ds_read_b64_tr_b16 v[224:225], v247 offset:8192
    ds_read_b64_tr_b16 v[226:227], v247 offset:10240
    v_mfma_f32_16x16x32_bf16 v[204:207], v[228:231], v[12:15], 0
    v_mul_f32 v146, v236, v146
    v_mul_f32 v147, v236, v147
    v_mfma_f32_16x16x32_bf16 v[200:203], v[228:231], v[8:11], 0
    v_cvt_pk_bf16_f32 v162, v144, v145
    v_cvt_pk_bf16_f32 v163, v146, v147
    v_mfma_f32_16x16x32_bf16 v[196:199], v[228:231], v[4:7], 0
    v_mul_f32 v148, v237, v148
    v_mul_f32 v149, v237, v149
    v_mfma_f32_16x16x32_bf16 v[192:195], v[228:231], v[0:3], 0
    s_waitcnt lgkmcnt(2)
    ds_read_b64_tr_b16 v[228:229], v247 offset:12288
    ds_read_b64_tr_b16 v[230:231], v247 offset:14336
    v_mfma_f32_16x16x32_bf16 v[192:195], v[232:235], v[16:19], v[192:195]
    v_mul_f32 v150, v237, v150
    v_mul_f32 v151, v237, v151
    v_mfma_f32_16x16x32_bf16 v[196:199], v[232:235], v[20:23], v[196:199]
    v_cvt_pk_bf16_f32 v166, v148, v149
    v_cvt_pk_bf16_f32 v167, v150, v151
    v_mfma_f32_16x16x32_bf16 v[200:203], v[232:235], v[24:27], v[200:203]
    v_mul_f32 v152, v238, v152
    v_mul_f32 v153, v238, v153
    v_mfma_f32_16x16x32_bf16 v[204:207], v[232:235], v[28:31], v[204:207]
    s_waitcnt lgkmcnt(2)
    ds_read_b64_tr_b16 v[232:233], v247 offset:16384
    ds_read_b64_tr_b16 v[234:235], v247 offset:18432
    v_mfma_f32_16x16x32_bf16 v[204:207], v[224:227], v[44:47], v[204:207]
    buffer_load_dwordx4 a[148:151], v242, s[12:15], s79 offen offset:1024 sc1
    buffer_store_dwordx4 v[160:163], v253, s[28:31], s48 offen
    v_mfma_f32_16x16x32_bf16 v[200:203], v[224:227], v[40:43], v[200:203]
    s_xor_b32 s48, s48, 0xc000
    v_mul_f32 v154, v238, v154
    v_mul_f32 v155, v238, v155
    v_mfma_f32_16x16x32_bf16 v[196:199], v[224:227], v[36:39], v[196:199]
    v_cvt_pk_bf16_f32 v170, v152, v153
    v_cvt_pk_bf16_f32 v171, v154, v155
    v_mfma_f32_16x16x32_bf16 v[192:195], v[224:227], v[32:35], v[192:195]
    s_waitcnt lgkmcnt(2)
    ds_read_b64_tr_b16 v[224:225], v247 offset:20480
    ds_read_b64_tr_b16 v[226:227], v247 offset:22528
    v_mfma_f32_16x16x32_bf16 v[192:195], v[228:231], v[48:51], v[192:195]
    v_mul_f32 v156, v239, v156
    v_mul_f32 v157, v239, v157
    v_mfma_f32_16x16x32_bf16 v[196:199], v[228:231], v[52:55], v[196:199]
    v_mul_f32 v158, v239, v158
    v_mul_f32 v159, v239, v159
    v_mfma_f32_16x16x32_bf16 v[200:203], v[228:231], v[56:59], v[200:203]
    v_cvt_pk_bf16_f32 v174, v156, v157
    v_cvt_pk_bf16_f32 v175, v158, v159
    v_mfma_f32_16x16x32_bf16 v[204:207], v[228:231], v[60:63], v[204:207]
    s_waitcnt lgkmcnt(2)
    ds_read_b64_tr_b16 v[228:229], v247 offset:24576
    ds_read_b64_tr_b16 v[230:231], v247 offset:26624
    v_mfma_f32_16x16x32_bf16 v[204:207], v[232:235], v[76:79], v[204:207]
    v_mfma_f32_16x16x32_bf16 v[200:203], v[232:235], v[72:75], v[200:203]
    v_mfma_f32_16x16x32_bf16 v[196:199], v[232:235], v[68:71], v[196:199]
    s_waitcnt vmcnt(3)
    s_cmp_lg_u32 s76, 0
    s_cbranch_scc1 L_fb10_
    buffer_store_dword v251, v241, s[8:11], s88 offen
L_fbr10_:
    v_mfma_f32_16x16x32_bf16 v[192:195], v[232:235], v[64:67], v[192:195]
    s_waitcnt lgkmcnt(2)
    ds_read_b64_tr_b16 v[232:233], v247 offset:28672
    ds_read_b64_tr_b16 v[234:235], v247 offset:30720
    v_mfma_f32_16x16x32_bf16 v[192:195], v[224:227], v[80:83], v[192:195]
    v_mfma_f32_16x16x32_bf16 v[196:199], v[224:227], v[84:87], v[196:199]
    v_mfma_f32_16x16x32_bf16 v[200:203], v[224:227], v[88:91], v[200:203]
    buffer_load_dwordx4 a[152:155], v242, s[12:15], s79 offen offset:2048 sc1
    buffer_store_dwordx4 v[164:167], v253, s[28:31], s49 offen
    v_mfma_f32_16x16x32_bf16 v[204:207], v[224:227], v[92:95], v[204:207]
    s_waitcnt lgkmcnt(2)
    s_xor_b32 s49, s49, 0xc000
    ds_read_b64_tr_b16 v[224:225], v248 offset:0
    ds_read_b64_tr_b16 v[226:227], v248 offset:2048
    v_mfma_f32_16x16x32_bf16 v[204:207], v[228:231], v[108:111], v[204:207]
    v_mfma_f32_16x16x32_bf16 v[200:203], v[228:231], v[104:107], v[200:203]
    v_mfma_f32_16x16x32_bf16 v[196:199], v[228:231], v[100:103], v[196:199]
    v_mfma_f32_16x16x32_bf16 v[192:195], v[228:231], v[96:99], v[192:195]
    s_waitcnt lgkmcnt(2)
    ds_read_b64_tr_b16 v[228:229], v248 offset:4096
    ds_read_b64_tr_b16 v[230:231], v248 offset:6144
    v_mfma_f32_16x16x32_bf16 v[192:195], v[232:235], v[112:115], v[192:195]
    v_mfma_f32_16x16x32_bf16 v[196:199], v[232:235], v[116:119], v[196:199]
    v_mfma_f32_16x16x32_bf16 v[200:203], v[232:235], v[120:123], v[200:203]
    v_mul_f32 v192, v236, v192
    v_mul_f32 v193, v236, v193
    v_mfma_f32_16x16x32_bf16 v[204:207], v[232:235], v[124:127], v[204:207]
    s_waitcnt lgkmcnt(2)
    ds_read_b64_tr_b16 v[232:233], v248 offset:8192
    ds_read_b64_tr_b16 v[234:235], v248 offset:10240
    v_mfma_f32_16x16x32_bf16 v[156:159], v[224:227], v[12:15], 0
    v_mul_f32 v194, v236, v194
    v_mul_f32 v195, v236, v195
    v_mfma_f32_16x16x32_bf16 v[152:155], v[224:227], v[8:11], 0
    v_cvt_pk_bf16_f32 v128, v192, v193
    v_cvt_pk_bf16_f32 v129, v194, v195
    v_mfma_f32_16x16x32_bf16 v[148:151], v[224:227], v[4:7], 0
    v_mul_f32 v196, v237, v196
    v_mul_f32 v197, v237, v197
    v_mfma_f32_16x16x32_bf16 v[144:147], v[224:227], v[0:3], 0
    s_waitcnt lgkmcnt(2)
    ds_read_b64_tr_b16 v[224:225], v248 offset:12288
    ds_read_b64_tr_b16 v[226:227], v248 offset:14336
    v_mfma_f32_16x16x32_bf16 v[144:147], v[228:231], v[16:19], v[144:147]
    buffer_load_dwordx4 a[156:159], v242, s[12:15], s79 offen offset:3072 sc1
    buffer_store_dwordx4 v[168:171], v253, s[28:31], s50 offen
    v_mfma_f32_16x16x32_bf16 v[148:151], v[228:231], v[20:23], v[148:151]
    s_xor_b32 s79, s79, 0xc000
    s_xor_b32 s50, s50, 0xc000
    v_mul_f32 v198, v237, v198
    v_mul_f32 v199, v237, v199
    v_mfma_f32_16x16x32_bf16 v[152:155], v[228:231], v[24:27], v[152:155]
    v_cvt_pk_bf16_f32 v132, v196, v197
    v_cvt_pk_bf16_f32 v133, v198, v199
    v_mfma_f32_16x16x32_bf16 v[156:159], v[228:231], v[28:31], v[156:159]
    s_waitcnt lgkmcnt(2)
    ds_read_b64_tr_b16 v[228:229], v248 offset:16384
    ds_read_b64_tr_b16 v[230:231], v248 offset:18432
    v_mfma_f32_16x16x32_bf16 v[156:159], v[232:235], v[44:47], v[156:159]
    buffer_load_dword v246, v240, s[8:11], 0 offen sc1
    v_mul_f32 v200, v238, v200
    v_mfma_f32_16x16x32_bf16 v[152:155], v[232:235], v[40:43], v[152:155]
    v_mul_f32 v201, v238, v201
    v_mul_f32 v202, v238, v202
    v_mfma_f32_16x16x32_bf16 v[148:151], v[232:235], v[36:39], v[148:151]
    v_mul_f32 v203, v238, v203
    v_cvt_pk_bf16_f32 v136, v200, v201
    v_mfma_f32_16x16x32_bf16 v[144:147], v[232:235], v[32:35], v[144:147]
    s_waitcnt lgkmcnt(2)
    ds_read_b64_tr_b16 v[232:233], v248 offset:20480
    ds_read_b64_tr_b16 v[234:235], v248 offset:22528
    v_mfma_f32_16x16x32_bf16 v[144:147], v[224:227], v[48:51], v[144:147]
    v_cvt_pk_bf16_f32 v137, v202, v203
    v_mul_f32 v204, v239, v204
    v_mfma_f32_16x16x32_bf16 v[148:151], v[224:227], v[52:55], v[148:151]
    v_mul_f32 v205, v239, v205
    v_mul_f32 v206, v239, v206
    v_mfma_f32_16x16x32_bf16 v[152:155], v[224:227], v[56:59], v[152:155]
    v_mul_f32 v207, v239, v207
    v_cvt_pk_bf16_f32 v140, v204, v205
    v_mfma_f32_16x16x32_bf16 v[156:159], v[224:227], v[60:63], v[156:159]
    s_waitcnt lgkmcnt(2)
    ds_read_b64_tr_b16 v[224:225], v248 offset:24576
    ds_read_b64_tr_b16 v[226:227], v248 offset:26624
    v_mfma_f32_16x16x32_bf16 v[156:159], v[228:231], v[76:79], v[156:159]
    v_cvt_pk_bf16_f32 v141, v206, v207
    v_mfma_f32_16x16x32_bf16 v[152:155], v[228:231], v[72:75], v[152:155]
    v_mfma_f32_16x16x32_bf16 v[148:151], v[228:231], v[68:71], v[148:151]
    buffer_store_dwordx4 v[172:175], v253, s[28:31], s51 offen
    v_mfma_f32_16x16x32_bf16 v[144:147], v[228:231], v[64:67], v[144:147]
    s_waitcnt lgkmcnt(2)
    s_xor_b32 s51, s51, 0xc000
    ds_read_b64_tr_b16 v[228:229], v248 offset:28672
    ds_read_b64_tr_b16 v[230:231], v248 offset:30720
    v_mfma_f32_16x16x32_bf16 v[144:147], v[232:235], v[80:83], v[144:147]
    v_add_u32 v251, 1, v251
    v_mfma_f32_16x16x32_bf16 v[148:151], v[232:235], v[84:87], v[148:151]
    v_mfma_f32_16x16x32_bf16 v[152:155], v[232:235], v[88:91], v[152:155]
    v_mfma_f32_16x16x32_bf16 v[156:159], v[232:235], v[92:95], v[156:159]
    s_waitcnt lgkmcnt(2)
    ds_read_b64_tr_b16 v[232:233], v249 offset:0
    ds_read_b64_tr_b16 v[234:235], v249 offset:2048
    v_mfma_f32_16x16x32_bf16 v[156:159], v[224:227], v[108:111], v[156:159]
    v_mfma_f32_16x16x32_bf16 v[152:155], v[224:227], v[104:107], v[152:155]
    v_mfma_f32_16x16x32_bf16 v[148:151], v[224:227], v[100:103], v[148:151]
    v_mfma_f32_16x16x32_bf16 v[144:147], v[224:227], v[96:99], v[144:147]
    s_waitcnt lgkmcnt(2)
    ds_read_b64_tr_b16 v[224:225], v249 offset:4096
    ds_read_b64_tr_b16 v[226:227], v249 offset:6144
    v_mfma_f32_16x16x32_bf16 v[144:147], v[228:231], v[112:115], v[144:147]
    v_mfma_f32_16x16x32_bf16 v[148:151], v[228:231], v[116:119], v[148:151]
    v_mfma_f32_16x16x32_bf16 v[152:155], v[228:231], v[120:123], v[152:155]
    s_waitcnt vmcnt(1)
    v_subrev_u32 v254, s73, v246
    v_cmp_lt_u32 vcc, 2, v254
    v_mfma_f32_16x16x32_bf16 v[156:159], v[228:231], v[124:127], v[156:159]
    s_waitcnt lgkmcnt(2)
    ds_read_b64_tr_b16 v[228:229], v249 offset:8192
    ds_read_b64_tr_b16 v[230:231], v249 offset:10240
    v_mfma_f32_16x16x32_bf16 v[204:207], v[232:235], v[12:15], 0
    s_or_b64 vcc, vcc, s[76:77]
    s_cbranch_vccnz L_sp10_
L_spr10_:
    s_add_u32 s73, s73, 1
    v_mul_f32 v144, v236, v144
    v_mul_f32 v145, v236, v145
    v_mfma_f32_16x16x32_bf16 v[200:203], v[232:235], v[8:11], 0
    buffer_load_dwordx4 a[160:163], v242, s[12:15], s79 offen sc1
    v_mul_f32 v146, v236, v146
    v_mfma_f32_16x16x32_bf16 v[196:199], v[232:235], v[4:7], 0
    v_mul_f32 v147, v236, v147
    v_cvt_pk_bf16_f32 v130, v144, v145
    v_mfma_f32_16x16x32_bf16 v[192:195], v[232:235], v[0:3], 0
    s_waitcnt lgkmcnt(2)
    ds_read_b64_tr_b16 v[232:233], v249 offset:12288
    ds_read_b64_tr_b16 v[234:235], v249 offset:14336
    v_mfma_f32_16x16x32_bf16 v[192:195], v[224:227], v[16:19], v[192:195]
    v_cvt_pk_bf16_f32 v131, v146, v147
    v_mul_f32 v148, v237, v148
    v_mfma_f32_16x16x32_bf16 v[196:199], v[224:227], v[20:23], v[196:199]
    v_mul_f32 v149, v237, v149
    v_mul_f32 v150, v237, v150
    v_mfma_f32_16x16x32_bf16 v[200:203], v[224:227], v[24:27], v[200:203]
    v_mul_f32 v151, v237, v151
    v_cvt_pk_bf16_f32 v134, v148, v149
    v_mfma_f32_16x16x32_bf16 v[204:207], v[224:227], v[28:31], v[204:207]
    s_waitcnt lgkmcnt(2)
    ds_read_b64_tr_b16 v[224:225], v249 offset:16384
    ds_read_b64_tr_b16 v[226:227], v249 offset:18432
    v_mfma_f32_16x16x32_bf16 v[204:207], v[228:231], v[44:47], v[204:207]
    buffer_store_dwordx4 v[128:131], v253, s[28:31], s48 offen
    v_cvt_pk_bf16_f32 v135, v150, v151
    v_mfma_f32_16x16x32_bf16 v[200:203], v[228:231], v[40:43], v[200:203]
    s_xor_b32 s48, s48, 0x4000
    v_mul_f32 v152, v238, v152
    v_mul_f32 v153, v238, v153
    v_mfma_f32_16x16x32_bf16 v[196:199], v[228:231], v[36:39], v[196:199]
    v_mul_f32 v154, v238, v154
    v_mul_f32 v155, v238, v155
    v_mfma_f32_16x16x32_bf16 v[192:195], v[228:231], v[32:35], v[192:195]
    s_waitcnt lgkmcnt(2)
    ds_read_b64_tr_b16 v[228:229], v249 offset:20480
    ds_read_b64_tr_b16 v[230:231], v249 offset:22528
    v_mfma_f32_16x16x32_bf16 v[192:195], v[232:235], v[48:51], v[192:195]
    v_cvt_pk_bf16_f32 v138, v152, v153
    v_cvt_pk_bf16_f32 v139, v154, v155
    v_mfma_f32_16x16x32_bf16 v[196:199], v[232:235], v[52:55], v[196:199]
    v_mul_f32 v156, v239, v156
    v_mul_f32 v157, v239, v157
    v_mfma_f32_16x16x32_bf16 v[200:203], v[232:235], v[56:59], v[200:203]
    buffer_store_dwordx4 v[132:135], v253, s[28:31], s49 offen
    v_mul_f32 v158, v239, v158
    v_mfma_f32_16x16x32_bf16 v[204:207], v[232:235], v[60:63], v[204:207]
    s_waitcnt lgkmcnt(2)
    s_xor_b32 s49, s49, 0x4000
    buffer_load_dwordx4 a[164:167], v242, s[12:15], s79 offen offset:1024 sc1
    v_mul_f32 v159, v239, v159
    v_mfma_f32_16x16x32_bf16 v[204:207], v[224:227], v[76:79], v[204:207]
    v_cvt_pk_bf16_f32 v142, v156, v157
    v_cvt_pk_bf16_f32 v143, v158, v159
    v_mfma_f32_16x16x32_bf16 v[200:203], v[224:227], v[72:75], v[200:203]
    v_mfma_f32_16x16x32_bf16 v[196:199], v[224:227], v[68:71], v[196:199]
    s_waitcnt vmcnt(4)
    s_cmp_lg_u32 s76, 0
    s_cbranch_scc1 L_fb11_
    buffer_store_dword v251, v241, s[8:11], s88 offen
L_fbr11_:
    v_mfma_f32_16x16x32_bf16 v[192:195], v[224:227], v[64:67], v[192:195]
    s_waitcnt lgkmcnt(0)
    v_mfma_f32_16x16x32_bf16 v[192:195], v[228:231], v[80:83], v[192:195]
    buffer_store_dwordx4 v[136:139], v253, s[28:31], s50 offen
    v_mfma_f32_16x16x32_bf16 v[196:199], v[228:231], v[84:87], v[196:199]
    s_xor_b32 s50, s50, 0x4000
    v_mfma_f32_16x16x32_bf16 v[200:203], v[228:231], v[88:91], v[200:203]
    v_mfma_f32_16x16x32_bf16 v[204:207], v[228:231], v[92:95], v[204:207]
    ds_read_b64_tr_b16 v[232:233], v249 offset:24576
    ds_read_b64_tr_b16 v[234:235], v249 offset:26624
    v_mfma_f32_16x16x32_bf16 v[180:183], v[176:179], a[128:131], 0
    v_mfma_f32_16x16x32_bf16 v[180:183], v[176:179], a[132:135], v[180:183]
    v_mfma_f32_16x16x32_bf16 v[180:183], v[176:179], a[136:139], v[180:183]
    buffer_store_dwordx4 v[140:143], v253, s[28:31], s51 offen
    v_mfma_f32_16x16x32_bf16 v[180:183], v[176:179], a[140:143], v[180:183]
    s_xor_b32 s51, s51, 0x4000
    ds_read_b64_tr_b16 v[224:225], v249 offset:28672
    ds_read_b64_tr_b16 v[226:227], v249 offset:30720
    v_mfma_f32_16x16x32_bf16 v[180:183], v[188:191], a[144:147], v[180:183]
    v_mfma_f32_16x16x32_bf16 v[180:183], v[188:191], a[148:151], v[180:183]
    buffer_load_dwordx4 a[168:171], v242, s[12:15], s79 offen offset:2048 sc1
    v_mfma_f32_16x16x32_bf16 v[180:183], v[188:191], a[152:155], v[180:183]
    v_mfma_f32_16x16x32_bf16 v[180:183], v[188:191], a[156:159], v[180:183]
    s_waitcnt lgkmcnt(2)
    ds_read_b64_tr_b16 v[228:229], v250 offset:0
    ds_read_b64_tr_b16 v[230:231], v250 offset:2048
    v_mfma_f32_16x16x32_bf16 v[204:207], v[232:235], v[108:111], v[204:207]
    v_mfma_f32_16x16x32_bf16 v[200:203], v[232:235], v[104:107], v[200:203]
    v_cvt_pk_bf16_f32 v184, v180, v181
    v_cvt_pk_bf16_f32 v185, v182, v183
    v_mfma_f32_16x16x32_bf16 v[196:199], v[232:235], v[100:103], v[196:199]
    v_mfma_f32_16x16x32_bf16 v[192:195], v[232:235], v[96:99], v[192:195]
    s_waitcnt lgkmcnt(2)
    ds_read_b64_tr_b16 v[232:233], v250 offset:4096
    ds_read_b64_tr_b16 v[234:235], v250 offset:6144
    v_mfma_f32_16x16x32_bf16 v[192:195], v[224:227], v[112:115], v[192:195]
    v_mfma_f32_16x16x32_bf16 v[196:199], v[224:227], v[116:119], v[196:199]
    v_mfma_f32_16x16x32_bf16 v[200:203], v[224:227], v[120:123], v[200:203]
    v_mul_f32 v192, v236, v192
    v_mul_f32 v193, v236, v193
    v_mfma_f32_16x16x32_bf16 v[204:207], v[224:227], v[124:127], v[204:207]
    s_waitcnt lgkmcnt(2)
    ds_read_b64_tr_b16 v[224:225], v250 offset:8192
    ds_read_b64_tr_b16 v[226:227], v250 offset:10240
    v_mfma_f32_16x16x32_bf16 v[156:159], v[228:231], v[12:15], 0
    buffer_load_dword v246, v240, s[8:11], 0 offen sc1
    v_mul_f32 v194, v236, v194
    v_mfma_f32_16x16x32_bf16 v[152:155], v[228:231], v[8:11], 0
    v_mul_f32 v195, v236, v195
    v_cvt_pk_bf16_f32 v160, v192, v193
    v_mfma_f32_16x16x32_bf16 v[148:151], v[228:231], v[4:7], 0
    v_cvt_pk_bf16_f32 v161, v194, v195
    v_mul_f32 v196, v237, v196
    v_mfma_f32_16x16x32_bf16 v[144:147], v[228:231], v[0:3], 0
    s_waitcnt lgkmcnt(2)
    ds_read_b64_tr_b16 v[228:229], v250 offset:12288
    ds_read_b64_tr_b16 v[230:231], v250 offset:14336
    v_mfma_f32_16x16x32_bf16 v[144:147], v[232:235], v[16:19], v[144:147]
    buffer_load_dwordx4 a[172:175], v242, s[12:15], s79 offen offset:3072 sc1
    buffer_store_dwordx2 v[184:185], v245, s[80:83], 0 offen offset:512
    v_mfma_f32_16x16x32_bf16 v[148:151], v[232:235], v[20:23], v[148:151]
    s_xor_b32 s79, s79, 0x4000
    v_mul_f32 v197, v237, v197
    v_mul_f32 v198, v237, v198
    v_mfma_f32_16x16x32_bf16 v[152:155], v[232:235], v[24:27], v[152:155]
    v_mul_f32 v199, v237, v199
    v_cvt_pk_bf16_f32 v164, v196, v197
    v_mfma_f32_16x16x32_bf16 v[156:159], v[232:235], v[28:31], v[156:159]
    s_waitcnt lgkmcnt(2)
    ds_read_b64_tr_b16 v[232:233], v250 offset:16384
    ds_read_b64_tr_b16 v[234:235], v250 offset:18432
    v_mfma_f32_16x16x32_bf16 v[156:159], v[224:227], v[44:47], v[156:159]
    v_cvt_pk_bf16_f32 v165, v198, v199
    v_mul_f32 v200, v238, v200
    v_mfma_f32_16x16x32_bf16 v[152:155], v[224:227], v[40:43], v[152:155]
    v_mul_f32 v201, v238, v201
    v_mul_f32 v202, v238, v202
    v_mfma_f32_16x16x32_bf16 v[148:151], v[224:227], v[36:39], v[148:151]
    v_mul_f32 v203, v238, v203
    v_cvt_pk_bf16_f32 v168, v200, v201
    v_mfma_f32_16x16x32_bf16 v[144:147], v[224:227], v[32:35], v[144:147]
    s_waitcnt lgkmcnt(2)
    ds_read_b64_tr_b16 v[224:225], v250 offset:20480
    ds_read_b64_tr_b16 v[226:227], v250 offset:22528
    v_mfma_f32_16x16x32_bf16 v[144:147], v[228:231], v[48:51], v[144:147]
    v_cvt_pk_bf16_f32 v169, v202, v203
    v_mul_f32 v204, v239, v204
    v_mfma_f32_16x16x32_bf16 v[148:151], v[228:231], v[52:55], v[148:151]
    v_mul_f32 v205, v239, v205
    v_mul_f32 v206, v239, v206
    v_mfma_f32_16x16x32_bf16 v[152:155], v[228:231], v[56:59], v[152:155]
    v_mul_f32 v207, v239, v207
    v_cvt_pk_bf16_f32 v172, v204, v205
    v_mfma_f32_16x16x32_bf16 v[156:159], v[228:231], v[60:63], v[156:159]
    s_waitcnt lgkmcnt(2)
    ds_read_b64_tr_b16 v[228:229], v250 offset:24576
    ds_read_b64_tr_b16 v[230:231], v250 offset:26624
    v_mfma_f32_16x16x32_bf16 v[156:159], v[232:235], v[76:79], v[156:159]
    v_cvt_pk_bf16_f32 v173, v206, v207
    v_mfma_f32_16x16x32_bf16 v[152:155], v[232:235], v[72:75], v[152:155]
    v_mfma_f32_16x16x32_bf16 v[148:151], v[232:235], v[68:71], v[148:151]
    v_mfma_f32_16x16x32_bf16 v[144:147], v[232:235], v[64:67], v[144:147]
    s_waitcnt lgkmcnt(2)
    ds_read_b64_tr_b16 v[232:233], v250 offset:28672
    ds_read_b64_tr_b16 v[234:235], v250 offset:30720
    v_mfma_f32_16x16x32_bf16 v[144:147], v[224:227], v[80:83], v[144:147]
    v_mfma_f32_16x16x32_bf16 v[148:151], v[224:227], v[84:87], v[148:151]
    v_mfma_f32_16x16x32_bf16 v[152:155], v[224:227], v[88:91], v[152:155]
    s_waitcnt vmcnt(2)
    v_subrev_u32 v254, s73, v246
    v_cmp_lt_u32 vcc, 1, v254
    v_mfma_f32_16x16x32_bf16 v[156:159], v[224:227], v[92:95], v[156:159]
    s_waitcnt lgkmcnt(2)
    v_mfma_f32_16x16x32_bf16 v[156:159], v[228:231], v[108:111], v[156:159]
    s_or_b64 vcc, vcc, s[76:77]
    s_cbranch_vccnz L_sp11_
L_spr11_:
    s_add_u32 s73, s73, 1
    v_mfma_f32_16x16x32_bf16 v[152:155], v[228:231], v[104:107], v[152:155]
    v_mfma_f32_16x16x32_bf16 v[148:151], v[228:231], v[100:103], v[148:151]
    v_mfma_f32_16x16x32_bf16 v[144:147], v[228:231], v[96:99], v[144:147]
    s_waitcnt lgkmcnt(0)
    v_mfma_f32_16x16x32_bf16 v[144:147], v[232:235], v[112:115], v[144:147]
    v_mfma_f32_16x16x32_bf16 v[148:151], v[232:235], v[116:119], v[148:151]
    v_mfma_f32_16x16x32_bf16 v[152:155], v[232:235], v[120:123], v[152:155]
    v_mul_f32 v144, v236, v144
    v_mul_f32 v145, v236, v145
    v_mfma_f32_16x16x32_bf16 v[156:159], v[232:235], v[124:127], v[156:159]
    v_mul_f32 v146, v236, v146
    v_mul_f32 v147, v236, v147
    v_cvt_pk_bf16_f32 v162, v144, v145
    v_cvt_pk_bf16_f32 v163, v146, v147
    buffer_store_dwordx4 v[160:163], v253, s[28:31], s48 offen
    s_xor_b32 s48, s48, 0xc000
    v_mul_f32 v148, v237, v148
    v_mul_f32 v149, v237, v149
    v_mul_f32 v150, v237, v150
    v_mul_f32 v151, v237, v151
    v_cvt_pk_bf16_f32 v166, v148, v149
    v_cvt_pk_bf16_f32 v167, v150, v151
    buffer_store_dwordx4 v[164:167], v253, s[28:31], s49 offen
    s_xor_b32 s49, s49, 0xc000
    v_mul_f32 v152, v238, v152
    v_mul_f32 v153, v238, v153
    v_mul_f32 v154, v238, v154
    v_mul_f32 v155, v238, v155
    v_cvt_pk_bf16_f32 v170, v152, v153
    v_cvt_pk_bf16_f32 v171, v154, v155
    buffer_store_dwordx4 v[168:171], v253, s[28:31], s50 offen
    s_xor_b32 s50, s50, 0xc000
    v_mul_f32 v156, v239, v156
    v_mul_f32 v157, v239, v157
    v_mul_f32 v158, v239, v158
    v_mul_f32 v159, v239, v159
    v_cvt_pk_bf16_f32 v174, v156, v157
    v_cvt_pk_bf16_f32 v175, v158, v159
    buffer_store_dwordx4 v[172:175], v253, s[28:31], s51 offen
    s_xor_b32 s51, s51, 0xc000
    buffer_load_dwordx4 a[176:179], v242, s[12:15], s79 offen sc1
    buffer_load_dwordx4 a[180:183], v242, s[12:15], s79 offen offset:1024 sc1
    buffer_load_dwordx4 a[184:187], v242, s[12:15], s79 offen offset:2048 sc1
    buffer_load_dwordx4 a[188:191], v242, s[12:15], s79 offen offset:3072 sc1
    s_xor_b32 s79, s79, 0xc000
    v_add_u32 v251, 1, v251
    s_waitcnt vmcnt(4)
    s_cmp_lg_u32 s76, 0
    s_cbranch_scc1 L_fb12_
    buffer_store_dword v251, v241, s[8:11], s88 offen
L_fbr12_:
    v_mfma_f32_16x16x32_bf16 v[180:183], v[176:179], a[160:163], 0
    v_mfma_f32_16x16x32_bf16 v[180:183], v[176:179], a[164:167], v[180:183]
    v_mfma_f32_16x16x32_bf16 v[180:183], v[176:179], a[168:171], v[180:183]
    v_mfma_f32_16x16x32_bf16 v[180:183], v[176:179], a[172:175], v[180:183]
    s_waitcnt vmcnt(4)
    v_mfma_f32_16x16x32_bf16 v[180:183], v[188:191], a[176:179], v[180:183]
    s_waitcnt vmcnt(3)
    v_mfma_f32_16x16x32_bf16 v[180:183], v[188:191], a[180:183], v[180:183]
    s_waitcnt vmcnt(2)
    v_mfma_f32_16x16x32_bf16 v[180:183], v[188:191], a[184:187], v[180:183]
    s_waitcnt vmcnt(1)
    v_mfma_f32_16x16x32_bf16 v[180:183], v[188:191], a[188:191], v[180:183]
    buffer_load_dword v246, v240, s[8:11], 0 offen sc1
    s_nop 6
    v_cvt_pk_bf16_f32 v184, v180, v181
    v_cvt_pk_bf16_f32 v185, v182, v183
    buffer_store_dwordx2 v[184:185], v245, s[80:83], 0 offen offset:640
    s_waitcnt vmcnt(1)
    v_subrev_u32 v254, s73, v246
    v_cmp_lt_u32 vcc, 0, v254
    s_nop 4
    s_or_b64 vcc, vcc, s[76:77]
    s_cbranch_vccnz L_sp12_
L_spr12_:
    s_add_u32 s73, s73, 1
    buffer_load_dwordx4 a[192:195], v242, s[12:15], s79 offen sc1
    buffer_load_dwordx4 a[196:199], v242, s[12:15], s79 offen offset:1024 sc1
    buffer_load_dwordx4 a[200:203], v242, s[12:15], s79 offen offset:2048 sc1
    buffer_load_dwordx4 a[204:207], v242, s[12:15], s79 offen offset:3072 sc1
    s_xor_b32 s79, s79, 0x4000
    buffer_load_dwordx4 a[208:211], v242, s[12:15], s79 offen sc1
    buffer_load_dwordx4 a[212:215], v242, s[12:15], s79 offen offset:1024 sc1
    buffer_load_dwordx4 a[216:219], v242, s[12:15], s79 offen offset:2048 sc1
    buffer_load_dwordx4 a[220:223], v242, s[12:15], s79 offen offset:3072 sc1
    s_xor_b32 s79, s79, 0xc000
    s_waitcnt vmcnt(7)
    v_mfma_f32_16x16x32_bf16 v[180:183], v[176:179], a[192:195], 0
    s_waitcnt vmcnt(6)
    v_mfma_f32_16x16x32_bf16 v[180:183], v[176:179], a[196:199], v[180:183]
    s_waitcnt vmcnt(5)
    v_mfma_f32_16x16x32_bf16 v[180:183], v[176:179], a[200:203], v[180:183]
    s_waitcnt vmcnt(4)
    v_mfma_f32_16x16x32_bf16 v[180:183], v[176:179], a[204:207], v[180:183]
    s_waitcnt vmcnt(3)
    v_mfma_f32_16x16x32_bf16 v[180:183], v[188:191], a[208:211], v[180:183]
    s_waitcnt vmcnt(2)
    v_mfma_f32_16x16x32_bf16 v[180:183], v[188:191], a[212:215], v[180:183]
    s_waitcnt vmcnt(1)
    v_mfma_f32_16x16x32_bf16 v[180:183], v[188:191], a[216:219], v[180:183]
    s_waitcnt vmcnt(0)
    v_mfma_f32_16x16x32_bf16 v[180:183], v[188:191], a[220:223], v[180:183]
    s_nop 7
    v_cvt_pk_bf16_f32 v184, v180, v181
    v_cvt_pk_bf16_f32 v185, v182, v183
    buffer_store_dwordx2 v[184:185], v245, s[80:83], 0 offen offset:768
    s_waitcnt vmcnt(0)
L_end:
    s_endpgm
L_mode:
    s_mov_b32 s91, 0x20000
L_model:
    buffer_load_dwordx3 v[196:198], off, s[84:87], 0 sc1
    s_waitcnt vmcnt(0)
    v_readfirstlane_b32 s72, v196
    v_readfirstlane_b32 s73, v197
    v_readfirstlane_b32 s74, v198
    s_nop 4
    s_lshr_b32 s54, s73, 2
    s_or_b32 s54, s54, s73
    s_lshr_b32 s56, s54, 1
    s_or_b32 s54, s54, s56
    s_lshr_b32 s55, s74, 2
    s_or_b32 s55, s55, s74
    s_lshr_b32 s56, s55, 1
    s_or_b32 s55, s55, s56
    s_and_b32 s54, s54, s55
    s_and_b32 s54, s54, 0x11111111
    s_cmp_lg_u32 s72, 0
    s_cselect_b32 s54, s54, 0
    s_cmp_eq_u32 s54, 0x11111111
    s_cbranch_scc1 L_moded
    s_sleep 2
    s_sub_u32 s91, s91, 1
    s_cmp_lg_u32 s91, 0
    s_cbranch_scc1 L_model
L_moded:
    s_cmp_eq_u32 s73, s79
    s_cselect_b32 s76, 0, -1
    s_cmp_eq_u32 s74, s79
    s_cselect_b32 s76, s76, -1
    s_branch L_moder
L_fb1_:
    buffer_wbl2 sc1
    s_waitcnt vmcnt(0)
    buffer_store_dword v251, v241, s[8:11], s88 offen sc1
    s_waitcnt vmcnt(0)
    s_branch L_fbr1_
L_sp1_:
    s_mov_b32 s91, 0x40000
L_spl1_:
    buffer_load_dword v246, v240, s[8:11], 0 offen sc1
    s_waitcnt vmcnt(0)
    v_subrev_u32 v254, s73, v246
    v_cmp_lt_u32 vcc, 11, v254
    s_nop 4
    s_cbranch_vccz L_spd1_
    s_sleep 2
    s_sub_u32 s91, s91, 1
    s_cmp_lg_u32 s91, 0
    s_cbranch_scc1 L_spl1_
L_spd1_:
    s_cmp_eq_u32 s76, 0
    s_cbranch_scc1 L_spr1_
    buffer_inv sc1
    s_waitcnt vmcnt(0)
    s_branch L_spr1_
L_fb2_:
    buffer_wbl2 sc1
    s_waitcnt vmcnt(0)
    buffer_store_dword v251, v241, s[8:11], s88 offen sc1
    s_waitcnt vmcnt(0)
    s_branch L_fbr2_
L_sp2_:
    s_mov_b32 s91, 0x40000
L_spl2_:
    buffer_load_dword v246, v240, s[8:11], 0 offen sc1
    s_waitcnt vmcnt(0)
    v_subrev_u32 v254, s73, v246
    v_cmp_lt_u32 vcc, 10, v254
    s_nop 4
    s_cbranch_vccz L_spd2_
    s_sleep 2
    s_sub_u32 s91, s91, 1
    s_cmp_lg_u32 s91, 0
    s_cbranch_scc1 L_spl2_
L_spd2_:
    s_cmp_eq_u32 s76, 0
    s_cbranch_scc1 L_spr2_
    buffer_inv sc1
    s_waitcnt vmcnt(0)
    s_branch L_spr2_
L_fb3_:
    buffer_wbl2 sc1
    s_waitcnt vmcnt(0)
    buffer_store_dword v251, v241, s[8:11], s88 offen sc1
    s_waitcnt vmcnt(0)
    s_branch L_fbr3_
L_sp3_:
    s_mov_b32 s91, 0x40000
L_spl3_:
    buffer_load_dword v246, v240, s[8:11], 0 offen sc1
    s_waitcnt vmcnt(0)
    v_subrev_u32 v254, s73, v246
    v_cmp_lt_u32 vcc, 9, v254
    s_nop 4
    s_cbranch_vccz L_spd3_
    s_sleep 2
    s_sub_u32 s91, s91, 1
    s_cmp_lg_u32 s91, 0
    s_cbranch_scc1 L_spl3_
L_spd3_:
    s_cmp_eq_u32 s76, 0
    s_cbranch_scc1 L_spr3_
    buffer_inv sc1
    s_waitcnt vmcnt(0)
    s_branch L_spr3_
L_fb4_:
    buffer_wbl2 sc1
    s_waitcnt vmcnt(0)
    buffer_store_dword v251, v241, s[8:11], s88 offen sc1
    s_waitcnt vmcnt(0)
    s_branch L_fbr4_
L_sp4_:
    s_mov_b32 s91, 0x40000
L_spl4_:
    buffer_load_dword v246, v240, s[8:11], 0 offen sc1
    s_waitcnt vmcnt(0)
    v_subrev_u32 v254, s73, v246
    v_cmp_lt_u32 vcc, 8, v254
    s_nop 4
    s_cbranch_vccz L_spd4_
    s_sleep 2
    s_sub_u32 s91, s91, 1
    s_cmp_lg_u32 s91, 0
    s_cbranch_scc1 L_spl4_
L_spd4_:
    s_cmp_eq_u32 s76, 0
    s_cbranch_scc1 L_spr4_
    buffer_inv sc1
    s_waitcnt vmcnt(0)
    s_branch L_spr4_
L_fb5_:
    buffer_wbl2 sc1
    s_waitcnt vmcnt(0)
    buffer_store_dword v251, v241, s[8:11], s88 offen sc1
    s_waitcnt vmcnt(0)
    s_branch L_fbr5_
L_sp5_:
    s_mov_b32 s91, 0x40000
L_spl5_:
    buffer_load_dword v246, v240, s[8:11], 0 offen sc1
    s_waitcnt vmcnt(0)
    v_subrev_u32 v254, s73, v246
    v_cmp_lt_u32 vcc, 7, v254
    s_nop 4
    s_cbranch_vccz L_spd5_
    s_sleep 2
    s_sub_u32 s91, s91, 1
    s_cmp_lg_u32 s91, 0
    s_cbranch_scc1 L_spl5_
L_spd5_:
    s_cmp_eq_u32 s76, 0
    s_cbranch_scc1 L_spr5_
    buffer_inv sc1
    s_waitcnt vmcnt(0)
    s_branch L_spr5_
L_fb6_:
    buffer_wbl2 sc1
    s_waitcnt vmcnt(0)
    buffer_store_dword v251, v241, s[8:11], s88 offen sc1
    s_waitcnt vmcnt(0)
    s_branch L_fbr6_
L_sp6_:
    s_mov_b32 s91, 0x40000
L_spl6_:
    buffer_load_dword v246, v240, s[8:11], 0 offen sc1
    s_waitcnt vmcnt(0)
    v_subrev_u32 v254, s73, v246
    v_cmp_lt_u32 vcc, 6, v254
    s_nop 4
    s_cbranch_vccz L_spd6_
    s_sleep 2
    s_sub_u32 s91, s91, 1
    s_cmp_lg_u32 s91, 0
    s_cbranch_scc1 L_spl6_
L_spd6_:
    s_cmp_eq_u32 s76, 0
    s_cbranch_scc1 L_spr6_
    buffer_inv sc1
    s_waitcnt vmcnt(0)
    s_branch L_spr6_
L_fb7_:
    buffer_wbl2 sc1
    s_waitcnt vmcnt(0)
    buffer_store_dword v251, v241, s[8:11], s88 offen sc1
    s_waitcnt vmcnt(0)
    s_branch L_fbr7_
L_sp7_:
    s_mov_b32 s91, 0x40000
L_spl7_:
    buffer_load_dword v246, v240, s[8:11], 0 offen sc1
    s_waitcnt vmcnt(0)
    v_subrev_u32 v254, s73, v246
    v_cmp_lt_u32 vcc, 5, v254
    s_nop 4
    s_cbranch_vccz L_spd7_
    s_sleep 2
    s_sub_u32 s91, s91, 1
    s_cmp_lg_u32 s91, 0
    s_cbranch_scc1 L_spl7_
L_spd7_:
    s_cmp_eq_u32 s76, 0
    s_cbranch_scc1 L_spr7_
    buffer_inv sc1
    s_waitcnt vmcnt(0)
    s_branch L_spr7_
L_fb8_:
    buffer_wbl2 sc1
    s_waitcnt vmcnt(0)
    buffer_store_dword v251, v241, s[8:11], s88 offen sc1
    s_waitcnt vmcnt(0)
    s_branch L_fbr8_
L_sp8_:
    s_mov_b32 s91, 0x40000
L_spl8_:
    buffer_load_dword v246, v240, s[8:11], 0 offen sc1
    s_waitcnt vmcnt(0)
    v_subrev_u32 v254, s73, v246
    v_cmp_lt_u32 vcc, 4, v254
    s_nop 4
    s_cbranch_vccz L_spd8_
    s_sleep 2
    s_sub_u32 s91, s91, 1
    s_cmp_lg_u32 s91, 0
    s_cbranch_scc1 L_spl8_
L_spd8_:
    s_cmp_eq_u32 s76, 0
    s_cbranch_scc1 L_spr8_
    buffer_inv sc1
    s_waitcnt vmcnt(0)
    s_branch L_spr8_
L_fb9_:
    buffer_wbl2 sc1
    s_waitcnt vmcnt(0)
    buffer_store_dword v251, v241, s[8:11], s88 offen sc1
    s_waitcnt vmcnt(0)
    s_branch L_fbr9_
L_sp9_:
    s_mov_b32 s91, 0x40000
L_spl9_:
    buffer_load_dword v246, v240, s[8:11], 0 offen sc1
    s_waitcnt vmcnt(0)
    v_subrev_u32 v254, s73, v246
    v_cmp_lt_u32 vcc, 3, v254
    s_nop 4
    s_cbranch_vccz L_spd9_
    s_sleep 2
    s_sub_u32 s91, s91, 1
    s_cmp_lg_u32 s91, 0
    s_cbranch_scc1 L_spl9_
L_spd9_:
    s_cmp_eq_u32 s76, 0
    s_cbranch_scc1 L_spr9_
    buffer_inv sc1
    s_waitcnt vmcnt(0)
    s_branch L_spr9_
L_fb10_:
    buffer_wbl2 sc1
    s_waitcnt vmcnt(0)
    buffer_store_dword v251, v241, s[8:11], s88 offen sc1
    s_waitcnt vmcnt(0)
    s_branch L_fbr10_
L_sp10_:
    s_mov_b32 s91, 0x40000
L_spl10_:
    buffer_load_dword v246, v240, s[8:11], 0 offen sc1
    s_waitcnt vmcnt(0)
    v_subrev_u32 v254, s73, v246
    v_cmp_lt_u32 vcc, 2, v254
    s_nop 4
    s_cbranch_vccz L_spd10_
    s_sleep 2
    s_sub_u32 s91, s91, 1
    s_cmp_lg_u32 s91, 0
    s_cbranch_scc1 L_spl10_
L_spd10_:
    s_cmp_eq_u32 s76, 0
    s_cbranch_scc1 L_spr10_
    buffer_inv sc1
    s_waitcnt vmcnt(0)
    s_branch L_spr10_
L_fb11_:
    buffer_wbl2 sc1
    s_waitcnt vmcnt(0)
    buffer_store_dword v251, v241, s[8:11], s88 offen sc1
    s_waitcnt vmcnt(0)
    s_branch L_fbr11_
L_sp11_:
    s_mov_b32 s91, 0x40000
L_spl11_:
    buffer_load_dword v246, v240, s[8:11], 0 offen sc1
    s_waitcnt vmcnt(0)
    v_subrev_u32 v254, s73, v246
    v_cmp_lt_u32 vcc, 1, v254
    s_nop 4
    s_cbranch_vccz L_spd11_
    s_sleep 2
    s_sub_u32 s91, s91, 1
    s_cmp_lg_u32 s91, 0
    s_cbranch_scc1 L_spl11_
L_spd11_:
    s_cmp_eq_u32 s76, 0
    s_cbranch_scc1 L_spr11_
    buffer_inv sc1
    s_waitcnt vmcnt(0)
    s_branch L_spr11_
L_fb12_:
    buffer_wbl2 sc1
    s_waitcnt vmcnt(0)
    buffer_store_dword v251, v241, s[8:11], s88 offen sc1
    s_waitcnt vmcnt(0)
    s_branch L_fbr12_
L_sp12_:
    s_mov_b32 s91, 0x40000
L_spl12_:
    buffer_load_dword v246, v240, s[8:11], 0 offen sc1
    s_waitcnt vmcnt(0)
    v_subrev_u32 v254, s73, v246
    v_cmp_lt_u32 vcc, 0, v254
    s_nop 4
    s_cbranch_vccz L_spd12_
    s_sleep 2
    s_sub_u32 s91, s91, 1
    s_cmp_lg_u32 s91, 0
    s_cbranch_scc1 L_spl12_
L_spd12_:
    s_cmp_eq_u32 s76, 0
    s_cbranch_scc1 L_spr12_
    buffer_inv sc1
    s_waitcnt vmcnt(0)
    s_branch L_spr12_
L_stub0:
    s_mov_b32 s37, 0
    s_and_b32 s52, s90, 0x7ffff
    s_branch L_rare
L_stub1:
    s_mov_b32 s37, 1
    s_and_b32 s52, s90, 0x7ffff
    s_branch L_rare
L_stub2:
    s_mov_b32 s37, 2
    s_and_b32 s52, s90, 0x7ffff
    s_branch L_rare
L_stub3:
    s_mov_b32 s37, 3
    s_and_b32 s52, s90, 0x7ffff
    s_branch L_rare
L_stub4:
    s_mov_b32 s37, 4
    s_and_b32 s52, s90, 0x7ffff
    s_branch L_rare
L_stub5:
    s_mov_b32 s37, 5
    s_and_b32 s52, s90, 0x7ffff
    s_branch L_rare
L_stub6:
    s_mov_b32 s37, 6
    s_and_b32 s52, s90, 0x7ffff
    s_branch L_rare
L_stub7:
    s_mov_b32 s37, 7
    s_and_b32 s52, s90, 0x7ffff
    s_branch L_rare
L_rare:
    s_nop 15
    s_waitcnt vmcnt(0) lgkmcnt(0)
    v_mbcnt_lo_u32_b32 v168, -1, 0
    v_mbcnt_hi_u32_b32 v168, -1, v168
    v_lshrrev_b32 v244, 4, v168
    v_lshlrev_b32 v244, 4, v244
    v_bfe_u32 v169, v168, 0, 1
    v_lshl_add_u32 v244, v169, 15, v244
    v_bfe_u32 v169, v168, 1, 1
    v_lshl_add_u32 v244, v169, 16, v244
    v_bfe_u32 v169, v168, 2, 1
    v_lshl_add_u32 v244, v169, 9, v244
    v_bfe_u32 v169, v168, 3, 1
    v_lshl_add_u32 v244, v169, 10, v244
    s_add_u32 s39, s52, 0x800
    buffer_load_dwordx4 v[224:227], v244, s[16:19], s52 offen
    buffer_load_dwordx4 v[228:231], v244, s[16:19], s52 offen offset:64
    buffer_load_dwordx4 v[232:235], v244, s[16:19], s52 offen offset:128
    s_waitcnt vmcnt(2)
    v_mfma_f32_16x16x32_bf16 v[128:131], v[224:227], v[0:3], 0
    v_mfma_f32_16x16x32_bf16 v[132:135], v[224:227], v[4:7], 0
    v_mfma_f32_16x16x32_bf16 v[136:139], v[224:227], v[8:11], 0
    v_mfma_f32_16x16x32_bf16 v[140:143], v[224:227], v[12:15], 0
    buffer_load_dwordx4 v[224:227], v244, s[16:19], s52 offen offset:192
    s_waitcnt vmcnt(2)
    v_mfma_f32_16x16x32_bf16 v[128:131], v[228:231], v[16:19], v[128:131]
    v_mfma_f32_16x16x32_bf16 v[132:135], v[228:231], v[20:23], v[132:135]
    v_mfma_f32_16x16x32_bf16 v[136:139], v[228:231], v[24:27], v[136:139]
    v_mfma_f32_16x16x32_bf16 v[140:143], v[228:231], v[28:31], v[140:143]
    buffer_load_dwordx4 v[228:231], v244, s[16:19], s52 offen offset:256
    s_waitcnt vmcnt(2)
    v_mfma_f32_16x16x32_bf16 v[128:131], v[232:235], v[32:35], v[128:131]
    v_mfma_f32_16x16x32_bf16 v[132:135], v[232:235], v[36:39], v[132:135]
    v_mfma_f32_16x16x32_bf16 v[136:139], v[232:235], v[40:43], v[136:139]
    v_mfma_f32_16x16x32_bf16 v[140:143], v[232:235], v[44:47], v[140:143]
    buffer_load_dwordx4 v[232:235], v244, s[16:19], s52 offen offset:320
    s_waitcnt vmcnt(2)
    v_mfma_f32_16x16x32_bf16 v[128:131], v[224:227], v[48:51], v[128:131]
    v_mfma_f32_16x16x32_bf16 v[132:135], v[224:227], v[52:55], v[132:135]
    v_mfma_f32_16x16x32_bf16 v[136:139], v[224:227], v[56:59], v[136:139]
    v_mfma_f32_16x16x32_bf16 v[140:143], v[224:227], v[60:63], v[140:143]
    buffer_load_dwordx4 v[224:227], v244, s[16:19], s52 offen offset:384
    s_waitcnt vmcnt(2)
    v_mfma_f32_16x16x32_bf16 v[128:131], v[228:231], v[64:67], v[128:131]
    v_mfma_f32_16x16x32_bf16 v[132:135], v[228:231], v[68:71], v[132:135]
    v_mfma_f32_16x16x32_bf16 v[136:139], v[228:231], v[72:75], v[136:139]
    v_mfma_f32_16x16x32_bf16 v[140:143], v[228:231], v[76:79], v[140:143]
    buffer_load_dwordx4 v[228:231], v244, s[16:19], s52 offen offset:448
    s_waitcnt vmcnt(2)
    v_mfma_f32_16x16x32_bf16 v[128:131], v[232:235], v[80:83], v[128:131]
    v_mfma_f32_16x16x32_bf16 v[132:135], v[232:235], v[84:87], v[132:135]
    v_mfma_f32_16x16x32_bf16 v[136:139], v[232:235], v[88:91], v[136:139]
    v_mfma_f32_16x16x32_bf16 v[140:143], v[232:235], v[92:95], v[140:143]
    buffer_load_dwordx4 v[232:235], v244, s[16:19], s39 offen
    s_waitcnt vmcnt(2)
    v_mfma_f32_16x16x32_bf16 v[128:131], v[224:227], v[96:99], v[128:131]
    v_mfma_f32_16x16x32_bf16 v[132:135], v[224:227], v[100:103], v[132:135]
    v_mfma_f32_16x16x32_bf16 v[136:139], v[224:227], v[104:107], v[136:139]
    v_mfma_f32_16x16x32_bf16 v[140:143], v[224:227], v[108:111], v[140:143]
    buffer_load_dwordx4 v[224:227], v244, s[16:19], s39 offen offset:64
    s_waitcnt vmcnt(2)
    v_mfma_f32_16x16x32_bf16 v[128:131], v[228:231], v[112:115], v[128:131]
    v_mfma_f32_16x16x32_bf16 v[132:135], v[228:231], v[116:119], v[132:135]
    v_mfma_f32_16x16x32_bf16 v[136:139], v[228:231], v[120:123], v[136:139]
    v_mfma_f32_16x16x32_bf16 v[140:143], v[228:231], v[124:127], v[140:143]
    buffer_load_dwordx4 v[228:231], v244, s[16:19], s39 offen offset:128
    s_waitcnt vmcnt(2)
    v_mfma_f32_16x16x32_bf16 v[144:147], v[232:235], v[0:3], 0
    v_mfma_f32_16x16x32_bf16 v[148:151], v[232:235], v[4:7], 0
    v_mfma_f32_16x16x32_bf16 v[152:155], v[232:235], v[8:11], 0
    v_mfma_f32_16x16x32_bf16 v[156:159], v[232:235], v[12:15], 0
    buffer_load_dwordx4 v[232:235], v244, s[16:19], s39 offen offset:192
    s_waitcnt vmcnt(2)
    v_mfma_f32_16x16x32_bf16 v[144:147], v[224:227], v[16:19], v[144:147]
    v_mfma_f32_16x16x32_bf16 v[148:151], v[224:227], v[20:23], v[148:151]
    v_mfma_f32_16x16x32_bf16 v[152:155], v[224:227], v[24:27], v[152:155]
    v_mfma_f32_16x16x32_bf16 v[156:159], v[224:227], v[28:31], v[156:159]
    buffer_load_dwordx4 v[224:227], v244, s[16:19], s39 offen offset:256
    s_waitcnt vmcnt(2)
    v_mfma_f32_16x16x32_bf16 v[144:147], v[228:231], v[32:35], v[144:147]
    v_mfma_f32_16x16x32_bf16 v[148:151], v[228:231], v[36:39], v[148:151]
    v_mfma_f32_16x16x32_bf16 v[152:155], v[228:231], v[40:43], v[152:155]
    v_mfma_f32_16x16x32_bf16 v[156:159], v[228:231], v[44:47], v[156:159]
    buffer_load_dwordx4 v[228:231], v244, s[16:19], s39 offen offset:320
    s_waitcnt vmcnt(2)
    v_mfma_f32_16x16x32_bf16 v[144:147], v[232:235], v[48:51], v[144:147]
    v_mfma_f32_16x16x32_bf16 v[148:151], v[232:235], v[52:55], v[148:151]
    v_mfma_f32_16x16x32_bf16 v[152:155], v[232:235], v[56:59], v[152:155]
    v_mfma_f32_16x16x32_bf16 v[156:159], v[232:235], v[60:63], v[156:159]
    buffer_load_dwordx4 v[232:235], v244, s[16:19], s39 offen offset:384
    s_waitcnt vmcnt(2)
    v_mfma_f32_16x16x32_bf16 v[144:147], v[224:227], v[64:67], v[144:147]
    v_mfma_f32_16x16x32_bf16 v[148:151], v[224:227], v[68:71], v[148:151]
    v_mfma_f32_16x16x32_bf16 v[152:155], v[224:227], v[72:75], v[152:155]
    v_mfma_f32_16x16x32_bf16 v[156:159], v[224:227], v[76:79], v[156:159]
    buffer_load_dwordx4 v[224:227], v244, s[16:19], s39 offen offset:448
    s_waitcnt vmcnt(2)
    v_mfma_f32_16x16x32_bf16 v[144:147], v[228:231], v[80:83], v[144:147]
    v_mfma_f32_16x16x32_bf16 v[148:151], v[228:231], v[84:87], v[148:151]
    v_mfma_f32_16x16x32_bf16 v[152:155], v[228:231], v[88:91], v[152:155]
    v_mfma_f32_16x16x32_bf16 v[156:159], v[228:231], v[92:95], v[156:159]
    s_waitcnt vmcnt(1)
    v_mfma_f32_16x16x32_bf16 v[144:147], v[232:235], v[96:99], v[144:147]
    v_mfma_f32_16x16x32_bf16 v[148:151], v[232:235], v[100:103], v[148:151]
    v_mfma_f32_16x16x32_bf16 v[152:155], v[232:235], v[104:107], v[152:155]
    v_mfma_f32_16x16x32_bf16 v[156:159], v[232:235], v[108:111], v[156:159]
    s_waitcnt vmcnt(0)
    v_mfma_f32_16x16x32_bf16 v[144:147], v[224:227], v[112:115], v[144:147]
    v_mfma_f32_16x16x32_bf16 v[148:151], v[224:227], v[116:119], v[148:151]
    v_mfma_f32_16x16x32_bf16 v[152:155], v[224:227], v[120:123], v[152:155]
    v_mfma_f32_16x16x32_bf16 v[156:159], v[224:227], v[124:127], v[156:159]
    v_max3_f32 v160, v128, v129, v130
    v_max3_f32 v160, v160, v131, v144
    v_max3_f32 v160, v160, v145, v146
    v_max_f32 v160, v160, v147
    v_max3_f32 v161, v132, v133, v134
    v_max3_f32 v161, v161, v135, v148
    v_max3_f32 v161, v161, v149, v150
    v_max_f32 v161, v161, v151
    v_max3_f32 v162, v136, v137, v138
    v_max3_f32 v162, v162, v139, v152
    v_max3_f32 v162, v162, v153, v154
    v_max_f32 v162, v162, v155
    v_max3_f32 v163, v140, v141, v142
    v_max3_f32 v163, v163, v143, v156
    v_max3_f32 v163, v163, v157, v158
    v_max_f32 v163, v163, v159
    v_mov_b32 v168, v160
    v_mov_b32 v169, v161
    v_mov_b32 v170, v162
    v_mov_b32 v171, v163
    v_permlane32_swap_b32 v160, v168
    v_permlane32_swap_b32 v161, v169
    v_permlane32_swap_b32 v162, v170
    v_permlane32_swap_b32 v163, v171
    v_max_f32 v160, v160, v168
    v_max_f32 v161, v161, v169
    v_max_f32 v162, v162, v170
    v_max_f32 v163, v163, v171
    v_mov_b32 v168, v160
    v_mov_b32 v169, v161
    v_mov_b32 v170, v162
    v_mov_b32 v171, v163
    v_permlane16_swap_b32 v160, v168
    v_permlane16_swap_b32 v161, v169
    v_permlane16_swap_b32 v162, v170
    v_permlane16_swap_b32 v163, v171
    v_max_f32 v160, v160, v168
    v_max_f32 v161, v161, v169
    v_max_f32 v162, v162, v170
    v_max_f32 v163, v163, v171
    v_ceil_f32 v160, v160
    v_ceil_f32 v161, v161
    v_ceil_f32 v162, v162
    v_ceil_f32 v163, v163
    s_cmp_eq_u32 s37, 0
    s_cbranch_scc1 L_rare_noscale
    v_max_f32 v160, v160, -v176
    v_max_f32 v161, v161, -v180
    v_max_f32 v162, v162, -v184
    v_max_f32 v163, v163, -v188
    v_sub_f32 v164, -v176, v160
    v_sub_f32 v165, -v180, v161
    v_sub_f32 v166, -v184, v162
    v_sub_f32 v167, -v188, v163
    v_exp_f32 v164, v164
    v_exp_f32 v165, v165
    v_exp_f32 v166, v166
    v_exp_f32 v167, v167
    v_mul_f32 v236, v236, v164
    v_mul_f32 v237, v237, v165
    v_mul_f32 v238, v238, v166
    v_mul_f32 v239, v239, v167
    v_accvgpr_read_b32 v168, a0
    v_accvgpr_read_b32 v169, a1
    v_accvgpr_read_b32 v170, a2
    v_accvgpr_read_b32 v171, a3
    v_mul_f32 v168, v168, v164
    v_mul_f32 v169, v169, v164
    v_mul_f32 v170, v170, v164
    v_mul_f32 v171, v171, v164
    v_accvgpr_write_b32 a0, v168
    v_accvgpr_write_b32 a1, v169
    v_accvgpr_write_b32 a2, v170
    v_accvgpr_write_b32 a3, v171
    v_accvgpr_read_b32 v168, a4
    v_accvgpr_read_b32 v169, a5
    v_accvgpr_read_b32 v170, a6
    v_accvgpr_read_b32 v171, a7
    v_mul_f32 v168, v168, v165
    v_mul_f32 v169, v169, v165
    v_mul_f32 v170, v170, v165
    v_mul_f32 v171, v171, v165
    v_accvgpr_write_b32 a4, v168
    v_accvgpr_write_b32 a5, v169
    v_accvgpr_write_b32 a6, v170
    v_accvgpr_write_b32 a7, v171
    v_accvgpr_read_b32 v168, a8
    v_accvgpr_read_b32 v169, a9
    v_accvgpr_read_b32 v170, a10
    v_accvgpr_read_b32 v171, a11
    v_mul_f32 v168, v168, v166
    v_mul_f32 v169, v169, v166
    v_mul_f32 v170, v170, v166
    v_mul_f32 v171, v171, v166
    v_accvgpr_write_b32 a8, v168
    v_accvgpr_write_b32 a9, v169
    v_accvgpr_write_b32 a10, v170
    v_accvgpr_write_b32 a11, v171
    v_accvgpr_read_b32 v168, a12
    v_accvgpr_read_b32 v169, a13
    v_accvgpr_read_b32 v170, a14
    v_accvgpr_read_b32 v171, a15
    v_mul_f32 v168, v168, v167
    v_mul_f32 v169, v169, v167
    v_mul_f32 v170, v170, v167
    v_mul_f32 v171, v171, v167
    v_accvgpr_write_b32 a12, v168
    v_accvgpr_write_b32 a13, v169
    v_accvgpr_write_b32 a14, v170
    v_accvgpr_write_b32 a15, v171
    v_accvgpr_read_b32 v168, a16
    v_accvgpr_read_b32 v169, a17
    v_accvgpr_read_b32 v170, a18
    v_accvgpr_read_b32 v171, a19
    v_mul_f32 v168, v168, v164
    v_mul_f32 v169, v169, v164
    v_mul_f32 v170, v170, v164
    v_mul_f32 v171, v171, v164
    v_accvgpr_write_b32 a16, v168
    v_accvgpr_write_b32 a17, v169
    v_accvgpr_write_b32 a18, v170
    v_accvgpr_write_b32 a19, v171
    v_accvgpr_read_b32 v168, a20
    v_accvgpr_read_b32 v169, a21
    v_accvgpr_read_b32 v170, a22
    v_accvgpr_read_b32 v171, a23
    v_mul_f32 v168, v168, v165
    v_mul_f32 v169, v169, v165
    v_mul_f32 v170, v170, v165
    v_mul_f32 v171, v171, v165
    v_accvgpr_write_b32 a20, v168
    v_accvgpr_write_b32 a21, v169
    v_accvgpr_write_b32 a22, v170
    v_accvgpr_write_b32 a23, v171
    v_accvgpr_read_b32 v168, a24
    v_accvgpr_read_b32 v169, a25
    v_accvgpr_read_b32 v170, a26
    v_accvgpr_read_b32 v171, a27
    v_mul_f32 v168, v168, v166
    v_mul_f32 v169, v169, v166
    v_mul_f32 v170, v170, v166
    v_mul_f32 v171, v171, v166
    v_accvgpr_write_b32 a24, v168
    v_accvgpr_write_b32 a25, v169
    v_accvgpr_write_b32 a26, v170
    v_accvgpr_write_b32 a27, v171
    v_accvgpr_read_b32 v168, a28
    v_accvgpr_read_b32 v169, a29
    v_accvgpr_read_b32 v170, a30
    v_accvgpr_read_b32 v171, a31
    v_mul_f32 v168, v168, v167
    v_mul_f32 v169, v169, v167
    v_mul_f32 v170, v170, v167
    v_mul_f32 v171, v171, v167
    v_accvgpr_write_b32 a28, v168
    v_accvgpr_write_b32 a29, v169
    v_accvgpr_write_b32 a30, v170
    v_accvgpr_write_b32 a31, v171
    v_accvgpr_read_b32 v168, a32
    v_accvgpr_read_b32 v169, a33
    v_accvgpr_read_b32 v170, a34
    v_accvgpr_read_b32 v171, a35
    v_mul_f32 v168, v168, v164
    v_mul_f32 v169, v169, v164
    v_mul_f32 v170, v170, v164
    v_mul_f32 v171, v171, v164
    v_accvgpr_write_b32 a32, v168
    v_accvgpr_write_b32 a33, v169
    v_accvgpr_write_b32 a34, v170
    v_accvgpr_write_b32 a35, v171
    v_accvgpr_read_b32 v168, a36
    v_accvgpr_read_b32 v169, a37
    v_accvgpr_read_b32 v170, a38
    v_accvgpr_read_b32 v171, a39
    v_mul_f32 v168, v168, v165
    v_mul_f32 v169, v169, v165
    v_mul_f32 v170, v170, v165
    v_mul_f32 v171, v171, v165
    v_accvgpr_write_b32 a36, v168
    v_accvgpr_write_b32 a37, v169
    v_accvgpr_write_b32 a38, v170
    v_accvgpr_write_b32 a39, v171
    v_accvgpr_read_b32 v168, a40
    v_accvgpr_read_b32 v169, a41
    v_accvgpr_read_b32 v170, a42
    v_accvgpr_read_b32 v171, a43
    v_mul_f32 v168, v168, v166
    v_mul_f32 v169, v169, v166
    v_mul_f32 v170, v170, v166
    v_mul_f32 v171, v171, v166
    v_accvgpr_write_b32 a40, v168
    v_accvgpr_write_b32 a41, v169
    v_accvgpr_write_b32 a42, v170
    v_accvgpr_write_b32 a43, v171
    v_accvgpr_read_b32 v168, a44
    v_accvgpr_read_b32 v169, a45
    v_accvgpr_read_b32 v170, a46
    v_accvgpr_read_b32 v171, a47
    v_mul_f32 v168, v168, v167
    v_mul_f32 v169, v169, v167
    v_mul_f32 v170, v170, v167
    v_mul_f32 v171, v171, v167
    v_accvgpr_write_b32 a44, v168
    v_accvgpr_write_b32 a45, v169
    v_accvgpr_write_b32 a46, v170
    v_accvgpr_write_b32 a47, v171
    v_accvgpr_read_b32 v168, a48
    v_accvgpr_read_b32 v169, a49
    v_accvgpr_read_b32 v170, a50
    v_accvgpr_read_b32 v171, a51
    v_mul_f32 v168, v168, v164
    v_mul_f32 v169, v169, v164
    v_mul_f32 v170, v170, v164
    v_mul_f32 v171, v171, v164
    v_accvgpr_write_b32 a48, v168
    v_accvgpr_write_b32 a49, v169
    v_accvgpr_write_b32 a50, v170
    v_accvgpr_write_b32 a51, v171
    v_accvgpr_read_b32 v168, a52
    v_accvgpr_read_b32 v169, a53
    v_accvgpr_read_b32 v170, a54
    v_accvgpr_read_b32 v171, a55
    v_mul_f32 v168, v168, v165
    v_mul_f32 v169, v169, v165
    v_mul_f32 v170, v170, v165
    v_mul_f32 v171, v171, v165
    v_accvgpr_write_b32 a52, v168
    v_accvgpr_write_b32 a53, v169
    v_accvgpr_write_b32 a54, v170
    v_accvgpr_write_b32 a55, v171
    v_accvgpr_read_b32 v168, a56
    v_accvgpr_read_b32 v169, a57
    v_accvgpr_read_b32 v170, a58
    v_accvgpr_read_b32 v171, a59
    v_mul_f32 v168, v168, v166
    v_mul_f32 v169, v169, v166
    v_mul_f32 v170, v170, v166
    v_mul_f32 v171, v171, v166
    v_accvgpr_write_b32 a56, v168
    v_accvgpr_write_b32 a57, v169
    v_accvgpr_write_b32 a58, v170
    v_accvgpr_write_b32 a59, v171
    v_accvgpr_read_b32 v168, a60
    v_accvgpr_read_b32 v169, a61
    v_accvgpr_read_b32 v170, a62
    v_accvgpr_read_b32 v171, a63
    v_mul_f32 v168, v168, v167
    v_mul_f32 v169, v169, v167
    v_mul_f32 v170, v170, v167
    v_mul_f32 v171, v171, v167
    v_accvgpr_write_b32 a60, v168
    v_accvgpr_write_b32 a61, v169
    v_accvgpr_write_b32 a62, v170
    v_accvgpr_write_b32 a63, v171
    v_accvgpr_read_b32 v168, a64
    v_accvgpr_read_b32 v169, a65
    v_accvgpr_read_b32 v170, a66
    v_accvgpr_read_b32 v171, a67
    v_mul_f32 v168, v168, v164
    v_mul_f32 v169, v169, v164
    v_mul_f32 v170, v170, v164
    v_mul_f32 v171, v171, v164
    v_accvgpr_write_b32 a64, v168
    v_accvgpr_write_b32 a65, v169
    v_accvgpr_write_b32 a66, v170
    v_accvgpr_write_b32 a67, v171
    v_accvgpr_read_b32 v168, a68
    v_accvgpr_read_b32 v169, a69
    v_accvgpr_read_b32 v170, a70
    v_accvgpr_read_b32 v171, a71
    v_mul_f32 v168, v168, v165
    v_mul_f32 v169, v169, v165
    v_mul_f32 v170, v170, v165
    v_mul_f32 v171, v171, v165
    v_accvgpr_write_b32 a68, v168
    v_accvgpr_write_b32 a69, v169
    v_accvgpr_write_b32 a70, v170
    v_accvgpr_write_b32 a71, v171
    v_accvgpr_read_b32 v168, a72
    v_accvgpr_read_b32 v169, a73
    v_accvgpr_read_b32 v170, a74
    v_accvgpr_read_b32 v171, a75
    v_mul_f32 v168, v168, v166
    v_mul_f32 v169, v169, v166
    v_mul_f32 v170, v170, v166
    v_mul_f32 v171, v171, v166
    v_accvgpr_write_b32 a72, v168
    v_accvgpr_write_b32 a73, v169
    v_accvgpr_write_b32 a74, v170
    v_accvgpr_write_b32 a75, v171
    v_accvgpr_read_b32 v168, a76
    v_accvgpr_read_b32 v169, a77
    v_accvgpr_read_b32 v170, a78
    v_accvgpr_read_b32 v171, a79
    v_mul_f32 v168, v168, v167
    v_mul_f32 v169, v169, v167
    v_mul_f32 v170, v170, v167
    v_mul_f32 v171, v171, v167
    v_accvgpr_write_b32 a76, v168
    v_accvgpr_write_b32 a77, v169
    v_accvgpr_write_b32 a78, v170
    v_accvgpr_write_b32 a79, v171
    v_accvgpr_read_b32 v168, a80
    v_accvgpr_read_b32 v169, a81
    v_accvgpr_read_b32 v170, a82
    v_accvgpr_read_b32 v171, a83
    v_mul_f32 v168, v168, v164
    v_mul_f32 v169, v169, v164
    v_mul_f32 v170, v170, v164
    v_mul_f32 v171, v171, v164
    v_accvgpr_write_b32 a80, v168
    v_accvgpr_write_b32 a81, v169
    v_accvgpr_write_b32 a82, v170
    v_accvgpr_write_b32 a83, v171
    v_accvgpr_read_b32 v168, a84
    v_accvgpr_read_b32 v169, a85
    v_accvgpr_read_b32 v170, a86
    v_accvgpr_read_b32 v171, a87
    v_mul_f32 v168, v168, v165
    v_mul_f32 v169, v169, v165
    v_mul_f32 v170, v170, v165
    v_mul_f32 v171, v171, v165
    v_accvgpr_write_b32 a84, v168
    v_accvgpr_write_b32 a85, v169
    v_accvgpr_write_b32 a86, v170
    v_accvgpr_write_b32 a87, v171
    v_accvgpr_read_b32 v168, a88
    v_accvgpr_read_b32 v169, a89
    v_accvgpr_read_b32 v170, a90
    v_accvgpr_read_b32 v171, a91
    v_mul_f32 v168, v168, v166
    v_mul_f32 v169, v169, v166
    v_mul_f32 v170, v170, v166
    v_mul_f32 v171, v171, v166
    v_accvgpr_write_b32 a88, v168
    v_accvgpr_write_b32 a89, v169
    v_accvgpr_write_b32 a90, v170
    v_accvgpr_write_b32 a91, v171
    v_accvgpr_read_b32 v168, a92
    v_accvgpr_read_b32 v169, a93
    v_accvgpr_read_b32 v170, a94
    v_accvgpr_read_b32 v171, a95
    v_mul_f32 v168, v168, v167
    v_mul_f32 v169, v169, v167
    v_mul_f32 v170, v170, v167
    v_mul_f32 v171, v171, v167
    v_accvgpr_write_b32 a92, v168
    v_accvgpr_write_b32 a93, v169
    v_accvgpr_write_b32 a94, v170
    v_accvgpr_write_b32 a95, v171
    v_accvgpr_read_b32 v168, a96
    v_accvgpr_read_b32 v169, a97
    v_accvgpr_read_b32 v170, a98
    v_accvgpr_read_b32 v171, a99
    v_mul_f32 v168, v168, v164
    v_mul_f32 v169, v169, v164
    v_mul_f32 v170, v170, v164
    v_mul_f32 v171, v171, v164
    v_accvgpr_write_b32 a96, v168
    v_accvgpr_write_b32 a97, v169
    v_accvgpr_write_b32 a98, v170
    v_accvgpr_write_b32 a99, v171
    v_accvgpr_read_b32 v168, a100
    v_accvgpr_read_b32 v169, a101
    v_accvgpr_read_b32 v170, a102
    v_accvgpr_read_b32 v171, a103
    v_mul_f32 v168, v168, v165
    v_mul_f32 v169, v169, v165
    v_mul_f32 v170, v170, v165
    v_mul_f32 v171, v171, v165
    v_accvgpr_write_b32 a100, v168
    v_accvgpr_write_b32 a101, v169
    v_accvgpr_write_b32 a102, v170
    v_accvgpr_write_b32 a103, v171
    v_accvgpr_read_b32 v168, a104
    v_accvgpr_read_b32 v169, a105
    v_accvgpr_read_b32 v170, a106
    v_accvgpr_read_b32 v171, a107
    v_mul_f32 v168, v168, v166
    v_mul_f32 v169, v169, v166
    v_mul_f32 v170, v170, v166
    v_mul_f32 v171, v171, v166
    v_accvgpr_write_b32 a104, v168
    v_accvgpr_write_b32 a105, v169
    v_accvgpr_write_b32 a106, v170
    v_accvgpr_write_b32 a107, v171
    v_accvgpr_read_b32 v168, a108
    v_accvgpr_read_b32 v169, a109
    v_accvgpr_read_b32 v170, a110
    v_accvgpr_read_b32 v171, a111
    v_mul_f32 v168, v168, v167
    v_mul_f32 v169, v169, v167
    v_mul_f32 v170, v170, v167
    v_mul_f32 v171, v171, v167
    v_accvgpr_write_b32 a108, v168
    v_accvgpr_write_b32 a109, v169
    v_accvgpr_write_b32 a110, v170
    v_accvgpr_write_b32 a111, v171
    v_accvgpr_read_b32 v168, a112
    v_accvgpr_read_b32 v169, a113
    v_accvgpr_read_b32 v170, a114
    v_accvgpr_read_b32 v171, a115
    v_mul_f32 v168, v168, v164
    v_mul_f32 v169, v169, v164
    v_mul_f32 v170, v170, v164
    v_mul_f32 v171, v171, v164
    v_accvgpr_write_b32 a112, v168
    v_accvgpr_write_b32 a113, v169
    v_accvgpr_write_b32 a114, v170
    v_accvgpr_write_b32 a115, v171
    v_accvgpr_read_b32 v168, a116
    v_accvgpr_read_b32 v169, a117
    v_accvgpr_read_b32 v170, a118
    v_accvgpr_read_b32 v171, a119
    v_mul_f32 v168, v168, v165
    v_mul_f32 v169, v169, v165
    v_mul_f32 v170, v170, v165
    v_mul_f32 v171, v171, v165
    v_accvgpr_write_b32 a116, v168
    v_accvgpr_write_b32 a117, v169
    v_accvgpr_write_b32 a118, v170
    v_accvgpr_write_b32 a119, v171
    v_accvgpr_read_b32 v168, a120
    v_accvgpr_read_b32 v169, a121
    v_accvgpr_read_b32 v170, a122
    v_accvgpr_read_b32 v171, a123
    v_mul_f32 v168, v168, v166
    v_mul_f32 v169, v169, v166
    v_mul_f32 v170, v170, v166
    v_mul_f32 v171, v171, v166
    v_accvgpr_write_b32 a120, v168
    v_accvgpr_write_b32 a121, v169
    v_accvgpr_write_b32 a122, v170
    v_accvgpr_write_b32 a123, v171
    v_accvgpr_read_b32 v168, a124
    v_accvgpr_read_b32 v169, a125
    v_accvgpr_read_b32 v170, a126
    v_accvgpr_read_b32 v171, a127
    v_mul_f32 v168, v168, v167
    v_mul_f32 v169, v169, v167
    v_mul_f32 v170, v170, v167
    v_mul_f32 v171, v171, v167
    v_accvgpr_write_b32 a124, v168
    v_accvgpr_write_b32 a125, v169
    v_accvgpr_write_b32 a126, v170
    v_accvgpr_write_b32 a127, v171
    v_accvgpr_read_b32 v168, a128
    v_accvgpr_read_b32 v169, a129
    v_accvgpr_read_b32 v170, a130
    v_accvgpr_read_b32 v171, a131
    v_mul_f32 v168, v168, v164
    v_mul_f32 v169, v169, v164
    v_mul_f32 v170, v170, v164
    v_mul_f32 v171, v171, v164
    v_accvgpr_write_b32 a128, v168
    v_accvgpr_write_b32 a129, v169
    v_accvgpr_write_b32 a130, v170
    v_accvgpr_write_b32 a131, v171
    v_accvgpr_read_b32 v168, a132
    v_accvgpr_read_b32 v169, a133
    v_accvgpr_read_b32 v170, a134
    v_accvgpr_read_b32 v171, a135
    v_mul_f32 v168, v168, v165
    v_mul_f32 v169, v169, v165
    v_mul_f32 v170, v170, v165
    v_mul_f32 v171, v171, v165
    v_accvgpr_write_b32 a132, v168
    v_accvgpr_write_b32 a133, v169
    v_accvgpr_write_b32 a134, v170
    v_accvgpr_write_b32 a135, v171
    v_accvgpr_read_b32 v168, a136
    v_accvgpr_read_b32 v169, a137
    v_accvgpr_read_b32 v170, a138
    v_accvgpr_read_b32 v171, a139
    v_mul_f32 v168, v168, v166
    v_mul_f32 v169, v169, v166
    v_mul_f32 v170, v170, v166
    v_mul_f32 v171, v171, v166
    v_accvgpr_write_b32 a136, v168
    v_accvgpr_write_b32 a137, v169
    v_accvgpr_write_b32 a138, v170
    v_accvgpr_write_b32 a139, v171
    v_accvgpr_read_b32 v168, a140
    v_accvgpr_read_b32 v169, a141
    v_accvgpr_read_b32 v170, a142
    v_accvgpr_read_b32 v171, a143
    v_mul_f32 v168, v168, v167
    v_mul_f32 v169, v169, v167
    v_mul_f32 v170, v170, v167
    v_mul_f32 v171, v171, v167
    v_accvgpr_write_b32 a140, v168
    v_accvgpr_write_b32 a141, v169
    v_accvgpr_write_b32 a142, v170
    v_accvgpr_write_b32 a143, v171
    v_accvgpr_read_b32 v168, a144
    v_accvgpr_read_b32 v169, a145
    v_accvgpr_read_b32 v170, a146
    v_accvgpr_read_b32 v171, a147
    v_mul_f32 v168, v168, v164
    v_mul_f32 v169, v169, v164
    v_mul_f32 v170, v170, v164
    v_mul_f32 v171, v171, v164
    v_accvgpr_write_b32 a144, v168
    v_accvgpr_write_b32 a145, v169
    v_accvgpr_write_b32 a146, v170
    v_accvgpr_write_b32 a147, v171
    v_accvgpr_read_b32 v168, a148
    v_accvgpr_read_b32 v169, a149
    v_accvgpr_read_b32 v170, a150
    v_accvgpr_read_b32 v171, a151
    v_mul_f32 v168, v168, v165
    v_mul_f32 v169, v169, v165
    v_mul_f32 v170, v170, v165
    v_mul_f32 v171, v171, v165
    v_accvgpr_write_b32 a148, v168
    v_accvgpr_write_b32 a149, v169
    v_accvgpr_write_b32 a150, v170
    v_accvgpr_write_b32 a151, v171
    v_accvgpr_read_b32 v168, a152
    v_accvgpr_read_b32 v169, a153
    v_accvgpr_read_b32 v170, a154
    v_accvgpr_read_b32 v171, a155
    v_mul_f32 v168, v168, v166
    v_mul_f32 v169, v169, v166
    v_mul_f32 v170, v170, v166
    v_mul_f32 v171, v171, v166
    v_accvgpr_write_b32 a152, v168
    v_accvgpr_write_b32 a153, v169
    v_accvgpr_write_b32 a154, v170
    v_accvgpr_write_b32 a155, v171
    v_accvgpr_read_b32 v168, a156
    v_accvgpr_read_b32 v169, a157
    v_accvgpr_read_b32 v170, a158
    v_accvgpr_read_b32 v171, a159
    v_mul_f32 v168, v168, v167
    v_mul_f32 v169, v169, v167
    v_mul_f32 v170, v170, v167
    v_mul_f32 v171, v171, v167
    v_accvgpr_write_b32 a156, v168
    v_accvgpr_write_b32 a157, v169
    v_accvgpr_write_b32 a158, v170
    v_accvgpr_write_b32 a159, v171
    v_accvgpr_read_b32 v168, a160
    v_accvgpr_read_b32 v169, a161
    v_accvgpr_read_b32 v170, a162
    v_accvgpr_read_b32 v171, a163
    v_mul_f32 v168, v168, v164
    v_mul_f32 v169, v169, v164
    v_mul_f32 v170, v170, v164
    v_mul_f32 v171, v171, v164
    v_accvgpr_write_b32 a160, v168
    v_accvgpr_write_b32 a161, v169
    v_accvgpr_write_b32 a162, v170
    v_accvgpr_write_b32 a163, v171
    v_accvgpr_read_b32 v168, a164
    v_accvgpr_read_b32 v169, a165
    v_accvgpr_read_b32 v170, a166
    v_accvgpr_read_b32 v171, a167
    v_mul_f32 v168, v168, v165
    v_mul_f32 v169, v169, v165
    v_mul_f32 v170, v170, v165
    v_mul_f32 v171, v171, v165
    v_accvgpr_write_b32 a164, v168
    v_accvgpr_write_b32 a165, v169
    v_accvgpr_write_b32 a166, v170
    v_accvgpr_write_b32 a167, v171
    v_accvgpr_read_b32 v168, a168
    v_accvgpr_read_b32 v169, a169
    v_accvgpr_read_b32 v170, a170
    v_accvgpr_read_b32 v171, a171
    v_mul_f32 v168, v168, v166
    v_mul_f32 v169, v169, v166
    v_mul_f32 v170, v170, v166
    v_mul_f32 v171, v171, v166
    v_accvgpr_write_b32 a168, v168
    v_accvgpr_write_b32 a169, v169
    v_accvgpr_write_b32 a170, v170
    v_accvgpr_write_b32 a171, v171
    v_accvgpr_read_b32 v168, a172
    v_accvgpr_read_b32 v169, a173
    v_accvgpr_read_b32 v170, a174
    v_accvgpr_read_b32 v171, a175
    v_mul_f32 v168, v168, v167
    v_mul_f32 v169, v169, v167
    v_mul_f32 v170, v170, v167
    v_mul_f32 v171, v171, v167
    v_accvgpr_write_b32 a172, v168
    v_accvgpr_write_b32 a173, v169
    v_accvgpr_write_b32 a174, v170
    v_accvgpr_write_b32 a175, v171
    v_accvgpr_read_b32 v168, a176
    v_accvgpr_read_b32 v169, a177
    v_accvgpr_read_b32 v170, a178
    v_accvgpr_read_b32 v171, a179
    v_mul_f32 v168, v168, v164
    v_mul_f32 v169, v169, v164
    v_mul_f32 v170, v170, v164
    v_mul_f32 v171, v171, v164
    v_accvgpr_write_b32 a176, v168
    v_accvgpr_write_b32 a177, v169
    v_accvgpr_write_b32 a178, v170
    v_accvgpr_write_b32 a179, v171
    v_accvgpr_read_b32 v168, a180
    v_accvgpr_read_b32 v169, a181
    v_accvgpr_read_b32 v170, a182
    v_accvgpr_read_b32 v171, a183
    v_mul_f32 v168, v168, v165
    v_mul_f32 v169, v169, v165
    v_mul_f32 v170, v170, v165
    v_mul_f32 v171, v171, v165
    v_accvgpr_write_b32 a180, v168
    v_accvgpr_write_b32 a181, v169
    v_accvgpr_write_b32 a182, v170
    v_accvgpr_write_b32 a183, v171
    v_accvgpr_read_b32 v168, a184
    v_accvgpr_read_b32 v169, a185
    v_accvgpr_read_b32 v170, a186
    v_accvgpr_read_b32 v171, a187
    v_mul_f32 v168, v168, v166
    v_mul_f32 v169, v169, v166
    v_mul_f32 v170, v170, v166
    v_mul_f32 v171, v171, v166
    v_accvgpr_write_b32 a184, v168
    v_accvgpr_write_b32 a185, v169
    v_accvgpr_write_b32 a186, v170
    v_accvgpr_write_b32 a187, v171
    v_accvgpr_read_b32 v168, a188
    v_accvgpr_read_b32 v169, a189
    v_accvgpr_read_b32 v170, a190
    v_accvgpr_read_b32 v171, a191
    v_mul_f32 v168, v168, v167
    v_mul_f32 v169, v169, v167
    v_mul_f32 v170, v170, v167
    v_mul_f32 v171, v171, v167
    v_accvgpr_write_b32 a188, v168
    v_accvgpr_write_b32 a189, v169
    v_accvgpr_write_b32 a190, v170
    v_accvgpr_write_b32 a191, v171
    v_accvgpr_read_b32 v168, a192
    v_accvgpr_read_b32 v169, a193
    v_accvgpr_read_b32 v170, a194
    v_accvgpr_read_b32 v171, a195
    v_mul_f32 v168, v168, v164
    v_mul_f32 v169, v169, v164
    v_mul_f32 v170, v170, v164
    v_mul_f32 v171, v171, v164
    v_accvgpr_write_b32 a192, v168
    v_accvgpr_write_b32 a193, v169
    v_accvgpr_write_b32 a194, v170
    v_accvgpr_write_b32 a195, v171
    v_accvgpr_read_b32 v168, a196
    v_accvgpr_read_b32 v169, a197
    v_accvgpr_read_b32 v170, a198
    v_accvgpr_read_b32 v171, a199
    v_mul_f32 v168, v168, v165
    v_mul_f32 v169, v169, v165
    v_mul_f32 v170, v170, v165
    v_mul_f32 v171, v171, v165
    v_accvgpr_write_b32 a196, v168
    v_accvgpr_write_b32 a197, v169
    v_accvgpr_write_b32 a198, v170
    v_accvgpr_write_b32 a199, v171
    v_accvgpr_read_b32 v168, a200
    v_accvgpr_read_b32 v169, a201
    v_accvgpr_read_b32 v170, a202
    v_accvgpr_read_b32 v171, a203
    v_mul_f32 v168, v168, v166
    v_mul_f32 v169, v169, v166
    v_mul_f32 v170, v170, v166
    v_mul_f32 v171, v171, v166
    v_accvgpr_write_b32 a200, v168
    v_accvgpr_write_b32 a201, v169
    v_accvgpr_write_b32 a202, v170
    v_accvgpr_write_b32 a203, v171
    v_accvgpr_read_b32 v168, a204
    v_accvgpr_read_b32 v169, a205
    v_accvgpr_read_b32 v170, a206
    v_accvgpr_read_b32 v171, a207
    v_mul_f32 v168, v168, v167
    v_mul_f32 v169, v169, v167
    v_mul_f32 v170, v170, v167
    v_mul_f32 v171, v171, v167
    v_accvgpr_write_b32 a204, v168
    v_accvgpr_write_b32 a205, v169
    v_accvgpr_write_b32 a206, v170
    v_accvgpr_write_b32 a207, v171
    v_accvgpr_read_b32 v168, a208
    v_accvgpr_read_b32 v169, a209
    v_accvgpr_read_b32 v170, a210
    v_accvgpr_read_b32 v171, a211
    v_mul_f32 v168, v168, v164
    v_mul_f32 v169, v169, v164
    v_mul_f32 v170, v170, v164
    v_mul_f32 v171, v171, v164
    v_accvgpr_write_b32 a208, v168
    v_accvgpr_write_b32 a209, v169
    v_accvgpr_write_b32 a210, v170
    v_accvgpr_write_b32 a211, v171
    v_accvgpr_read_b32 v168, a212
    v_accvgpr_read_b32 v169, a213
    v_accvgpr_read_b32 v170, a214
    v_accvgpr_read_b32 v171, a215
    v_mul_f32 v168, v168, v165
    v_mul_f32 v169, v169, v165
    v_mul_f32 v170, v170, v165
    v_mul_f32 v171, v171, v165
    v_accvgpr_write_b32 a212, v168
    v_accvgpr_write_b32 a213, v169
    v_accvgpr_write_b32 a214, v170
    v_accvgpr_write_b32 a215, v171
    v_accvgpr_read_b32 v168, a216
    v_accvgpr_read_b32 v169, a217
    v_accvgpr_read_b32 v170, a218
    v_accvgpr_read_b32 v171, a219
    v_mul_f32 v168, v168, v166
    v_mul_f32 v169, v169, v166
    v_mul_f32 v170, v170, v166
    v_mul_f32 v171, v171, v166
    v_accvgpr_write_b32 a216, v168
    v_accvgpr_write_b32 a217, v169
    v_accvgpr_write_b32 a218, v170
    v_accvgpr_write_b32 a219, v171
    v_accvgpr_read_b32 v168, a220
    v_accvgpr_read_b32 v169, a221
    v_accvgpr_read_b32 v170, a222
    v_accvgpr_read_b32 v171, a223
    v_mul_f32 v168, v168, v167
    v_mul_f32 v169, v169, v167
    v_mul_f32 v170, v170, v167
    v_mul_f32 v171, v171, v167
    v_accvgpr_write_b32 a220, v168
    v_accvgpr_write_b32 a221, v169
    v_accvgpr_write_b32 a222, v170
    v_accvgpr_write_b32 a223, v171
    v_accvgpr_read_b32 v168, a224
    v_accvgpr_read_b32 v169, a225
    v_accvgpr_read_b32 v170, a226
    v_accvgpr_read_b32 v171, a227
    v_mul_f32 v168, v168, v164
    v_mul_f32 v169, v169, v164
    v_mul_f32 v170, v170, v164
    v_mul_f32 v171, v171, v164
    v_accvgpr_write_b32 a224, v168
    v_accvgpr_write_b32 a225, v169
    v_accvgpr_write_b32 a226, v170
    v_accvgpr_write_b32 a227, v171
    v_accvgpr_read_b32 v168, a228
    v_accvgpr_read_b32 v169, a229
    v_accvgpr_read_b32 v170, a230
    v_accvgpr_read_b32 v171, a231
    v_mul_f32 v168, v168, v165
    v_mul_f32 v169, v169, v165
    v_mul_f32 v170, v170, v165
    v_mul_f32 v171, v171, v165
    v_accvgpr_write_b32 a228, v168
    v_accvgpr_write_b32 a229, v169
    v_accvgpr_write_b32 a230, v170
    v_accvgpr_write_b32 a231, v171
    v_accvgpr_read_b32 v168, a232
    v_accvgpr_read_b32 v169, a233
    v_accvgpr_read_b32 v170, a234
    v_accvgpr_read_b32 v171, a235
    v_mul_f32 v168, v168, v166
    v_mul_f32 v169, v169, v166
    v_mul_f32 v170, v170, v166
    v_mul_f32 v171, v171, v166
    v_accvgpr_write_b32 a232, v168
    v_accvgpr_write_b32 a233, v169
    v_accvgpr_write_b32 a234, v170
    v_accvgpr_write_b32 a235, v171
    v_accvgpr_read_b32 v168, a236
    v_accvgpr_read_b32 v169, a237
    v_accvgpr_read_b32 v170, a238
    v_accvgpr_read_b32 v171, a239
    v_mul_f32 v168, v168, v167
    v_mul_f32 v169, v169, v167
    v_mul_f32 v170, v170, v167
    v_mul_f32 v171, v171, v167
    v_accvgpr_write_b32 a236, v168
    v_accvgpr_write_b32 a237, v169
    v_accvgpr_write_b32 a238, v170
    v_accvgpr_write_b32 a239, v171
    v_accvgpr_read_b32 v168, a240
    v_accvgpr_read_b32 v169, a241
    v_accvgpr_read_b32 v170, a242
    v_accvgpr_read_b32 v171, a243
    v_mul_f32 v168, v168, v164
    v_mul_f32 v169, v169, v164
    v_mul_f32 v170, v170, v164
    v_mul_f32 v171, v171, v164
    v_accvgpr_write_b32 a240, v168
    v_accvgpr_write_b32 a241, v169
    v_accvgpr_write_b32 a242, v170
    v_accvgpr_write_b32 a243, v171
    v_accvgpr_read_b32 v168, a244
    v_accvgpr_read_b32 v169, a245
    v_accvgpr_read_b32 v170, a246
    v_accvgpr_read_b32 v171, a247
    v_mul_f32 v168, v168, v165
    v_mul_f32 v169, v169, v165
    v_mul_f32 v170, v170, v165
    v_mul_f32 v171, v171, v165
    v_accvgpr_write_b32 a244, v168
    v_accvgpr_write_b32 a245, v169
    v_accvgpr_write_b32 a246, v170
    v_accvgpr_write_b32 a247, v171
    v_accvgpr_read_b32 v168, a248
    v_accvgpr_read_b32 v169, a249
    v_accvgpr_read_b32 v170, a250
    v_accvgpr_read_b32 v171, a251
    v_mul_f32 v168, v168, v166
    v_mul_f32 v169, v169, v166
    v_mul_f32 v170, v170, v166
    v_mul_f32 v171, v171, v166
    v_accvgpr_write_b32 a248, v168
    v_accvgpr_write_b32 a249, v169
    v_accvgpr_write_b32 a250, v170
    v_accvgpr_write_b32 a251, v171
    v_accvgpr_read_b32 v168, a252
    v_accvgpr_read_b32 v169, a253
    v_accvgpr_read_b32 v170, a254
    v_accvgpr_read_b32 v171, a255
    v_mul_f32 v168, v168, v167
    v_mul_f32 v169, v169, v167
    v_mul_f32 v170, v170, v167
    v_mul_f32 v171, v171, v167
    v_accvgpr_write_b32 a252, v168
    v_accvgpr_write_b32 a253, v169
    v_accvgpr_write_b32 a254, v170
    v_accvgpr_write_b32 a255, v171
L_rare_noscale:
    v_sub_f32 v176, 0, v160
    v_sub_f32 v177, 0, v160
    v_sub_f32 v178, 0, v160
    v_sub_f32 v179, 0, v160
    v_sub_f32 v180, 0, v161
    v_sub_f32 v181, 0, v161
    v_sub_f32 v182, 0, v161
    v_sub_f32 v183, 0, v161
    v_sub_f32 v184, 0, v162
    v_sub_f32 v185, 0, v162
    v_sub_f32 v186, 0, v162
    v_sub_f32 v187, 0, v162
    v_sub_f32 v188, 0, v163
    v_sub_f32 v189, 0, v163
    v_sub_f32 v190, 0, v163
    v_sub_f32 v191, 0, v163
    v_add_f32 v128, v128, v176
    v_add_f32 v129, v129, v176
    v_add_f32 v130, v130, v176
    v_add_f32 v131, v131, v176
    v_exp_f32 v128, v128
    v_exp_f32 v129, v129
    v_exp_f32 v130, v130
    v_exp_f32 v131, v131
    v_add_f32 v132, v132, v180
    v_add_f32 v133, v133, v180
    v_add_f32 v134, v134, v180
    v_add_f32 v135, v135, v180
    v_exp_f32 v132, v132
    v_exp_f32 v133, v133
    v_exp_f32 v134, v134
    v_exp_f32 v135, v135
    v_add_f32 v136, v136, v184
    v_add_f32 v137, v137, v184
    v_add_f32 v138, v138, v184
    v_add_f32 v139, v139, v184
    v_exp_f32 v136, v136
    v_exp_f32 v137, v137
    v_exp_f32 v138, v138
    v_exp_f32 v139, v139
    v_add_f32 v140, v140, v188
    v_add_f32 v141, v141, v188
    v_add_f32 v142, v142, v188
    v_add_f32 v143, v143, v188
    v_exp_f32 v140, v140
    v_exp_f32 v141, v141
    v_exp_f32 v142, v142
    v_exp_f32 v143, v143
    v_add_f32 v144, v144, v176
    v_add_f32 v145, v145, v176
    v_add_f32 v146, v146, v176
    v_add_f32 v147, v147, v176
    v_exp_f32 v144, v144
    v_exp_f32 v145, v145
    v_exp_f32 v146, v146
    v_exp_f32 v147, v147
    v_add_f32 v148, v148, v180
    v_add_f32 v149, v149, v180
    v_add_f32 v150, v150, v180
    v_add_f32 v151, v151, v180
    v_exp_f32 v148, v148
    v_exp_f32 v149, v149
    v_exp_f32 v150, v150
    v_exp_f32 v151, v151
    v_add_f32 v152, v152, v184
    v_add_f32 v153, v153, v184
    v_add_f32 v154, v154, v184
    v_add_f32 v155, v155, v184
    v_exp_f32 v152, v152
    v_exp_f32 v153, v153
    v_exp_f32 v154, v154
    v_exp_f32 v155, v155
    v_add_f32 v156, v156, v188
    v_add_f32 v157, v157, v188
    v_add_f32 v158, v158, v188
    v_add_f32 v159, v159, v188
    v_exp_f32 v156, v156
    v_exp_f32 v157, v157
    v_exp_f32 v158, v158
    v_exp_f32 v159, v159
    v_add_f32 v240, v128, v129
    v_add_f32 v240, v240, v130
    v_add_f32 v240, v240, v131
    v_add_f32 v240, v240, v144
    v_add_f32 v240, v240, v145
    v_add_f32 v240, v240, v146
    v_add_f32 v240, v240, v147
    v_add_f32 v241, v132, v133
    v_add_f32 v241, v241, v134
    v_add_f32 v241, v241, v135
    v_add_f32 v241, v241, v148
    v_add_f32 v241, v241, v149
    v_add_f32 v241, v241, v150
    v_add_f32 v241, v241, v151
    v_add_f32 v242, v136, v137
    v_add_f32 v242, v242, v138
    v_add_f32 v242, v242, v139
    v_add_f32 v242, v242, v152
    v_add_f32 v242, v242, v153
    v_add_f32 v242, v242, v154
    v_add_f32 v242, v242, v155
    v_add_f32 v243, v140, v141
    v_add_f32 v243, v243, v142
    v_add_f32 v243, v243, v143
    v_add_f32 v243, v243, v156
    v_add_f32 v243, v243, v157
    v_add_f32 v243, v243, v158
    v_add_f32 v243, v243, v159
    v_cvt_pk_bf16_f32 v160, v128, v129
    v_cvt_pk_bf16_f32 v161, v130, v131
    s_cmp_eq_u32 s37, 0
    s_cbranch_scc1 L_ret0
    s_cmp_eq_u32 s37, 1
    s_cbranch_scc1 L_ret1
    s_cmp_eq_u32 s37, 2
    s_cbranch_scc1 L_ret2
    s_cmp_eq_u32 s37, 3
    s_cbranch_scc1 L_ret3
    s_cmp_eq_u32 s37, 4
    s_cbranch_scc1 L_ret4
    s_cmp_eq_u32 s37, 5
    s_cbranch_scc1 L_ret5
    s_cmp_eq_u32 s37, 6
    s_cbranch_scc1 L_ret6
    v_cvt_pk_bf16_f32 v192, v128, v129
    v_cvt_pk_bf16_f32 v193, v130, v131
    v_cvt_pk_bf16_f32 v196, v132, v133
    v_cvt_pk_bf16_f32 v197, v134, v135
    v_cvt_pk_bf16_f32 v200, v136, v137
    v_cvt_pk_bf16_f32 v201, v138, v139
    v_cvt_pk_bf16_f32 v204, v140, v141
    v_cvt_pk_bf16_f32 v205, v142, v143
    v_cvt_pk_bf16_f32 v194, v144, v145
    v_cvt_pk_bf16_f32 v195, v146, v147
    v_cvt_pk_bf16_f32 v198, v148, v149
    v_cvt_pk_bf16_f32 v199, v150, v151
    v_cvt_pk_bf16_f32 v202, v152, v153
    v_cvt_pk_bf16_f32 v203, v154, v155
    v_cvt_pk_bf16_f32 v206, v156, v157
    v_cvt_pk_bf16_f32 v207, v158, v159
    ds_read_b64_tr_b16 v[224:225], v247 offset:49152
    ds_read_b64_tr_b16 v[226:227], v247 offset:51200
    ds_read_b64_tr_b16 v[228:229], v248 offset:49152
    ds_read_b64_tr_b16 v[230:231], v248 offset:51200
    ds_read_b64_tr_b16 v[232:233], v249 offset:49152
    ds_read_b64_tr_b16 v[234:235], v249 offset:51200
    s_waitcnt lgkmcnt(0)
    s_nop 3
    s_branch L_ret7
L_code_end:
.section .rodata,"a"
.p2align 6
.amdhsa_kernel standalone__mha_block_cached__near_ridge_kernel
  .amdhsa_next_free_vgpr 512
  .amdhsa_next_free_sgpr 102
  .amdhsa_accum_offset 256
  .amdhsa_group_segment_fixed_size 0
  .amdhsa_kernarg_size 64
  .amdhsa_user_sgpr_count 2
  .amdhsa_user_sgpr_kernarg_segment_ptr 1
  .amdhsa_system_sgpr_workgroup_id_x 1
.end_amdhsa_kernel
```
